```python
import torch

def _softmax(x, axis=-1):
    return torch.softmax(x, dim=axis)

def _gelu(x):
    return torch.nn.functional.gelu(x, approximate='tanh')

def _silu(x):
    return torch.nn.functional.silu(x)

def _sigmoid(x):
    return torch.sigmoid(x)

def _layernorm(x, axis=-1, eps=1e-05):
    m = x.mean(dim=axis, keepdim=True)
    v = x.var(dim=axis, keepdim=True, unbiased=False)
    return (x - m) / torch.sqrt(v + eps)

def _scatter_add(tgt, idx, src, axis=0):
    return tgt.clone().index_add_(axis, idx, src)

def _segment_sum(src, seg, n):
    out = torch.zeros((n,) + src.shape[1:], dtype=src.dtype)
    return out.index_add_(0, seg, src)

def _pad(x, pw):
    flat = tuple((v for pair in reversed(pw) for v in pair))
    return torch.nn.functional.pad(x, flat)
kernel_name = 'recurrent_scan__mha_block_cached__mixer_gmlp__prompt'

def setup_inputs():

    _w = lambda a: (lambda t: t.to(torch.bfloat16) if t.is_floating_point() else t)(torch.as_tensor(a))

    def _A_setup():
        B, Sq, D = (1, 2048, 640)
        H, Sk, Dh = (32, 2048, 128)
        return {'x': _w((lambda *s: torch.randn(*s, dtype=torch.bfloat16) * 0.05)(B, Sq, D)), 'k_cache': _w((lambda *s: torch.randn(*s, dtype=torch.bfloat16) * 0.8)(B, H, Sk, Dh)), 'v_cache': _w((lambda *s: torch.randn(*s, dtype=torch.bfloat16) * 0.2)(B, H, Sk, Dh)), 'wq': _w((lambda *s: torch.randn(*s, dtype=torch.bfloat16) * 0.8)(D, H * Dh) * D ** (-0.5)), 'wo': _w((lambda *s: torch.randn(*s, dtype=torch.bfloat16) * 0.2)(H * Dh, D) * (H * Dh) ** (-0.5))}
    _A_in = _A_setup()

    def _B_setup():
        B, S, D, F = (1, 2048, 640, 1728)
        Fh = F // 2
        return {'x': _w((lambda *s: torch.randn(*s, dtype=torch.bfloat16) * 0.05)(B, S, D)), 'w_in': _w((lambda *s: torch.randn(*s, dtype=torch.bfloat16) * 0.4)(D, 2 * Fh)), 'w_sp': _w(0.01 * (lambda *s: torch.randn(*s, dtype=torch.bfloat16) * 0.4)(S, S)), 'b_sp': _w(1.0 + 0.01 * (lambda *s: torch.randn(*s, dtype=torch.bfloat16) * 0.1)(S)), 'w_out': _w((lambda *s: torch.randn(*s, dtype=torch.bfloat16) * 0.1)(Fh, D))}
    _B_in = _B_setup()
    return {'A_x': _A_in['x'], 'A_k_cache': _A_in['k_cache'], 'A_v_cache': _A_in['v_cache'], 'A_wq': _A_in['wq'], 'A_wo': _A_in['wo'], 'B_x': _B_in['x'], 'B_w_in': _B_in['w_in'], 'B_w_sp': _B_in['w_sp'], 'B_b_sp': _B_in['b_sp'], 'B_w_out': _B_in['w_out']}

def reference(A_x, A_k_cache, A_v_cache, A_wq, A_wo, B_x, B_w_in, B_w_sp, B_b_sp, B_w_out):

    def _A_ref(x, k_cache, v_cache, wq, wo):
        B, Sq, D = x.shape
        H, Dh = (32, 128)
        q = (lambda x, *d: x.permute(*d))((x @ wq).reshape(B, Sq, H, Dh), 0, 2, 1, 3)
        scores = torch.einsum('bhqd,bhkd->bhqk', q, k_cache) * Dh ** (-0.5)
        p = _softmax(scores, axis=-1)
        o = torch.einsum('bhqk,bhkd->bhqd', p, v_cache)
        return (lambda x, *d: x.permute(*d))(o, 0, 2, 1, 3).reshape(B, Sq, H * Dh) @ wo

    def _B_ref(x, w_in, w_sp, b_sp, w_out):
        B, S, D = x.shape
        F = w_in.shape[-1]
        Fh = F // 2
        z = _gelu(torch.einsum('bsd,df->bsf', x, w_in))
        z1 = z[..., :Fh].clone()
        z2 = _layernorm(z[..., Fh:], axis=-1)
        g = torch.einsum('ts,bsf->btf', w_sp, z2) + b_sp[None, :, None]
        return torch.einsum('bsf,fd->bsd', z1 * g, w_out)
    x = A_x
    xn = _layernorm(x, axis=-1)
    s = _A_ref(xn, A_k_cache, A_v_cache, A_wq, A_wo)
    g = _silu(_B_ref(xn, B_w_in, B_w_sp, B_b_sp, B_w_out))
    return x + s * g
```

```asm
; @launch kernel=ln1_kernel grid=(256,1,1) block=(128,1,1) lds=0
; @launch kernel=win_kernel grid=(224,1,1) block=(512,1,1) lds=65536
; @launch kernel=attn_kernel grid=(256,1,1) block=(256,1,1) lds=163840
; @launch kernel=spwo_kernel grid=(248,1,1) block=(256,1,1) lds=131072
; @launch kernel=fin_kernel grid=(160,1,1) block=(256,1,1) lds=49152
.amdgcn_target "amdgcn-amd-amdhsa--gfx950"
.text
.globl ln1_kernel
.p2align 8
.type ln1_kernel,@function
ln1_kernel:
    s_cmp_ge_u32 s2, 256
    s_cbranch_scc1 ln1_kernel_done
    s_load_dwordx2 s[4:5], s[0:1], 0
    s_load_dwordx2 s[8:9], s[0:1], 96
    v_lshrrev_b32 v1, 6, v0
    v_and_b32 v2, 63, v0
    s_nop 0
    v_readfirstlane_b32 s20, v1
    s_lshl_b32 s21, s2, 3
    s_lshl_b32 s22, s20, 2
    s_add_u32 s21, s21, s22
    v_and_b32 v3, 3, v2
    v_lshrrev_b32 v4, 2, v2
    v_add_u32 v5, s21, v3
    s_mov_b32 s22, 1280
    v_mul_lo_u32 v6, v5, s22
    v_lshl_add_u32 v6, v4, 4, v6
    s_waitcnt lgkmcnt(0)
    s_mov_b32 s6, 2621440
    s_mov_b32 s7, 0x20000
    s_mov_b32 s10, 2621440
    s_mov_b32 s11, 0x20000
    buffer_load_dwordx4 v[16:19], v6, s[4:7], 0 offen offset:0
    buffer_load_dwordx4 v[20:23], v6, s[4:7], 0 offen offset:256
    buffer_load_dwordx4 v[24:27], v6, s[4:7], 0 offen offset:512
    buffer_load_dwordx4 v[28:31], v6, s[4:7], 0 offen offset:768
    buffer_load_dwordx4 v[32:35], v6, s[4:7], 0 offen offset:1024
    s_load_dwordx2 s[12:13], s[0:1], 48
    s_load_dwordx2 s[16:17], s[0:1], 24
    s_lshl_b32 s22, s2, 1
    s_add_u32 s22, s22, s20
    s_lshl_b32 s22, s22, 10
    v_lshl_add_u32 v9, v2, 4, s22
    s_waitcnt lgkmcnt(0)
    s_mov_b32 s14, 2211840
    s_mov_b32 s15, 0x20000
    s_mov_b32 s18, 5242880
    s_mov_b32 s19, 0x20000
    s_mov_b32 s22, 0
    buffer_load_dwordx4 v[12:15], v9, s[12:15], s22 offen
    s_mov_b32 s22, 524288
    buffer_load_dwordx4 v[12:15], v9, s[12:15], s22 offen
    s_mov_b32 s22, 1048576
    buffer_load_dwordx4 v[12:15], v9, s[12:15], s22 offen
    s_mov_b32 s22, 1572864
    buffer_load_dwordx4 v[12:15], v9, s[12:15], s22 offen
    s_mov_b32 s22, 2097152
    buffer_load_dwordx4 v[12:15], v9, s[12:15], s22 offen
    s_mov_b32 s22, 0
    buffer_load_dwordx4 v[12:15], v9, s[16:19], s22 offen
    s_mov_b32 s22, 524288
    buffer_load_dwordx4 v[12:15], v9, s[16:19], s22 offen
    s_mov_b32 s22, 1048576
    buffer_load_dwordx4 v[12:15], v9, s[16:19], s22 offen
    s_mov_b32 s22, 1572864
    buffer_load_dwordx4 v[12:15], v9, s[16:19], s22 offen
    s_mov_b32 s22, 2097152
    buffer_load_dwordx4 v[12:15], v9, s[16:19], s22 offen
    s_mov_b32 s22, 2621440
    buffer_load_dwordx4 v[12:15], v9, s[16:19], s22 offen
    s_mov_b32 s22, 3145728
    buffer_load_dwordx4 v[12:15], v9, s[16:19], s22 offen
    s_mov_b32 s22, 3670016
    buffer_load_dwordx4 v[12:15], v9, s[16:19], s22 offen
    s_mov_b32 s22, 4194304
    buffer_load_dwordx4 v[12:15], v9, s[16:19], s22 offen
    s_mov_b32 s22, 4718592
    buffer_load_dwordx4 v[12:15], v9, s[16:19], s22 offen
    s_lshr_b32 s23, s2, 3
    s_lshl_b32 s23, s23, 1
    s_add_u32 s23, s23, s20
    s_getpc_b64 s[28:29]
Lpc_1:
    s_sub_u32 s28, s28, Lpc_1-ln1_kernel
    s_subb_u32 s29, s29, 0
    s_mov_b32 s30, text_end-ln1_kernel
    s_mov_b32 s31, 0x20000
    s_lshl_b32 s23, s23, 10
    v_lshl_add_u32 v10, v2, 4, s23
    buffer_load_dwordx4 v[12:15], v10, s[28:31], 0 offen
    v_add_u32 v10, 65536, v10
    buffer_load_dwordx4 v[12:15], v10, s[28:31], 0 offen
    v_lshrrev_b32 v7, 5, v5
    s_mov_b32 s22, 40960
    v_mul_lo_u32 v7, v7, s22
    v_lshrrev_b32 v8, 1, v4
    v_lshl_add_u32 v7, v8, 10, v7
    v_and_b32 v8, 1, v4
    v_lshl_add_u32 v7, v8, 9, v7
    v_and_b32 v8, 31, v5
    v_lshl_add_u32 v7, v8, 4, v7
    s_mov_b32 s24, 0xffff0000
    s_waitcnt vmcnt(17)
    v_lshlrev_b32 v36, 16, v16
    v_and_b32 v37, s24, v16
    v_lshlrev_b32 v38, 16, v17
    v_and_b32 v39, s24, v17
    v_lshlrev_b32 v40, 16, v18
    v_and_b32 v41, s24, v18
    v_lshlrev_b32 v42, 16, v19
    v_and_b32 v43, s24, v19
    v_lshlrev_b32 v44, 16, v20
    v_and_b32 v45, s24, v20
    v_lshlrev_b32 v46, 16, v21
    v_and_b32 v47, s24, v21
    v_lshlrev_b32 v48, 16, v22
    v_and_b32 v49, s24, v22
    v_lshlrev_b32 v50, 16, v23
    v_and_b32 v51, s24, v23
    v_lshlrev_b32 v52, 16, v24
    v_and_b32 v53, s24, v24
    v_lshlrev_b32 v54, 16, v25
    v_and_b32 v55, s24, v25
    v_lshlrev_b32 v56, 16, v26
    v_and_b32 v57, s24, v26
    v_lshlrev_b32 v58, 16, v27
    v_and_b32 v59, s24, v27
    v_lshlrev_b32 v60, 16, v28
    v_and_b32 v61, s24, v28
    v_lshlrev_b32 v62, 16, v29
    v_and_b32 v63, s24, v29
    v_lshlrev_b32 v64, 16, v30
    v_and_b32 v65, s24, v30
    v_lshlrev_b32 v66, 16, v31
    v_and_b32 v67, s24, v31
    v_lshlrev_b32 v68, 16, v32
    v_and_b32 v69, s24, v32
    v_lshlrev_b32 v70, 16, v33
    v_and_b32 v71, s24, v33
    v_lshlrev_b32 v72, 16, v34
    v_and_b32 v73, s24, v34
    v_lshlrev_b32 v74, 16, v35
    v_and_b32 v75, s24, v35
    v_add_f32 v76, v36, v37
    v_add_f32 v77, v38, v39
    v_add_f32 v76, v76, v40
    v_add_f32 v77, v77, v41
    v_add_f32 v76, v76, v42
    v_add_f32 v77, v77, v43
    v_add_f32 v76, v76, v44
    v_add_f32 v77, v77, v45
    v_add_f32 v76, v76, v46
    v_add_f32 v77, v77, v47
    v_add_f32 v76, v76, v48
    v_add_f32 v77, v77, v49
    v_add_f32 v76, v76, v50
    v_add_f32 v77, v77, v51
    v_add_f32 v76, v76, v52
    v_add_f32 v77, v77, v53
    v_add_f32 v76, v76, v54
    v_add_f32 v77, v77, v55
    v_add_f32 v76, v76, v56
    v_add_f32 v77, v77, v57
    v_add_f32 v76, v76, v58
    v_add_f32 v77, v77, v59
    v_add_f32 v76, v76, v60
    v_add_f32 v77, v77, v61
    v_add_f32 v76, v76, v62
    v_add_f32 v77, v77, v63
    v_add_f32 v76, v76, v64
    v_add_f32 v77, v77, v65
    v_add_f32 v76, v76, v66
    v_add_f32 v77, v77, v67
    v_add_f32 v76, v76, v68
    v_add_f32 v77, v77, v69
    v_add_f32 v76, v76, v70
    v_add_f32 v77, v77, v71
    v_add_f32 v76, v76, v72
    v_add_f32 v77, v77, v73
    v_add_f32 v76, v76, v74
    v_add_f32 v77, v77, v75
    v_add_f32 v76, v76, v77
    ds_swizzle_b32 v80, v76 offset:0x101f
    s_waitcnt lgkmcnt(0)
    v_add_f32 v76, v76, v80
    ds_swizzle_b32 v80, v76 offset:0x201f
    s_waitcnt lgkmcnt(0)
    v_add_f32 v76, v76, v80
    ds_swizzle_b32 v80, v76 offset:0x401f
    s_waitcnt lgkmcnt(0)
    v_add_f32 v76, v76, v80
    v_mov_b32 v80, v76
    s_nop 1
    v_permlane32_swap_b32 v80, v76
    s_nop 1
    v_add_f32 v76, v76, v80
    s_mov_b32 s25, 0x3acccccd
    v_mul_f32 v76, s25, v76
    v_mov_b32 v77, 0
    v_mov_b32 v78, 0
    v_sub_f32 v81, v36, v76
    v_fmac_f32 v77, v81, v81
    v_sub_f32 v82, v37, v76
    v_fmac_f32 v78, v82, v82
    v_sub_f32 v81, v38, v76
    v_fmac_f32 v77, v81, v81
    v_sub_f32 v82, v39, v76
    v_fmac_f32 v78, v82, v82
    v_sub_f32 v81, v40, v76
    v_fmac_f32 v77, v81, v81
    v_sub_f32 v82, v41, v76
    v_fmac_f32 v78, v82, v82
    v_sub_f32 v81, v42, v76
    v_fmac_f32 v77, v81, v81
    v_sub_f32 v82, v43, v76
    v_fmac_f32 v78, v82, v82
    v_sub_f32 v81, v44, v76
    v_fmac_f32 v77, v81, v81
    v_sub_f32 v82, v45, v76
    v_fmac_f32 v78, v82, v82
    v_sub_f32 v81, v46, v76
    v_fmac_f32 v77, v81, v81
    v_sub_f32 v82, v47, v76
    v_fmac_f32 v78, v82, v82
    v_sub_f32 v81, v48, v76
    v_fmac_f32 v77, v81, v81
    v_sub_f32 v82, v49, v76
    v_fmac_f32 v78, v82, v82
    v_sub_f32 v81, v50, v76
    v_fmac_f32 v77, v81, v81
    v_sub_f32 v82, v51, v76
    v_fmac_f32 v78, v82, v82
    v_sub_f32 v81, v52, v76
    v_fmac_f32 v77, v81, v81
    v_sub_f32 v82, v53, v76
    v_fmac_f32 v78, v82, v82
    v_sub_f32 v81, v54, v76
    v_fmac_f32 v77, v81, v81
    v_sub_f32 v82, v55, v76
    v_fmac_f32 v78, v82, v82
    v_sub_f32 v81, v56, v76
    v_fmac_f32 v77, v81, v81
    v_sub_f32 v82, v57, v76
    v_fmac_f32 v78, v82, v82
    v_sub_f32 v81, v58, v76
    v_fmac_f32 v77, v81, v81
    v_sub_f32 v82, v59, v76
    v_fmac_f32 v78, v82, v82
    v_sub_f32 v81, v60, v76
    v_fmac_f32 v77, v81, v81
    v_sub_f32 v82, v61, v76
    v_fmac_f32 v78, v82, v82
    v_sub_f32 v81, v62, v76
    v_fmac_f32 v77, v81, v81
    v_sub_f32 v82, v63, v76
    v_fmac_f32 v78, v82, v82
    v_sub_f32 v81, v64, v76
    v_fmac_f32 v77, v81, v81
    v_sub_f32 v82, v65, v76
    v_fmac_f32 v78, v82, v82
    v_sub_f32 v81, v66, v76
    v_fmac_f32 v77, v81, v81
    v_sub_f32 v82, v67, v76
    v_fmac_f32 v78, v82, v82
    v_sub_f32 v81, v68, v76
    v_fmac_f32 v77, v81, v81
    v_sub_f32 v82, v69, v76
    v_fmac_f32 v78, v82, v82
    v_sub_f32 v81, v70, v76
    v_fmac_f32 v77, v81, v81
    v_sub_f32 v82, v71, v76
    v_fmac_f32 v78, v82, v82
    v_sub_f32 v81, v72, v76
    v_fmac_f32 v77, v81, v81
    v_sub_f32 v82, v73, v76
    v_fmac_f32 v78, v82, v82
    v_sub_f32 v81, v74, v76
    v_fmac_f32 v77, v81, v81
    v_sub_f32 v82, v75, v76
    v_fmac_f32 v78, v82, v82
    v_add_f32 v77, v77, v78
    ds_swizzle_b32 v80, v77 offset:0x101f
    s_waitcnt lgkmcnt(0)
    v_add_f32 v77, v77, v80
    ds_swizzle_b32 v80, v77 offset:0x201f
    s_waitcnt lgkmcnt(0)
    v_add_f32 v77, v77, v80
    ds_swizzle_b32 v80, v77 offset:0x401f
    s_waitcnt lgkmcnt(0)
    v_add_f32 v77, v77, v80
    v_mov_b32 v80, v77
    s_nop 1
    v_permlane32_swap_b32 v80, v77
    s_nop 1
    v_add_f32 v77, v77, v80
    s_mov_b32 s26, 0x3727c5ac
    v_mul_f32 v77, s25, v77
    v_cvt_pk_bf16_f32 v80, v76, v77
    v_lshlrev_b32 v76, 16, v80
    v_and_b32 v77, s24, v80
    v_add_f32 v77, s26, v77
    v_cvt_pk_bf16_f32 v80, v77, v77
    v_and_b32 v77, s24, v80
    v_sqrt_f32 v77, v77
    s_nop 0
    v_cvt_pk_bf16_f32 v80, v77, v77
    v_and_b32 v77, s24, v80
    v_rcp_f32 v77, v77
    s_nop 0
    v_sub_f32 v36, v36, v76
    v_sub_f32 v37, v37, v76
    v_cvt_pk_bf16_f32 v81, v36, v37
    v_lshlrev_b32 v36, 16, v81
    v_and_b32 v37, s24, v81
    v_mul_f32 v36, v36, v77
    v_mul_f32 v37, v37, v77
    v_cvt_pk_bf16_f32 v16, v36, v37
    v_sub_f32 v38, v38, v76
    v_sub_f32 v39, v39, v76
    v_cvt_pk_bf16_f32 v82, v38, v39
    v_lshlrev_b32 v38, 16, v82
    v_and_b32 v39, s24, v82
    v_mul_f32 v38, v38, v77
    v_mul_f32 v39, v39, v77
    v_cvt_pk_bf16_f32 v17, v38, v39
    v_sub_f32 v40, v40, v76
    v_sub_f32 v41, v41, v76
    v_cvt_pk_bf16_f32 v81, v40, v41
    v_lshlrev_b32 v40, 16, v81
    v_and_b32 v41, s24, v81
    v_mul_f32 v40, v40, v77
    v_mul_f32 v41, v41, v77
    v_cvt_pk_bf16_f32 v18, v40, v41
    v_sub_f32 v42, v42, v76
    v_sub_f32 v43, v43, v76
    v_cvt_pk_bf16_f32 v82, v42, v43
    v_lshlrev_b32 v42, 16, v82
    v_and_b32 v43, s24, v82
    v_mul_f32 v42, v42, v77
    v_mul_f32 v43, v43, v77
    v_cvt_pk_bf16_f32 v19, v42, v43
    v_sub_f32 v44, v44, v76
    v_sub_f32 v45, v45, v76
    v_cvt_pk_bf16_f32 v81, v44, v45
    v_lshlrev_b32 v44, 16, v81
    v_and_b32 v45, s24, v81
    v_mul_f32 v44, v44, v77
    v_mul_f32 v45, v45, v77
    v_cvt_pk_bf16_f32 v20, v44, v45
    v_sub_f32 v46, v46, v76
    v_sub_f32 v47, v47, v76
    v_cvt_pk_bf16_f32 v82, v46, v47
    v_lshlrev_b32 v46, 16, v82
    v_and_b32 v47, s24, v82
    v_mul_f32 v46, v46, v77
    v_mul_f32 v47, v47, v77
    v_cvt_pk_bf16_f32 v21, v46, v47
    v_sub_f32 v48, v48, v76
    v_sub_f32 v49, v49, v76
    v_cvt_pk_bf16_f32 v81, v48, v49
    v_lshlrev_b32 v48, 16, v81
    v_and_b32 v49, s24, v81
    v_mul_f32 v48, v48, v77
    v_mul_f32 v49, v49, v77
    v_cvt_pk_bf16_f32 v22, v48, v49
    v_sub_f32 v50, v50, v76
    v_sub_f32 v51, v51, v76
    v_cvt_pk_bf16_f32 v82, v50, v51
    v_lshlrev_b32 v50, 16, v82
    v_and_b32 v51, s24, v82
    v_mul_f32 v50, v50, v77
    v_mul_f32 v51, v51, v77
    v_cvt_pk_bf16_f32 v23, v50, v51
    v_sub_f32 v52, v52, v76
    v_sub_f32 v53, v53, v76
    v_cvt_pk_bf16_f32 v81, v52, v53
    v_lshlrev_b32 v52, 16, v81
    v_and_b32 v53, s24, v81
    v_mul_f32 v52, v52, v77
    v_mul_f32 v53, v53, v77
    v_cvt_pk_bf16_f32 v24, v52, v53
    v_sub_f32 v54, v54, v76
    v_sub_f32 v55, v55, v76
    v_cvt_pk_bf16_f32 v82, v54, v55
    v_lshlrev_b32 v54, 16, v82
    v_and_b32 v55, s24, v82
    v_mul_f32 v54, v54, v77
    v_mul_f32 v55, v55, v77
    v_cvt_pk_bf16_f32 v25, v54, v55
    v_sub_f32 v56, v56, v76
    v_sub_f32 v57, v57, v76
    v_cvt_pk_bf16_f32 v81, v56, v57
    v_lshlrev_b32 v56, 16, v81
    v_and_b32 v57, s24, v81
    v_mul_f32 v56, v56, v77
    v_mul_f32 v57, v57, v77
    v_cvt_pk_bf16_f32 v26, v56, v57
    v_sub_f32 v58, v58, v76
    v_sub_f32 v59, v59, v76
    v_cvt_pk_bf16_f32 v82, v58, v59
    v_lshlrev_b32 v58, 16, v82
    v_and_b32 v59, s24, v82
    v_mul_f32 v58, v58, v77
    v_mul_f32 v59, v59, v77
    v_cvt_pk_bf16_f32 v27, v58, v59
    v_sub_f32 v60, v60, v76
    v_sub_f32 v61, v61, v76
    v_cvt_pk_bf16_f32 v81, v60, v61
    v_lshlrev_b32 v60, 16, v81
    v_and_b32 v61, s24, v81
    v_mul_f32 v60, v60, v77
    v_mul_f32 v61, v61, v77
    v_cvt_pk_bf16_f32 v28, v60, v61
    v_sub_f32 v62, v62, v76
    v_sub_f32 v63, v63, v76
    v_cvt_pk_bf16_f32 v82, v62, v63
    v_lshlrev_b32 v62, 16, v82
    v_and_b32 v63, s24, v82
    v_mul_f32 v62, v62, v77
    v_mul_f32 v63, v63, v77
    v_cvt_pk_bf16_f32 v29, v62, v63
    v_sub_f32 v64, v64, v76
    v_sub_f32 v65, v65, v76
    v_cvt_pk_bf16_f32 v81, v64, v65
    v_lshlrev_b32 v64, 16, v81
    v_and_b32 v65, s24, v81
    v_mul_f32 v64, v64, v77
    v_mul_f32 v65, v65, v77
    v_cvt_pk_bf16_f32 v30, v64, v65
    v_sub_f32 v66, v66, v76
    v_sub_f32 v67, v67, v76
    v_cvt_pk_bf16_f32 v82, v66, v67
    v_lshlrev_b32 v66, 16, v82
    v_and_b32 v67, s24, v82
    v_mul_f32 v66, v66, v77
    v_mul_f32 v67, v67, v77
    v_cvt_pk_bf16_f32 v31, v66, v67
    v_sub_f32 v68, v68, v76
    v_sub_f32 v69, v69, v76
    v_cvt_pk_bf16_f32 v81, v68, v69
    v_lshlrev_b32 v68, 16, v81
    v_and_b32 v69, s24, v81
    v_mul_f32 v68, v68, v77
    v_mul_f32 v69, v69, v77
    v_cvt_pk_bf16_f32 v32, v68, v69
    v_sub_f32 v70, v70, v76
    v_sub_f32 v71, v71, v76
    v_cvt_pk_bf16_f32 v82, v70, v71
    v_lshlrev_b32 v70, 16, v82
    v_and_b32 v71, s24, v82
    v_mul_f32 v70, v70, v77
    v_mul_f32 v71, v71, v77
    v_cvt_pk_bf16_f32 v33, v70, v71
    v_sub_f32 v72, v72, v76
    v_sub_f32 v73, v73, v76
    v_cvt_pk_bf16_f32 v81, v72, v73
    v_lshlrev_b32 v72, 16, v81
    v_and_b32 v73, s24, v81
    v_mul_f32 v72, v72, v77
    v_mul_f32 v73, v73, v77
    v_cvt_pk_bf16_f32 v34, v72, v73
    v_sub_f32 v74, v74, v76
    v_sub_f32 v75, v75, v76
    v_cvt_pk_bf16_f32 v82, v74, v75
    v_lshlrev_b32 v74, 16, v82
    v_and_b32 v75, s24, v82
    v_mul_f32 v74, v74, v77
    v_mul_f32 v75, v75, v77
    v_cvt_pk_bf16_f32 v35, v74, v75
    s_mov_b32 s22, 0
    buffer_store_dwordx4 v[16:19], v7, s[8:11], s22 offen
    s_mov_b32 s22, 8192
    buffer_store_dwordx4 v[20:23], v7, s[8:11], s22 offen
    s_mov_b32 s22, 16384
    buffer_store_dwordx4 v[24:27], v7, s[8:11], s22 offen
    s_mov_b32 s22, 24576
    buffer_store_dwordx4 v[28:31], v7, s[8:11], s22 offen
    s_mov_b32 s22, 32768
    buffer_store_dwordx4 v[32:35], v7, s[8:11], s22 offen
ln1_kernel_done:
    s_endpgm
.globl win_kernel
.p2align 8
.type win_kernel,@function
win_kernel:
    s_cmp_ge_u32 s2, 224
    s_cbranch_scc1 win_kernel_done
    s_load_dwordx2 s[4:5], s[0:1], 96
    s_load_dwordx2 s[8:9], s[0:1], 48
    s_load_dwordx2 s[12:13], s[0:1], 96
    v_lshrrev_b32 v1, 6, v0
    v_and_b32 v2, 63, v0
    s_nop 0
    v_readfirstlane_b32 s24, v1
    s_waitcnt lgkmcnt(0)
    s_mov_b32 s6, 2621440
    s_mov_b32 s7, 0x20000
    s_mov_b32 s10, 2211840
    s_mov_b32 s11, 0x20000
    s_add_u32 s12, s12, 4194304
    s_addc_u32 s13, s13, 0
    s_mov_b32 s14, 7077888
    s_mov_b32 s15, 0x20000
    s_and_b32 s29, s2, 7
    s_lshl_b32 s29, s29, 1
    s_lshr_b32 s31, s2, 3
    s_and_b32 s30, s31, 1
    s_add_u32 s29, s29, s30
    s_lshr_b32 s30, s31, 1
    s_mul_i32 s29, s29, 128
    s_mul_i32 s30, s30, 128
    s_mov_b32 s37, 0
    s_and_b32 s33, s24, 1
    s_lshr_b32 s32, s24, 1
    s_lshr_b32 s38, s29, 5
    s_mul_i32 s31, s32, 1
    s_add_u32 s38, s38, s31
    v_lshlrev_b32 v16, 4, v2
    s_mul_i32 s26, s38, 40960
    s_lshl_b32 s31, s37, 12
    s_add_u32 s26, s26, s31
    v_lshrrev_b32 v3, 4, v2
    v_and_b32 v4, 15, v2
    s_mul_i32 s31, s24, 8
    v_add_u32 v3, s31, v3
    s_mov_b32 s34, 3456
    s_lshl_b32 s35, s30, 1
    v_add_u32 v5, 0, v3
    v_and_b32 v6, 3, v5
    v_lshlrev_b32 v6, 2, v6
    v_xor_b32 v6, v6, v4
    v_mul_lo_u32 v5, v5, s34
    v_lshl_add_u32 v5, v6, 4, v5
    v_add_u32 v5, s35, v5
    v_mov_b32 v20, v5
    v_add_u32 v5, 4, v3
    v_and_b32 v6, 3, v5
    v_lshlrev_b32 v6, 2, v6
    v_xor_b32 v6, v6, v4
    v_mul_lo_u32 v5, v5, s34
    v_lshl_add_u32 v5, v6, 4, v5
    v_add_u32 v5, s35, v5
    v_subrev_u32 v5, 1024, v5
    v_mov_b32 v21, v5
    s_mul_i32 s25, s24, 0
    s_mul_i32 s36, s24, 2048
    s_mul_i32 s27, s37, 221184
    s_add_u32 m0, s36, 0
    s_nop 0
    buffer_load_dwordx4 v20, s[8:11], s27 offen offset:0 lds
    buffer_load_dwordx4 v21, s[8:11], s27 offen offset:1024 lds
    s_add_u32 s27, s27, 221184
    buffer_load_dwordx4 a[0:3], v16, s[4:7], s26 offen offset:0
    buffer_load_dwordx4 a[4:7], v16, s[4:7], s26 offen offset:1024
    buffer_load_dwordx4 a[8:11], v16, s[4:7], s26 offen offset:2048
    buffer_load_dwordx4 a[12:15], v16, s[4:7], s26 offen offset:3072
    s_add_u32 s26, s26, 4096
    v_and_b32 v3, 31, v2
    v_lshrrev_b32 v4, 5, v2
    v_bfe_u32 v5, v2, 2, 2
    v_lshl_add_u32 v6, v4, 3, v5
    v_mul_u32_u24 v6, 256, v6
    v_and_b32 v7, 3, v2
    v_lshl_add_u32 v6, v7, 3, v6
    v_bfe_u32 v7, v2, 4, 1
    v_lshl_add_u32 v6, v7, 5, v6
    s_mul_i32 s31, s33, 2
    s_add_u32 s34, s31, 0
    v_xor_b32 v7, s34, v5
    v_lshl_add_u32 v12, v7, 6, v6
    s_add_u32 s34, s31, 1
    v_xor_b32 v7, s34, v5
    v_lshl_add_u32 v13, v7, 6, v6
    s_mul_i32 s31, s33, 64
    s_add_u32 s39, s30, s31
    v_lshlrev_b32 v26, 4, v2
    s_add_u32 m0, s36, 16384
    s_nop 0
    buffer_load_dwordx4 v20, s[8:11], s27 offen offset:0 lds
    buffer_load_dwordx4 v21, s[8:11], s27 offen offset:1024 lds
    s_add_u32 s27, s27, 221184
    buffer_load_dwordx4 a[16:19], v16, s[4:7], s26 offen offset:0
    buffer_load_dwordx4 a[20:23], v16, s[4:7], s26 offen offset:1024
    buffer_load_dwordx4 a[24:27], v16, s[4:7], s26 offen offset:2048
    buffer_load_dwordx4 a[28:31], v16, s[4:7], s26 offen offset:3072
    s_add_u32 s26, s26, 4096
    v_mov_b32 v48, 0
    v_mov_b32 v49, 0
    v_mov_b32 v50, 0
    v_mov_b32 v51, 0
    v_mov_b32 v52, 0
    v_mov_b32 v53, 0
    v_mov_b32 v54, 0
    v_mov_b32 v55, 0
    v_mov_b32 v56, 0
    v_mov_b32 v57, 0
    v_mov_b32 v58, 0
    v_mov_b32 v59, 0
    v_mov_b32 v60, 0
    v_mov_b32 v61, 0
    v_mov_b32 v62, 0
    v_mov_b32 v63, 0
    v_mov_b32 v64, 0
    v_mov_b32 v65, 0
    v_mov_b32 v66, 0
    v_mov_b32 v67, 0
    v_mov_b32 v68, 0
    v_mov_b32 v69, 0
    v_mov_b32 v70, 0
    v_mov_b32 v71, 0
    v_mov_b32 v72, 0
    v_mov_b32 v73, 0
    v_mov_b32 v74, 0
    v_mov_b32 v75, 0
    v_mov_b32 v76, 0
    v_mov_b32 v77, 0
    v_mov_b32 v78, 0
    v_mov_b32 v79, 0
    s_add_u32 m0, s36, 32768
    s_nop 0
    buffer_load_dwordx4 v20, s[8:11], s27 offen offset:0 lds
    buffer_load_dwordx4 v21, s[8:11], s27 offen offset:1024 lds
    s_add_u32 s27, s27, 221184
    buffer_load_dwordx4 a[32:35], v16, s[4:7], s26 offen offset:0
    buffer_load_dwordx4 a[36:39], v16, s[4:7], s26 offen offset:1024
    buffer_load_dwordx4 a[40:43], v16, s[4:7], s26 offen offset:2048
    buffer_load_dwordx4 a[44:47], v16, s[4:7], s26 offen offset:3072
    s_add_u32 s26, s26, 4096
    s_add_u32 m0, s36, 49152
    s_nop 0
    buffer_load_dwordx4 v20, s[8:11], s27 offen offset:0 lds
    buffer_load_dwordx4 v21, s[8:11], s27 offen offset:1024 lds
    s_add_u32 s27, s27, 221184
    s_waitcnt vmcnt(14)
    s_barrier
    ds_read_b64_tr_b16 v[80:81], v12 offset:0
    ds_read_b64_tr_b16 v[82:83], v12 offset:1024
    ds_read_b64_tr_b16 v[84:85], v13 offset:0
    ds_read_b64_tr_b16 v[86:87], v13 offset:1024
    s_waitcnt lgkmcnt(0)
    v_mfma_f32_32x32x16_bf16 v[48:63], v[80:83], a[0:3], v[48:63]
    ds_read_b64_tr_b16 v[88:89], v12 offset:4096
    ds_read_b64_tr_b16 v[90:91], v12 offset:5120
    ds_read_b64_tr_b16 v[92:93], v13 offset:4096
    ds_read_b64_tr_b16 v[94:95], v13 offset:5120
    v_mfma_f32_32x32x16_bf16 v[64:79], v[84:87], a[0:3], v[64:79]
    buffer_load_dwordx4 a[48:51], v16, s[4:7], s26 offen offset:0
    buffer_load_dwordx4 a[52:55], v16, s[4:7], s26 offen offset:1024
    s_waitcnt lgkmcnt(0)
    v_mfma_f32_32x32x16_bf16 v[48:63], v[88:91], a[4:7], v[48:63]
    ds_read_b64_tr_b16 v[80:81], v12 offset:8192
    ds_read_b64_tr_b16 v[82:83], v12 offset:9216
    ds_read_b64_tr_b16 v[84:85], v13 offset:8192
    ds_read_b64_tr_b16 v[86:87], v13 offset:9216
    v_mfma_f32_32x32x16_bf16 v[64:79], v[92:95], a[4:7], v[64:79]
    buffer_load_dwordx4 a[56:59], v16, s[4:7], s26 offen offset:2048
    s_waitcnt lgkmcnt(0)
    v_mfma_f32_32x32x16_bf16 v[48:63], v[80:83], a[8:11], v[48:63]
    ds_read_b64_tr_b16 v[88:89], v12 offset:12288
    ds_read_b64_tr_b16 v[90:91], v12 offset:13312
    ds_read_b64_tr_b16 v[92:93], v13 offset:12288
    ds_read_b64_tr_b16 v[94:95], v13 offset:13312
    v_mfma_f32_32x32x16_bf16 v[64:79], v[84:87], a[8:11], v[64:79]
    buffer_load_dwordx4 a[60:63], v16, s[4:7], s26 offen offset:3072
    s_add_u32 s26, s26, 4096
    s_waitcnt vmcnt(12) lgkmcnt(0)
    s_barrier
    v_mfma_f32_32x32x16_bf16 v[48:63], v[88:91], a[12:15], v[48:63]
    ds_read_b64_tr_b16 v[80:81], v12 offset:16384
    ds_read_b64_tr_b16 v[82:83], v12 offset:17408
    ds_read_b64_tr_b16 v[84:85], v13 offset:16384
    ds_read_b64_tr_b16 v[86:87], v13 offset:17408
    v_mfma_f32_32x32x16_bf16 v[64:79], v[92:95], a[12:15], v[64:79]
    s_add_u32 m0, s36, 0
    s_nop 0
    buffer_load_dwordx4 v20, s[8:11], s27 offen offset:0 lds
    s_waitcnt lgkmcnt(0)
    v_mfma_f32_32x32x16_bf16 v[48:63], v[80:83], a[16:19], v[48:63]
    ds_read_b64_tr_b16 v[88:89], v12 offset:20480
    ds_read_b64_tr_b16 v[90:91], v12 offset:21504
    ds_read_b64_tr_b16 v[92:93], v13 offset:20480
    ds_read_b64_tr_b16 v[94:95], v13 offset:21504
    v_mfma_f32_32x32x16_bf16 v[64:79], v[84:87], a[16:19], v[64:79]
    buffer_load_dwordx4 v21, s[8:11], s27 offen offset:1024 lds
    s_add_u32 s27, s27, 221184
    buffer_load_dwordx4 a[0:3], v16, s[4:7], s26 offen offset:0
    s_waitcnt lgkmcnt(0)
    v_mfma_f32_32x32x16_bf16 v[48:63], v[88:91], a[20:23], v[48:63]
    ds_read_b64_tr_b16 v[80:81], v12 offset:24576
    ds_read_b64_tr_b16 v[82:83], v12 offset:25600
    ds_read_b64_tr_b16 v[84:85], v13 offset:24576
    ds_read_b64_tr_b16 v[86:87], v13 offset:25600
    v_mfma_f32_32x32x16_bf16 v[64:79], v[92:95], a[20:23], v[64:79]
    buffer_load_dwordx4 a[4:7], v16, s[4:7], s26 offen offset:1024
    buffer_load_dwordx4 a[8:11], v16, s[4:7], s26 offen offset:2048
    s_waitcnt lgkmcnt(0)
    v_mfma_f32_32x32x16_bf16 v[48:63], v[80:83], a[24:27], v[48:63]
    ds_read_b64_tr_b16 v[88:89], v12 offset:28672
    ds_read_b64_tr_b16 v[90:91], v12 offset:29696
    ds_read_b64_tr_b16 v[92:93], v13 offset:28672
    ds_read_b64_tr_b16 v[94:95], v13 offset:29696
    v_mfma_f32_32x32x16_bf16 v[64:79], v[84:87], a[24:27], v[64:79]
    buffer_load_dwordx4 a[12:15], v16, s[4:7], s26 offen offset:3072
    s_add_u32 s26, s26, 4096
    s_waitcnt vmcnt(12) lgkmcnt(0)
    s_barrier
    v_mfma_f32_32x32x16_bf16 v[48:63], v[88:91], a[28:31], v[48:63]
    ds_read_b64_tr_b16 v[80:81], v12 offset:32768
    ds_read_b64_tr_b16 v[82:83], v12 offset:33792
    ds_read_b64_tr_b16 v[84:85], v13 offset:32768
    ds_read_b64_tr_b16 v[86:87], v13 offset:33792
    v_mfma_f32_32x32x16_bf16 v[64:79], v[92:95], a[28:31], v[64:79]
    s_add_u32 m0, s36, 16384
    s_nop 0
    buffer_load_dwordx4 v20, s[8:11], s27 offen offset:0 lds
    s_waitcnt lgkmcnt(0)
    v_mfma_f32_32x32x16_bf16 v[48:63], v[80:83], a[32:35], v[48:63]
    ds_read_b64_tr_b16 v[88:89], v12 offset:36864
    ds_read_b64_tr_b16 v[90:91], v12 offset:37888
    ds_read_b64_tr_b16 v[92:93], v13 offset:36864
    ds_read_b64_tr_b16 v[94:95], v13 offset:37888
    v_mfma_f32_32x32x16_bf16 v[64:79], v[84:87], a[32:35], v[64:79]
    buffer_load_dwordx4 v21, s[8:11], s27 offen offset:1024 lds
    s_add_u32 s27, s27, 221184
    buffer_load_dwordx4 a[16:19], v16, s[4:7], s26 offen offset:0
    s_waitcnt lgkmcnt(0)
    v_mfma_f32_32x32x16_bf16 v[48:63], v[88:91], a[36:39], v[48:63]
    ds_read_b64_tr_b16 v[80:81], v12 offset:40960
    ds_read_b64_tr_b16 v[82:83], v12 offset:41984
    ds_read_b64_tr_b16 v[84:85], v13 offset:40960
    ds_read_b64_tr_b16 v[86:87], v13 offset:41984
    v_mfma_f32_32x32x16_bf16 v[64:79], v[92:95], a[36:39], v[64:79]
    buffer_load_dwordx4 a[20:23], v16, s[4:7], s26 offen offset:1024
    buffer_load_dwordx4 a[24:27], v16, s[4:7], s26 offen offset:2048
    s_waitcnt lgkmcnt(0)
    v_mfma_f32_32x32x16_bf16 v[48:63], v[80:83], a[40:43], v[48:63]
    ds_read_b64_tr_b16 v[88:89], v12 offset:45056
    ds_read_b64_tr_b16 v[90:91], v12 offset:46080
    ds_read_b64_tr_b16 v[92:93], v13 offset:45056
    ds_read_b64_tr_b16 v[94:95], v13 offset:46080
    v_mfma_f32_32x32x16_bf16 v[64:79], v[84:87], a[40:43], v[64:79]
    buffer_load_dwordx4 a[28:31], v16, s[4:7], s26 offen offset:3072
    s_add_u32 s26, s26, 4096
    s_waitcnt vmcnt(12) lgkmcnt(0)
    s_barrier
    v_mfma_f32_32x32x16_bf16 v[48:63], v[88:91], a[44:47], v[48:63]
    ds_read_b64_tr_b16 v[80:81], v12 offset:49152
    ds_read_b64_tr_b16 v[82:83], v12 offset:50176
    ds_read_b64_tr_b16 v[84:85], v13 offset:49152
    ds_read_b64_tr_b16 v[86:87], v13 offset:50176
    v_mfma_f32_32x32x16_bf16 v[64:79], v[92:95], a[44:47], v[64:79]
    s_add_u32 m0, s36, 32768
    s_nop 0
    buffer_load_dwordx4 v20, s[8:11], s27 offen offset:0 lds
    s_waitcnt lgkmcnt(0)
    v_mfma_f32_32x32x16_bf16 v[48:63], v[80:83], a[48:51], v[48:63]
    ds_read_b64_tr_b16 v[88:89], v12 offset:53248
    ds_read_b64_tr_b16 v[90:91], v12 offset:54272
    ds_read_b64_tr_b16 v[92:93], v13 offset:53248
    ds_read_b64_tr_b16 v[94:95], v13 offset:54272
    v_mfma_f32_32x32x16_bf16 v[64:79], v[84:87], a[48:51], v[64:79]
    buffer_load_dwordx4 v21, s[8:11], s27 offen offset:1024 lds
    s_add_u32 s27, s27, 221184
    buffer_load_dwordx4 a[32:35], v16, s[4:7], s26 offen offset:0
    s_waitcnt lgkmcnt(0)
    v_mfma_f32_32x32x16_bf16 v[48:63], v[88:91], a[52:55], v[48:63]
    ds_read_b64_tr_b16 v[80:81], v12 offset:57344
    ds_read_b64_tr_b16 v[82:83], v12 offset:58368
    ds_read_b64_tr_b16 v[84:85], v13 offset:57344
    ds_read_b64_tr_b16 v[86:87], v13 offset:58368
    v_mfma_f32_32x32x16_bf16 v[64:79], v[92:95], a[52:55], v[64:79]
    buffer_load_dwordx4 a[36:39], v16, s[4:7], s26 offen offset:1024
    buffer_load_dwordx4 a[40:43], v16, s[4:7], s26 offen offset:2048
    s_waitcnt lgkmcnt(0)
    v_mfma_f32_32x32x16_bf16 v[48:63], v[80:83], a[56:59], v[48:63]
    ds_read_b64_tr_b16 v[88:89], v12 offset:61440
    ds_read_b64_tr_b16 v[90:91], v12 offset:62464
    ds_read_b64_tr_b16 v[92:93], v13 offset:61440
    ds_read_b64_tr_b16 v[94:95], v13 offset:62464
    v_mfma_f32_32x32x16_bf16 v[64:79], v[84:87], a[56:59], v[64:79]
    buffer_load_dwordx4 a[44:47], v16, s[4:7], s26 offen offset:3072
    s_add_u32 s26, s26, 4096
    s_waitcnt vmcnt(12) lgkmcnt(0)
    s_barrier
    v_mfma_f32_32x32x16_bf16 v[48:63], v[88:91], a[60:63], v[48:63]
    ds_read_b64_tr_b16 v[80:81], v12 offset:0
    ds_read_b64_tr_b16 v[82:83], v12 offset:1024
    ds_read_b64_tr_b16 v[84:85], v13 offset:0
    ds_read_b64_tr_b16 v[86:87], v13 offset:1024
    v_mfma_f32_32x32x16_bf16 v[64:79], v[92:95], a[60:63], v[64:79]
    s_add_u32 m0, s36, 49152
    s_nop 0
    buffer_load_dwordx4 v20, s[8:11], s27 offen offset:0 lds
    s_waitcnt lgkmcnt(0)
    v_mfma_f32_32x32x16_bf16 v[48:63], v[80:83], a[0:3], v[48:63]
    ds_read_b64_tr_b16 v[88:89], v12 offset:4096
    ds_read_b64_tr_b16 v[90:91], v12 offset:5120
    ds_read_b64_tr_b16 v[92:93], v13 offset:4096
    ds_read_b64_tr_b16 v[94:95], v13 offset:5120
    v_mfma_f32_32x32x16_bf16 v[64:79], v[84:87], a[0:3], v[64:79]
    buffer_load_dwordx4 v21, s[8:11], s27 offen offset:1024 lds
    s_add_u32 s27, s27, 221184
    buffer_load_dwordx4 a[48:51], v16, s[4:7], s26 offen offset:0
    s_waitcnt lgkmcnt(0)
    v_mfma_f32_32x32x16_bf16 v[48:63], v[88:91], a[4:7], v[48:63]
    ds_read_b64_tr_b16 v[80:81], v12 offset:8192
    ds_read_b64_tr_b16 v[82:83], v12 offset:9216
    ds_read_b64_tr_b16 v[84:85], v13 offset:8192
    ds_read_b64_tr_b16 v[86:87], v13 offset:9216
    v_mfma_f32_32x32x16_bf16 v[64:79], v[92:95], a[4:7], v[64:79]
    buffer_load_dwordx4 a[52:55], v16, s[4:7], s26 offen offset:1024
    buffer_load_dwordx4 a[56:59], v16, s[4:7], s26 offen offset:2048
    s_waitcnt lgkmcnt(0)
    v_mfma_f32_32x32x16_bf16 v[48:63], v[80:83], a[8:11], v[48:63]
    ds_read_b64_tr_b16 v[88:89], v12 offset:12288
    ds_read_b64_tr_b16 v[90:91], v12 offset:13312
    ds_read_b64_tr_b16 v[92:93], v13 offset:12288
    ds_read_b64_tr_b16 v[94:95], v13 offset:13312
    v_mfma_f32_32x32x16_bf16 v[64:79], v[84:87], a[8:11], v[64:79]
    buffer_load_dwordx4 a[60:63], v16, s[4:7], s26 offen offset:3072
    s_add_u32 s26, s26, 4096
    s_waitcnt vmcnt(12) lgkmcnt(0)
    s_barrier
    v_mfma_f32_32x32x16_bf16 v[48:63], v[88:91], a[12:15], v[48:63]
    ds_read_b64_tr_b16 v[80:81], v12 offset:16384
    ds_read_b64_tr_b16 v[82:83], v12 offset:17408
    ds_read_b64_tr_b16 v[84:85], v13 offset:16384
    ds_read_b64_tr_b16 v[86:87], v13 offset:17408
    v_mfma_f32_32x32x16_bf16 v[64:79], v[92:95], a[12:15], v[64:79]
    s_add_u32 m0, s36, 0
    s_nop 0
    buffer_load_dwordx4 v20, s[8:11], s27 offen offset:0 lds
    s_waitcnt lgkmcnt(0)
    v_mfma_f32_32x32x16_bf16 v[48:63], v[80:83], a[16:19], v[48:63]
    ds_read_b64_tr_b16 v[88:89], v12 offset:20480
    ds_read_b64_tr_b16 v[90:91], v12 offset:21504
    ds_read_b64_tr_b16 v[92:93], v13 offset:20480
    ds_read_b64_tr_b16 v[94:95], v13 offset:21504
    v_mfma_f32_32x32x16_bf16 v[64:79], v[84:87], a[16:19], v[64:79]
    buffer_load_dwordx4 v21, s[8:11], s27 offen offset:1024 lds
    s_add_u32 s27, s27, 221184
    buffer_load_dwordx4 a[0:3], v16, s[4:7], s26 offen offset:0
    s_waitcnt lgkmcnt(0)
    v_mfma_f32_32x32x16_bf16 v[48:63], v[88:91], a[20:23], v[48:63]
    ds_read_b64_tr_b16 v[80:81], v12 offset:24576
    ds_read_b64_tr_b16 v[82:83], v12 offset:25600
    ds_read_b64_tr_b16 v[84:85], v13 offset:24576
    ds_read_b64_tr_b16 v[86:87], v13 offset:25600
    v_mfma_f32_32x32x16_bf16 v[64:79], v[92:95], a[20:23], v[64:79]
    buffer_load_dwordx4 a[4:7], v16, s[4:7], s26 offen offset:1024
    buffer_load_dwordx4 a[8:11], v16, s[4:7], s26 offen offset:2048
    s_waitcnt lgkmcnt(0)
    v_mfma_f32_32x32x16_bf16 v[48:63], v[80:83], a[24:27], v[48:63]
    ds_read_b64_tr_b16 v[88:89], v12 offset:28672
    ds_read_b64_tr_b16 v[90:91], v12 offset:29696
    ds_read_b64_tr_b16 v[92:93], v13 offset:28672
    ds_read_b64_tr_b16 v[94:95], v13 offset:29696
    v_mfma_f32_32x32x16_bf16 v[64:79], v[84:87], a[24:27], v[64:79]
    buffer_load_dwordx4 a[12:15], v16, s[4:7], s26 offen offset:3072
    s_add_u32 s26, s26, 4096
    s_waitcnt vmcnt(12) lgkmcnt(0)
    s_barrier
    v_mfma_f32_32x32x16_bf16 v[48:63], v[88:91], a[28:31], v[48:63]
    ds_read_b64_tr_b16 v[80:81], v12 offset:32768
    ds_read_b64_tr_b16 v[82:83], v12 offset:33792
    ds_read_b64_tr_b16 v[84:85], v13 offset:32768
    ds_read_b64_tr_b16 v[86:87], v13 offset:33792
    v_mfma_f32_32x32x16_bf16 v[64:79], v[92:95], a[28:31], v[64:79]
    s_add_u32 m0, s36, 16384
    s_nop 0
    buffer_load_dwordx4 v20, s[8:11], s27 offen offset:0 lds
    s_waitcnt lgkmcnt(0)
    v_mfma_f32_32x32x16_bf16 v[48:63], v[80:83], a[32:35], v[48:63]
    ds_read_b64_tr_b16 v[88:89], v12 offset:36864
    ds_read_b64_tr_b16 v[90:91], v12 offset:37888
    ds_read_b64_tr_b16 v[92:93], v13 offset:36864
    ds_read_b64_tr_b16 v[94:95], v13 offset:37888
    v_mfma_f32_32x32x16_bf16 v[64:79], v[84:87], a[32:35], v[64:79]
    buffer_load_dwordx4 v21, s[8:11], s27 offen offset:1024 lds
    s_add_u32 s27, s27, 221184
    buffer_load_dwordx4 a[16:19], v16, s[4:7], s26 offen offset:0
    s_waitcnt lgkmcnt(0)
    v_mfma_f32_32x32x16_bf16 v[48:63], v[88:91], a[36:39], v[48:63]
    ds_read_b64_tr_b16 v[80:81], v12 offset:40960
    ds_read_b64_tr_b16 v[82:83], v12 offset:41984
    ds_read_b64_tr_b16 v[84:85], v13 offset:40960
    ds_read_b64_tr_b16 v[86:87], v13 offset:41984
    v_mfma_f32_32x32x16_bf16 v[64:79], v[92:95], a[36:39], v[64:79]
    buffer_load_dwordx4 a[20:23], v16, s[4:7], s26 offen offset:1024
    buffer_load_dwordx4 a[24:27], v16, s[4:7], s26 offen offset:2048
    s_waitcnt lgkmcnt(0)
    v_mfma_f32_32x32x16_bf16 v[48:63], v[80:83], a[40:43], v[48:63]
    ds_read_b64_tr_b16 v[88:89], v12 offset:45056
    ds_read_b64_tr_b16 v[90:91], v12 offset:46080
    ds_read_b64_tr_b16 v[92:93], v13 offset:45056
    ds_read_b64_tr_b16 v[94:95], v13 offset:46080
    v_mfma_f32_32x32x16_bf16 v[64:79], v[84:87], a[40:43], v[64:79]
    buffer_load_dwordx4 a[28:31], v16, s[4:7], s26 offen offset:3072
    s_add_u32 s26, s26, 4096
    s_waitcnt vmcnt(12) lgkmcnt(0)
    s_barrier
    v_mfma_f32_32x32x16_bf16 v[48:63], v[88:91], a[44:47], v[48:63]
    ds_read_b64_tr_b16 v[80:81], v12 offset:49152
    ds_read_b64_tr_b16 v[82:83], v12 offset:50176
    ds_read_b64_tr_b16 v[84:85], v13 offset:49152
    ds_read_b64_tr_b16 v[86:87], v13 offset:50176
    v_mfma_f32_32x32x16_bf16 v[64:79], v[92:95], a[44:47], v[64:79]
    s_waitcnt lgkmcnt(0)
    v_mfma_f32_32x32x16_bf16 v[48:63], v[80:83], a[48:51], v[48:63]
    ds_read_b64_tr_b16 v[88:89], v12 offset:53248
    ds_read_b64_tr_b16 v[90:91], v12 offset:54272
    ds_read_b64_tr_b16 v[92:93], v13 offset:53248
    ds_read_b64_tr_b16 v[94:95], v13 offset:54272
    v_mfma_f32_32x32x16_bf16 v[64:79], v[84:87], a[48:51], v[64:79]
    s_waitcnt lgkmcnt(0)
    v_mfma_f32_32x32x16_bf16 v[48:63], v[88:91], a[52:55], v[48:63]
    ds_read_b64_tr_b16 v[80:81], v12 offset:57344
    ds_read_b64_tr_b16 v[82:83], v12 offset:58368
    ds_read_b64_tr_b16 v[84:85], v13 offset:57344
    ds_read_b64_tr_b16 v[86:87], v13 offset:58368
    v_mfma_f32_32x32x16_bf16 v[64:79], v[92:95], a[52:55], v[64:79]
    s_waitcnt lgkmcnt(0)
    v_mfma_f32_32x32x16_bf16 v[48:63], v[80:83], a[56:59], v[48:63]
    ds_read_b64_tr_b16 v[88:89], v12 offset:61440
    ds_read_b64_tr_b16 v[90:91], v12 offset:62464
    ds_read_b64_tr_b16 v[92:93], v13 offset:61440
    ds_read_b64_tr_b16 v[94:95], v13 offset:62464
    v_mfma_f32_32x32x16_bf16 v[64:79], v[84:87], a[56:59], v[64:79]
    s_waitcnt vmcnt(6) lgkmcnt(0)
    s_barrier
    v_mfma_f32_32x32x16_bf16 v[48:63], v[88:91], a[60:63], v[48:63]
    ds_read_b64_tr_b16 v[80:81], v12 offset:0
    ds_read_b64_tr_b16 v[82:83], v12 offset:1024
    ds_read_b64_tr_b16 v[84:85], v13 offset:0
    ds_read_b64_tr_b16 v[86:87], v13 offset:1024
    v_mfma_f32_32x32x16_bf16 v[64:79], v[92:95], a[60:63], v[64:79]
    s_waitcnt lgkmcnt(0)
    v_mfma_f32_32x32x16_bf16 v[48:63], v[80:83], a[0:3], v[48:63]
    ds_read_b64_tr_b16 v[88:89], v12 offset:4096
    ds_read_b64_tr_b16 v[90:91], v12 offset:5120
    ds_read_b64_tr_b16 v[92:93], v13 offset:4096
    ds_read_b64_tr_b16 v[94:95], v13 offset:5120
    v_mfma_f32_32x32x16_bf16 v[64:79], v[84:87], a[0:3], v[64:79]
    s_waitcnt lgkmcnt(0)
    v_mfma_f32_32x32x16_bf16 v[48:63], v[88:91], a[4:7], v[48:63]
    ds_read_b64_tr_b16 v[80:81], v12 offset:8192
    ds_read_b64_tr_b16 v[82:83], v12 offset:9216
    ds_read_b64_tr_b16 v[84:85], v13 offset:8192
    ds_read_b64_tr_b16 v[86:87], v13 offset:9216
    v_mfma_f32_32x32x16_bf16 v[64:79], v[92:95], a[4:7], v[64:79]
    s_waitcnt lgkmcnt(0)
    v_mfma_f32_32x32x16_bf16 v[48:63], v[80:83], a[8:11], v[48:63]
    ds_read_b64_tr_b16 v[88:89], v12 offset:12288
    ds_read_b64_tr_b16 v[90:91], v12 offset:13312
    ds_read_b64_tr_b16 v[92:93], v13 offset:12288
    ds_read_b64_tr_b16 v[94:95], v13 offset:13312
    v_mfma_f32_32x32x16_bf16 v[64:79], v[84:87], a[8:11], v[64:79]
    s_waitcnt vmcnt(0) lgkmcnt(0)
    s_barrier
    v_mfma_f32_32x32x16_bf16 v[48:63], v[88:91], a[12:15], v[48:63]
    ds_read_b64_tr_b16 v[80:81], v12 offset:16384
    ds_read_b64_tr_b16 v[82:83], v12 offset:17408
    ds_read_b64_tr_b16 v[84:85], v13 offset:16384
    ds_read_b64_tr_b16 v[86:87], v13 offset:17408
    v_mfma_f32_32x32x16_bf16 v[64:79], v[92:95], a[12:15], v[64:79]
    s_waitcnt lgkmcnt(0)
    v_mfma_f32_32x32x16_bf16 v[48:63], v[80:83], a[16:19], v[48:63]
    ds_read_b64_tr_b16 v[88:89], v12 offset:20480
    ds_read_b64_tr_b16 v[90:91], v12 offset:21504
    ds_read_b64_tr_b16 v[92:93], v13 offset:20480
    ds_read_b64_tr_b16 v[94:95], v13 offset:21504
    v_mfma_f32_32x32x16_bf16 v[64:79], v[84:87], a[16:19], v[64:79]
    s_waitcnt lgkmcnt(0)
    v_mfma_f32_32x32x16_bf16 v[48:63], v[88:91], a[20:23], v[48:63]
    ds_read_b64_tr_b16 v[80:81], v12 offset:24576
    ds_read_b64_tr_b16 v[82:83], v12 offset:25600
    ds_read_b64_tr_b16 v[84:85], v13 offset:24576
    ds_read_b64_tr_b16 v[86:87], v13 offset:25600
    v_mfma_f32_32x32x16_bf16 v[64:79], v[92:95], a[20:23], v[64:79]
    s_waitcnt lgkmcnt(0)
    v_mfma_f32_32x32x16_bf16 v[48:63], v[80:83], a[24:27], v[48:63]
    ds_read_b64_tr_b16 v[88:89], v12 offset:28672
    ds_read_b64_tr_b16 v[90:91], v12 offset:29696
    ds_read_b64_tr_b16 v[92:93], v13 offset:28672
    ds_read_b64_tr_b16 v[94:95], v13 offset:29696
    v_mfma_f32_32x32x16_bf16 v[64:79], v[84:87], a[24:27], v[64:79]
    s_waitcnt lgkmcnt(0)
    v_mfma_f32_32x32x16_bf16 v[48:63], v[88:91], a[28:31], v[48:63]
    v_mfma_f32_32x32x16_bf16 v[64:79], v[92:95], a[28:31], v[64:79]
    s_nop 15
    s_mov_b32 s27, 0xffff0000
    s_mov_b32 s36, 0x3d372713
    s_mov_b32 s26, 0xc0135761
    s_lshr_b32 s46, s2, 3
    s_mul_i32 s46, s46, 8
    s_add_u32 s46, s46, s24
    s_getpc_b64 s[48:49]
Lpc_2:
    s_sub_u32 s48, s48, Lpc_2-ln1_kernel
    s_subb_u32 s49, s49, 0
    s_mov_b32 s50, text_end-ln1_kernel
    s_mov_b32 s51, 0x20000
    s_lshl_b32 s46, s46, 10
    v_lshl_add_u32 v1, v2, 4, s46
    buffer_load_dwordx4 v[40:43], v1, s[48:51], 0 offen
    s_add_u32 s31, s39, 0
    s_cmp_ge_u32 s31, 1728
    s_cbranch_scc1 win_kernel_skip_3
    v_cvt_pk_bf16_f32 v28, v48, v49
    v_lshlrev_b32 v48, 16, v28
    v_and_b32 v49, s27, v28
    v_cvt_pk_bf16_f32 v32, v50, v51
    v_lshlrev_b32 v50, 16, v32
    v_and_b32 v51, s27, v32
    v_mul_f32 v36, v48, v48
    v_mul_f32 v37, v49, v49
    v_mul_f32 v38, v50, v50
    v_mul_f32 v39, v51, v51
    v_fma_f32 v36, v36, s36, 1.0
    v_fma_f32 v37, v37, s36, 1.0
    v_fma_f32 v38, v38, s36, 1.0
    v_fma_f32 v39, v39, s36, 1.0
    v_mul_f32 v36, v36, v48
    v_mul_f32 v37, v37, v49
    v_mul_f32 v38, v38, v50
    v_mul_f32 v39, v39, v51
    v_mul_f32 v36, s26, v36
    v_mul_f32 v37, s26, v37
    v_mul_f32 v38, s26, v38
    v_mul_f32 v39, s26, v39
    v_exp_f32 v36, v36
    v_exp_f32 v37, v37
    v_exp_f32 v38, v38
    v_exp_f32 v39, v39
    v_add_f32 v36, 1.0, v36
    v_add_f32 v37, 1.0, v37
    v_add_f32 v38, 1.0, v38
    v_add_f32 v39, 1.0, v39
    v_rcp_f32 v36, v36
    v_rcp_f32 v37, v37
    v_rcp_f32 v38, v38
    v_rcp_f32 v39, v39
    v_mul_f32 v48, v48, v36
    v_mul_f32 v49, v49, v37
    v_mul_f32 v50, v50, v38
    v_mul_f32 v51, v51, v39
    v_cvt_pk_bf16_f32 v48, v48, v49
    v_cvt_pk_bf16_f32 v49, v50, v51
    v_cvt_pk_bf16_f32 v28, v52, v53
    v_lshlrev_b32 v52, 16, v28
    v_and_b32 v53, s27, v28
    v_cvt_pk_bf16_f32 v32, v54, v55
    v_lshlrev_b32 v54, 16, v32
    v_and_b32 v55, s27, v32
    v_mul_f32 v36, v52, v52
    v_mul_f32 v37, v53, v53
    v_mul_f32 v38, v54, v54
    v_mul_f32 v39, v55, v55
    v_fma_f32 v36, v36, s36, 1.0
    v_fma_f32 v37, v37, s36, 1.0
    v_fma_f32 v38, v38, s36, 1.0
    v_fma_f32 v39, v39, s36, 1.0
    v_mul_f32 v36, v36, v52
    v_mul_f32 v37, v37, v53
    v_mul_f32 v38, v38, v54
    v_mul_f32 v39, v39, v55
    v_mul_f32 v36, s26, v36
    v_mul_f32 v37, s26, v37
    v_mul_f32 v38, s26, v38
    v_mul_f32 v39, s26, v39
    v_exp_f32 v36, v36
    v_exp_f32 v37, v37
    v_exp_f32 v38, v38
    v_exp_f32 v39, v39
    v_add_f32 v36, 1.0, v36
    v_add_f32 v37, 1.0, v37
    v_add_f32 v38, 1.0, v38
    v_add_f32 v39, 1.0, v39
    v_rcp_f32 v36, v36
    v_rcp_f32 v37, v37
    v_rcp_f32 v38, v38
    v_rcp_f32 v39, v39
    v_mul_f32 v52, v52, v36
    v_mul_f32 v53, v53, v37
    v_mul_f32 v54, v54, v38
    v_mul_f32 v55, v55, v39
    v_cvt_pk_bf16_f32 v50, v52, v53
    v_cvt_pk_bf16_f32 v51, v54, v55
    v_cvt_pk_bf16_f32 v28, v56, v57
    v_lshlrev_b32 v56, 16, v28
    v_and_b32 v57, s27, v28
    v_cvt_pk_bf16_f32 v32, v58, v59
    v_lshlrev_b32 v58, 16, v32
    v_and_b32 v59, s27, v32
    v_mul_f32 v36, v56, v56
    v_mul_f32 v37, v57, v57
    v_mul_f32 v38, v58, v58
    v_mul_f32 v39, v59, v59
    v_fma_f32 v36, v36, s36, 1.0
    v_fma_f32 v37, v37, s36, 1.0
    v_fma_f32 v38, v38, s36, 1.0
    v_fma_f32 v39, v39, s36, 1.0
    v_mul_f32 v36, v36, v56
    v_mul_f32 v37, v37, v57
    v_mul_f32 v38, v38, v58
    v_mul_f32 v39, v39, v59
    v_mul_f32 v36, s26, v36
    v_mul_f32 v37, s26, v37
    v_mul_f32 v38, s26, v38
    v_mul_f32 v39, s26, v39
    v_exp_f32 v36, v36
    v_exp_f32 v37, v37
    v_exp_f32 v38, v38
    v_exp_f32 v39, v39
    v_add_f32 v36, 1.0, v36
    v_add_f32 v37, 1.0, v37
    v_add_f32 v38, 1.0, v38
    v_add_f32 v39, 1.0, v39
    v_rcp_f32 v36, v36
    v_rcp_f32 v37, v37
    v_rcp_f32 v38, v38
    v_rcp_f32 v39, v39
    v_mul_f32 v56, v56, v36
    v_mul_f32 v57, v57, v37
    v_mul_f32 v58, v58, v38
    v_mul_f32 v59, v59, v39
    v_cvt_pk_bf16_f32 v52, v56, v57
    v_cvt_pk_bf16_f32 v53, v58, v59
    v_cvt_pk_bf16_f32 v28, v60, v61
    v_lshlrev_b32 v60, 16, v28
    v_and_b32 v61, s27, v28
    v_cvt_pk_bf16_f32 v32, v62, v63
    v_lshlrev_b32 v62, 16, v32
    v_and_b32 v63, s27, v32
    v_mul_f32 v36, v60, v60
    v_mul_f32 v37, v61, v61
    v_mul_f32 v38, v62, v62
    v_mul_f32 v39, v63, v63
    v_fma_f32 v36, v36, s36, 1.0
    v_fma_f32 v37, v37, s36, 1.0
    v_fma_f32 v38, v38, s36, 1.0
    v_fma_f32 v39, v39, s36, 1.0
    v_mul_f32 v36, v36, v60
    v_mul_f32 v37, v37, v61
    v_mul_f32 v38, v38, v62
    v_mul_f32 v39, v39, v63
    v_mul_f32 v36, s26, v36
    v_mul_f32 v37, s26, v37
    v_mul_f32 v38, s26, v38
    v_mul_f32 v39, s26, v39
    v_exp_f32 v36, v36
    v_exp_f32 v37, v37
    v_exp_f32 v38, v38
    v_exp_f32 v39, v39
    v_add_f32 v36, 1.0, v36
    v_add_f32 v37, 1.0, v37
    v_add_f32 v38, 1.0, v38
    v_add_f32 v39, 1.0, v39
    v_rcp_f32 v36, v36
    v_rcp_f32 v37, v37
    v_rcp_f32 v38, v38
    v_rcp_f32 v39, v39
    v_mul_f32 v60, v60, v36
    v_mul_f32 v61, v61, v37
    v_mul_f32 v62, v62, v38
    v_mul_f32 v63, v63, v39
    v_cvt_pk_bf16_f32 v54, v60, v61
    v_cvt_pk_bf16_f32 v55, v62, v63
    s_nop 1
    v_permlane32_swap_b32 v48, v50
    v_permlane32_swap_b32 v49, v51
    v_permlane32_swap_b32 v52, v54
    v_permlane32_swap_b32 v53, v55
    s_nop 1
    s_add_u32 s31, s38, 0
    s_mul_i32 s31, s31, 108
    s_lshr_b32 s34, s39, 4
    s_add_u32 s31, s31, s34
    s_add_u32 s31, s31, 0
    s_lshl_b32 s31, s31, 10
    buffer_store_dwordx4 v[48:51], v26, s[12:15], s31 offen offset:0
    buffer_store_dwordx4 v[52:55], v26, s[12:15], s31 offen offset:1024
win_kernel_skip_3:
    s_add_u32 s31, s39, 32
    s_cmp_ge_u32 s31, 1728
    s_cbranch_scc1 win_kernel_skip_4
    v_cvt_pk_bf16_f32 v28, v64, v65
    v_lshlrev_b32 v64, 16, v28
    v_and_b32 v65, s27, v28
    v_cvt_pk_bf16_f32 v32, v66, v67
    v_lshlrev_b32 v66, 16, v32
    v_and_b32 v67, s27, v32
    v_mul_f32 v36, v64, v64
    v_mul_f32 v37, v65, v65
    v_mul_f32 v38, v66, v66
    v_mul_f32 v39, v67, v67
    v_fma_f32 v36, v36, s36, 1.0
    v_fma_f32 v37, v37, s36, 1.0
    v_fma_f32 v38, v38, s36, 1.0
    v_fma_f32 v39, v39, s36, 1.0
    v_mul_f32 v36, v36, v64
    v_mul_f32 v37, v37, v65
    v_mul_f32 v38, v38, v66
    v_mul_f32 v39, v39, v67
    v_mul_f32 v36, s26, v36
    v_mul_f32 v37, s26, v37
    v_mul_f32 v38, s26, v38
    v_mul_f32 v39, s26, v39
    v_exp_f32 v36, v36
    v_exp_f32 v37, v37
    v_exp_f32 v38, v38
    v_exp_f32 v39, v39
    v_add_f32 v36, 1.0, v36
    v_add_f32 v37, 1.0, v37
    v_add_f32 v38, 1.0, v38
    v_add_f32 v39, 1.0, v39
    v_rcp_f32 v36, v36
    v_rcp_f32 v37, v37
    v_rcp_f32 v38, v38
    v_rcp_f32 v39, v39
    v_mul_f32 v64, v64, v36
    v_mul_f32 v65, v65, v37
    v_mul_f32 v66, v66, v38
    v_mul_f32 v67, v67, v39
    v_cvt_pk_bf16_f32 v64, v64, v65
    v_cvt_pk_bf16_f32 v65, v66, v67
    v_cvt_pk_bf16_f32 v28, v68, v69
    v_lshlrev_b32 v68, 16, v28
    v_and_b32 v69, s27, v28
    v_cvt_pk_bf16_f32 v32, v70, v71
    v_lshlrev_b32 v70, 16, v32
    v_and_b32 v71, s27, v32
    v_mul_f32 v36, v68, v68
    v_mul_f32 v37, v69, v69
    v_mul_f32 v38, v70, v70
    v_mul_f32 v39, v71, v71
    v_fma_f32 v36, v36, s36, 1.0
    v_fma_f32 v37, v37, s36, 1.0
    v_fma_f32 v38, v38, s36, 1.0
    v_fma_f32 v39, v39, s36, 1.0
    v_mul_f32 v36, v36, v68
    v_mul_f32 v37, v37, v69
    v_mul_f32 v38, v38, v70
    v_mul_f32 v39, v39, v71
    v_mul_f32 v36, s26, v36
    v_mul_f32 v37, s26, v37
    v_mul_f32 v38, s26, v38
    v_mul_f32 v39, s26, v39
    v_exp_f32 v36, v36
    v_exp_f32 v37, v37
    v_exp_f32 v38, v38
    v_exp_f32 v39, v39
    v_add_f32 v36, 1.0, v36
    v_add_f32 v37, 1.0, v37
    v_add_f32 v38, 1.0, v38
    v_add_f32 v39, 1.0, v39
    v_rcp_f32 v36, v36
    v_rcp_f32 v37, v37
    v_rcp_f32 v38, v38
    v_rcp_f32 v39, v39
    v_mul_f32 v68, v68, v36
    v_mul_f32 v69, v69, v37
    v_mul_f32 v70, v70, v38
    v_mul_f32 v71, v71, v39
    v_cvt_pk_bf16_f32 v66, v68, v69
    v_cvt_pk_bf16_f32 v67, v70, v71
    v_cvt_pk_bf16_f32 v28, v72, v73
    v_lshlrev_b32 v72, 16, v28
    v_and_b32 v73, s27, v28
    v_cvt_pk_bf16_f32 v32, v74, v75
    v_lshlrev_b32 v74, 16, v32
    v_and_b32 v75, s27, v32
    v_mul_f32 v36, v72, v72
    v_mul_f32 v37, v73, v73
    v_mul_f32 v38, v74, v74
    v_mul_f32 v39, v75, v75
    v_fma_f32 v36, v36, s36, 1.0
    v_fma_f32 v37, v37, s36, 1.0
    v_fma_f32 v38, v38, s36, 1.0
    v_fma_f32 v39, v39, s36, 1.0
    v_mul_f32 v36, v36, v72
    v_mul_f32 v37, v37, v73
    v_mul_f32 v38, v38, v74
    v_mul_f32 v39, v39, v75
    v_mul_f32 v36, s26, v36
    v_mul_f32 v37, s26, v37
    v_mul_f32 v38, s26, v38
    v_mul_f32 v39, s26, v39
    v_exp_f32 v36, v36
    v_exp_f32 v37, v37
    v_exp_f32 v38, v38
    v_exp_f32 v39, v39
    v_add_f32 v36, 1.0, v36
    v_add_f32 v37, 1.0, v37
    v_add_f32 v38, 1.0, v38
    v_add_f32 v39, 1.0, v39
    v_rcp_f32 v36, v36
    v_rcp_f32 v37, v37
    v_rcp_f32 v38, v38
    v_rcp_f32 v39, v39
    v_mul_f32 v72, v72, v36
    v_mul_f32 v73, v73, v37
    v_mul_f32 v74, v74, v38
    v_mul_f32 v75, v75, v39
    v_cvt_pk_bf16_f32 v68, v72, v73
    v_cvt_pk_bf16_f32 v69, v74, v75
    v_cvt_pk_bf16_f32 v28, v76, v77
    v_lshlrev_b32 v76, 16, v28
    v_and_b32 v77, s27, v28
    v_cvt_pk_bf16_f32 v32, v78, v79
    v_lshlrev_b32 v78, 16, v32
    v_and_b32 v79, s27, v32
    v_mul_f32 v36, v76, v76
    v_mul_f32 v37, v77, v77
    v_mul_f32 v38, v78, v78
    v_mul_f32 v39, v79, v79
    v_fma_f32 v36, v36, s36, 1.0
    v_fma_f32 v37, v37, s36, 1.0
    v_fma_f32 v38, v38, s36, 1.0
    v_fma_f32 v39, v39, s36, 1.0
    v_mul_f32 v36, v36, v76
    v_mul_f32 v37, v37, v77
    v_mul_f32 v38, v38, v78
    v_mul_f32 v39, v39, v79
    v_mul_f32 v36, s26, v36
    v_mul_f32 v37, s26, v37
    v_mul_f32 v38, s26, v38
    v_mul_f32 v39, s26, v39
    v_exp_f32 v36, v36
    v_exp_f32 v37, v37
    v_exp_f32 v38, v38
    v_exp_f32 v39, v39
    v_add_f32 v36, 1.0, v36
    v_add_f32 v37, 1.0, v37
    v_add_f32 v38, 1.0, v38
    v_add_f32 v39, 1.0, v39
    v_rcp_f32 v36, v36
    v_rcp_f32 v37, v37
    v_rcp_f32 v38, v38
    v_rcp_f32 v39, v39
    v_mul_f32 v76, v76, v36
    v_mul_f32 v77, v77, v37
    v_mul_f32 v78, v78, v38
    v_mul_f32 v79, v79, v39
    v_cvt_pk_bf16_f32 v70, v76, v77
    v_cvt_pk_bf16_f32 v71, v78, v79
    s_nop 1
    v_permlane32_swap_b32 v64, v66
    v_permlane32_swap_b32 v65, v67
    v_permlane32_swap_b32 v68, v70
    v_permlane32_swap_b32 v69, v71
    s_nop 1
    s_add_u32 s31, s38, 0
    s_mul_i32 s31, s31, 108
    s_lshr_b32 s34, s39, 4
    s_add_u32 s31, s31, s34
    s_add_u32 s31, s31, 2
    s_lshl_b32 s31, s31, 10
    buffer_store_dwordx4 v[64:67], v26, s[12:15], s31 offen offset:0
    buffer_store_dwordx4 v[68:71], v26, s[12:15], s31 offen offset:1024
win_kernel_skip_4:
win_kernel_done:
    s_endpgm
.globl attn_kernel
.p2align 8
.type attn_kernel,@function
attn_kernel:
    s_cmp_ge_u32 s2, 256
    s_cbranch_scc1 attn_kernel_done
    s_load_dwordx4 s[24:27], s[0:1], 8
    s_load_dwordx2 s[28:29], s[0:1], 96
    s_load_dwordx2 s[36:37], s[0:1], 24
    s_load_dwordx2 s[84:85], s[0:1], 56
    s_load_dwordx2 s[88:89], s[0:1], 32
    s_load_dwordx2 s[92:93], s[0:1], 72
    s_and_b32 s34, s2, 7
    s_lshl_b32 s34, s34, 2
    s_lshr_b32 s32, s2, 6
    s_add_u32 s32, s32, s34
    s_lshr_b32 s33, s2, 3
    s_and_b32 s33, s33, 7
    v_lshrrev_b32 v1, 6, v0
    v_and_b32 v2, 63, v0
    s_nop 0
    v_readfirstlane_b32 s20, v1
    s_lshl_b32 s34, s32, 19
    s_waitcnt lgkmcnt(0)
    s_add_u32 s4, s24, s34
    s_addc_u32 s5, s25, 0
    s_mov_b32 s6, 524288
    s_mov_b32 s7, 0x20000
    s_add_u32 s8, s26, s34
    s_addc_u32 s9, s27, 0
    s_mov_b32 s10, 524288
    s_mov_b32 s11, 0x20000
    s_mov_b32 s12, s28
    s_mov_b32 s13, s29
    s_mov_b32 s14, 2621440
    s_mov_b32 s15, 0x20000
    s_add_u32 s16, s28, 50331648
    s_addc_u32 s17, s29, 0
    s_mov_b32 s18, 16777216
    s_mov_b32 s19, 0x20000
    s_add_u32 s40, s28, 4194304
    s_addc_u32 s41, s29, 0
    s_mov_b32 s42, 7077888
    s_mov_b32 s43, 0x20000
    s_add_u32 s44, s28, 12582912
    s_addc_u32 s45, s29, 0
    s_mov_b32 s46, 3538944
    s_mov_b32 s47, 0x20000
    s_mov_b32 s86, 8388608
    s_mov_b32 s87, 0x20000
    s_mov_b32 s90, 5242880
    s_mov_b32 s91, 0x20000
    s_mov_b32 s94, 1105920
    s_mov_b32 s95, 0x20000
    s_lshl_b32 s96, s2, 2
    s_add_u32 s96, s96, s20
    s_lshl_b32 s96, s96, 10
    s_mov_b32 s38, 5242880
    s_mov_b32 s39, 0x20000
    s_lshl_b32 s34, s2, 3
    s_lshl_b32 s35, s20, 1
    s_add_u32 s50, s34, s35
    v_and_b32 v3, 1, v2
    v_add_u32 v3, s50, v3
    v_lshrrev_b32 v5, 1, v2
    v_lshrrev_b32 v6, 5, v3
    s_mov_b32 s34, 110592
    v_mul_lo_u32 v6, v6, s34
    v_lshrrev_b32 v7, 1, v5
    v_lshl_add_u32 v6, v7, 10, v6
    v_and_b32 v7, 1, v5
    v_lshl_add_u32 v6, v7, 9, v6
    v_and_b32 v7, 31, v3
    v_lshl_add_u32 v6, v7, 4, v6
    v_mov_b32 v235, v6
    s_mov_b32 s34, 1728
    v_mul_lo_u32 v3, v3, s34
    v_lshl_add_u32 v3, v5, 4, v3
    v_cmp_gt_u32 s[54:55], 12, v5
    v_mov_b32 v176, 0x7fff0000
    s_nop 0
    v_cndmask_b32 v176, v176, v3, s[54:55]
    s_mul_i32 s21, s20, 4096
    s_mov_b32 s31, 0x49800000
    s_lshl_b32 s34, s33, 8
    s_lshl_b32 s35, s20, 6
    s_add_u32 s51, s34, s35
    v_lshrrev_b32 v4, 5, v2
    v_lshlrev_b32 v168, 4, v2
    s_lshr_b32 s34, s51, 5
    s_mul_i32 s57, s34, 40960
    s_add_u32 s49, s57, 40960
    v_lshrrev_b32 v5, 4, v2
    v_and_b32 v6, 15, v2
    s_lshl_b32 s34, s20, 4
    v_add_u32 v7, s34, v5
    v_add_u32 v1, 0, v7
    v_and_b32 v1, 15, v1
    v_xor_b32 v1, v1, v6
    v_lshlrev_b32 v1, 4, v1
    v_lshl_add_u32 v20, v7, 8, v1
    v_add_u32 v1, 4, v7
    v_and_b32 v1, 15, v1
    v_xor_b32 v1, v1, v6
    v_lshlrev_b32 v1, 4, v1
    v_lshl_add_u32 v21, v7, 8, v1
    v_add_u32 v1, 8, v7
    v_and_b32 v1, 15, v1
    v_xor_b32 v1, v1, v6
    v_lshlrev_b32 v1, 4, v1
    v_lshl_add_u32 v22, v7, 8, v1
    v_add_u32 v1, 12, v7
    v_and_b32 v1, 15, v1
    v_xor_b32 v1, v1, v6
    v_lshlrev_b32 v1, 4, v1
    v_lshl_add_u32 v23, v7, 8, v1
    v_lshlrev_b32 v1, 2, v5
    v_xor_b32 v1, v1, v6
    v_lshlrev_b32 v1, 4, v1
    v_lshl_add_u32 v24, v7, 8, v1
    s_lshl_b32 s34, s32, 8
    v_add_u32 v1, s34, v1
    v_lshl_add_u32 v1, v7, 13, v1
    v_add_u32 v160, 0, v1
    v_add_u32 v161, 31744, v1
    v_add_u32 v162, 63488, v1
    v_add_u32 v163, 95232, v1
    s_mov_b32 s22, 0
    s_mov_b32 s23, 0
    s_mov_b32 s48, 0
    s_add_u32 m0, s21, 98304
    s_nop 0
    buffer_load_dwordx4 v160, s[36:39], s48 offen offset:0 lds
    buffer_load_dwordx4 v161, s[36:39], s48 offen offset:1024 lds
    buffer_load_dwordx4 v162, s[36:39], s48 offen offset:2048 lds
    buffer_load_dwordx4 v163, s[36:39], s48 offen offset:3072 lds
    s_add_u32 s48, s48, 524288
    buffer_load_dwordx4 a[0:3], v168, s[12:15], s57 offen offset:0
    buffer_load_dwordx4 a[4:7], v168, s[12:15], s57 offen offset:1024
    buffer_load_dwordx4 a[8:11], v168, s[12:15], s57 offen offset:2048
    buffer_load_dwordx4 a[12:15], v168, s[12:15], s57 offen offset:3072
    buffer_load_dwordx4 a[16:19], v168, s[12:15], s49 offen offset:0
    buffer_load_dwordx4 a[20:23], v168, s[12:15], s49 offen offset:1024
    buffer_load_dwordx4 a[24:27], v168, s[12:15], s49 offen offset:2048
    buffer_load_dwordx4 a[28:31], v168, s[12:15], s49 offen offset:3072
    s_add_u32 s57, s57, 4096
    s_add_u32 s49, s49, 4096
    s_add_u32 m0, s21, 114688
    s_nop 0
    buffer_load_dwordx4 v160, s[36:39], s48 offen offset:0 lds
    buffer_load_dwordx4 v161, s[36:39], s48 offen offset:1024 lds
    buffer_load_dwordx4 v162, s[36:39], s48 offen offset:2048 lds
    buffer_load_dwordx4 v163, s[36:39], s48 offen offset:3072 lds
    s_add_u32 s48, s48, 524288
    buffer_load_dwordx4 a[32:35], v168, s[12:15], s57 offen offset:0
    buffer_load_dwordx4 a[36:39], v168, s[12:15], s57 offen offset:1024
    buffer_load_dwordx4 a[40:43], v168, s[12:15], s57 offen offset:2048
    buffer_load_dwordx4 a[44:47], v168, s[12:15], s57 offen offset:3072
    buffer_load_dwordx4 a[48:51], v168, s[12:15], s49 offen offset:0
    buffer_load_dwordx4 a[52:55], v168, s[12:15], s49 offen offset:1024
    buffer_load_dwordx4 a[56:59], v168, s[12:15], s49 offen offset:2048
    buffer_load_dwordx4 a[60:63], v168, s[12:15], s49 offen offset:3072
    s_add_u32 s57, s57, 4096
    s_add_u32 s49, s49, 4096
    v_and_b32 v1, 31, v2
    v_and_b32 v5, 15, v2
    v_add_u32 v6, 0, v4
    v_xor_b32 v6, v6, v5
    v_lshlrev_b32 v6, 4, v6
    v_lshl_add_u32 v8, v1, 8, v6
    v_add_u32 v6, 2, v4
    v_xor_b32 v6, v6, v5
    v_lshlrev_b32 v6, 4, v6
    v_lshl_add_u32 v9, v1, 8, v6
    v_add_u32 v6, 4, v4
    v_xor_b32 v6, v6, v5
    v_lshlrev_b32 v6, 4, v6
    v_lshl_add_u32 v10, v1, 8, v6
    v_add_u32 v6, 6, v4
    v_xor_b32 v6, v6, v5
    v_lshlrev_b32 v6, 4, v6
    v_lshl_add_u32 v11, v1, 8, v6
    v_add_u32 v6, 8, v4
    v_xor_b32 v6, v6, v5
    v_lshlrev_b32 v6, 4, v6
    v_lshl_add_u32 v12, v1, 8, v6
    v_add_u32 v6, 10, v4
    v_xor_b32 v6, v6, v5
    v_lshlrev_b32 v6, 4, v6
    v_lshl_add_u32 v13, v1, 8, v6
    v_add_u32 v6, 12, v4
    v_xor_b32 v6, v6, v5
    v_lshlrev_b32 v6, 4, v6
    v_lshl_add_u32 v14, v1, 8, v6
    v_add_u32 v6, 14, v4
    v_xor_b32 v6, v6, v5
    v_lshlrev_b32 v6, 4, v6
    v_lshl_add_u32 v15, v1, 8, v6
    v_lshrrev_b32 v6, 2, v5
    v_lshl_add_u32 v7, v4, 2, v6
    v_lshlrev_b32 v7, 8, v7
    v_and_b32 v1, 3, v2
    v_lshl_add_u32 v7, v1, 3, v7
    v_bfe_u32 v1, v2, 4, 1
    v_lshl_add_u32 v7, v1, 5, v7
    v_add_u32 v7, 65536, v7
    v_xor_b32 v1, 0, v6
    v_lshl_add_u32 v16, v1, 6, v7
    v_xor_b32 v1, 1, v6
    v_lshl_add_u32 v17, v1, 6, v7
    v_xor_b32 v1, 2, v6
    v_lshl_add_u32 v18, v1, 6, v7
    v_xor_b32 v1, 3, v6
    v_lshl_add_u32 v19, v1, 6, v7
    v_lshl_add_u32 v7, v4, 3, v6
    v_lshlrev_b32 v7, 8, v7
    v_and_b32 v1, 1, v2
    v_lshl_add_u32 v7, v1, 4, v7
    v_bfe_u32 v1, v2, 1, 1
    v_lshl_add_u32 v7, v1, 3, v7
    v_bfe_u32 v1, v2, 4, 1
    v_lshl_add_u32 v7, v1, 5, v7
    v_add_u32 v7, 98304, v7
    v_xor_b32 v1, 0, v6
    v_lshl_add_u32 v164, v1, 6, v7
    v_xor_b32 v1, 1, v6
    v_lshl_add_u32 v165, v1, 6, v7
    v_xor_b32 v1, 2, v6
    v_lshl_add_u32 v166, v1, 6, v7
    v_xor_b32 v1, 3, v6
    v_lshl_add_u32 v167, v1, 6, v7
    s_mov_b32 s52, 0xffff0000
    s_mov_b32 s59, 0x3e0293ee
    s_waitcnt vmcnt(12)
    s_barrier
    ds_read_b64_tr_b16 a[192:193], v164 offset:0
    ds_read_b64_tr_b16 a[194:195], v164 offset:1024
    ds_read_b64_tr_b16 a[196:197], v165 offset:0
    ds_read_b64_tr_b16 a[198:199], v165 offset:1024
    ds_read_b64_tr_b16 a[200:201], v166 offset:0
    ds_read_b64_tr_b16 a[202:203], v166 offset:1024
    ds_read_b64_tr_b16 a[204:205], v167 offset:0
    ds_read_b64_tr_b16 a[206:207], v167 offset:1024
    s_waitcnt lgkmcnt(0)
    v_mfma_f32_32x32x16_bf16 v[32:47], a[192:195], a[0:3], 0
    ds_read_b64_tr_b16 a[208:209], v164 offset:4096
    ds_read_b64_tr_b16 a[210:211], v164 offset:5120
    s_add_u32 m0, s21, 131072
    s_nop 0
    buffer_load_dwordx4 v160, s[36:39], s48 offen offset:0 lds
    v_mfma_f32_32x32x16_bf16 v[96:111], a[192:195], a[16:19], 0
    ds_read_b64_tr_b16 a[212:213], v165 offset:4096
    ds_read_b64_tr_b16 a[214:215], v165 offset:5120
    buffer_load_dwordx4 v161, s[36:39], s48 offen offset:1024 lds
    v_mfma_f32_32x32x16_bf16 v[48:63], a[196:199], a[0:3], 0
    ds_read_b64_tr_b16 a[216:217], v166 offset:4096
    ds_read_b64_tr_b16 a[218:219], v166 offset:5120
    buffer_load_dwordx4 v162, s[36:39], s48 offen offset:2048 lds
    v_mfma_f32_32x32x16_bf16 v[112:127], a[196:199], a[16:19], 0
    ds_read_b64_tr_b16 a[220:221], v167 offset:4096
    ds_read_b64_tr_b16 a[222:223], v167 offset:5120
    buffer_load_dwordx4 v163, s[36:39], s48 offen offset:3072 lds
    s_add_u32 s48, s48, 524288
    v_mfma_f32_32x32x16_bf16 v[64:79], a[200:203], a[0:3], 0
    buffer_load_dwordx4 a[64:67], v168, s[12:15], s57 offen offset:0
    v_mfma_f32_32x32x16_bf16 v[128:143], a[200:203], a[16:19], 0
    buffer_load_dwordx4 a[68:71], v168, s[12:15], s57 offen offset:1024
    v_mfma_f32_32x32x16_bf16 v[80:95], a[204:207], a[0:3], 0
    buffer_load_dwordx4 a[72:75], v168, s[12:15], s57 offen offset:2048
    v_mfma_f32_32x32x16_bf16 v[144:159], a[204:207], a[16:19], 0
    buffer_load_dwordx4 a[76:79], v168, s[12:15], s57 offen offset:3072
    s_waitcnt lgkmcnt(0)
    v_mfma_f32_32x32x16_bf16 v[32:47], a[208:211], a[4:7], v[32:47]
    ds_read_b64_tr_b16 a[192:193], v164 offset:8192
    ds_read_b64_tr_b16 a[194:195], v164 offset:9216
    buffer_load_dwordx4 a[80:83], v168, s[12:15], s49 offen offset:0
    v_mfma_f32_32x32x16_bf16 v[96:111], a[208:211], a[20:23], v[96:111]
    ds_read_b64_tr_b16 a[196:197], v165 offset:8192
    ds_read_b64_tr_b16 a[198:199], v165 offset:9216
    buffer_load_dwordx4 a[84:87], v168, s[12:15], s49 offen offset:1024
    v_mfma_f32_32x32x16_bf16 v[48:63], a[212:215], a[4:7], v[48:63]
    ds_read_b64_tr_b16 a[200:201], v166 offset:8192
    ds_read_b64_tr_b16 a[202:203], v166 offset:9216
    buffer_load_dwordx4 a[88:91], v168, s[12:15], s49 offen offset:2048
    v_mfma_f32_32x32x16_bf16 v[112:127], a[212:215], a[20:23], v[112:127]
    ds_read_b64_tr_b16 a[204:205], v167 offset:8192
    ds_read_b64_tr_b16 a[206:207], v167 offset:9216
    buffer_load_dwordx4 a[92:95], v168, s[12:15], s49 offen offset:3072
    s_add_u32 s57, s57, 4096
    s_add_u32 s49, s49, 4096
    v_mfma_f32_32x32x16_bf16 v[64:79], a[216:219], a[4:7], v[64:79]
    s_add_u32 m0, s21, 147456
    s_nop 0
    buffer_load_dwordx4 v160, s[36:39], s48 offen offset:0 lds
    v_mfma_f32_32x32x16_bf16 v[128:143], a[216:219], a[20:23], v[128:143]
    buffer_load_dwordx4 v161, s[36:39], s48 offen offset:1024 lds
    v_mfma_f32_32x32x16_bf16 v[80:95], a[220:223], a[4:7], v[80:95]
    buffer_load_dwordx4 v162, s[36:39], s48 offen offset:2048 lds
    v_mfma_f32_32x32x16_bf16 v[144:159], a[220:223], a[20:23], v[144:159]
    buffer_load_dwordx4 v163, s[36:39], s48 offen offset:3072 lds
    s_add_u32 s48, s48, 524288
    s_waitcnt lgkmcnt(0)
    v_mfma_f32_32x32x16_bf16 v[32:47], a[192:195], a[8:11], v[32:47]
    ds_read_b64_tr_b16 a[208:209], v164 offset:12288
    ds_read_b64_tr_b16 a[210:211], v164 offset:13312
    buffer_load_dwordx4 a[96:99], v168, s[12:15], s57 offen offset:0
    v_mfma_f32_32x32x16_bf16 v[96:111], a[192:195], a[24:27], v[96:111]
    ds_read_b64_tr_b16 a[212:213], v165 offset:12288
    ds_read_b64_tr_b16 a[214:215], v165 offset:13312
    buffer_load_dwordx4 a[100:103], v168, s[12:15], s57 offen offset:1024
    v_mfma_f32_32x32x16_bf16 v[48:63], a[196:199], a[8:11], v[48:63]
    ds_read_b64_tr_b16 a[216:217], v166 offset:12288
    ds_read_b64_tr_b16 a[218:219], v166 offset:13312
    buffer_load_dwordx4 a[104:107], v168, s[12:15], s57 offen offset:2048
    v_mfma_f32_32x32x16_bf16 v[112:127], a[196:199], a[24:27], v[112:127]
    ds_read_b64_tr_b16 a[220:221], v167 offset:12288
    ds_read_b64_tr_b16 a[222:223], v167 offset:13312
    buffer_load_dwordx4 a[108:111], v168, s[12:15], s57 offen offset:3072
    v_mfma_f32_32x32x16_bf16 v[64:79], a[200:203], a[8:11], v[64:79]
    buffer_load_dwordx4 a[112:115], v168, s[12:15], s49 offen offset:0
    v_mfma_f32_32x32x16_bf16 v[128:143], a[200:203], a[24:27], v[128:143]
    buffer_load_dwordx4 a[116:119], v168, s[12:15], s49 offen offset:1024
    v_mfma_f32_32x32x16_bf16 v[80:95], a[204:207], a[8:11], v[80:95]
    buffer_load_dwordx4 a[120:123], v168, s[12:15], s49 offen offset:2048
    v_mfma_f32_32x32x16_bf16 v[144:159], a[204:207], a[24:27], v[144:159]
    buffer_load_dwordx4 a[124:127], v168, s[12:15], s49 offen offset:3072
    s_add_u32 s57, s57, 4096
    s_add_u32 s49, s49, 4096
    s_waitcnt vmcnt(24) lgkmcnt(0)
    s_barrier
    v_mfma_f32_32x32x16_bf16 v[32:47], a[208:211], a[12:15], v[32:47]
    ds_read_b64_tr_b16 a[192:193], v164 offset:16384
    ds_read_b64_tr_b16 a[194:195], v164 offset:17408
    v_mfma_f32_32x32x16_bf16 v[96:111], a[208:211], a[28:31], v[96:111]
    ds_read_b64_tr_b16 a[196:197], v165 offset:16384
    ds_read_b64_tr_b16 a[198:199], v165 offset:17408
    v_mfma_f32_32x32x16_bf16 v[48:63], a[212:215], a[12:15], v[48:63]
    ds_read_b64_tr_b16 a[200:201], v166 offset:16384
    ds_read_b64_tr_b16 a[202:203], v166 offset:17408
    v_mfma_f32_32x32x16_bf16 v[112:127], a[212:215], a[28:31], v[112:127]
    ds_read_b64_tr_b16 a[204:205], v167 offset:16384
    ds_read_b64_tr_b16 a[206:207], v167 offset:17408
    v_mfma_f32_32x32x16_bf16 v[64:79], a[216:219], a[12:15], v[64:79]
    v_mfma_f32_32x32x16_bf16 v[128:143], a[216:219], a[28:31], v[128:143]
    v_mfma_f32_32x32x16_bf16 v[80:95], a[220:223], a[12:15], v[80:95]
    v_mfma_f32_32x32x16_bf16 v[144:159], a[220:223], a[28:31], v[144:159]
    s_add_u32 m0, s21, 98304
    s_nop 0
    buffer_load_dwordx4 v160, s[36:39], s48 offen offset:0 lds
    s_waitcnt lgkmcnt(0)
    v_mfma_f32_32x32x16_bf16 v[32:47], a[192:195], a[32:35], v[32:47]
    ds_read_b64_tr_b16 a[208:209], v164 offset:20480
    ds_read_b64_tr_b16 a[210:211], v164 offset:21504
    v_mfma_f32_32x32x16_bf16 v[96:111], a[192:195], a[48:51], v[96:111]
    ds_read_b64_tr_b16 a[212:213], v165 offset:20480
    ds_read_b64_tr_b16 a[214:215], v165 offset:21504
    v_mfma_f32_32x32x16_bf16 v[48:63], a[196:199], a[32:35], v[48:63]
    ds_read_b64_tr_b16 a[216:217], v166 offset:20480
    ds_read_b64_tr_b16 a[218:219], v166 offset:21504
    v_mfma_f32_32x32x16_bf16 v[112:127], a[196:199], a[48:51], v[112:127]
    ds_read_b64_tr_b16 a[220:221], v167 offset:20480
    ds_read_b64_tr_b16 a[222:223], v167 offset:21504
    v_mfma_f32_32x32x16_bf16 v[64:79], a[200:203], a[32:35], v[64:79]
    buffer_load_dwordx4 v161, s[36:39], s48 offen offset:1024 lds
    v_mfma_f32_32x32x16_bf16 v[128:143], a[200:203], a[48:51], v[128:143]
    buffer_load_dwordx4 v162, s[36:39], s48 offen offset:2048 lds
    v_mfma_f32_32x32x16_bf16 v[80:95], a[204:207], a[32:35], v[80:95]
    buffer_load_dwordx4 v163, s[36:39], s48 offen offset:3072 lds
    s_add_u32 s48, s48, 524288
    v_mfma_f32_32x32x16_bf16 v[144:159], a[204:207], a[48:51], v[144:159]
    buffer_load_dwordx4 a[0:3], v168, s[12:15], s57 offen offset:0
    s_waitcnt lgkmcnt(0)
    v_mfma_f32_32x32x16_bf16 v[32:47], a[208:211], a[36:39], v[32:47]
    ds_read_b64_tr_b16 a[192:193], v164 offset:24576
    ds_read_b64_tr_b16 a[194:195], v164 offset:25600
    v_mfma_f32_32x32x16_bf16 v[96:111], a[208:211], a[52:55], v[96:111]
    ds_read_b64_tr_b16 a[196:197], v165 offset:24576
    ds_read_b64_tr_b16 a[198:199], v165 offset:25600
    v_mfma_f32_32x32x16_bf16 v[48:63], a[212:215], a[36:39], v[48:63]
    ds_read_b64_tr_b16 a[200:201], v166 offset:24576
    ds_read_b64_tr_b16 a[202:203], v166 offset:25600
    v_mfma_f32_32x32x16_bf16 v[112:127], a[212:215], a[52:55], v[112:127]
    ds_read_b64_tr_b16 a[204:205], v167 offset:24576
    ds_read_b64_tr_b16 a[206:207], v167 offset:25600
    v_mfma_f32_32x32x16_bf16 v[64:79], a[216:219], a[36:39], v[64:79]
    buffer_load_dwordx4 a[4:7], v168, s[12:15], s57 offen offset:1024
    v_mfma_f32_32x32x16_bf16 v[128:143], a[216:219], a[52:55], v[128:143]
    buffer_load_dwordx4 a[8:11], v168, s[12:15], s57 offen offset:2048
    v_mfma_f32_32x32x16_bf16 v[80:95], a[220:223], a[36:39], v[80:95]
    buffer_load_dwordx4 a[12:15], v168, s[12:15], s57 offen offset:3072
    v_mfma_f32_32x32x16_bf16 v[144:159], a[220:223], a[52:55], v[144:159]
    buffer_load_dwordx4 a[16:19], v168, s[12:15], s49 offen offset:0
    s_waitcnt lgkmcnt(0)
    v_mfma_f32_32x32x16_bf16 v[32:47], a[192:195], a[40:43], v[32:47]
    ds_read_b64_tr_b16 a[208:209], v164 offset:28672
    ds_read_b64_tr_b16 a[210:211], v164 offset:29696
    v_mfma_f32_32x32x16_bf16 v[96:111], a[192:195], a[56:59], v[96:111]
    ds_read_b64_tr_b16 a[212:213], v165 offset:28672
    ds_read_b64_tr_b16 a[214:215], v165 offset:29696
    v_mfma_f32_32x32x16_bf16 v[48:63], a[196:199], a[40:43], v[48:63]
    ds_read_b64_tr_b16 a[216:217], v166 offset:28672
    ds_read_b64_tr_b16 a[218:219], v166 offset:29696
    v_mfma_f32_32x32x16_bf16 v[112:127], a[196:199], a[56:59], v[112:127]
    ds_read_b64_tr_b16 a[220:221], v167 offset:28672
    ds_read_b64_tr_b16 a[222:223], v167 offset:29696
    v_mfma_f32_32x32x16_bf16 v[64:79], a[200:203], a[40:43], v[64:79]
    v_mfma_f32_32x32x16_bf16 v[128:143], a[200:203], a[56:59], v[128:143]
    buffer_load_dwordx4 a[20:23], v168, s[12:15], s49 offen offset:1024
    v_mfma_f32_32x32x16_bf16 v[80:95], a[204:207], a[40:43], v[80:95]
    buffer_load_dwordx4 a[24:27], v168, s[12:15], s49 offen offset:2048
    v_mfma_f32_32x32x16_bf16 v[144:159], a[204:207], a[56:59], v[144:159]
    buffer_load_dwordx4 a[28:31], v168, s[12:15], s49 offen offset:3072
    s_add_u32 s57, s57, 4096
    s_add_u32 s49, s49, 4096
    s_waitcnt vmcnt(24) lgkmcnt(0)
    s_barrier
    v_mfma_f32_32x32x16_bf16 v[32:47], a[208:211], a[44:47], v[32:47]
    ds_read_b64_tr_b16 a[192:193], v164 offset:32768
    ds_read_b64_tr_b16 a[194:195], v164 offset:33792
    v_mfma_f32_32x32x16_bf16 v[96:111], a[208:211], a[60:63], v[96:111]
    ds_read_b64_tr_b16 a[196:197], v165 offset:32768
    ds_read_b64_tr_b16 a[198:199], v165 offset:33792
    v_mfma_f32_32x32x16_bf16 v[48:63], a[212:215], a[44:47], v[48:63]
    ds_read_b64_tr_b16 a[200:201], v166 offset:32768
    ds_read_b64_tr_b16 a[202:203], v166 offset:33792
    v_mfma_f32_32x32x16_bf16 v[112:127], a[212:215], a[60:63], v[112:127]
    ds_read_b64_tr_b16 a[204:205], v167 offset:32768
    ds_read_b64_tr_b16 a[206:207], v167 offset:33792
    v_mfma_f32_32x32x16_bf16 v[64:79], a[216:219], a[44:47], v[64:79]
    v_mfma_f32_32x32x16_bf16 v[128:143], a[216:219], a[60:63], v[128:143]
    v_mfma_f32_32x32x16_bf16 v[80:95], a[220:223], a[44:47], v[80:95]
    v_mfma_f32_32x32x16_bf16 v[144:159], a[220:223], a[60:63], v[144:159]
    s_add_u32 m0, s21, 114688
    s_nop 0
    buffer_load_dwordx4 v160, s[36:39], s48 offen offset:0 lds
    s_waitcnt lgkmcnt(0)
    v_mfma_f32_32x32x16_bf16 v[32:47], a[192:195], a[64:67], v[32:47]
    ds_read_b64_tr_b16 a[208:209], v164 offset:36864
    ds_read_b64_tr_b16 a[210:211], v164 offset:37888
    v_mfma_f32_32x32x16_bf16 v[96:111], a[192:195], a[80:83], v[96:111]
    ds_read_b64_tr_b16 a[212:213], v165 offset:36864
    ds_read_b64_tr_b16 a[214:215], v165 offset:37888
    v_mfma_f32_32x32x16_bf16 v[48:63], a[196:199], a[64:67], v[48:63]
    ds_read_b64_tr_b16 a[216:217], v166 offset:36864
    ds_read_b64_tr_b16 a[218:219], v166 offset:37888
    v_mfma_f32_32x32x16_bf16 v[112:127], a[196:199], a[80:83], v[112:127]
    ds_read_b64_tr_b16 a[220:221], v167 offset:36864
    ds_read_b64_tr_b16 a[222:223], v167 offset:37888
    buffer_load_dwordx4 v161, s[36:39], s48 offen offset:1024 lds
    v_mfma_f32_32x32x16_bf16 v[64:79], a[200:203], a[64:67], v[64:79]
    buffer_load_dwordx4 v162, s[36:39], s48 offen offset:2048 lds
    v_mfma_f32_32x32x16_bf16 v[128:143], a[200:203], a[80:83], v[128:143]
    buffer_load_dwordx4 v163, s[36:39], s48 offen offset:3072 lds
    s_add_u32 s48, s48, 524288
    v_mfma_f32_32x32x16_bf16 v[80:95], a[204:207], a[64:67], v[80:95]
    buffer_load_dwordx4 a[32:35], v168, s[12:15], s57 offen offset:0
    v_mfma_f32_32x32x16_bf16 v[144:159], a[204:207], a[80:83], v[144:159]
    buffer_load_dwordx4 a[36:39], v168, s[12:15], s57 offen offset:1024
    s_waitcnt lgkmcnt(0)
    v_mfma_f32_32x32x16_bf16 v[32:47], a[208:211], a[68:71], v[32:47]
    ds_read_b64_tr_b16 a[192:193], v164 offset:40960
    ds_read_b64_tr_b16 a[194:195], v164 offset:41984
    v_mfma_f32_32x32x16_bf16 v[96:111], a[208:211], a[84:87], v[96:111]
    ds_read_b64_tr_b16 a[196:197], v165 offset:40960
    ds_read_b64_tr_b16 a[198:199], v165 offset:41984
    v_mfma_f32_32x32x16_bf16 v[48:63], a[212:215], a[68:71], v[48:63]
    ds_read_b64_tr_b16 a[200:201], v166 offset:40960
    ds_read_b64_tr_b16 a[202:203], v166 offset:41984
    v_mfma_f32_32x32x16_bf16 v[112:127], a[212:215], a[84:87], v[112:127]
    ds_read_b64_tr_b16 a[204:205], v167 offset:40960
    ds_read_b64_tr_b16 a[206:207], v167 offset:41984
    buffer_load_dwordx4 a[40:43], v168, s[12:15], s57 offen offset:2048
    v_mfma_f32_32x32x16_bf16 v[64:79], a[216:219], a[68:71], v[64:79]
    buffer_load_dwordx4 a[44:47], v168, s[12:15], s57 offen offset:3072
    v_mfma_f32_32x32x16_bf16 v[128:143], a[216:219], a[84:87], v[128:143]
    buffer_load_dwordx4 a[48:51], v168, s[12:15], s49 offen offset:0
    v_mfma_f32_32x32x16_bf16 v[80:95], a[220:223], a[68:71], v[80:95]
    buffer_load_dwordx4 a[52:55], v168, s[12:15], s49 offen offset:1024
    v_mfma_f32_32x32x16_bf16 v[144:159], a[220:223], a[84:87], v[144:159]
    buffer_load_dwordx4 a[56:59], v168, s[12:15], s49 offen offset:2048
    s_waitcnt lgkmcnt(0)
    v_mfma_f32_32x32x16_bf16 v[32:47], a[192:195], a[72:75], v[32:47]
    ds_read_b64_tr_b16 a[208:209], v164 offset:45056
    ds_read_b64_tr_b16 a[210:211], v164 offset:46080
    v_mfma_f32_32x32x16_bf16 v[96:111], a[192:195], a[88:91], v[96:111]
    ds_read_b64_tr_b16 a[212:213], v165 offset:45056
    ds_read_b64_tr_b16 a[214:215], v165 offset:46080
    v_mfma_f32_32x32x16_bf16 v[48:63], a[196:199], a[72:75], v[48:63]
    ds_read_b64_tr_b16 a[216:217], v166 offset:45056
    ds_read_b64_tr_b16 a[218:219], v166 offset:46080
    v_mfma_f32_32x32x16_bf16 v[112:127], a[196:199], a[88:91], v[112:127]
    ds_read_b64_tr_b16 a[220:221], v167 offset:45056
    ds_read_b64_tr_b16 a[222:223], v167 offset:46080
    buffer_load_dwordx4 a[60:63], v168, s[12:15], s49 offen offset:3072
    s_add_u32 s57, s57, 4096
    s_add_u32 s49, s49, 4096
    v_mfma_f32_32x32x16_bf16 v[64:79], a[200:203], a[72:75], v[64:79]
    s_mov_b32 s58, 55296
    buffer_load_dwordx4 v[180:183], v235, s[40:43], s58 offen
    v_mfma_f32_32x32x16_bf16 v[128:143], a[200:203], a[88:91], v[128:143]
    s_mov_b32 s58, 71680
    buffer_load_dwordx4 v[184:187], v235, s[40:43], s58 offen
    v_mfma_f32_32x32x16_bf16 v[80:95], a[204:207], a[72:75], v[80:95]
    s_mov_b32 s58, 88064
    buffer_load_dwordx4 v[188:191], v235, s[40:43], s58 offen
    v_mfma_f32_32x32x16_bf16 v[144:159], a[204:207], a[88:91], v[144:159]
    s_mov_b32 s58, 104448
    buffer_load_dwordx4 v[192:195], v235, s[40:43], s58 offen
    s_waitcnt vmcnt(28) lgkmcnt(0)
    s_barrier
    v_mfma_f32_32x32x16_bf16 v[32:47], a[208:211], a[76:79], v[32:47]
    ds_read_b64_tr_b16 a[192:193], v164 offset:49152
    ds_read_b64_tr_b16 a[194:195], v164 offset:50176
    v_mfma_f32_32x32x16_bf16 v[96:111], a[208:211], a[92:95], v[96:111]
    ds_read_b64_tr_b16 a[196:197], v165 offset:49152
    ds_read_b64_tr_b16 a[198:199], v165 offset:50176
    v_mfma_f32_32x32x16_bf16 v[48:63], a[212:215], a[76:79], v[48:63]
    ds_read_b64_tr_b16 a[200:201], v166 offset:49152
    ds_read_b64_tr_b16 a[202:203], v166 offset:50176
    v_mfma_f32_32x32x16_bf16 v[112:127], a[212:215], a[92:95], v[112:127]
    ds_read_b64_tr_b16 a[204:205], v167 offset:49152
    ds_read_b64_tr_b16 a[206:207], v167 offset:50176
    v_mfma_f32_32x32x16_bf16 v[64:79], a[216:219], a[76:79], v[64:79]
    v_mfma_f32_32x32x16_bf16 v[128:143], a[216:219], a[92:95], v[128:143]
    v_mfma_f32_32x32x16_bf16 v[80:95], a[220:223], a[76:79], v[80:95]
    v_mfma_f32_32x32x16_bf16 v[144:159], a[220:223], a[92:95], v[144:159]
    s_add_u32 m0, s21, 131072
    s_nop 0
    buffer_load_dwordx4 v160, s[36:39], s48 offen offset:0 lds
    s_waitcnt lgkmcnt(0)
    v_mfma_f32_32x32x16_bf16 v[32:47], a[192:195], a[96:99], v[32:47]
    ds_read_b64_tr_b16 a[208:209], v164 offset:53248
    ds_read_b64_tr_b16 a[210:211], v164 offset:54272
    v_mfma_f32_32x32x16_bf16 v[96:111], a[192:195], a[112:115], v[96:111]
    ds_read_b64_tr_b16 a[212:213], v165 offset:53248
    ds_read_b64_tr_b16 a[214:215], v165 offset:54272
    v_mfma_f32_32x32x16_bf16 v[48:63], a[196:199], a[96:99], v[48:63]
    ds_read_b64_tr_b16 a[216:217], v166 offset:53248
    ds_read_b64_tr_b16 a[218:219], v166 offset:54272
    v_mfma_f32_32x32x16_bf16 v[112:127], a[196:199], a[112:115], v[112:127]
    ds_read_b64_tr_b16 a[220:221], v167 offset:53248
    ds_read_b64_tr_b16 a[222:223], v167 offset:54272
    v_mfma_f32_32x32x16_bf16 v[64:79], a[200:203], a[96:99], v[64:79]
    buffer_load_dwordx4 v161, s[36:39], s48 offen offset:1024 lds
    v_mfma_f32_32x32x16_bf16 v[128:143], a[200:203], a[112:115], v[128:143]
    buffer_load_dwordx4 v162, s[36:39], s48 offen offset:2048 lds
    v_mfma_f32_32x32x16_bf16 v[80:95], a[204:207], a[96:99], v[80:95]
    buffer_load_dwordx4 v163, s[36:39], s48 offen offset:3072 lds
    s_add_u32 s48, s48, 524288
    v_mfma_f32_32x32x16_bf16 v[144:159], a[204:207], a[112:115], v[144:159]
    buffer_load_dwordx4 a[64:67], v168, s[12:15], s57 offen offset:0
    s_waitcnt lgkmcnt(0)
    v_mfma_f32_32x32x16_bf16 v[32:47], a[208:211], a[100:103], v[32:47]
    ds_read_b64_tr_b16 a[192:193], v164 offset:57344
    ds_read_b64_tr_b16 a[194:195], v164 offset:58368
    v_mfma_f32_32x32x16_bf16 v[96:111], a[208:211], a[116:119], v[96:111]
    ds_read_b64_tr_b16 a[196:197], v165 offset:57344
    ds_read_b64_tr_b16 a[198:199], v165 offset:58368
    v_mfma_f32_32x32x16_bf16 v[48:63], a[212:215], a[100:103], v[48:63]
    ds_read_b64_tr_b16 a[200:201], v166 offset:57344
    ds_read_b64_tr_b16 a[202:203], v166 offset:58368
    v_mfma_f32_32x32x16_bf16 v[112:127], a[212:215], a[116:119], v[112:127]
    ds_read_b64_tr_b16 a[204:205], v167 offset:57344
    ds_read_b64_tr_b16 a[206:207], v167 offset:58368
    v_mfma_f32_32x32x16_bf16 v[64:79], a[216:219], a[100:103], v[64:79]
    buffer_load_dwordx4 a[68:71], v168, s[12:15], s57 offen offset:1024
    v_mfma_f32_32x32x16_bf16 v[128:143], a[216:219], a[116:119], v[128:143]
    buffer_load_dwordx4 a[72:75], v168, s[12:15], s57 offen offset:2048
    v_mfma_f32_32x32x16_bf16 v[80:95], a[220:223], a[100:103], v[80:95]
    buffer_load_dwordx4 a[76:79], v168, s[12:15], s57 offen offset:3072
    v_mfma_f32_32x32x16_bf16 v[144:159], a[220:223], a[116:119], v[144:159]
    buffer_load_dwordx4 a[80:83], v168, s[12:15], s49 offen offset:0
    s_waitcnt lgkmcnt(0)
    v_mfma_f32_32x32x16_bf16 v[32:47], a[192:195], a[104:107], v[32:47]
    ds_read_b64_tr_b16 a[208:209], v164 offset:61440
    ds_read_b64_tr_b16 a[210:211], v164 offset:62464
    v_mfma_f32_32x32x16_bf16 v[96:111], a[192:195], a[120:123], v[96:111]
    ds_read_b64_tr_b16 a[212:213], v165 offset:61440
    ds_read_b64_tr_b16 a[214:215], v165 offset:62464
    v_mfma_f32_32x32x16_bf16 v[48:63], a[196:199], a[104:107], v[48:63]
    ds_read_b64_tr_b16 a[216:217], v166 offset:61440
    ds_read_b64_tr_b16 a[218:219], v166 offset:62464
    v_mfma_f32_32x32x16_bf16 v[112:127], a[196:199], a[120:123], v[112:127]
    ds_read_b64_tr_b16 a[220:221], v167 offset:61440
    ds_read_b64_tr_b16 a[222:223], v167 offset:62464
    v_mfma_f32_32x32x16_bf16 v[64:79], a[200:203], a[104:107], v[64:79]
    v_mfma_f32_32x32x16_bf16 v[128:143], a[200:203], a[120:123], v[128:143]
    buffer_load_dwordx4 a[84:87], v168, s[12:15], s49 offen offset:1024
    v_mfma_f32_32x32x16_bf16 v[80:95], a[204:207], a[104:107], v[80:95]
    buffer_load_dwordx4 a[88:91], v168, s[12:15], s49 offen offset:2048
    v_mfma_f32_32x32x16_bf16 v[144:159], a[204:207], a[120:123], v[144:159]
    buffer_load_dwordx4 a[92:95], v168, s[12:15], s49 offen offset:3072
    s_add_u32 s57, s57, 4096
    s_add_u32 s49, s49, 4096
    s_waitcnt vmcnt(28) lgkmcnt(0)
    s_barrier
    v_mfma_f32_32x32x16_bf16 v[32:47], a[208:211], a[108:111], v[32:47]
    ds_read_b64_tr_b16 a[192:193], v164 offset:0
    ds_read_b64_tr_b16 a[194:195], v164 offset:1024
    v_mfma_f32_32x32x16_bf16 v[96:111], a[208:211], a[124:127], v[96:111]
    ds_read_b64_tr_b16 a[196:197], v165 offset:0
    ds_read_b64_tr_b16 a[198:199], v165 offset:1024
    v_mfma_f32_32x32x16_bf16 v[48:63], a[212:215], a[108:111], v[48:63]
    ds_read_b64_tr_b16 a[200:201], v166 offset:0
    ds_read_b64_tr_b16 a[202:203], v166 offset:1024
    v_mfma_f32_32x32x16_bf16 v[112:127], a[212:215], a[124:127], v[112:127]
    ds_read_b64_tr_b16 a[204:205], v167 offset:0
    ds_read_b64_tr_b16 a[206:207], v167 offset:1024
    v_mfma_f32_32x32x16_bf16 v[64:79], a[216:219], a[108:111], v[64:79]
    v_mfma_f32_32x32x16_bf16 v[128:143], a[216:219], a[124:127], v[128:143]
    v_mfma_f32_32x32x16_bf16 v[80:95], a[220:223], a[108:111], v[80:95]
    v_mfma_f32_32x32x16_bf16 v[144:159], a[220:223], a[124:127], v[144:159]
    s_add_u32 m0, s21, 147456
    s_nop 0
    buffer_load_dwordx4 v160, s[36:39], s48 offen offset:0 lds
    s_waitcnt lgkmcnt(0)
    v_mfma_f32_32x32x16_bf16 v[32:47], a[192:195], a[0:3], v[32:47]
    ds_read_b64_tr_b16 a[208:209], v164 offset:4096
    ds_read_b64_tr_b16 a[210:211], v164 offset:5120
    s_waitcnt vmcnt(13)
    v_cndmask_b32 v192, 0, v192, s[54:55]
    v_cndmask_b32 v193, 0, v193, s[54:55]
    v_cndmask_b32 v194, 0, v194, s[54:55]
    v_mfma_f32_32x32x16_bf16 v[96:111], a[192:195], a[16:19], v[96:111]
    ds_read_b64_tr_b16 a[212:213], v165 offset:4096
    ds_read_b64_tr_b16 a[214:215], v165 offset:5120
    v_cndmask_b32 v195, 0, v195, s[54:55]
    v_lshlrev_b32 v196, 16, v180
    v_and_b32 v197, s52, v180
    v_lshlrev_b32 v198, 16, v181
    v_mfma_f32_32x32x16_bf16 v[48:63], a[196:199], a[0:3], v[48:63]
    ds_read_b64_tr_b16 a[216:217], v166 offset:4096
    ds_read_b64_tr_b16 a[218:219], v166 offset:5120
    v_and_b32 v199, s52, v181
    v_lshlrev_b32 v200, 16, v182
    v_and_b32 v201, s52, v182
    v_lshlrev_b32 v202, 16, v183
    v_mfma_f32_32x32x16_bf16 v[112:127], a[196:199], a[16:19], v[112:127]
    ds_read_b64_tr_b16 a[220:221], v167 offset:4096
    ds_read_b64_tr_b16 a[222:223], v167 offset:5120
    v_and_b32 v203, s52, v183
    v_lshlrev_b32 v204, 16, v184
    v_and_b32 v205, s52, v184
    v_lshlrev_b32 v206, 16, v185
    v_mfma_f32_32x32x16_bf16 v[64:79], a[200:203], a[0:3], v[64:79]
    buffer_load_dwordx4 v161, s[36:39], s48 offen offset:1024 lds
    v_and_b32 v207, s52, v185
    v_lshlrev_b32 v208, 16, v186
    v_mfma_f32_32x32x16_bf16 v[128:143], a[200:203], a[16:19], v[128:143]
    buffer_load_dwordx4 v162, s[36:39], s48 offen offset:2048 lds
    v_and_b32 v209, s52, v186
    v_lshlrev_b32 v210, 16, v187
    v_mfma_f32_32x32x16_bf16 v[80:95], a[204:207], a[0:3], v[80:95]
    buffer_load_dwordx4 v163, s[36:39], s48 offen offset:3072 lds
    s_add_u32 s48, s48, 524288
    v_and_b32 v211, s52, v187
    v_lshlrev_b32 v212, 16, v188
    v_mfma_f32_32x32x16_bf16 v[144:159], a[204:207], a[16:19], v[144:159]
    buffer_load_dwordx4 a[96:99], v168, s[12:15], s57 offen offset:0
    v_and_b32 v213, s52, v188
    v_lshlrev_b32 v214, 16, v189
    s_waitcnt lgkmcnt(0)
    v_mfma_f32_32x32x16_bf16 v[32:47], a[208:211], a[4:7], v[32:47]
    ds_read_b64_tr_b16 a[192:193], v164 offset:8192
    ds_read_b64_tr_b16 a[194:195], v164 offset:9216
    v_and_b32 v215, s52, v189
    v_lshlrev_b32 v216, 16, v190
    v_and_b32 v217, s52, v190
    v_lshlrev_b32 v218, 16, v191
    v_mfma_f32_32x32x16_bf16 v[96:111], a[208:211], a[20:23], v[96:111]
    ds_read_b64_tr_b16 a[196:197], v165 offset:8192
    ds_read_b64_tr_b16 a[198:199], v165 offset:9216
    v_and_b32 v219, s52, v191
    v_lshlrev_b32 v220, 16, v192
    v_and_b32 v221, s52, v192
    v_lshlrev_b32 v222, 16, v193
    v_mfma_f32_32x32x16_bf16 v[48:63], a[212:215], a[4:7], v[48:63]
    ds_read_b64_tr_b16 a[200:201], v166 offset:8192
    ds_read_b64_tr_b16 a[202:203], v166 offset:9216
    v_and_b32 v223, s52, v193
    v_lshlrev_b32 v224, 16, v194
    v_and_b32 v225, s52, v194
    v_lshlrev_b32 v226, 16, v195
    v_mfma_f32_32x32x16_bf16 v[112:127], a[212:215], a[20:23], v[112:127]
    ds_read_b64_tr_b16 a[204:205], v167 offset:8192
    ds_read_b64_tr_b16 a[206:207], v167 offset:9216
    v_and_b32 v227, s52, v195
    v_add_f32 v228, v196, v197
    v_add_f32 v229, v198, v199
    v_add_f32 v228, v228, v200
    v_mfma_f32_32x32x16_bf16 v[64:79], a[216:219], a[4:7], v[64:79]
    buffer_load_dwordx4 a[100:103], v168, s[12:15], s57 offen offset:1024
    v_add_f32 v229, v229, v201
    v_add_f32 v228, v228, v202
    v_mfma_f32_32x32x16_bf16 v[128:143], a[216:219], a[20:23], v[128:143]
    buffer_load_dwordx4 a[104:107], v168, s[12:15], s57 offen offset:2048
    v_add_f32 v229, v229, v203
    v_add_f32 v228, v228, v204
    v_mfma_f32_32x32x16_bf16 v[80:95], a[220:223], a[4:7], v[80:95]
    buffer_load_dwordx4 a[108:111], v168, s[12:15], s57 offen offset:3072
    v_add_f32 v229, v229, v205
    v_add_f32 v228, v228, v206
    v_mfma_f32_32x32x16_bf16 v[144:159], a[220:223], a[20:23], v[144:159]
    buffer_load_dwordx4 a[112:115], v168, s[12:15], s49 offen offset:0
    v_add_f32 v229, v229, v207
    v_add_f32 v228, v228, v208
    s_waitcnt lgkmcnt(0)
    v_mfma_f32_32x32x16_bf16 v[32:47], a[192:195], a[8:11], v[32:47]
    ds_read_b64_tr_b16 a[208:209], v164 offset:12288
    ds_read_b64_tr_b16 a[210:211], v164 offset:13312
    v_add_f32 v229, v229, v209
    v_add_f32 v228, v228, v210
    v_add_f32 v229, v229, v211
    v_add_f32 v228, v228, v212
    v_mfma_f32_32x32x16_bf16 v[96:111], a[192:195], a[24:27], v[96:111]
    ds_read_b64_tr_b16 a[212:213], v165 offset:12288
    ds_read_b64_tr_b16 a[214:215], v165 offset:13312
    v_add_f32 v229, v229, v213
    v_add_f32 v228, v228, v214
    v_add_f32 v229, v229, v215
    v_add_f32 v228, v228, v216
    v_mfma_f32_32x32x16_bf16 v[48:63], a[196:199], a[8:11], v[48:63]
    ds_read_b64_tr_b16 a[216:217], v166 offset:12288
    ds_read_b64_tr_b16 a[218:219], v166 offset:13312
    v_add_f32 v229, v229, v217
    v_add_f32 v228, v228, v218
    v_add_f32 v229, v229, v219
    v_add_f32 v228, v228, v220
    v_mfma_f32_32x32x16_bf16 v[112:127], a[196:199], a[24:27], v[112:127]
    ds_read_b64_tr_b16 a[220:221], v167 offset:12288
    ds_read_b64_tr_b16 a[222:223], v167 offset:13312
    v_add_f32 v229, v229, v221
    v_add_f32 v228, v228, v222
    v_add_f32 v229, v229, v223
    v_add_f32 v228, v228, v224
    v_mfma_f32_32x32x16_bf16 v[64:79], a[200:203], a[8:11], v[64:79]
    v_add_f32 v229, v229, v225
    v_add_f32 v228, v228, v226
    v_add_f32 v229, v229, v227
    v_add_f32 v228, v228, v229
    ds_swizzle_b32 v232, v228 offset:0x81f
    s_waitcnt lgkmcnt(0)
    v_mfma_f32_32x32x16_bf16 v[128:143], a[200:203], a[24:27], v[128:143]
    buffer_load_dwordx4 a[116:119], v168, s[12:15], s49 offen offset:1024
    v_add_f32 v228, v228, v232
    ds_swizzle_b32 v232, v228 offset:0x101f
    v_mfma_f32_32x32x16_bf16 v[80:95], a[204:207], a[8:11], v[80:95]
    buffer_load_dwordx4 a[120:123], v168, s[12:15], s49 offen offset:2048
    s_waitcnt lgkmcnt(0)
    v_add_f32 v228, v228, v232
    v_mfma_f32_32x32x16_bf16 v[144:159], a[204:207], a[24:27], v[144:159]
    buffer_load_dwordx4 a[124:127], v168, s[12:15], s49 offen offset:3072
    s_add_u32 s57, s57, 4096
    s_add_u32 s49, s49, 4096
    ds_swizzle_b32 v232, v228 offset:0x201f
    s_waitcnt lgkmcnt(0)
    s_waitcnt vmcnt(28) lgkmcnt(0)
    s_barrier
    v_mfma_f32_32x32x16_bf16 v[32:47], a[208:211], a[12:15], v[32:47]
    ds_read_b64_tr_b16 a[192:193], v164 offset:16384
    ds_read_b64_tr_b16 a[194:195], v164 offset:17408
    v_add_f32 v228, v228, v232
    ds_swizzle_b32 v232, v228 offset:0x401f
    s_waitcnt lgkmcnt(0)
    v_add_f32 v228, v228, v232
    v_mfma_f32_32x32x16_bf16 v[96:111], a[208:211], a[28:31], v[96:111]
    ds_read_b64_tr_b16 a[196:197], v165 offset:16384
    ds_read_b64_tr_b16 a[198:199], v165 offset:17408
    v_mov_b32 v232, v228
    s_nop 1
    v_permlane32_swap_b32 v232, v228
    s_nop 1
    v_mfma_f32_32x32x16_bf16 v[48:63], a[212:215], a[12:15], v[48:63]
    ds_read_b64_tr_b16 a[200:201], v166 offset:16384
    ds_read_b64_tr_b16 a[202:203], v166 offset:17408
    v_add_f32 v228, v228, v232
    s_mov_b32 s53, 0x3a97b426
    v_mul_f32 v228, s53, v228
    v_mov_b32 v229, 0
    v_mfma_f32_32x32x16_bf16 v[112:127], a[212:215], a[28:31], v[112:127]
    ds_read_b64_tr_b16 a[204:205], v167 offset:16384
    ds_read_b64_tr_b16 a[206:207], v167 offset:17408
    v_mov_b32 v230, 0
    v_sub_f32 v233, v196, v228
    v_fmac_f32 v229, v233, v233
    v_sub_f32 v234, v197, v228
    v_mfma_f32_32x32x16_bf16 v[64:79], a[216:219], a[12:15], v[64:79]
    v_fmac_f32 v230, v234, v234
    v_sub_f32 v233, v198, v228
    v_fmac_f32 v229, v233, v233
    v_sub_f32 v234, v199, v228
    v_fmac_f32 v230, v234, v234
    v_sub_f32 v233, v200, v228
    v_mfma_f32_32x32x16_bf16 v[128:143], a[216:219], a[28:31], v[128:143]
    v_fmac_f32 v229, v233, v233
    v_sub_f32 v234, v201, v228
    v_fmac_f32 v230, v234, v234
    v_sub_f32 v233, v202, v228
    v_fmac_f32 v229, v233, v233
    v_sub_f32 v234, v203, v228
    v_mfma_f32_32x32x16_bf16 v[80:95], a[220:223], a[12:15], v[80:95]
    v_fmac_f32 v230, v234, v234
    v_sub_f32 v233, v204, v228
    v_fmac_f32 v229, v233, v233
    v_sub_f32 v234, v205, v228
    v_fmac_f32 v230, v234, v234
    v_sub_f32 v233, v206, v228
    v_mfma_f32_32x32x16_bf16 v[144:159], a[220:223], a[28:31], v[144:159]
    s_add_u32 m0, s21, 98304
    s_nop 0
    buffer_load_dwordx4 v160, s[36:39], s48 offen offset:0 lds
    v_fmac_f32 v229, v233, v233
    v_sub_f32 v234, v207, v228
    s_waitcnt lgkmcnt(0)
    v_mfma_f32_32x32x16_bf16 v[32:47], a[192:195], a[32:35], v[32:47]
    ds_read_b64_tr_b16 a[208:209], v164 offset:20480
    ds_read_b64_tr_b16 a[210:211], v164 offset:21504
    v_fmac_f32 v230, v234, v234
    v_sub_f32 v233, v208, v228
    v_fmac_f32 v229, v233, v233
    v_sub_f32 v234, v209, v228
    v_mfma_f32_32x32x16_bf16 v[96:111], a[192:195], a[48:51], v[96:111]
    ds_read_b64_tr_b16 a[212:213], v165 offset:20480
    ds_read_b64_tr_b16 a[214:215], v165 offset:21504
    v_fmac_f32 v230, v234, v234
    v_sub_f32 v233, v210, v228
    v_fmac_f32 v229, v233, v233
    v_sub_f32 v234, v211, v228
    v_mfma_f32_32x32x16_bf16 v[48:63], a[196:199], a[32:35], v[48:63]
    ds_read_b64_tr_b16 a[216:217], v166 offset:20480
    ds_read_b64_tr_b16 a[218:219], v166 offset:21504
    v_fmac_f32 v230, v234, v234
    v_sub_f32 v233, v212, v228
    v_fmac_f32 v229, v233, v233
    v_sub_f32 v234, v213, v228
    v_mfma_f32_32x32x16_bf16 v[112:127], a[196:199], a[48:51], v[112:127]
    ds_read_b64_tr_b16 a[220:221], v167 offset:20480
    ds_read_b64_tr_b16 a[222:223], v167 offset:21504
    v_fmac_f32 v230, v234, v234
    v_sub_f32 v233, v214, v228
    v_fmac_f32 v229, v233, v233
    v_sub_f32 v234, v215, v228
    v_mfma_f32_32x32x16_bf16 v[64:79], a[200:203], a[32:35], v[64:79]
    buffer_load_dwordx4 v161, s[36:39], s48 offen offset:1024 lds
    v_fmac_f32 v230, v234, v234
    v_sub_f32 v233, v216, v228
    v_mfma_f32_32x32x16_bf16 v[128:143], a[200:203], a[48:51], v[128:143]
    buffer_load_dwordx4 v162, s[36:39], s48 offen offset:2048 lds
    v_fmac_f32 v229, v233, v233
    v_sub_f32 v234, v217, v228
    v_mfma_f32_32x32x16_bf16 v[80:95], a[204:207], a[32:35], v[80:95]
    buffer_load_dwordx4 v163, s[36:39], s48 offen offset:3072 lds
    s_add_u32 s48, s48, 524288
    v_fmac_f32 v230, v234, v234
    v_sub_f32 v233, v218, v228
    v_mfma_f32_32x32x16_bf16 v[144:159], a[204:207], a[48:51], v[144:159]
    buffer_load_dwordx4 a[0:3], v168, s[12:15], s57 offen offset:0
    v_fmac_f32 v229, v233, v233
    v_sub_f32 v234, v219, v228
    s_waitcnt lgkmcnt(0)
    v_mfma_f32_32x32x16_bf16 v[32:47], a[208:211], a[36:39], v[32:47]
    ds_read_b64_tr_b16 a[192:193], v164 offset:24576
    ds_read_b64_tr_b16 a[194:195], v164 offset:25600
    v_fmac_f32 v230, v234, v234
    v_sub_f32 v233, v220, v228
    v_cndmask_b32 v233, 0, v233, s[54:55]
    v_fmac_f32 v229, v233, v233
    v_mfma_f32_32x32x16_bf16 v[96:111], a[208:211], a[52:55], v[96:111]
    ds_read_b64_tr_b16 a[196:197], v165 offset:24576
    ds_read_b64_tr_b16 a[198:199], v165 offset:25600
    v_sub_f32 v234, v221, v228
    v_cndmask_b32 v234, 0, v234, s[54:55]
    v_fmac_f32 v230, v234, v234
    v_sub_f32 v233, v222, v228
    v_mfma_f32_32x32x16_bf16 v[48:63], a[212:215], a[36:39], v[48:63]
    ds_read_b64_tr_b16 a[200:201], v166 offset:24576
    ds_read_b64_tr_b16 a[202:203], v166 offset:25600
    v_cndmask_b32 v233, 0, v233, s[54:55]
    v_fmac_f32 v229, v233, v233
    v_sub_f32 v234, v223, v228
    v_cndmask_b32 v234, 0, v234, s[54:55]
    v_mfma_f32_32x32x16_bf16 v[112:127], a[212:215], a[52:55], v[112:127]
    ds_read_b64_tr_b16 a[204:205], v167 offset:24576
    ds_read_b64_tr_b16 a[206:207], v167 offset:25600
    v_fmac_f32 v230, v234, v234
    v_sub_f32 v233, v224, v228
    v_cndmask_b32 v233, 0, v233, s[54:55]
    v_fmac_f32 v229, v233, v233
    v_mfma_f32_32x32x16_bf16 v[64:79], a[216:219], a[36:39], v[64:79]
    buffer_load_dwordx4 a[4:7], v168, s[12:15], s57 offen offset:1024
    v_sub_f32 v234, v225, v228
    v_cndmask_b32 v234, 0, v234, s[54:55]
    v_mfma_f32_32x32x16_bf16 v[128:143], a[216:219], a[52:55], v[128:143]
    buffer_load_dwordx4 a[8:11], v168, s[12:15], s57 offen offset:2048
    v_fmac_f32 v230, v234, v234
    v_sub_f32 v233, v226, v228
    v_mfma_f32_32x32x16_bf16 v[80:95], a[220:223], a[36:39], v[80:95]
    buffer_load_dwordx4 a[12:15], v168, s[12:15], s57 offen offset:3072
    v_cndmask_b32 v233, 0, v233, s[54:55]
    v_fmac_f32 v229, v233, v233
    v_mfma_f32_32x32x16_bf16 v[144:159], a[220:223], a[52:55], v[144:159]
    buffer_load_dwordx4 a[16:19], v168, s[12:15], s49 offen offset:0
    v_sub_f32 v234, v227, v228
    v_cndmask_b32 v234, 0, v234, s[54:55]
    s_waitcnt lgkmcnt(0)
    v_mfma_f32_32x32x16_bf16 v[32:47], a[192:195], a[40:43], v[32:47]
    ds_read_b64_tr_b16 a[208:209], v164 offset:28672
    ds_read_b64_tr_b16 a[210:211], v164 offset:29696
    v_fmac_f32 v230, v234, v234
    v_add_f32 v229, v229, v230
    ds_swizzle_b32 v232, v229 offset:0x81f
    s_waitcnt lgkmcnt(0)
    v_mfma_f32_32x32x16_bf16 v[96:111], a[192:195], a[56:59], v[96:111]
    ds_read_b64_tr_b16 a[212:213], v165 offset:28672
    ds_read_b64_tr_b16 a[214:215], v165 offset:29696
    v_add_f32 v229, v229, v232
    ds_swizzle_b32 v232, v229 offset:0x101f
    s_waitcnt lgkmcnt(0)
    v_add_f32 v229, v229, v232
    v_mfma_f32_32x32x16_bf16 v[48:63], a[196:199], a[40:43], v[48:63]
    ds_read_b64_tr_b16 a[216:217], v166 offset:28672
    ds_read_b64_tr_b16 a[218:219], v166 offset:29696
    ds_swizzle_b32 v232, v229 offset:0x201f
    s_waitcnt lgkmcnt(0)
    v_add_f32 v229, v229, v232
    ds_swizzle_b32 v232, v229 offset:0x401f
    v_mfma_f32_32x32x16_bf16 v[112:127], a[196:199], a[56:59], v[112:127]
    ds_read_b64_tr_b16 a[220:221], v167 offset:28672
    ds_read_b64_tr_b16 a[222:223], v167 offset:29696
    s_waitcnt lgkmcnt(0)
    v_add_f32 v229, v229, v232
    v_mov_b32 v232, v229
    s_nop 1
    v_mfma_f32_32x32x16_bf16 v[64:79], a[200:203], a[40:43], v[64:79]
    v_permlane32_swap_b32 v232, v229
    s_nop 1
    v_add_f32 v229, v229, v232
    s_mov_b32 s56, 0x3727c5ac
    v_mul_f32 v229, s53, v229
    v_cvt_pk_bf16_f32 v232, v228, v229
    v_mfma_f32_32x32x16_bf16 v[128:143], a[200:203], a[56:59], v[128:143]
    buffer_load_dwordx4 a[20:23], v168, s[12:15], s49 offen offset:1024
    v_lshlrev_b32 v228, 16, v232
    v_and_b32 v229, s52, v232
    v_mfma_f32_32x32x16_bf16 v[80:95], a[204:207], a[40:43], v[80:95]
    buffer_load_dwordx4 a[24:27], v168, s[12:15], s49 offen offset:2048
    v_add_f32 v229, s56, v229
    v_cvt_pk_bf16_f32 v232, v229, v229
    v_mfma_f32_32x32x16_bf16 v[144:159], a[204:207], a[56:59], v[144:159]
    buffer_load_dwordx4 a[28:31], v168, s[12:15], s49 offen offset:3072
    s_add_u32 s57, s57, 4096
    s_add_u32 s49, s49, 4096
    v_and_b32 v229, s52, v232
    v_sqrt_f32 v229, v229
    s_waitcnt vmcnt(24) lgkmcnt(0)
    s_barrier
    v_mfma_f32_32x32x16_bf16 v[32:47], a[208:211], a[44:47], v[32:47]
    ds_read_b64_tr_b16 a[192:193], v164 offset:32768
    ds_read_b64_tr_b16 a[194:195], v164 offset:33792
    s_nop 0
    v_cvt_pk_bf16_f32 v232, v229, v229
    v_and_b32 v229, s52, v232
    v_rcp_f32 v229, v229
    v_mfma_f32_32x32x16_bf16 v[96:111], a[208:211], a[60:63], v[96:111]
    ds_read_b64_tr_b16 a[196:197], v165 offset:32768
    ds_read_b64_tr_b16 a[198:199], v165 offset:33792
    s_nop 0
    v_sub_f32 v196, v196, v228
    v_sub_f32 v197, v197, v228
    v_cvt_pk_bf16_f32 v233, v196, v197
    v_mfma_f32_32x32x16_bf16 v[48:63], a[212:215], a[44:47], v[48:63]
    ds_read_b64_tr_b16 a[200:201], v166 offset:32768
    ds_read_b64_tr_b16 a[202:203], v166 offset:33792
    v_lshlrev_b32 v196, 16, v233
    v_and_b32 v197, s52, v233
    v_mul_f32 v196, v196, v229
    v_mul_f32 v197, v197, v229
    v_mfma_f32_32x32x16_bf16 v[112:127], a[212:215], a[60:63], v[112:127]
    ds_read_b64_tr_b16 a[204:205], v167 offset:32768
    ds_read_b64_tr_b16 a[206:207], v167 offset:33792
    v_cvt_pk_bf16_f32 v180, v196, v197
    v_sub_f32 v198, v198, v228
    v_sub_f32 v199, v199, v228
    v_cvt_pk_bf16_f32 v234, v198, v199
    v_mfma_f32_32x32x16_bf16 v[64:79], a[216:219], a[44:47], v[64:79]
    v_lshlrev_b32 v198, 16, v234
    v_and_b32 v199, s52, v234
    v_mul_f32 v198, v198, v229
    v_mul_f32 v199, v199, v229
    v_cvt_pk_bf16_f32 v181, v198, v199
    v_sub_f32 v200, v200, v228
    v_mfma_f32_32x32x16_bf16 v[128:143], a[216:219], a[60:63], v[128:143]
    v_sub_f32 v201, v201, v228
    v_cvt_pk_bf16_f32 v233, v200, v201
    v_lshlrev_b32 v200, 16, v233
    v_and_b32 v201, s52, v233
    v_mul_f32 v200, v200, v229
    v_mul_f32 v201, v201, v229
    v_mfma_f32_32x32x16_bf16 v[80:95], a[220:223], a[44:47], v[80:95]
    v_cvt_pk_bf16_f32 v182, v200, v201
    v_sub_f32 v202, v202, v228
    v_sub_f32 v203, v203, v228
    v_cvt_pk_bf16_f32 v234, v202, v203
    v_lshlrev_b32 v202, 16, v234
    v_and_b32 v203, s52, v234
    v_mfma_f32_32x32x16_bf16 v[144:159], a[220:223], a[60:63], v[144:159]
    s_add_u32 m0, s21, 114688
    s_nop 0
    buffer_load_dwordx4 v160, s[36:39], s48 offen offset:0 lds
    v_mul_f32 v202, v202, v229
    v_mul_f32 v203, v203, v229
    s_waitcnt lgkmcnt(0)
    v_mfma_f32_32x32x16_bf16 v[32:47], a[192:195], a[64:67], v[32:47]
    ds_read_b64_tr_b16 a[208:209], v164 offset:36864
    ds_read_b64_tr_b16 a[210:211], v164 offset:37888
    v_cvt_pk_bf16_f32 v183, v202, v203
    v_sub_f32 v204, v204, v228
    v_sub_f32 v205, v205, v228
    v_cvt_pk_bf16_f32 v233, v204, v205
    v_mfma_f32_32x32x16_bf16 v[96:111], a[192:195], a[80:83], v[96:111]
    ds_read_b64_tr_b16 a[212:213], v165 offset:36864
    ds_read_b64_tr_b16 a[214:215], v165 offset:37888
    buffer_load_dwordx4 v161, s[36:39], s48 offen offset:1024 lds
    v_mfma_f32_32x32x16_bf16 v[48:63], a[196:199], a[64:67], v[48:63]
    ds_read_b64_tr_b16 a[216:217], v166 offset:36864
    ds_read_b64_tr_b16 a[218:219], v166 offset:37888
    buffer_load_dwordx4 v162, s[36:39], s48 offen offset:2048 lds
    v_mfma_f32_32x32x16_bf16 v[112:127], a[196:199], a[80:83], v[112:127]
    ds_read_b64_tr_b16 a[220:221], v167 offset:36864
    ds_read_b64_tr_b16 a[222:223], v167 offset:37888
    buffer_load_dwordx4 v163, s[36:39], s48 offen offset:3072 lds
    s_add_u32 s48, s48, 524288
    v_mfma_f32_32x32x16_bf16 v[64:79], a[200:203], a[64:67], v[64:79]
    buffer_load_dwordx4 a[32:35], v168, s[12:15], s57 offen offset:0
    v_lshlrev_b32 v204, 16, v233
    v_and_b32 v205, s52, v233
    v_mfma_f32_32x32x16_bf16 v[128:143], a[200:203], a[80:83], v[128:143]
    buffer_load_dwordx4 a[36:39], v168, s[12:15], s57 offen offset:1024
    v_mul_f32 v204, v204, v229
    v_mul_f32 v205, v205, v229
    v_mfma_f32_32x32x16_bf16 v[80:95], a[204:207], a[64:67], v[80:95]
    buffer_load_dwordx4 a[40:43], v168, s[12:15], s57 offen offset:2048
    v_cvt_pk_bf16_f32 v184, v204, v205
    v_sub_f32 v206, v206, v228
    v_mfma_f32_32x32x16_bf16 v[144:159], a[204:207], a[80:83], v[144:159]
    buffer_load_dwordx4 a[44:47], v168, s[12:15], s57 offen offset:3072
    v_sub_f32 v207, v207, v228
    v_cvt_pk_bf16_f32 v234, v206, v207
    s_waitcnt lgkmcnt(0)
    v_mfma_f32_32x32x16_bf16 v[32:47], a[208:211], a[68:71], v[32:47]
    ds_read_b64_tr_b16 a[192:193], v164 offset:40960
    ds_read_b64_tr_b16 a[194:195], v164 offset:41984
    v_lshlrev_b32 v206, 16, v234
    v_and_b32 v207, s52, v234
    v_mul_f32 v206, v206, v229
    v_mul_f32 v207, v207, v229
    v_mfma_f32_32x32x16_bf16 v[96:111], a[208:211], a[84:87], v[96:111]
    ds_read_b64_tr_b16 a[196:197], v165 offset:40960
    ds_read_b64_tr_b16 a[198:199], v165 offset:41984
    v_cvt_pk_bf16_f32 v185, v206, v207
    v_sub_f32 v208, v208, v228
    v_sub_f32 v209, v209, v228
    v_cvt_pk_bf16_f32 v233, v208, v209
    v_mfma_f32_32x32x16_bf16 v[48:63], a[212:215], a[68:71], v[48:63]
    ds_read_b64_tr_b16 a[200:201], v166 offset:40960
    ds_read_b64_tr_b16 a[202:203], v166 offset:41984
    buffer_load_dwordx4 a[48:51], v168, s[12:15], s49 offen offset:0
    v_mfma_f32_32x32x16_bf16 v[112:127], a[212:215], a[84:87], v[112:127]
    ds_read_b64_tr_b16 a[204:205], v167 offset:40960
    ds_read_b64_tr_b16 a[206:207], v167 offset:41984
    buffer_load_dwordx4 a[52:55], v168, s[12:15], s49 offen offset:1024
    v_mfma_f32_32x32x16_bf16 v[64:79], a[216:219], a[68:71], v[64:79]
    buffer_load_dwordx4 a[56:59], v168, s[12:15], s49 offen offset:2048
    v_lshlrev_b32 v208, 16, v233
    v_and_b32 v209, s52, v233
    v_mfma_f32_32x32x16_bf16 v[128:143], a[216:219], a[84:87], v[128:143]
    buffer_load_dwordx4 a[60:63], v168, s[12:15], s49 offen offset:3072
    s_add_u32 s57, s57, 4096
    s_add_u32 s49, s49, 4096
    v_mul_f32 v208, v208, v229
    v_mul_f32 v209, v209, v229
    v_mfma_f32_32x32x16_bf16 v[80:95], a[220:223], a[68:71], v[80:95]
    s_add_u32 m0, s21, 0
    s_nop 0
    buffer_load_dwordx4 v20, s[4:7], s22 offen offset:0 lds
    v_cvt_pk_bf16_f32 v186, v208, v209
    v_sub_f32 v210, v210, v228
    v_mfma_f32_32x32x16_bf16 v[144:159], a[220:223], a[84:87], v[144:159]
    buffer_load_dwordx4 v21, s[4:7], s22 offen offset:1024 lds
    v_sub_f32 v211, v211, v228
    v_cvt_pk_bf16_f32 v234, v210, v211
    s_waitcnt lgkmcnt(0)
    v_mfma_f32_32x32x16_bf16 v[32:47], a[192:195], a[72:75], v[32:47]
    ds_read_b64_tr_b16 a[208:209], v164 offset:45056
    ds_read_b64_tr_b16 a[210:211], v164 offset:46080
    v_lshlrev_b32 v210, 16, v234
    v_and_b32 v211, s52, v234
    v_mul_f32 v210, v210, v229
    v_mul_f32 v211, v211, v229
    v_mfma_f32_32x32x16_bf16 v[96:111], a[192:195], a[88:91], v[96:111]
    ds_read_b64_tr_b16 a[212:213], v165 offset:45056
    ds_read_b64_tr_b16 a[214:215], v165 offset:46080
    v_cvt_pk_bf16_f32 v187, v210, v211
    v_sub_f32 v212, v212, v228
    v_sub_f32 v213, v213, v228
    v_cvt_pk_bf16_f32 v233, v212, v213
    v_mfma_f32_32x32x16_bf16 v[48:63], a[196:199], a[72:75], v[48:63]
    ds_read_b64_tr_b16 a[216:217], v166 offset:45056
    ds_read_b64_tr_b16 a[218:219], v166 offset:46080
    buffer_load_dwordx4 v22, s[4:7], s22 offen offset:2048 lds
    v_mfma_f32_32x32x16_bf16 v[112:127], a[196:199], a[88:91], v[112:127]
    ds_read_b64_tr_b16 a[220:221], v167 offset:45056
    ds_read_b64_tr_b16 a[222:223], v167 offset:46080
    buffer_load_dwordx4 v23, s[4:7], s22 offen offset:3072 lds
    s_add_u32 s22, s22, 16384
    v_mfma_f32_32x32x16_bf16 v[64:79], a[200:203], a[72:75], v[64:79]
    s_add_u32 m0, s21, 16384
    s_nop 0
    buffer_load_dwordx4 v20, s[4:7], s22 offen offset:0 lds
    v_lshlrev_b32 v212, 16, v233
    v_and_b32 v213, s52, v233
    v_mfma_f32_32x32x16_bf16 v[128:143], a[200:203], a[88:91], v[128:143]
    buffer_load_dwordx4 v21, s[4:7], s22 offen offset:1024 lds
    v_mul_f32 v212, v212, v229
    v_mul_f32 v213, v213, v229
    v_mfma_f32_32x32x16_bf16 v[80:95], a[204:207], a[72:75], v[80:95]
    buffer_load_dwordx4 v22, s[4:7], s22 offen offset:2048 lds
    v_cvt_pk_bf16_f32 v188, v212, v213
    v_sub_f32 v214, v214, v228
    v_mfma_f32_32x32x16_bf16 v[144:159], a[204:207], a[88:91], v[144:159]
    buffer_load_dwordx4 v23, s[4:7], s22 offen offset:3072 lds
    s_add_u32 s22, s22, 16384
    v_sub_f32 v215, v215, v228
    v_cvt_pk_bf16_f32 v234, v214, v215
    s_waitcnt vmcnt(32) lgkmcnt(0)
    s_barrier
    v_mfma_f32_32x32x16_bf16 v[32:47], a[208:211], a[76:79], v[32:47]
    ds_read_b64_tr_b16 a[192:193], v164 offset:49152
    ds_read_b64_tr_b16 a[194:195], v164 offset:50176
    v_lshlrev_b32 v214, 16, v234
    v_and_b32 v215, s52, v234
    v_mul_f32 v214, v214, v229
    v_mul_f32 v215, v215, v229
    v_mfma_f32_32x32x16_bf16 v[96:111], a[208:211], a[92:95], v[96:111]
    ds_read_b64_tr_b16 a[196:197], v165 offset:49152
    ds_read_b64_tr_b16 a[198:199], v165 offset:50176
    v_cvt_pk_bf16_f32 v189, v214, v215
    v_sub_f32 v216, v216, v228
    v_sub_f32 v217, v217, v228
    v_cvt_pk_bf16_f32 v233, v216, v217
    v_mfma_f32_32x32x16_bf16 v[48:63], a[212:215], a[76:79], v[48:63]
    ds_read_b64_tr_b16 a[200:201], v166 offset:49152
    ds_read_b64_tr_b16 a[202:203], v166 offset:50176
    v_lshlrev_b32 v216, 16, v233
    v_and_b32 v217, s52, v233
    v_mul_f32 v216, v216, v229
    v_mul_f32 v217, v217, v229
    v_mfma_f32_32x32x16_bf16 v[112:127], a[212:215], a[92:95], v[112:127]
    ds_read_b64_tr_b16 a[204:205], v167 offset:49152
    ds_read_b64_tr_b16 a[206:207], v167 offset:50176
    v_cvt_pk_bf16_f32 v190, v216, v217
    v_sub_f32 v218, v218, v228
    v_sub_f32 v219, v219, v228
    v_cvt_pk_bf16_f32 v234, v218, v219
    v_mfma_f32_32x32x16_bf16 v[64:79], a[216:219], a[76:79], v[64:79]
    v_lshlrev_b32 v218, 16, v234
    v_and_b32 v219, s52, v234
    v_mul_f32 v218, v218, v229
    v_mul_f32 v219, v219, v229
    v_cvt_pk_bf16_f32 v191, v218, v219
    v_sub_f32 v220, v220, v228
    v_mfma_f32_32x32x16_bf16 v[128:143], a[216:219], a[92:95], v[128:143]
    v_sub_f32 v221, v221, v228
    v_cvt_pk_bf16_f32 v233, v220, v221
    v_lshlrev_b32 v220, 16, v233
    v_and_b32 v221, s52, v233
    v_mul_f32 v220, v220, v229
    v_mul_f32 v221, v221, v229
    v_mfma_f32_32x32x16_bf16 v[80:95], a[220:223], a[76:79], v[80:95]
    v_cvt_pk_bf16_f32 v192, v220, v221
    v_sub_f32 v222, v222, v228
    v_sub_f32 v223, v223, v228
    v_cvt_pk_bf16_f32 v234, v222, v223
    v_lshlrev_b32 v222, 16, v234
    v_and_b32 v223, s52, v234
    v_mfma_f32_32x32x16_bf16 v[144:159], a[220:223], a[92:95], v[144:159]
    v_mul_f32 v222, v222, v229
    v_mul_f32 v223, v223, v229
    v_cvt_pk_bf16_f32 v193, v222, v223
    v_sub_f32 v224, v224, v228
    v_sub_f32 v225, v225, v228
    v_cvt_pk_bf16_f32 v233, v224, v225
    s_waitcnt lgkmcnt(0)
    v_mfma_f32_32x32x16_bf16 v[32:47], a[192:195], a[96:99], v[32:47]
    ds_read_b64_tr_b16 a[208:209], v164 offset:53248
    ds_read_b64_tr_b16 a[210:211], v164 offset:54272
    v_lshlrev_b32 v224, 16, v233
    v_and_b32 v225, s52, v233
    v_mul_f32 v224, v224, v229
    v_mul_f32 v225, v225, v229
    v_mfma_f32_32x32x16_bf16 v[96:111], a[192:195], a[112:115], v[96:111]
    ds_read_b64_tr_b16 a[212:213], v165 offset:53248
    ds_read_b64_tr_b16 a[214:215], v165 offset:54272
    v_cvt_pk_bf16_f32 v194, v224, v225
    v_sub_f32 v226, v226, v228
    v_sub_f32 v227, v227, v228
    v_cvt_pk_bf16_f32 v234, v226, v227
    v_mfma_f32_32x32x16_bf16 v[48:63], a[196:199], a[96:99], v[48:63]
    ds_read_b64_tr_b16 a[216:217], v166 offset:53248
    ds_read_b64_tr_b16 a[218:219], v166 offset:54272
    v_lshlrev_b32 v226, 16, v234
    v_and_b32 v227, s52, v234
    v_mul_f32 v226, v226, v229
    v_mul_f32 v227, v227, v229
    v_mfma_f32_32x32x16_bf16 v[112:127], a[196:199], a[112:115], v[112:127]
    ds_read_b64_tr_b16 a[220:221], v167 offset:53248
    ds_read_b64_tr_b16 a[222:223], v167 offset:54272
    v_cvt_pk_bf16_f32 v195, v226, v227
    buffer_store_dwordx4 v[180:183], v3, s[44:47], 0 offen offset:0
    v_mfma_f32_32x32x16_bf16 v[64:79], a[200:203], a[96:99], v[64:79]
    s_add_u32 m0, s21, 65536
    s_nop 0
    buffer_load_dwordx4 v24, s[8:11], s23 offen offset:0 lds
    buffer_store_dwordx4 v[184:187], v3, s[44:47], 0 offen offset:512
    v_mfma_f32_32x32x16_bf16 v[128:143], a[200:203], a[112:115], v[128:143]
    buffer_load_dwordx4 v24, s[8:11], s23 offen offset:1024 lds
    buffer_store_dwordx4 v[188:191], v3, s[44:47], 0 offen offset:1024
    v_mfma_f32_32x32x16_bf16 v[80:95], a[204:207], a[96:99], v[80:95]
    buffer_load_dwordx4 v24, s[8:11], s23 offen offset:2048 lds
    buffer_store_dwordx4 v[192:195], v176, s[44:47], 0 offen offset:1536
    v_mfma_f32_32x32x16_bf16 v[144:159], a[204:207], a[112:115], v[144:159]
    buffer_load_dwordx4 v24, s[8:11], s23 offen offset:3072 lds
    s_add_u32 s23, s23, 16384
    v_accvgpr_write_b32 a224, 0
    v_accvgpr_write_b32 a225, 0
    s_waitcnt lgkmcnt(0)
    v_mfma_f32_32x32x16_bf16 v[32:47], a[208:211], a[100:103], v[32:47]
    ds_read_b64_tr_b16 a[192:193], v164 offset:57344
    ds_read_b64_tr_b16 a[194:195], v164 offset:58368
    v_accvgpr_write_b32 a226, 0
    v_accvgpr_write_b32 a227, 0
    v_accvgpr_write_b32 a228, 0
    v_accvgpr_write_b32 a229, 0
    v_mfma_f32_32x32x16_bf16 v[96:111], a[208:211], a[116:119], v[96:111]
    ds_read_b64_tr_b16 a[196:197], v165 offset:57344
    ds_read_b64_tr_b16 a[198:199], v165 offset:58368
    v_accvgpr_write_b32 a230, 0
    v_accvgpr_write_b32 a231, 0
    v_accvgpr_write_b32 a232, 0
    v_accvgpr_write_b32 a233, 0
    v_mfma_f32_32x32x16_bf16 v[48:63], a[212:215], a[100:103], v[48:63]
    ds_read_b64_tr_b16 a[200:201], v166 offset:57344
    ds_read_b64_tr_b16 a[202:203], v166 offset:58368
    v_accvgpr_write_b32 a234, 0
    v_accvgpr_write_b32 a235, 0
    v_accvgpr_write_b32 a236, 0
    v_accvgpr_write_b32 a237, 0
    v_mfma_f32_32x32x16_bf16 v[112:127], a[212:215], a[116:119], v[112:127]
    ds_read_b64_tr_b16 a[204:205], v167 offset:57344
    ds_read_b64_tr_b16 a[206:207], v167 offset:58368
    v_accvgpr_write_b32 a238, 0
    v_accvgpr_write_b32 a239, 0
    v_accvgpr_write_b32 a240, 0
    v_accvgpr_write_b32 a241, 0
    v_mfma_f32_32x32x16_bf16 v[64:79], a[216:219], a[100:103], v[64:79]
    s_add_u32 m0, s21, 32768
    s_nop 0
    buffer_load_dwordx4 v20, s[4:7], s22 offen offset:0 lds
    v_accvgpr_write_b32 a242, 0
    v_accvgpr_write_b32 a243, 0
    v_mfma_f32_32x32x16_bf16 v[128:143], a[216:219], a[116:119], v[128:143]
    buffer_load_dwordx4 v21, s[4:7], s22 offen offset:1024 lds
    v_accvgpr_write_b32 a244, 0
    v_accvgpr_write_b32 a245, 0
    v_mfma_f32_32x32x16_bf16 v[80:95], a[220:223], a[100:103], v[80:95]
    buffer_load_dwordx4 v22, s[4:7], s22 offen offset:2048 lds
    v_accvgpr_write_b32 a246, 0
    v_accvgpr_write_b32 a247, 0
    v_mfma_f32_32x32x16_bf16 v[144:159], a[220:223], a[116:119], v[144:159]
    buffer_load_dwordx4 v23, s[4:7], s22 offen offset:3072 lds
    s_add_u32 s22, s22, 16384
    v_accvgpr_write_b32 a248, 0
    v_accvgpr_write_b32 a249, 0
    s_waitcnt lgkmcnt(0)
    v_mfma_f32_32x32x16_bf16 v[32:47], a[192:195], a[104:107], v[32:47]
    ds_read_b64_tr_b16 a[208:209], v164 offset:61440
    ds_read_b64_tr_b16 a[210:211], v164 offset:62464
    v_accvgpr_write_b32 a250, 0
    v_accvgpr_write_b32 a251, 0
    v_accvgpr_write_b32 a252, 0
    v_accvgpr_write_b32 a253, 0
    v_mfma_f32_32x32x16_bf16 v[96:111], a[192:195], a[120:123], v[96:111]
    ds_read_b64_tr_b16 a[212:213], v165 offset:61440
    ds_read_b64_tr_b16 a[214:215], v165 offset:62464
    v_accvgpr_write_b32 a254, 0
    v_accvgpr_write_b32 a255, 0
    v_mfma_f32_32x32x16_bf16 v[48:63], a[196:199], a[104:107], v[48:63]
    ds_read_b64_tr_b16 a[216:217], v166 offset:61440
    ds_read_b64_tr_b16 a[218:219], v166 offset:62464
    v_mfma_f32_32x32x16_bf16 v[112:127], a[196:199], a[120:123], v[112:127]
    ds_read_b64_tr_b16 a[220:221], v167 offset:61440
    ds_read_b64_tr_b16 a[222:223], v167 offset:62464
    v_mfma_f32_32x32x16_bf16 v[64:79], a[200:203], a[104:107], v[64:79]
    s_add_u32 m0, s21, 81920
    s_nop 0
    buffer_load_dwordx4 v24, s[8:11], s23 offen offset:0 lds
    v_mfma_f32_32x32x16_bf16 v[128:143], a[200:203], a[120:123], v[128:143]
    buffer_load_dwordx4 v24, s[8:11], s23 offen offset:1024 lds
    v_mfma_f32_32x32x16_bf16 v[80:95], a[204:207], a[104:107], v[80:95]
    buffer_load_dwordx4 v24, s[8:11], s23 offen offset:2048 lds
    v_mfma_f32_32x32x16_bf16 v[144:159], a[204:207], a[120:123], v[144:159]
    buffer_load_dwordx4 v24, s[8:11], s23 offen offset:3072 lds
    s_add_u32 s23, s23, 16384
    s_waitcnt vmcnt(36) lgkmcnt(0)
    s_barrier
    v_mfma_f32_32x32x16_bf16 v[32:47], a[208:211], a[108:111], v[32:47]
    ds_read_b64_tr_b16 a[192:193], v164 offset:0
    ds_read_b64_tr_b16 a[194:195], v164 offset:1024
    v_mfma_f32_32x32x16_bf16 v[96:111], a[208:211], a[124:127], v[96:111]
    ds_read_b64_tr_b16 a[196:197], v165 offset:0
    ds_read_b64_tr_b16 a[198:199], v165 offset:1024
    v_mfma_f32_32x32x16_bf16 v[48:63], a[212:215], a[108:111], v[48:63]
    ds_read_b64_tr_b16 a[200:201], v166 offset:0
    ds_read_b64_tr_b16 a[202:203], v166 offset:1024
    v_mfma_f32_32x32x16_bf16 v[112:127], a[212:215], a[124:127], v[112:127]
    ds_read_b64_tr_b16 a[204:205], v167 offset:0
    ds_read_b64_tr_b16 a[206:207], v167 offset:1024
    v_mfma_f32_32x32x16_bf16 v[64:79], a[216:219], a[108:111], v[64:79]
    v_mfma_f32_32x32x16_bf16 v[128:143], a[216:219], a[124:127], v[128:143]
    v_mfma_f32_32x32x16_bf16 v[80:95], a[220:223], a[108:111], v[80:95]
    v_mfma_f32_32x32x16_bf16 v[144:159], a[220:223], a[124:127], v[144:159]
    s_waitcnt lgkmcnt(0)
    v_mfma_f32_32x32x16_bf16 v[32:47], a[192:195], a[0:3], v[32:47]
    ds_read_b64_tr_b16 a[208:209], v164 offset:4096
    ds_read_b64_tr_b16 a[210:211], v164 offset:5120
    v_accvgpr_write_b32 a64, 0
    v_accvgpr_write_b32 a65, 0
    v_accvgpr_write_b32 a66, 0
    v_accvgpr_write_b32 a67, 0
    v_mfma_f32_32x32x16_bf16 v[96:111], a[192:195], a[16:19], v[96:111]
    ds_read_b64_tr_b16 a[212:213], v165 offset:4096
    ds_read_b64_tr_b16 a[214:215], v165 offset:5120
    v_accvgpr_write_b32 a68, 0
    v_accvgpr_write_b32 a69, 0
    v_accvgpr_write_b32 a70, 0
    v_accvgpr_write_b32 a71, 0
    v_mfma_f32_32x32x16_bf16 v[48:63], a[196:199], a[0:3], v[48:63]
    ds_read_b64_tr_b16 a[216:217], v166 offset:4096
    ds_read_b64_tr_b16 a[218:219], v166 offset:5120
    v_accvgpr_write_b32 a72, 0
    v_accvgpr_write_b32 a73, 0
    v_accvgpr_write_b32 a74, 0
    v_accvgpr_write_b32 a75, 0
    v_mfma_f32_32x32x16_bf16 v[112:127], a[196:199], a[16:19], v[112:127]
    ds_read_b64_tr_b16 a[220:221], v167 offset:4096
    ds_read_b64_tr_b16 a[222:223], v167 offset:5120
    v_accvgpr_write_b32 a76, 0
    v_accvgpr_write_b32 a77, 0
    v_accvgpr_write_b32 a78, 0
    v_accvgpr_write_b32 a79, 0
    v_mfma_f32_32x32x16_bf16 v[64:79], a[200:203], a[0:3], v[64:79]
    v_accvgpr_write_b32 a80, 0
    v_accvgpr_write_b32 a81, 0
    v_accvgpr_write_b32 a82, 0
    v_accvgpr_write_b32 a83, 0
    v_accvgpr_write_b32 a84, 0
    v_accvgpr_write_b32 a85, 0
    v_mfma_f32_32x32x16_bf16 v[128:143], a[200:203], a[16:19], v[128:143]
    v_accvgpr_write_b32 a86, 0
    v_accvgpr_write_b32 a87, 0
    v_accvgpr_write_b32 a88, 0
    v_accvgpr_write_b32 a89, 0
    v_accvgpr_write_b32 a90, 0
    v_accvgpr_write_b32 a91, 0
    v_mfma_f32_32x32x16_bf16 v[80:95], a[204:207], a[0:3], v[80:95]
    v_accvgpr_write_b32 a92, 0
    v_accvgpr_write_b32 a93, 0
    v_accvgpr_write_b32 a94, 0
    v_accvgpr_write_b32 a95, 0
    v_accvgpr_write_b32 a96, 0
    v_accvgpr_write_b32 a97, 0
    v_mfma_f32_32x32x16_bf16 v[144:159], a[204:207], a[16:19], v[144:159]
    v_accvgpr_write_b32 a98, 0
    v_accvgpr_write_b32 a99, 0
    v_accvgpr_write_b32 a100, 0
    v_accvgpr_write_b32 a101, 0
    v_accvgpr_write_b32 a102, 0
    v_accvgpr_write_b32 a103, 0
    s_waitcnt lgkmcnt(0)
    v_mfma_f32_32x32x16_bf16 v[32:47], a[208:211], a[4:7], v[32:47]
    ds_read_b64_tr_b16 a[192:193], v164 offset:8192
    ds_read_b64_tr_b16 a[194:195], v164 offset:9216
    v_accvgpr_write_b32 a104, 0
    v_accvgpr_write_b32 a105, 0
    v_accvgpr_write_b32 a106, 0
    v_accvgpr_write_b32 a107, 0
    v_mfma_f32_32x32x16_bf16 v[96:111], a[208:211], a[20:23], v[96:111]
    ds_read_b64_tr_b16 a[196:197], v165 offset:8192
    ds_read_b64_tr_b16 a[198:199], v165 offset:9216
    v_accvgpr_write_b32 a108, 0
    v_accvgpr_write_b32 a109, 0
    v_accvgpr_write_b32 a110, 0
    v_accvgpr_write_b32 a111, 0
    v_mfma_f32_32x32x16_bf16 v[48:63], a[212:215], a[4:7], v[48:63]
    ds_read_b64_tr_b16 a[200:201], v166 offset:8192
    ds_read_b64_tr_b16 a[202:203], v166 offset:9216
    v_accvgpr_write_b32 a112, 0
    v_accvgpr_write_b32 a113, 0
    v_accvgpr_write_b32 a114, 0
    v_accvgpr_write_b32 a115, 0
    v_mfma_f32_32x32x16_bf16 v[112:127], a[212:215], a[20:23], v[112:127]
    ds_read_b64_tr_b16 a[204:205], v167 offset:8192
    ds_read_b64_tr_b16 a[206:207], v167 offset:9216
    v_accvgpr_write_b32 a116, 0
    v_accvgpr_write_b32 a117, 0
    v_accvgpr_write_b32 a118, 0
    v_accvgpr_write_b32 a119, 0
    v_mfma_f32_32x32x16_bf16 v[64:79], a[216:219], a[4:7], v[64:79]
    v_accvgpr_write_b32 a120, 0
    v_accvgpr_write_b32 a121, 0
    v_accvgpr_write_b32 a122, 0
    v_accvgpr_write_b32 a123, 0
    v_accvgpr_write_b32 a124, 0
    v_accvgpr_write_b32 a125, 0
    v_mfma_f32_32x32x16_bf16 v[128:143], a[216:219], a[20:23], v[128:143]
    v_accvgpr_write_b32 a126, 0
    v_accvgpr_write_b32 a127, 0
    v_mfma_f32_32x32x16_bf16 v[80:95], a[220:223], a[4:7], v[80:95]
    v_mfma_f32_32x32x16_bf16 v[144:159], a[220:223], a[20:23], v[144:159]
    s_waitcnt lgkmcnt(0)
    v_mfma_f32_32x32x16_bf16 v[32:47], a[192:195], a[8:11], v[32:47]
    ds_read_b64_tr_b16 a[208:209], v164 offset:12288
    ds_read_b64_tr_b16 a[210:211], v164 offset:13312
    v_mfma_f32_32x32x16_bf16 v[96:111], a[192:195], a[24:27], v[96:111]
    ds_read_b64_tr_b16 a[212:213], v165 offset:12288
    ds_read_b64_tr_b16 a[214:215], v165 offset:13312
    v_mfma_f32_32x32x16_bf16 v[48:63], a[196:199], a[8:11], v[48:63]
    ds_read_b64_tr_b16 a[216:217], v166 offset:12288
    ds_read_b64_tr_b16 a[218:219], v166 offset:13312
    v_mfma_f32_32x32x16_bf16 v[112:127], a[196:199], a[24:27], v[112:127]
    ds_read_b64_tr_b16 a[220:221], v167 offset:12288
    ds_read_b64_tr_b16 a[222:223], v167 offset:13312
    v_mfma_f32_32x32x16_bf16 v[64:79], a[200:203], a[8:11], v[64:79]
    v_mfma_f32_32x32x16_bf16 v[128:143], a[200:203], a[24:27], v[128:143]
    v_mfma_f32_32x32x16_bf16 v[80:95], a[204:207], a[8:11], v[80:95]
    v_mfma_f32_32x32x16_bf16 v[144:159], a[204:207], a[24:27], v[144:159]
    s_waitcnt vmcnt(24) lgkmcnt(0)
    s_barrier
    v_mfma_f32_32x32x16_bf16 v[32:47], a[208:211], a[12:15], v[32:47]
    ds_read_b64_tr_b16 a[192:193], v164 offset:16384
    ds_read_b64_tr_b16 a[194:195], v164 offset:17408
    v_mfma_f32_32x32x16_bf16 v[96:111], a[208:211], a[28:31], v[96:111]
    ds_read_b64_tr_b16 a[196:197], v164 offset:20480
    ds_read_b64_tr_b16 a[198:199], v164 offset:21504
    v_mfma_f32_32x32x16_bf16 v[48:63], a[212:215], a[12:15], v[48:63]
    ds_read_b64_tr_b16 a[200:201], v164 offset:24576
    ds_read_b64_tr_b16 a[202:203], v164 offset:25600
    v_mfma_f32_32x32x16_bf16 v[112:127], a[212:215], a[28:31], v[112:127]
    ds_read_b64_tr_b16 a[204:205], v164 offset:28672
    ds_read_b64_tr_b16 a[206:207], v164 offset:29696
    v_mfma_f32_32x32x16_bf16 v[64:79], a[216:219], a[12:15], v[64:79]
    v_mfma_f32_32x32x16_bf16 v[128:143], a[216:219], a[28:31], v[128:143]
    v_mfma_f32_32x32x16_bf16 v[80:95], a[220:223], a[12:15], v[80:95]
    v_mfma_f32_32x32x16_bf16 v[144:159], a[220:223], a[28:31], v[144:159]
    s_waitcnt lgkmcnt(0)
    v_mfma_f32_32x32x16_bf16 v[32:47], a[192:195], a[32:35], v[32:47]
    ds_read_b64_tr_b16 a[208:209], v165 offset:16384
    ds_read_b64_tr_b16 a[210:211], v165 offset:17408
    v_accvgpr_write_b32 a0, 0
    v_accvgpr_write_b32 a1, 0
    v_accvgpr_write_b32 a2, 0
    v_accvgpr_write_b32 a3, 0
    v_mfma_f32_32x32x16_bf16 v[96:111], a[192:195], a[48:51], v[96:111]
    ds_read_b64_tr_b16 a[212:213], v165 offset:20480
    ds_read_b64_tr_b16 a[214:215], v165 offset:21504
    v_accvgpr_write_b32 a4, 0
    v_accvgpr_write_b32 a5, 0
    v_accvgpr_write_b32 a6, 0
    v_accvgpr_write_b32 a7, 0
    v_mfma_f32_32x32x16_bf16 v[32:47], a[196:199], a[36:39], v[32:47]
    ds_read_b64_tr_b16 a[216:217], v165 offset:24576
    ds_read_b64_tr_b16 a[218:219], v165 offset:25600
    v_accvgpr_write_b32 a8, 0
    v_accvgpr_write_b32 a9, 0
    v_accvgpr_write_b32 a10, 0
    v_accvgpr_write_b32 a11, 0
    v_mfma_f32_32x32x16_bf16 v[96:111], a[196:199], a[52:55], v[96:111]
    ds_read_b64_tr_b16 a[220:221], v165 offset:28672
    ds_read_b64_tr_b16 a[222:223], v165 offset:29696
    v_accvgpr_write_b32 a12, 0
    v_accvgpr_write_b32 a13, 0
    v_accvgpr_write_b32 a14, 0
    v_accvgpr_write_b32 a15, 0
    v_mfma_f32_32x32x16_bf16 v[32:47], a[200:203], a[40:43], v[32:47]
    v_accvgpr_write_b32 a16, 0
    v_accvgpr_write_b32 a17, 0
    v_accvgpr_write_b32 a18, 0
    v_accvgpr_write_b32 a19, 0
    v_accvgpr_write_b32 a20, 0
    v_accvgpr_write_b32 a21, 0
    v_mfma_f32_32x32x16_bf16 v[96:111], a[200:203], a[56:59], v[96:111]
    v_accvgpr_write_b32 a22, 0
    v_accvgpr_write_b32 a23, 0
    v_accvgpr_write_b32 a24, 0
    v_accvgpr_write_b32 a25, 0
    v_accvgpr_write_b32 a26, 0
    v_accvgpr_write_b32 a27, 0
    v_mfma_f32_32x32x16_bf16 v[32:47], a[204:207], a[44:47], v[32:47]
    v_accvgpr_write_b32 a28, 0
    v_accvgpr_write_b32 a29, 0
    v_accvgpr_write_b32 a30, 0
    v_accvgpr_write_b32 a31, 0
    v_mfma_f32_32x32x16_bf16 v[96:111], a[204:207], a[60:63], v[96:111]
    s_waitcnt lgkmcnt(0)
    v_mfma_f32_32x32x16_bf16 v[48:63], a[208:211], a[32:35], v[48:63]
    ds_read_b64_tr_b16 a[192:193], v166 offset:16384
    ds_read_b64_tr_b16 a[194:195], v166 offset:17408
    v_mfma_f32_32x32x16_bf16 v[112:127], a[208:211], a[48:51], v[112:127]
    ds_read_b64_tr_b16 a[196:197], v166 offset:20480
    ds_read_b64_tr_b16 a[198:199], v166 offset:21504
    v_mfma_f32_32x32x16_bf16 v[48:63], a[212:215], a[36:39], v[48:63]
    ds_read_b64_tr_b16 a[200:201], v166 offset:24576
    ds_read_b64_tr_b16 a[202:203], v166 offset:25600
    v_mfma_f32_32x32x16_bf16 v[112:127], a[212:215], a[52:55], v[112:127]
    ds_read_b64_tr_b16 a[204:205], v166 offset:28672
    ds_read_b64_tr_b16 a[206:207], v166 offset:29696
    v_mfma_f32_32x32x16_bf16 v[48:63], a[216:219], a[40:43], v[48:63]
    v_mfma_f32_32x32x16_bf16 v[112:127], a[216:219], a[56:59], v[112:127]
    v_mfma_f32_32x32x16_bf16 v[48:63], a[220:223], a[44:47], v[48:63]
    v_mfma_f32_32x32x16_bf16 v[112:127], a[220:223], a[60:63], v[112:127]
    s_waitcnt lgkmcnt(0)
    v_mfma_f32_32x32x16_bf16 v[64:79], a[192:195], a[32:35], v[64:79]
    ds_read_b64_tr_b16 a[208:209], v167 offset:16384
    ds_read_b64_tr_b16 a[210:211], v167 offset:17408
    v_mul_f32 v32, s59, v32
    v_mul_f32 v33, s59, v33
    v_mul_f32 v34, s59, v34
    v_mul_f32 v35, s59, v35
    v_mfma_f32_32x32x16_bf16 v[128:143], a[192:195], a[48:51], v[128:143]
    ds_read_b64_tr_b16 a[212:213], v167 offset:20480
    ds_read_b64_tr_b16 a[214:215], v167 offset:21504
    v_mul_f32 v36, s59, v36
    v_mul_f32 v37, s59, v37
    v_mul_f32 v38, s59, v38
    v_mul_f32 v39, s59, v39
    v_mfma_f32_32x32x16_bf16 v[64:79], a[196:199], a[36:39], v[64:79]
    ds_read_b64_tr_b16 a[216:217], v167 offset:24576
    ds_read_b64_tr_b16 a[218:219], v167 offset:25600
    v_cvt_pk_bf16_f32 v32, v32, v33
    v_cvt_pk_bf16_f32 v33, v34, v35
    v_cvt_pk_bf16_f32 v34, v36, v37
    v_cvt_pk_bf16_f32 v35, v38, v39
    v_mfma_f32_32x32x16_bf16 v[128:143], a[196:199], a[52:55], v[128:143]
    ds_read_b64_tr_b16 a[220:221], v167 offset:28672
    ds_read_b64_tr_b16 a[222:223], v167 offset:29696
    v_accvgpr_write_b32 a128, v32
    v_accvgpr_write_b32 a129, v33
    v_accvgpr_write_b32 a130, v34
    v_accvgpr_write_b32 a131, v35
    v_mfma_f32_32x32x16_bf16 v[64:79], a[200:203], a[40:43], v[64:79]
    v_mul_f32 v40, s59, v40
    v_mul_f32 v41, s59, v41
    v_mul_f32 v42, s59, v42
    v_mul_f32 v43, s59, v43
    v_mul_f32 v44, s59, v44
    v_mul_f32 v45, s59, v45
    v_mfma_f32_32x32x16_bf16 v[128:143], a[200:203], a[56:59], v[128:143]
    v_mul_f32 v46, s59, v46
    v_mul_f32 v47, s59, v47
    v_cvt_pk_bf16_f32 v40, v40, v41
    v_cvt_pk_bf16_f32 v41, v42, v43
    v_cvt_pk_bf16_f32 v42, v44, v45
    v_cvt_pk_bf16_f32 v43, v46, v47
    v_mfma_f32_32x32x16_bf16 v[64:79], a[204:207], a[44:47], v[64:79]
    v_accvgpr_write_b32 a132, v40
    v_accvgpr_write_b32 a133, v41
    v_accvgpr_write_b32 a134, v42
    v_accvgpr_write_b32 a135, v43
    v_mul_f32 v96, s59, v96
    v_mul_f32 v97, s59, v97
    v_mfma_f32_32x32x16_bf16 v[128:143], a[204:207], a[60:63], v[128:143]
    v_mul_f32 v98, s59, v98
    v_mul_f32 v99, s59, v99
    v_mul_f32 v100, s59, v100
    v_mul_f32 v101, s59, v101
    v_mul_f32 v102, s59, v102
    v_mul_f32 v103, s59, v103
    s_waitcnt lgkmcnt(0)
    v_mfma_f32_32x32x16_bf16 v[80:95], a[208:211], a[32:35], v[80:95]
    v_cvt_pk_bf16_f32 v96, v96, v97
    v_cvt_pk_bf16_f32 v97, v98, v99
    v_cvt_pk_bf16_f32 v98, v100, v101
    v_cvt_pk_bf16_f32 v99, v102, v103
    v_accvgpr_write_b32 a160, v96
    v_accvgpr_write_b32 a161, v97
    v_mfma_f32_32x32x16_bf16 v[144:159], a[208:211], a[48:51], v[144:159]
    v_accvgpr_write_b32 a162, v98
    v_accvgpr_write_b32 a163, v99
    v_mul_f32 v104, s59, v104
    v_mul_f32 v105, s59, v105
    v_mul_f32 v106, s59, v106
    v_mul_f32 v107, s59, v107
    v_mfma_f32_32x32x16_bf16 v[80:95], a[212:215], a[36:39], v[80:95]
    v_mul_f32 v108, s59, v108
    v_mul_f32 v109, s59, v109
    v_mul_f32 v110, s59, v110
    v_mul_f32 v111, s59, v111
    v_cvt_pk_bf16_f32 v104, v104, v105
    v_cvt_pk_bf16_f32 v105, v106, v107
    v_mfma_f32_32x32x16_bf16 v[144:159], a[212:215], a[52:55], v[144:159]
    v_cvt_pk_bf16_f32 v106, v108, v109
    v_cvt_pk_bf16_f32 v107, v110, v111
    v_accvgpr_write_b32 a164, v104
    v_accvgpr_write_b32 a165, v105
    v_accvgpr_write_b32 a166, v106
    v_accvgpr_write_b32 a167, v107
    v_mfma_f32_32x32x16_bf16 v[80:95], a[216:219], a[40:43], v[80:95]
    v_mul_f32 v48, s59, v48
    v_mul_f32 v49, s59, v49
    v_mul_f32 v50, s59, v50
    v_mul_f32 v51, s59, v51
    v_mul_f32 v52, s59, v52
    v_mul_f32 v53, s59, v53
    v_mfma_f32_32x32x16_bf16 v[144:159], a[216:219], a[56:59], v[144:159]
    v_mul_f32 v54, s59, v54
    v_mul_f32 v55, s59, v55
    v_cvt_pk_bf16_f32 v48, v48, v49
    v_cvt_pk_bf16_f32 v49, v50, v51
    v_cvt_pk_bf16_f32 v50, v52, v53
    v_cvt_pk_bf16_f32 v51, v54, v55
    v_mfma_f32_32x32x16_bf16 v[80:95], a[220:223], a[44:47], v[80:95]
    v_accvgpr_write_b32 a136, v48
    v_accvgpr_write_b32 a137, v49
    v_accvgpr_write_b32 a138, v50
    v_accvgpr_write_b32 a139, v51
    v_mul_f32 v56, s59, v56
    v_mul_f32 v57, s59, v57
    v_mfma_f32_32x32x16_bf16 v[144:159], a[220:223], a[60:63], v[144:159]
    v_mul_f32 v58, s59, v58
    v_mul_f32 v59, s59, v59
    v_mul_f32 v60, s59, v60
    v_mul_f32 v61, s59, v61
    v_mul_f32 v62, s59, v62
    v_mul_f32 v63, s59, v63
    s_waitcnt vmcnt(0)
    s_barrier
    v_cvt_pk_bf16_f32 v56, v56, v57
    v_cvt_pk_bf16_f32 v57, v58, v59
    v_cvt_pk_bf16_f32 v58, v60, v61
    v_cvt_pk_bf16_f32 v59, v62, v63
    v_accvgpr_write_b32 a140, v56
    v_accvgpr_write_b32 a141, v57
    v_accvgpr_write_b32 a142, v58
    v_accvgpr_write_b32 a143, v59
    v_mul_f32 v112, s59, v112
    v_mul_f32 v113, s59, v113
    v_mul_f32 v114, s59, v114
    v_mul_f32 v115, s59, v115
    v_mul_f32 v116, s59, v116
    v_mul_f32 v117, s59, v117
    v_mul_f32 v118, s59, v118
    v_mul_f32 v119, s59, v119
    v_cvt_pk_bf16_f32 v112, v112, v113
    v_cvt_pk_bf16_f32 v113, v114, v115
    v_cvt_pk_bf16_f32 v114, v116, v117
    v_cvt_pk_bf16_f32 v115, v118, v119
    v_accvgpr_write_b32 a168, v112
    v_accvgpr_write_b32 a169, v113
    v_accvgpr_write_b32 a170, v114
    v_accvgpr_write_b32 a171, v115
    v_mul_f32 v120, s59, v120
    v_mul_f32 v121, s59, v121
    v_mul_f32 v122, s59, v122
    v_mul_f32 v123, s59, v123
    v_mul_f32 v124, s59, v124
    v_mul_f32 v125, s59, v125
    v_mul_f32 v126, s59, v126
    v_mul_f32 v127, s59, v127
    v_cvt_pk_bf16_f32 v120, v120, v121
    v_cvt_pk_bf16_f32 v121, v122, v123
    v_cvt_pk_bf16_f32 v122, v124, v125
    v_cvt_pk_bf16_f32 v123, v126, v127
    v_accvgpr_write_b32 a172, v120
    v_accvgpr_write_b32 a173, v121
    v_accvgpr_write_b32 a174, v122
    v_accvgpr_write_b32 a175, v123
    v_accvgpr_write_b32 a32, 0
    v_accvgpr_write_b32 a33, 0
    v_accvgpr_write_b32 a34, 0
    v_accvgpr_write_b32 a35, 0
    v_accvgpr_write_b32 a36, 0
    v_accvgpr_write_b32 a37, 0
    v_accvgpr_write_b32 a38, 0
    v_accvgpr_write_b32 a39, 0
    v_accvgpr_write_b32 a40, 0
    v_accvgpr_write_b32 a41, 0
    v_accvgpr_write_b32 a42, 0
    v_accvgpr_write_b32 a43, 0
    v_accvgpr_write_b32 a44, 0
    v_accvgpr_write_b32 a45, 0
    v_accvgpr_write_b32 a46, 0
    v_accvgpr_write_b32 a47, 0
    v_accvgpr_write_b32 a48, 0
    v_accvgpr_write_b32 a49, 0
    v_accvgpr_write_b32 a50, 0
    v_accvgpr_write_b32 a51, 0
    v_accvgpr_write_b32 a52, 0
    v_accvgpr_write_b32 a53, 0
    v_accvgpr_write_b32 a54, 0
    v_accvgpr_write_b32 a55, 0
    v_accvgpr_write_b32 a56, 0
    v_accvgpr_write_b32 a57, 0
    v_accvgpr_write_b32 a58, 0
    v_accvgpr_write_b32 a59, 0
    v_accvgpr_write_b32 a60, 0
    v_accvgpr_write_b32 a61, 0
    v_accvgpr_write_b32 a62, 0
    v_accvgpr_write_b32 a63, 0
    v_mul_f32 v64, s59, v64
    v_mul_f32 v65, s59, v65
    v_mul_f32 v66, s59, v66
    v_mul_f32 v67, s59, v67
    v_mul_f32 v68, s59, v68
    v_mul_f32 v69, s59, v69
    v_mul_f32 v70, s59, v70
    v_mul_f32 v71, s59, v71
    v_cvt_pk_bf16_f32 v64, v64, v65
    v_cvt_pk_bf16_f32 v65, v66, v67
    v_cvt_pk_bf16_f32 v66, v68, v69
    v_cvt_pk_bf16_f32 v67, v70, v71
    v_accvgpr_write_b32 a144, v64
    v_accvgpr_write_b32 a145, v65
    v_accvgpr_write_b32 a146, v66
    v_accvgpr_write_b32 a147, v67
    v_mul_f32 v72, s59, v72
    v_mul_f32 v73, s59, v73
    v_mul_f32 v74, s59, v74
    v_mul_f32 v75, s59, v75
    v_mul_f32 v76, s59, v76
    v_mul_f32 v77, s59, v77
    v_mul_f32 v78, s59, v78
    v_mul_f32 v79, s59, v79
    v_cvt_pk_bf16_f32 v72, v72, v73
    v_cvt_pk_bf16_f32 v73, v74, v75
    v_cvt_pk_bf16_f32 v74, v76, v77
    v_cvt_pk_bf16_f32 v75, v78, v79
    v_accvgpr_write_b32 a148, v72
    v_accvgpr_write_b32 a149, v73
    v_accvgpr_write_b32 a150, v74
    v_accvgpr_write_b32 a151, v75
    v_mul_f32 v128, s59, v128
    v_mul_f32 v129, s59, v129
    v_mul_f32 v130, s59, v130
    v_mul_f32 v131, s59, v131
    v_mul_f32 v132, s59, v132
    v_mul_f32 v133, s59, v133
    v_mul_f32 v134, s59, v134
    v_mul_f32 v135, s59, v135
    v_cvt_pk_bf16_f32 v128, v128, v129
    v_cvt_pk_bf16_f32 v129, v130, v131
    v_cvt_pk_bf16_f32 v130, v132, v133
    v_cvt_pk_bf16_f32 v131, v134, v135
    v_accvgpr_write_b32 a176, v128
    v_accvgpr_write_b32 a177, v129
    v_accvgpr_write_b32 a178, v130
    v_accvgpr_write_b32 a179, v131
    v_mul_f32 v136, s59, v136
    v_mul_f32 v137, s59, v137
    v_mul_f32 v138, s59, v138
    v_mul_f32 v139, s59, v139
    v_mul_f32 v140, s59, v140
    v_mul_f32 v141, s59, v141
    v_mul_f32 v142, s59, v142
    v_mul_f32 v143, s59, v143
    v_cvt_pk_bf16_f32 v136, v136, v137
    v_cvt_pk_bf16_f32 v137, v138, v139
    v_cvt_pk_bf16_f32 v138, v140, v141
    v_cvt_pk_bf16_f32 v139, v142, v143
    v_accvgpr_write_b32 a180, v136
    v_accvgpr_write_b32 a181, v137
    v_accvgpr_write_b32 a182, v138
    v_accvgpr_write_b32 a183, v139
    v_mul_f32 v80, s59, v80
    v_mul_f32 v81, s59, v81
    v_mul_f32 v82, s59, v82
    v_mul_f32 v83, s59, v83
    v_mul_f32 v84, s59, v84
    v_mul_f32 v85, s59, v85
    v_mul_f32 v86, s59, v86
    v_mul_f32 v87, s59, v87
    v_cvt_pk_bf16_f32 v80, v80, v81
    v_cvt_pk_bf16_f32 v81, v82, v83
    v_cvt_pk_bf16_f32 v82, v84, v85
    v_cvt_pk_bf16_f32 v83, v86, v87
    v_accvgpr_write_b32 a152, v80
    v_accvgpr_write_b32 a153, v81
    v_accvgpr_write_b32 a154, v82
    v_accvgpr_write_b32 a155, v83
    v_mul_f32 v88, s59, v88
    v_mul_f32 v89, s59, v89
    v_mul_f32 v90, s59, v90
    v_mul_f32 v91, s59, v91
    v_mul_f32 v92, s59, v92
    v_mul_f32 v93, s59, v93
    v_mul_f32 v94, s59, v94
    v_mul_f32 v95, s59, v95
    v_cvt_pk_bf16_f32 v88, v88, v89
    v_cvt_pk_bf16_f32 v89, v90, v91
    v_cvt_pk_bf16_f32 v90, v92, v93
    v_cvt_pk_bf16_f32 v91, v94, v95
    v_accvgpr_write_b32 a156, v88
    v_accvgpr_write_b32 a157, v89
    v_accvgpr_write_b32 a158, v90
    v_accvgpr_write_b32 a159, v91
    v_mul_f32 v144, s59, v144
    v_mul_f32 v145, s59, v145
    v_mul_f32 v146, s59, v146
    v_mul_f32 v147, s59, v147
    v_mul_f32 v148, s59, v148
    v_mul_f32 v149, s59, v149
    v_mul_f32 v150, s59, v150
    v_mul_f32 v151, s59, v151
    v_cvt_pk_bf16_f32 v144, v144, v145
    v_cvt_pk_bf16_f32 v145, v146, v147
    v_cvt_pk_bf16_f32 v146, v148, v149
    v_cvt_pk_bf16_f32 v147, v150, v151
    v_accvgpr_write_b32 a184, v144
    v_accvgpr_write_b32 a185, v145
    v_accvgpr_write_b32 a186, v146
    v_accvgpr_write_b32 a187, v147
    v_mul_f32 v152, s59, v152
    v_mul_f32 v153, s59, v153
    v_mul_f32 v154, s59, v154
    v_mul_f32 v155, s59, v155
    v_mul_f32 v156, s59, v156
    v_mul_f32 v157, s59, v157
    v_mul_f32 v158, s59, v158
    v_mul_f32 v159, s59, v159
    v_cvt_pk_bf16_f32 v152, v152, v153
    v_cvt_pk_bf16_f32 v153, v154, v155
    v_cvt_pk_bf16_f32 v154, v156, v157
    v_cvt_pk_bf16_f32 v155, v158, v159
    v_accvgpr_write_b32 a188, v152
    v_accvgpr_write_b32 a189, v153
    v_accvgpr_write_b32 a190, v154
    v_accvgpr_write_b32 a191, v155
    v_mov_b32 v144, 0
    v_mov_b32 v145, 0
    v_mov_b32 v146, 0
    v_mov_b32 v147, 0
    v_mov_b32 v148, 0
    v_mov_b32 v149, 0
    v_mov_b32 v150, 0
    v_mov_b32 v151, 0
    v_mov_b32 v25, 0
    v_mov_b32 v152, 0
    v_mov_b32 v153, 0
    v_mov_b32 v154, 0
    v_mov_b32 v155, 0
    v_mov_b32 v156, 0
    v_mov_b32 v157, 0
    v_mov_b32 v158, 0
    v_mov_b32 v159, 0
    v_mov_b32 v26, 0
    ds_read_b128 a[192:195], v8 offset:0
    ds_read_b128 a[196:199], v9 offset:0
    ds_read_b128 a[200:203], v10 offset:0
    ds_read_b128 a[204:207], v11 offset:0
    ds_read_b128 a[208:211], v12 offset:0
    ds_read_b128 a[212:215], v13 offset:0
    ds_read_b128 a[216:219], v14 offset:0
    ds_read_b128 a[220:223], v15 offset:0
    s_waitcnt lgkmcnt(0)
    v_mfma_f32_32x32x16_bf16 v[32:47], a[192:195], a[128:131], 0
    v_mfma_f32_32x32x16_bf16 v[32:47], a[196:199], a[132:135], v[32:47]
    v_mfma_f32_32x32x16_bf16 v[32:47], a[200:203], a[136:139], v[32:47]
    v_mfma_f32_32x32x16_bf16 v[32:47], a[204:207], a[140:143], v[32:47]
    v_mfma_f32_32x32x16_bf16 v[32:47], a[208:211], a[144:147], v[32:47]
    v_mfma_f32_32x32x16_bf16 v[32:47], a[212:215], a[148:151], v[32:47]
    v_mfma_f32_32x32x16_bf16 v[32:47], a[216:219], a[152:155], v[32:47]
    v_mfma_f32_32x32x16_bf16 v[32:47], a[220:223], a[156:159], v[32:47]
    v_mfma_f32_32x32x16_bf16 v[48:63], a[192:195], a[160:163], 0
    v_mfma_f32_32x32x16_bf16 v[48:63], a[196:199], a[164:167], v[48:63]
    v_mfma_f32_32x32x16_bf16 v[48:63], a[200:203], a[168:171], v[48:63]
    v_mfma_f32_32x32x16_bf16 v[48:63], a[204:207], a[172:175], v[48:63]
    v_mfma_f32_32x32x16_bf16 v[48:63], a[208:211], a[176:179], v[48:63]
    v_mfma_f32_32x32x16_bf16 v[48:63], a[212:215], a[180:183], v[48:63]
    v_mfma_f32_32x32x16_bf16 v[48:63], a[216:219], a[184:187], v[48:63]
    v_mfma_f32_32x32x16_bf16 v[48:63], a[220:223], a[188:191], v[48:63]
    ds_read_b128 a[192:195], v8 offset:8192
    ds_read_b128 a[196:199], v9 offset:8192
    ds_read_b128 a[200:203], v10 offset:8192
    ds_read_b128 a[204:207], v11 offset:8192
    ds_read_b128 a[208:211], v12 offset:8192
    ds_read_b128 a[212:215], v13 offset:8192
    ds_read_b128 a[216:219], v14 offset:8192
    ds_read_b128 a[220:223], v15 offset:8192
    s_nop 15
    s_nop 3
    v_max3_f32 v28, v32, v33, v34
    v_max3_f32 v28, v28, v35, v36
    v_max3_f32 v28, v28, v37, v38
    v_max3_f32 v28, v28, v39, v40
    v_max3_f32 v28, v28, v41, v42
    v_max3_f32 v28, v28, v43, v44
    v_max3_f32 v28, v28, v45, v46
    v_max_f32 v28, v28, v47
    v_mov_b32 v29, v28
    s_nop 1
    v_permlane32_swap_b32 v29, v28
    s_nop 1
    v_max_f32 v28, v28, v29
    v_sub_f32 v96, 0, v28
    v_sub_f32 v32, v32, v28
    v_sub_f32 v97, 0, v28
    v_sub_f32 v33, v33, v28
    v_sub_f32 v98, 0, v28
    v_sub_f32 v34, v34, v28
    v_sub_f32 v99, 0, v28
    v_sub_f32 v35, v35, v28
    v_sub_f32 v100, 0, v28
    v_sub_f32 v36, v36, v28
    v_sub_f32 v101, 0, v28
    v_sub_f32 v37, v37, v28
    v_sub_f32 v102, 0, v28
    v_sub_f32 v38, v38, v28
    v_sub_f32 v103, 0, v28
    v_sub_f32 v39, v39, v28
    v_sub_f32 v104, 0, v28
    v_sub_f32 v40, v40, v28
    v_sub_f32 v105, 0, v28
    v_sub_f32 v41, v41, v28
    v_sub_f32 v106, 0, v28
    v_sub_f32 v42, v42, v28
    v_sub_f32 v107, 0, v28
    v_sub_f32 v43, v43, v28
    v_sub_f32 v108, 0, v28
    v_sub_f32 v44, v44, v28
    v_sub_f32 v109, 0, v28
    v_sub_f32 v45, v45, v28
    v_sub_f32 v110, 0, v28
    v_sub_f32 v46, v46, v28
    v_sub_f32 v111, 0, v28
    v_sub_f32 v47, v47, v28
    v_max3_f32 v28, v48, v49, v50
    v_max3_f32 v28, v28, v51, v52
    v_max3_f32 v28, v28, v53, v54
    v_max3_f32 v28, v28, v55, v56
    v_max3_f32 v28, v28, v57, v58
    v_max3_f32 v28, v28, v59, v60
    v_max3_f32 v28, v28, v61, v62
    v_max_f32 v28, v28, v63
    v_mov_b32 v29, v28
    s_nop 1
    v_permlane32_swap_b32 v29, v28
    s_nop 1
    v_max_f32 v28, v28, v29
    v_sub_f32 v112, 0, v28
    v_sub_f32 v48, v48, v28
    v_sub_f32 v113, 0, v28
    v_sub_f32 v49, v49, v28
    v_sub_f32 v114, 0, v28
    v_sub_f32 v50, v50, v28
    v_sub_f32 v115, 0, v28
    v_sub_f32 v51, v51, v28
    v_sub_f32 v116, 0, v28
    v_sub_f32 v52, v52, v28
    v_sub_f32 v117, 0, v28
    v_sub_f32 v53, v53, v28
    v_sub_f32 v118, 0, v28
    v_sub_f32 v54, v54, v28
    v_sub_f32 v119, 0, v28
    v_sub_f32 v55, v55, v28
    v_sub_f32 v120, 0, v28
    v_sub_f32 v56, v56, v28
    v_sub_f32 v121, 0, v28
    v_sub_f32 v57, v57, v28
    v_sub_f32 v122, 0, v28
    v_sub_f32 v58, v58, v28
    v_sub_f32 v123, 0, v28
    v_sub_f32 v59, v59, v28
    v_sub_f32 v124, 0, v28
    v_sub_f32 v60, v60, v28
    v_sub_f32 v125, 0, v28
    v_sub_f32 v61, v61, v28
    v_sub_f32 v126, 0, v28
    v_sub_f32 v62, v62, v28
    v_sub_f32 v127, 0, v28
    v_sub_f32 v63, v63, v28
    s_mov_b32 s30, 0
    s_waitcnt lgkmcnt(0)
    s_nop 1
.p2align 6
attn_kernel_loop:
    v_mfma_f32_32x32x16_bf16 v[64:79], a[192:195], a[128:131], v[96:111]
    v_exp_f32 v28, v32
    v_exp_f32 v29, v33
    v_mfma_f32_32x32x16_bf16 v[64:79], a[196:199], a[132:135], v[64:79]
    v_exp_f32 v30, v34
    v_add_f32 v27, v28, v29
    v_exp_f32 v31, v35
    v_cvt_pk_bf16_f32 v128, v28, v29
    v_mfma_f32_32x32x16_bf16 v[64:79], a[200:203], a[136:139], v[64:79]
    v_exp_f32 v28, v36
    v_add_f32 v27, v27, v30
    v_add_f32 v27, v27, v31
    v_mfma_f32_32x32x16_bf16 v[64:79], a[204:207], a[140:143], v[64:79]
    v_exp_f32 v29, v37
    v_cvt_pk_bf16_f32 v129, v30, v31
    v_exp_f32 v30, v38
    v_mfma_f32_32x32x16_bf16 v[64:79], a[208:211], a[144:147], v[64:79]
    v_add_f32 v27, v27, v28
    v_add_f32 v27, v27, v29
    v_exp_f32 v31, v39
    v_cvt_pk_bf16_f32 v130, v28, v29
    v_mfma_f32_32x32x16_bf16 v[64:79], a[212:215], a[148:151], v[64:79]
    v_exp_f32 v28, v40
    v_add_f32 v27, v27, v30
    v_add_f32 v27, v27, v31
    v_mfma_f32_32x32x16_bf16 v[64:79], a[216:219], a[152:155], v[64:79]
    v_exp_f32 v29, v41
    v_cvt_pk_bf16_f32 v131, v30, v31
    v_exp_f32 v30, v42
    v_mfma_f32_32x32x16_bf16 v[64:79], a[220:223], a[156:159], v[64:79]
    v_add_f32 v27, v27, v28
    v_add_f32 v27, v27, v29
    v_exp_f32 v31, v43
    v_cvt_pk_bf16_f32 v132, v28, v29
    s_waitcnt vmcnt(8) lgkmcnt(0)
    s_barrier
    v_mfma_f32_32x32x16_bf16 a[0:15], a[224:227], v[144:147], a[0:15]
    s_add_u32 m0, s21, 49152
    v_exp_f32 v28, v44
    v_add_f32 v27, v27, v30
    v_add_f32 v27, v27, v31
    v_mfma_f32_32x32x16_bf16 a[16:31], a[232:235], v[144:147], a[16:31]
    buffer_load_dwordx4 v20, s[4:7], s22 offen offset:0 lds
    v_mfma_f32_32x32x16_bf16 a[32:47], a[240:243], v[144:147], a[32:47]
    buffer_load_dwordx4 v21, s[4:7], s22 offen offset:1024 lds
    v_exp_f32 v29, v45
    v_mfma_f32_32x32x16_bf16 a[48:63], a[248:251], v[144:147], a[48:63]
    buffer_load_dwordx4 v22, s[4:7], s22 offen offset:2048 lds
    v_mfma_f32_32x32x16_bf16 a[0:15], a[228:231], v[148:151], a[0:15]
    buffer_load_dwordx4 v23, s[4:7], s22 offen offset:3072 lds
    v_cvt_pk_bf16_f32 v133, v30, v31
    v_mfma_f32_32x32x16_bf16 a[16:31], a[236:239], v[148:151], a[16:31]
    v_exp_f32 v30, v46
    v_add_f32 v27, v27, v28
    v_add_f32 v27, v27, v29
    v_mfma_f32_32x32x16_bf16 a[32:47], a[244:247], v[148:151], a[32:47]
    v_exp_f32 v31, v47
    v_cvt_pk_bf16_f32 v134, v28, v29
    v_add_f32 v27, v27, v30
    v_add_f32 v27, v27, v31
    v_mfma_f32_32x32x16_bf16 a[48:63], a[252:255], v[148:151], a[48:63]
    s_add_u32 s22, s22, 16384
    v_cvt_pk_bf16_f32 v135, v30, v31
    v_cmp_lt_f32 vcc, s31, v27
    s_cbranch_vccnz attn_kernel_slow_0_0
attn_kernel_ret_0_0:
    v_add_f32 v25, v25, v27
    v_mfma_f32_32x32x16_bf16 v[80:95], a[192:195], a[160:163], v[112:127]
    ds_read_b128 a[192:195], v8 offset:16384
    v_exp_f32 v28, v48
    v_exp_f32 v29, v49
    v_mfma_f32_32x32x16_bf16 v[80:95], a[196:199], a[164:167], v[80:95]
    ds_read_b128 a[196:199], v9 offset:16384
    v_exp_f32 v30, v50
    v_add_f32 v27, v28, v29
    v_exp_f32 v31, v51
    v_mfma_f32_32x32x16_bf16 v[80:95], a[200:203], a[168:171], v[80:95]
    ds_read_b128 a[200:203], v10 offset:16384
    v_cvt_pk_bf16_f32 v136, v28, v29
    v_exp_f32 v28, v52
    v_add_f32 v27, v27, v30
    v_mfma_f32_32x32x16_bf16 v[80:95], a[204:207], a[172:175], v[80:95]
    ds_read_b128 a[204:207], v11 offset:16384
    v_add_f32 v27, v27, v31
    v_exp_f32 v29, v53
    v_cvt_pk_bf16_f32 v137, v30, v31
    v_mfma_f32_32x32x16_bf16 v[80:95], a[208:211], a[176:179], v[80:95]
    ds_read_b128 a[208:211], v12 offset:16384
    v_exp_f32 v30, v54
    v_add_f32 v27, v27, v28
    v_add_f32 v27, v27, v29
    v_mfma_f32_32x32x16_bf16 v[80:95], a[212:215], a[180:183], v[80:95]
    ds_read_b128 a[212:215], v13 offset:16384
    v_exp_f32 v31, v55
    v_cvt_pk_bf16_f32 v138, v28, v29
    v_exp_f32 v28, v56
    v_mfma_f32_32x32x16_bf16 v[80:95], a[216:219], a[184:187], v[80:95]
    ds_read_b128 a[216:219], v14 offset:16384
    v_add_f32 v27, v27, v30
    v_add_f32 v27, v27, v31
    v_exp_f32 v29, v57
    v_mfma_f32_32x32x16_bf16 v[80:95], a[220:223], a[188:191], v[80:95]
    ds_read_b128 a[220:223], v15 offset:16384
    v_cvt_pk_bf16_f32 v139, v30, v31
    v_exp_f32 v30, v58
    v_add_f32 v27, v27, v28
    v_mfma_f32_32x32x16_bf16 a[64:79], a[224:227], v[152:155], a[64:79]
    ds_read_b64_tr_b16 a[224:225], v16 offset:0
    ds_read_b64_tr_b16 a[226:227], v16 offset:2048
    v_add_f32 v27, v27, v29
    v_exp_f32 v31, v59
    v_mfma_f32_32x32x16_bf16 a[80:95], a[232:235], v[152:155], a[80:95]
    ds_read_b64_tr_b16 a[232:233], v17 offset:0
    ds_read_b64_tr_b16 a[234:235], v17 offset:2048
    v_cvt_pk_bf16_f32 v140, v28, v29
    v_exp_f32 v28, v60
    v_mfma_f32_32x32x16_bf16 a[96:111], a[240:243], v[152:155], a[96:111]
    s_waitcnt lgkmcnt(4)
    ds_read_b64_tr_b16 a[240:241], v18 offset:0
    ds_read_b64_tr_b16 a[242:243], v18 offset:2048
    v_add_f32 v27, v27, v30
    v_add_f32 v27, v27, v31
    v_mfma_f32_32x32x16_bf16 a[112:127], a[248:251], v[152:155], a[112:127]
    ds_read_b64_tr_b16 a[248:249], v19 offset:0
    ds_read_b64_tr_b16 a[250:251], v19 offset:2048
    v_exp_f32 v29, v61
    v_cvt_pk_bf16_f32 v141, v30, v31
    v_mfma_f32_32x32x16_bf16 a[64:79], a[228:231], v[156:159], a[64:79]
    ds_read_b64_tr_b16 a[228:229], v16 offset:4096
    ds_read_b64_tr_b16 a[230:231], v16 offset:6144
    v_exp_f32 v30, v62
    v_add_f32 v27, v27, v28
    v_mfma_f32_32x32x16_bf16 a[80:95], a[236:239], v[156:159], a[80:95]
    ds_read_b64_tr_b16 a[236:237], v17 offset:4096
    ds_read_b64_tr_b16 a[238:239], v17 offset:6144
    v_add_f32 v27, v27, v29
    v_exp_f32 v31, v63
    v_cvt_pk_bf16_f32 v142, v28, v29
    v_mfma_f32_32x32x16_bf16 a[96:111], a[244:247], v[156:159], a[96:111]
    ds_read_b64_tr_b16 a[244:245], v18 offset:4096
    ds_read_b64_tr_b16 a[246:247], v18 offset:6144
    v_add_f32 v27, v27, v30
    v_add_f32 v27, v27, v31
    v_cvt_pk_bf16_f32 v143, v30, v31
    v_mfma_f32_32x32x16_bf16 a[112:127], a[252:255], v[156:159], a[112:127]
    ds_read_b64_tr_b16 a[252:253], v19 offset:4096
    ds_read_b64_tr_b16 a[254:255], v19 offset:6144
    v_cmp_lt_f32 vcc, s31, v27
    s_cbranch_vccnz attn_kernel_slow_0_1
attn_kernel_ret_0_1:
    v_add_f32 v26, v26, v27
    v_mfma_f32_32x32x16_bf16 v[32:47], a[192:195], a[128:131], v[96:111]
    v_exp_f32 v28, v64
    v_exp_f32 v29, v65
    v_mfma_f32_32x32x16_bf16 v[32:47], a[196:199], a[132:135], v[32:47]
    v_exp_f32 v30, v66
    v_add_f32 v27, v28, v29
    v_exp_f32 v31, v67
    v_cvt_pk_bf16_f32 v144, v28, v29
    v_mfma_f32_32x32x16_bf16 v[32:47], a[200:203], a[136:139], v[32:47]
    v_exp_f32 v28, v68
    v_add_f32 v27, v27, v30
    v_add_f32 v27, v27, v31
    v_mfma_f32_32x32x16_bf16 v[32:47], a[204:207], a[140:143], v[32:47]
    v_exp_f32 v29, v69
    v_cvt_pk_bf16_f32 v145, v30, v31
    v_exp_f32 v30, v70
    v_mfma_f32_32x32x16_bf16 v[32:47], a[208:211], a[144:147], v[32:47]
    v_add_f32 v27, v27, v28
    v_add_f32 v27, v27, v29
    v_exp_f32 v31, v71
    v_cvt_pk_bf16_f32 v146, v28, v29
    v_mfma_f32_32x32x16_bf16 v[32:47], a[212:215], a[148:151], v[32:47]
    v_exp_f32 v28, v72
    v_add_f32 v27, v27, v30
    v_add_f32 v27, v27, v31
    v_mfma_f32_32x32x16_bf16 v[32:47], a[216:219], a[152:155], v[32:47]
    v_exp_f32 v29, v73
    v_cvt_pk_bf16_f32 v147, v30, v31
    v_exp_f32 v30, v74
    v_add_f32 v27, v27, v28
    v_mfma_f32_32x32x16_bf16 v[32:47], a[220:223], a[156:159], v[32:47]
    v_add_f32 v27, v27, v29
    v_exp_f32 v31, v75
    v_cvt_pk_bf16_f32 v148, v28, v29
    s_waitcnt lgkmcnt(0)
    v_mfma_f32_32x32x16_bf16 a[0:15], a[224:227], v[128:131], a[0:15]
    s_add_u32 m0, s21, 98304
    v_exp_f32 v28, v76
    v_add_f32 v27, v27, v30
    v_add_f32 v27, v27, v31
    v_mfma_f32_32x32x16_bf16 a[16:31], a[232:235], v[128:131], a[16:31]
    buffer_load_dwordx4 v24, s[8:11], s23 offen offset:0 lds
    v_exp_f32 v29, v77
    v_mfma_f32_32x32x16_bf16 a[32:47], a[240:243], v[128:131], a[32:47]
    buffer_load_dwordx4 v24, s[8:11], s23 offen offset:1024 lds
    v_mfma_f32_32x32x16_bf16 a[48:63], a[248:251], v[128:131], a[48:63]
    buffer_load_dwordx4 v24, s[8:11], s23 offen offset:2048 lds
    v_cvt_pk_bf16_f32 v149, v30, v31
    v_mfma_f32_32x32x16_bf16 a[0:15], a[228:231], v[132:135], a[0:15]
    buffer_load_dwordx4 v24, s[8:11], s23 offen offset:3072 lds
    v_mfma_f32_32x32x16_bf16 a[16:31], a[236:239], v[132:135], a[16:31]
    v_exp_f32 v30, v78
    v_add_f32 v27, v27, v28
    v_add_f32 v27, v27, v29
    v_exp_f32 v31, v79
    v_mfma_f32_32x32x16_bf16 a[32:47], a[244:247], v[132:135], a[32:47]
    buffer_load_dwordx4 v[172:175], v168, s[84:87], s96 offen
    v_cvt_pk_bf16_f32 v150, v28, v29
    v_add_f32 v27, v27, v30
    v_add_f32 v27, v27, v31
    v_mfma_f32_32x32x16_bf16 a[48:63], a[252:255], v[132:135], a[48:63]
    s_add_u32 s23, s23, 16384
    v_cvt_pk_bf16_f32 v151, v30, v31
    v_cmp_lt_f32 vcc, s31, v27
    s_cbranch_vccnz attn_kernel_slow_1_0
attn_kernel_ret_1_0:
    v_add_f32 v25, v25, v27
    v_mfma_f32_32x32x16_bf16 v[48:63], a[192:195], a[160:163], v[112:127]
    ds_read_b128 a[192:195], v8 offset:24576
    v_exp_f32 v28, v80
    v_exp_f32 v29, v81
    v_mfma_f32_32x32x16_bf16 v[48:63], a[196:199], a[164:167], v[48:63]
    ds_read_b128 a[196:199], v9 offset:24576
    v_exp_f32 v30, v82
    v_add_f32 v27, v28, v29
    v_exp_f32 v31, v83
    v_mfma_f32_32x32x16_bf16 v[48:63], a[200:203], a[168:171], v[48:63]
    ds_read_b128 a[200:203], v10 offset:24576
    v_cvt_pk_bf16_f32 v152, v28, v29
    v_exp_f32 v28, v84
    v_add_f32 v27, v27, v30
    v_mfma_f32_32x32x16_bf16 v[48:63], a[204:207], a[172:175], v[48:63]
    ds_read_b128 a[204:207], v11 offset:24576
    v_add_f32 v27, v27, v31
    v_exp_f32 v29, v85
    v_cvt_pk_bf16_f32 v153, v30, v31
    v_mfma_f32_32x32x16_bf16 v[48:63], a[208:211], a[176:179], v[48:63]
    ds_read_b128 a[208:211], v12 offset:24576
    v_exp_f32 v30, v86
    v_add_f32 v27, v27, v28
    v_add_f32 v27, v27, v29
    v_mfma_f32_32x32x16_bf16 v[48:63], a[212:215], a[180:183], v[48:63]
    ds_read_b128 a[212:215], v13 offset:24576
    v_exp_f32 v31, v87
    v_cvt_pk_bf16_f32 v154, v28, v29
    v_exp_f32 v28, v88
    v_mfma_f32_32x32x16_bf16 v[48:63], a[216:219], a[184:187], v[48:63]
    ds_read_b128 a[216:219], v14 offset:24576
    v_add_f32 v27, v27, v30
    v_add_f32 v27, v27, v31
    v_exp_f32 v29, v89
    v_mfma_f32_32x32x16_bf16 v[48:63], a[220:223], a[188:191], v[48:63]
    ds_read_b128 a[220:223], v15 offset:24576
    v_cvt_pk_bf16_f32 v155, v30, v31
    v_exp_f32 v30, v90
    v_add_f32 v27, v27, v28
    v_mfma_f32_32x32x16_bf16 a[64:79], a[224:227], v[136:139], a[64:79]
    ds_read_b64_tr_b16 a[224:225], v16 offset:8192
    ds_read_b64_tr_b16 a[226:227], v16 offset:10240
    v_add_f32 v27, v27, v29
    v_exp_f32 v31, v91
    v_mfma_f32_32x32x16_bf16 a[80:95], a[232:235], v[136:139], a[80:95]
    ds_read_b64_tr_b16 a[232:233], v17 offset:8192
    ds_read_b64_tr_b16 a[234:235], v17 offset:10240
    v_cvt_pk_bf16_f32 v156, v28, v29
    v_exp_f32 v28, v92
    v_mfma_f32_32x32x16_bf16 a[96:111], a[240:243], v[136:139], a[96:111]
    s_waitcnt lgkmcnt(4)
    ds_read_b64_tr_b16 a[240:241], v18 offset:8192
    ds_read_b64_tr_b16 a[242:243], v18 offset:10240
    v_add_f32 v27, v27, v30
    v_add_f32 v27, v27, v31
    v_mfma_f32_32x32x16_bf16 a[112:127], a[248:251], v[136:139], a[112:127]
    ds_read_b64_tr_b16 a[248:249], v19 offset:8192
    ds_read_b64_tr_b16 a[250:251], v19 offset:10240
    v_exp_f32 v29, v93
    v_cvt_pk_bf16_f32 v157, v30, v31
    v_mfma_f32_32x32x16_bf16 a[64:79], a[228:231], v[140:143], a[64:79]
    ds_read_b64_tr_b16 a[228:229], v16 offset:12288
    ds_read_b64_tr_b16 a[230:231], v16 offset:14336
    v_exp_f32 v30, v94
    v_add_f32 v27, v27, v28
    v_mfma_f32_32x32x16_bf16 a[80:95], a[236:239], v[140:143], a[80:95]
    ds_read_b64_tr_b16 a[236:237], v17 offset:12288
    ds_read_b64_tr_b16 a[238:239], v17 offset:14336
    v_add_f32 v27, v27, v29
    v_exp_f32 v31, v95
    v_cvt_pk_bf16_f32 v158, v28, v29
    v_mfma_f32_32x32x16_bf16 a[96:111], a[244:247], v[140:143], a[96:111]
    ds_read_b64_tr_b16 a[244:245], v18 offset:12288
    ds_read_b64_tr_b16 a[246:247], v18 offset:14336
    v_add_f32 v27, v27, v30
    v_add_f32 v27, v27, v31
    v_cvt_pk_bf16_f32 v159, v30, v31
    v_mfma_f32_32x32x16_bf16 a[112:127], a[252:255], v[140:143], a[112:127]
    ds_read_b64_tr_b16 a[252:253], v19 offset:12288
    ds_read_b64_tr_b16 a[254:255], v19 offset:14336
    v_cmp_lt_f32 vcc, s31, v27
    s_cbranch_vccnz attn_kernel_slow_1_1
attn_kernel_ret_1_1:
    v_add_f32 v26, v26, v27
    v_mfma_f32_32x32x16_bf16 v[64:79], a[192:195], a[128:131], v[96:111]
    v_exp_f32 v28, v32
    v_exp_f32 v29, v33
    v_mfma_f32_32x32x16_bf16 v[64:79], a[196:199], a[132:135], v[64:79]
    v_exp_f32 v30, v34
    v_add_f32 v27, v28, v29
    v_exp_f32 v31, v35
    v_cvt_pk_bf16_f32 v128, v28, v29
    v_mfma_f32_32x32x16_bf16 v[64:79], a[200:203], a[136:139], v[64:79]
    v_exp_f32 v28, v36
    v_add_f32 v27, v27, v30
    v_add_f32 v27, v27, v31
    v_mfma_f32_32x32x16_bf16 v[64:79], a[204:207], a[140:143], v[64:79]
    v_exp_f32 v29, v37
    v_cvt_pk_bf16_f32 v129, v30, v31
    v_exp_f32 v30, v38
    v_mfma_f32_32x32x16_bf16 v[64:79], a[208:211], a[144:147], v[64:79]
    v_add_f32 v27, v27, v28
    v_add_f32 v27, v27, v29
    v_exp_f32 v31, v39
    v_cvt_pk_bf16_f32 v130, v28, v29
    v_mfma_f32_32x32x16_bf16 v[64:79], a[212:215], a[148:151], v[64:79]
    v_exp_f32 v28, v40
    v_add_f32 v27, v27, v30
    v_add_f32 v27, v27, v31
    v_mfma_f32_32x32x16_bf16 v[64:79], a[216:219], a[152:155], v[64:79]
    v_exp_f32 v29, v41
    v_cvt_pk_bf16_f32 v131, v30, v31
    v_exp_f32 v30, v42
    v_mfma_f32_32x32x16_bf16 v[64:79], a[220:223], a[156:159], v[64:79]
    v_add_f32 v27, v27, v28
    v_add_f32 v27, v27, v29
    v_exp_f32 v31, v43
    v_cvt_pk_bf16_f32 v132, v28, v29
    s_waitcnt vmcnt(8) lgkmcnt(0)
    s_barrier
    v_mfma_f32_32x32x16_bf16 a[0:15], a[224:227], v[144:147], a[0:15]
    s_add_u32 m0, s21, 0
    v_exp_f32 v28, v44
    v_add_f32 v27, v27, v30
    v_add_f32 v27, v27, v31
    v_mfma_f32_32x32x16_bf16 a[16:31], a[232:235], v[144:147], a[16:31]
    buffer_load_dwordx4 v20, s[4:7], s22 offen offset:0 lds
    v_mfma_f32_32x32x16_bf16 a[32:47], a[240:243], v[144:147], a[32:47]
    buffer_load_dwordx4 v21, s[4:7], s22 offen offset:1024 lds
    v_exp_f32 v29, v45
    v_mfma_f32_32x32x16_bf16 a[48:63], a[248:251], v[144:147], a[48:63]
    buffer_load_dwordx4 v22, s[4:7], s22 offen offset:2048 lds
    v_mfma_f32_32x32x16_bf16 a[0:15], a[228:231], v[148:151], a[0:15]
    buffer_load_dwordx4 v23, s[4:7], s22 offen offset:3072 lds
    v_cvt_pk_bf16_f32 v133, v30, v31
    v_mfma_f32_32x32x16_bf16 a[16:31], a[236:239], v[148:151], a[16:31]
    v_exp_f32 v30, v46
    v_add_f32 v27, v27, v28
    v_add_f32 v27, v27, v29
    v_mfma_f32_32x32x16_bf16 a[32:47], a[244:247], v[148:151], a[32:47]
    v_exp_f32 v31, v47
    v_cvt_pk_bf16_f32 v134, v28, v29
    v_add_f32 v27, v27, v30
    v_add_f32 v27, v27, v31
    v_mfma_f32_32x32x16_bf16 a[48:63], a[252:255], v[148:151], a[48:63]
    s_add_u32 s22, s22, 16384
    v_cvt_pk_bf16_f32 v135, v30, v31
    v_cmp_lt_f32 vcc, s31, v27
    s_cbranch_vccnz attn_kernel_slow_2_0
attn_kernel_ret_2_0:
    v_add_f32 v25, v25, v27
    v_mfma_f32_32x32x16_bf16 v[80:95], a[192:195], a[160:163], v[112:127]
    ds_read_b128 a[192:195], v8 offset:32768
    v_exp_f32 v28, v48
    v_exp_f32 v29, v49
    v_mfma_f32_32x32x16_bf16 v[80:95], a[196:199], a[164:167], v[80:95]
    ds_read_b128 a[196:199], v9 offset:32768
    v_exp_f32 v30, v50
    v_add_f32 v27, v28, v29
    v_exp_f32 v31, v51
    v_mfma_f32_32x32x16_bf16 v[80:95], a[200:203], a[168:171], v[80:95]
    ds_read_b128 a[200:203], v10 offset:32768
    v_cvt_pk_bf16_f32 v136, v28, v29
    v_exp_f32 v28, v52
    v_add_f32 v27, v27, v30
    v_mfma_f32_32x32x16_bf16 v[80:95], a[204:207], a[172:175], v[80:95]
    ds_read_b128 a[204:207], v11 offset:32768
    v_add_f32 v27, v27, v31
    v_exp_f32 v29, v53
    v_cvt_pk_bf16_f32 v137, v30, v31
    v_mfma_f32_32x32x16_bf16 v[80:95], a[208:211], a[176:179], v[80:95]
    ds_read_b128 a[208:211], v12 offset:32768
    v_exp_f32 v30, v54
    v_add_f32 v27, v27, v28
    v_add_f32 v27, v27, v29
    v_mfma_f32_32x32x16_bf16 v[80:95], a[212:215], a[180:183], v[80:95]
    ds_read_b128 a[212:215], v13 offset:32768
    v_exp_f32 v31, v55
    v_cvt_pk_bf16_f32 v138, v28, v29
    v_exp_f32 v28, v56
    v_mfma_f32_32x32x16_bf16 v[80:95], a[216:219], a[184:187], v[80:95]
    ds_read_b128 a[216:219], v14 offset:32768
    v_add_f32 v27, v27, v30
    v_add_f32 v27, v27, v31
    v_exp_f32 v29, v57
    v_mfma_f32_32x32x16_bf16 v[80:95], a[220:223], a[188:191], v[80:95]
    ds_read_b128 a[220:223], v15 offset:32768
    v_cvt_pk_bf16_f32 v139, v30, v31
    v_exp_f32 v30, v58
    v_add_f32 v27, v27, v28
    v_mfma_f32_32x32x16_bf16 a[64:79], a[224:227], v[152:155], a[64:79]
    ds_read_b64_tr_b16 a[224:225], v16 offset:16384
    ds_read_b64_tr_b16 a[226:227], v16 offset:18432
    v_add_f32 v27, v27, v29
    v_exp_f32 v31, v59
    v_mfma_f32_32x32x16_bf16 a[80:95], a[232:235], v[152:155], a[80:95]
    ds_read_b64_tr_b16 a[232:233], v17 offset:16384
    ds_read_b64_tr_b16 a[234:235], v17 offset:18432
    v_cvt_pk_bf16_f32 v140, v28, v29
    v_exp_f32 v28, v60
    v_mfma_f32_32x32x16_bf16 a[96:111], a[240:243], v[152:155], a[96:111]
    s_waitcnt lgkmcnt(4)
    ds_read_b64_tr_b16 a[240:241], v18 offset:16384
    ds_read_b64_tr_b16 a[242:243], v18 offset:18432
    v_add_f32 v27, v27, v30
    v_add_f32 v27, v27, v31
    v_mfma_f32_32x32x16_bf16 a[112:127], a[248:251], v[152:155], a[112:127]
    ds_read_b64_tr_b16 a[248:249], v19 offset:16384
    ds_read_b64_tr_b16 a[250:251], v19 offset:18432
    v_exp_f32 v29, v61
    v_cvt_pk_bf16_f32 v141, v30, v31
    v_mfma_f32_32x32x16_bf16 a[64:79], a[228:231], v[156:159], a[64:79]
    ds_read_b64_tr_b16 a[228:229], v16 offset:20480
    ds_read_b64_tr_b16 a[230:231], v16 offset:22528
    v_exp_f32 v30, v62
    v_add_f32 v27, v27, v28
    v_mfma_f32_32x32x16_bf16 a[80:95], a[236:239], v[156:159], a[80:95]
    ds_read_b64_tr_b16 a[236:237], v17 offset:20480
    ds_read_b64_tr_b16 a[238:239], v17 offset:22528
    v_add_f32 v27, v27, v29
    v_exp_f32 v31, v63
    v_cvt_pk_bf16_f32 v142, v28, v29
    v_mfma_f32_32x32x16_bf16 a[96:111], a[244:247], v[156:159], a[96:111]
    ds_read_b64_tr_b16 a[244:245], v18 offset:20480
    ds_read_b64_tr_b16 a[246:247], v18 offset:22528
    v_add_f32 v27, v27, v30
    v_add_f32 v27, v27, v31
    v_cvt_pk_bf16_f32 v143, v30, v31
    v_mfma_f32_32x32x16_bf16 a[112:127], a[252:255], v[156:159], a[112:127]
    ds_read_b64_tr_b16 a[252:253], v19 offset:20480
    ds_read_b64_tr_b16 a[254:255], v19 offset:22528
    v_cmp_lt_f32 vcc, s31, v27
    s_cbranch_vccnz attn_kernel_slow_2_1
attn_kernel_ret_2_1:
    v_add_f32 v26, v26, v27
    v_mfma_f32_32x32x16_bf16 v[32:47], a[192:195], a[128:131], v[96:111]
    v_exp_f32 v28, v64
    v_exp_f32 v29, v65
    v_mfma_f32_32x32x16_bf16 v[32:47], a[196:199], a[132:135], v[32:47]
    v_exp_f32 v30, v66
    v_add_f32 v27, v28, v29
    v_exp_f32 v31, v67
    v_cvt_pk_bf16_f32 v144, v28, v29
    v_mfma_f32_32x32x16_bf16 v[32:47], a[200:203], a[136:139], v[32:47]
    v_exp_f32 v28, v68
    v_add_f32 v27, v27, v30
    v_add_f32 v27, v27, v31
    v_mfma_f32_32x32x16_bf16 v[32:47], a[204:207], a[140:143], v[32:47]
    v_exp_f32 v29, v69
    v_cvt_pk_bf16_f32 v145, v30, v31
    v_exp_f32 v30, v70
    v_mfma_f32_32x32x16_bf16 v[32:47], a[208:211], a[144:147], v[32:47]
    v_add_f32 v27, v27, v28
    v_add_f32 v27, v27, v29
    v_exp_f32 v31, v71
    v_cvt_pk_bf16_f32 v146, v28, v29
    v_mfma_f32_32x32x16_bf16 v[32:47], a[212:215], a[148:151], v[32:47]
    v_exp_f32 v28, v72
    v_add_f32 v27, v27, v30
    v_add_f32 v27, v27, v31
    v_mfma_f32_32x32x16_bf16 v[32:47], a[216:219], a[152:155], v[32:47]
    v_exp_f32 v29, v73
    v_cvt_pk_bf16_f32 v147, v30, v31
    v_exp_f32 v30, v74
    v_add_f32 v27, v27, v28
    v_mfma_f32_32x32x16_bf16 v[32:47], a[220:223], a[156:159], v[32:47]
    v_add_f32 v27, v27, v29
    v_exp_f32 v31, v75
    v_cvt_pk_bf16_f32 v148, v28, v29
    s_waitcnt lgkmcnt(0)
    v_mfma_f32_32x32x16_bf16 a[0:15], a[224:227], v[128:131], a[0:15]
    s_add_u32 m0, s21, 114688
    v_exp_f32 v28, v76
    v_add_f32 v27, v27, v30
    v_add_f32 v27, v27, v31
    v_mfma_f32_32x32x16_bf16 a[16:31], a[232:235], v[128:131], a[16:31]
    buffer_load_dwordx4 v24, s[8:11], s23 offen offset:0 lds
    v_exp_f32 v29, v77
    v_mfma_f32_32x32x16_bf16 a[32:47], a[240:243], v[128:131], a[32:47]
    buffer_load_dwordx4 v24, s[8:11], s23 offen offset:1024 lds
    v_mfma_f32_32x32x16_bf16 a[48:63], a[248:251], v[128:131], a[48:63]
    buffer_load_dwordx4 v24, s[8:11], s23 offen offset:2048 lds
    v_cvt_pk_bf16_f32 v149, v30, v31
    v_mfma_f32_32x32x16_bf16 a[0:15], a[228:231], v[132:135], a[0:15]
    buffer_load_dwordx4 v24, s[8:11], s23 offen offset:3072 lds
    v_mfma_f32_32x32x16_bf16 a[16:31], a[236:239], v[132:135], a[16:31]
    v_exp_f32 v30, v78
    v_add_f32 v27, v27, v28
    v_add_f32 v27, v27, v29
    v_exp_f32 v31, v79
    v_mfma_f32_32x32x16_bf16 a[32:47], a[244:247], v[132:135], a[32:47]
    buffer_load_dwordx4 v[172:175], v168, s[88:91], s96 offen
    v_cvt_pk_bf16_f32 v150, v28, v29
    v_add_f32 v27, v27, v30
    v_add_f32 v27, v27, v31
    v_mfma_f32_32x32x16_bf16 a[48:63], a[252:255], v[132:135], a[48:63]
    s_add_u32 s23, s23, 16384
    v_cvt_pk_bf16_f32 v151, v30, v31
    v_cmp_lt_f32 vcc, s31, v27
    s_cbranch_vccnz attn_kernel_slow_3_0
attn_kernel_ret_3_0:
    v_add_f32 v25, v25, v27
    v_mfma_f32_32x32x16_bf16 v[48:63], a[192:195], a[160:163], v[112:127]
    ds_read_b128 a[192:195], v8 offset:40960
    v_exp_f32 v28, v80
    v_exp_f32 v29, v81
    v_mfma_f32_32x32x16_bf16 v[48:63], a[196:199], a[164:167], v[48:63]
    ds_read_b128 a[196:199], v9 offset:40960
    v_exp_f32 v30, v82
    v_add_f32 v27, v28, v29
    v_exp_f32 v31, v83
    v_mfma_f32_32x32x16_bf16 v[48:63], a[200:203], a[168:171], v[48:63]
    ds_read_b128 a[200:203], v10 offset:40960
    v_cvt_pk_bf16_f32 v152, v28, v29
    v_exp_f32 v28, v84
    v_add_f32 v27, v27, v30
    v_mfma_f32_32x32x16_bf16 v[48:63], a[204:207], a[172:175], v[48:63]
    ds_read_b128 a[204:207], v11 offset:40960
    v_add_f32 v27, v27, v31
    v_exp_f32 v29, v85
    v_cvt_pk_bf16_f32 v153, v30, v31
    v_mfma_f32_32x32x16_bf16 v[48:63], a[208:211], a[176:179], v[48:63]
    ds_read_b128 a[208:211], v12 offset:40960
    v_exp_f32 v30, v86
    v_add_f32 v27, v27, v28
    v_add_f32 v27, v27, v29
    v_mfma_f32_32x32x16_bf16 v[48:63], a[212:215], a[180:183], v[48:63]
    ds_read_b128 a[212:215], v13 offset:40960
    v_exp_f32 v31, v87
    v_cvt_pk_bf16_f32 v154, v28, v29
    v_exp_f32 v28, v88
    v_mfma_f32_32x32x16_bf16 v[48:63], a[216:219], a[184:187], v[48:63]
    ds_read_b128 a[216:219], v14 offset:40960
    v_add_f32 v27, v27, v30
    v_add_f32 v27, v27, v31
    v_exp_f32 v29, v89
    v_mfma_f32_32x32x16_bf16 v[48:63], a[220:223], a[188:191], v[48:63]
    ds_read_b128 a[220:223], v15 offset:40960
    v_cvt_pk_bf16_f32 v155, v30, v31
    v_exp_f32 v30, v90
    v_add_f32 v27, v27, v28
    v_mfma_f32_32x32x16_bf16 a[64:79], a[224:227], v[136:139], a[64:79]
    ds_read_b64_tr_b16 a[224:225], v16 offset:24576
    ds_read_b64_tr_b16 a[226:227], v16 offset:26624
    v_add_f32 v27, v27, v29
    v_exp_f32 v31, v91
    v_mfma_f32_32x32x16_bf16 a[80:95], a[232:235], v[136:139], a[80:95]
    ds_read_b64_tr_b16 a[232:233], v17 offset:24576
    ds_read_b64_tr_b16 a[234:235], v17 offset:26624
    v_cvt_pk_bf16_f32 v156, v28, v29
    v_exp_f32 v28, v92
    v_mfma_f32_32x32x16_bf16 a[96:111], a[240:243], v[136:139], a[96:111]
    s_waitcnt lgkmcnt(4)
    ds_read_b64_tr_b16 a[240:241], v18 offset:24576
    ds_read_b64_tr_b16 a[242:243], v18 offset:26624
    v_add_f32 v27, v27, v30
    v_add_f32 v27, v27, v31
    v_mfma_f32_32x32x16_bf16 a[112:127], a[248:251], v[136:139], a[112:127]
    ds_read_b64_tr_b16 a[248:249], v19 offset:24576
    ds_read_b64_tr_b16 a[250:251], v19 offset:26624
    v_exp_f32 v29, v93
    v_cvt_pk_bf16_f32 v157, v30, v31
    v_mfma_f32_32x32x16_bf16 a[64:79], a[228:231], v[140:143], a[64:79]
    ds_read_b64_tr_b16 a[228:229], v16 offset:28672
    ds_read_b64_tr_b16 a[230:231], v16 offset:30720
    v_exp_f32 v30, v94
    v_add_f32 v27, v27, v28
    v_mfma_f32_32x32x16_bf16 a[80:95], a[236:239], v[140:143], a[80:95]
    ds_read_b64_tr_b16 a[236:237], v17 offset:28672
    ds_read_b64_tr_b16 a[238:239], v17 offset:30720
    v_add_f32 v27, v27, v29
    v_exp_f32 v31, v95
    v_cvt_pk_bf16_f32 v158, v28, v29
    v_mfma_f32_32x32x16_bf16 a[96:111], a[244:247], v[140:143], a[96:111]
    ds_read_b64_tr_b16 a[244:245], v18 offset:28672
    ds_read_b64_tr_b16 a[246:247], v18 offset:30720
    v_add_f32 v27, v27, v30
    v_add_f32 v27, v27, v31
    v_cvt_pk_bf16_f32 v159, v30, v31
    v_mfma_f32_32x32x16_bf16 a[112:127], a[252:255], v[140:143], a[112:127]
    ds_read_b64_tr_b16 a[252:253], v19 offset:28672
    ds_read_b64_tr_b16 a[254:255], v19 offset:30720
    v_cmp_lt_f32 vcc, s31, v27
    s_cbranch_vccnz attn_kernel_slow_3_1
attn_kernel_ret_3_1:
    v_add_f32 v26, v26, v27
    v_mfma_f32_32x32x16_bf16 v[64:79], a[192:195], a[128:131], v[96:111]
    v_exp_f32 v28, v32
    v_exp_f32 v29, v33
    v_mfma_f32_32x32x16_bf16 v[64:79], a[196:199], a[132:135], v[64:79]
    v_exp_f32 v30, v34
    v_add_f32 v27, v28, v29
    v_exp_f32 v31, v35
    v_cvt_pk_bf16_f32 v128, v28, v29
    v_mfma_f32_32x32x16_bf16 v[64:79], a[200:203], a[136:139], v[64:79]
    v_exp_f32 v28, v36
    v_add_f32 v27, v27, v30
    v_add_f32 v27, v27, v31
    v_mfma_f32_32x32x16_bf16 v[64:79], a[204:207], a[140:143], v[64:79]
    v_exp_f32 v29, v37
    v_cvt_pk_bf16_f32 v129, v30, v31
    v_exp_f32 v30, v38
    v_mfma_f32_32x32x16_bf16 v[64:79], a[208:211], a[144:147], v[64:79]
    v_add_f32 v27, v27, v28
    v_add_f32 v27, v27, v29
    v_exp_f32 v31, v39
    v_cvt_pk_bf16_f32 v130, v28, v29
    v_mfma_f32_32x32x16_bf16 v[64:79], a[212:215], a[148:151], v[64:79]
    v_exp_f32 v28, v40
    v_add_f32 v27, v27, v30
    v_add_f32 v27, v27, v31
    v_mfma_f32_32x32x16_bf16 v[64:79], a[216:219], a[152:155], v[64:79]
    v_exp_f32 v29, v41
    v_cvt_pk_bf16_f32 v131, v30, v31
    v_exp_f32 v30, v42
    v_mfma_f32_32x32x16_bf16 v[64:79], a[220:223], a[156:159], v[64:79]
    v_add_f32 v27, v27, v28
    v_add_f32 v27, v27, v29
    v_exp_f32 v31, v43
    v_cvt_pk_bf16_f32 v132, v28, v29
    s_waitcnt vmcnt(8) lgkmcnt(0)
    s_barrier
    v_mfma_f32_32x32x16_bf16 a[0:15], a[224:227], v[144:147], a[0:15]
    s_add_u32 m0, s21, 16384
    v_exp_f32 v28, v44
    v_add_f32 v27, v27, v30
    v_add_f32 v27, v27, v31
    v_mfma_f32_32x32x16_bf16 a[16:31], a[232:235], v[144:147], a[16:31]
    buffer_load_dwordx4 v20, s[4:7], s22 offen offset:0 lds
    v_mfma_f32_32x32x16_bf16 a[32:47], a[240:243], v[144:147], a[32:47]
    buffer_load_dwordx4 v21, s[4:7], s22 offen offset:1024 lds
    v_exp_f32 v29, v45
    v_mfma_f32_32x32x16_bf16 a[48:63], a[248:251], v[144:147], a[48:63]
    buffer_load_dwordx4 v22, s[4:7], s22 offen offset:2048 lds
    v_mfma_f32_32x32x16_bf16 a[0:15], a[228:231], v[148:151], a[0:15]
    buffer_load_dwordx4 v23, s[4:7], s22 offen offset:3072 lds
    v_cvt_pk_bf16_f32 v133, v30, v31
    v_mfma_f32_32x32x16_bf16 a[16:31], a[236:239], v[148:151], a[16:31]
    v_exp_f32 v30, v46
    v_add_f32 v27, v27, v28
    v_add_f32 v27, v27, v29
    v_mfma_f32_32x32x16_bf16 a[32:47], a[244:247], v[148:151], a[32:47]
    v_exp_f32 v31, v47
    v_cvt_pk_bf16_f32 v134, v28, v29
    v_add_f32 v27, v27, v30
    v_add_f32 v27, v27, v31
    v_mfma_f32_32x32x16_bf16 a[48:63], a[252:255], v[148:151], a[48:63]
    s_add_u32 s22, s22, 16384
    v_cvt_pk_bf16_f32 v135, v30, v31
    v_cmp_lt_f32 vcc, s31, v27
    s_cbranch_vccnz attn_kernel_slow_4_0
attn_kernel_ret_4_0:
    v_add_f32 v25, v25, v27
    v_mfma_f32_32x32x16_bf16 v[80:95], a[192:195], a[160:163], v[112:127]
    ds_read_b128 a[192:195], v8 offset:49152
    v_exp_f32 v28, v48
    v_exp_f32 v29, v49
    v_mfma_f32_32x32x16_bf16 v[80:95], a[196:199], a[164:167], v[80:95]
    ds_read_b128 a[196:199], v9 offset:49152
    v_exp_f32 v30, v50
    v_add_f32 v27, v28, v29
    v_exp_f32 v31, v51
    v_mfma_f32_32x32x16_bf16 v[80:95], a[200:203], a[168:171], v[80:95]
    ds_read_b128 a[200:203], v10 offset:49152
    v_cvt_pk_bf16_f32 v136, v28, v29
    v_exp_f32 v28, v52
    v_add_f32 v27, v27, v30
    v_mfma_f32_32x32x16_bf16 v[80:95], a[204:207], a[172:175], v[80:95]
    ds_read_b128 a[204:207], v11 offset:49152
    v_add_f32 v27, v27, v31
    v_exp_f32 v29, v53
    v_cvt_pk_bf16_f32 v137, v30, v31
    v_mfma_f32_32x32x16_bf16 v[80:95], a[208:211], a[176:179], v[80:95]
    ds_read_b128 a[208:211], v12 offset:49152
    v_exp_f32 v30, v54
    v_add_f32 v27, v27, v28
    v_add_f32 v27, v27, v29
    v_mfma_f32_32x32x16_bf16 v[80:95], a[212:215], a[180:183], v[80:95]
    ds_read_b128 a[212:215], v13 offset:49152
    v_exp_f32 v31, v55
    v_cvt_pk_bf16_f32 v138, v28, v29
    v_exp_f32 v28, v56
    v_mfma_f32_32x32x16_bf16 v[80:95], a[216:219], a[184:187], v[80:95]
    ds_read_b128 a[216:219], v14 offset:49152
    v_add_f32 v27, v27, v30
    v_add_f32 v27, v27, v31
    v_exp_f32 v29, v57
    v_mfma_f32_32x32x16_bf16 v[80:95], a[220:223], a[188:191], v[80:95]
    ds_read_b128 a[220:223], v15 offset:49152
    v_cvt_pk_bf16_f32 v139, v30, v31
    v_exp_f32 v30, v58
    v_add_f32 v27, v27, v28
    v_mfma_f32_32x32x16_bf16 a[64:79], a[224:227], v[152:155], a[64:79]
    ds_read_b64_tr_b16 a[224:225], v16 offset:32768
    ds_read_b64_tr_b16 a[226:227], v16 offset:34816
    v_add_f32 v27, v27, v29
    v_exp_f32 v31, v59
    v_mfma_f32_32x32x16_bf16 a[80:95], a[232:235], v[152:155], a[80:95]
    ds_read_b64_tr_b16 a[232:233], v17 offset:32768
    ds_read_b64_tr_b16 a[234:235], v17 offset:34816
    v_cvt_pk_bf16_f32 v140, v28, v29
    v_exp_f32 v28, v60
    v_mfma_f32_32x32x16_bf16 a[96:111], a[240:243], v[152:155], a[96:111]
    s_waitcnt lgkmcnt(4)
    ds_read_b64_tr_b16 a[240:241], v18 offset:32768
    ds_read_b64_tr_b16 a[242:243], v18 offset:34816
    v_add_f32 v27, v27, v30
    v_add_f32 v27, v27, v31
    v_mfma_f32_32x32x16_bf16 a[112:127], a[248:251], v[152:155], a[112:127]
    ds_read_b64_tr_b16 a[248:249], v19 offset:32768
    ds_read_b64_tr_b16 a[250:251], v19 offset:34816
    v_exp_f32 v29, v61
    v_cvt_pk_bf16_f32 v141, v30, v31
    v_mfma_f32_32x32x16_bf16 a[64:79], a[228:231], v[156:159], a[64:79]
    ds_read_b64_tr_b16 a[228:229], v16 offset:36864
    ds_read_b64_tr_b16 a[230:231], v16 offset:38912
    v_exp_f32 v30, v62
    v_add_f32 v27, v27, v28
    v_mfma_f32_32x32x16_bf16 a[80:95], a[236:239], v[156:159], a[80:95]
    ds_read_b64_tr_b16 a[236:237], v17 offset:36864
    ds_read_b64_tr_b16 a[238:239], v17 offset:38912
    v_add_f32 v27, v27, v29
    v_exp_f32 v31, v63
    v_cvt_pk_bf16_f32 v142, v28, v29
    v_mfma_f32_32x32x16_bf16 a[96:111], a[244:247], v[156:159], a[96:111]
    ds_read_b64_tr_b16 a[244:245], v18 offset:36864
    ds_read_b64_tr_b16 a[246:247], v18 offset:38912
    v_add_f32 v27, v27, v30
    v_add_f32 v27, v27, v31
    v_cvt_pk_bf16_f32 v143, v30, v31
    v_mfma_f32_32x32x16_bf16 a[112:127], a[252:255], v[156:159], a[112:127]
    ds_read_b64_tr_b16 a[252:253], v19 offset:36864
    ds_read_b64_tr_b16 a[254:255], v19 offset:38912
    v_cmp_lt_f32 vcc, s31, v27
    s_cbranch_vccnz attn_kernel_slow_4_1
attn_kernel_ret_4_1:
    v_add_f32 v26, v26, v27
    v_mfma_f32_32x32x16_bf16 v[32:47], a[192:195], a[128:131], v[96:111]
    v_exp_f32 v28, v64
    v_exp_f32 v29, v65
    v_mfma_f32_32x32x16_bf16 v[32:47], a[196:199], a[132:135], v[32:47]
    v_exp_f32 v30, v66
    v_add_f32 v27, v28, v29
    v_exp_f32 v31, v67
    v_cvt_pk_bf16_f32 v144, v28, v29
    v_mfma_f32_32x32x16_bf16 v[32:47], a[200:203], a[136:139], v[32:47]
    v_exp_f32 v28, v68
    v_add_f32 v27, v27, v30
    v_add_f32 v27, v27, v31
    v_mfma_f32_32x32x16_bf16 v[32:47], a[204:207], a[140:143], v[32:47]
    v_exp_f32 v29, v69
    v_cvt_pk_bf16_f32 v145, v30, v31
    v_exp_f32 v30, v70
    v_mfma_f32_32x32x16_bf16 v[32:47], a[208:211], a[144:147], v[32:47]
    v_add_f32 v27, v27, v28
    v_add_f32 v27, v27, v29
    v_exp_f32 v31, v71
    v_cvt_pk_bf16_f32 v146, v28, v29
    v_mfma_f32_32x32x16_bf16 v[32:47], a[212:215], a[148:151], v[32:47]
    v_exp_f32 v28, v72
    v_add_f32 v27, v27, v30
    v_add_f32 v27, v27, v31
    v_mfma_f32_32x32x16_bf16 v[32:47], a[216:219], a[152:155], v[32:47]
    v_exp_f32 v29, v73
    v_cvt_pk_bf16_f32 v147, v30, v31
    v_exp_f32 v30, v74
    v_add_f32 v27, v27, v28
    v_mfma_f32_32x32x16_bf16 v[32:47], a[220:223], a[156:159], v[32:47]
    v_add_f32 v27, v27, v29
    v_exp_f32 v31, v75
    v_cvt_pk_bf16_f32 v148, v28, v29
    s_waitcnt lgkmcnt(0)
    v_mfma_f32_32x32x16_bf16 a[0:15], a[224:227], v[128:131], a[0:15]
    s_add_u32 m0, s21, 65536
    v_exp_f32 v28, v76
    v_add_f32 v27, v27, v30
    v_add_f32 v27, v27, v31
    v_mfma_f32_32x32x16_bf16 a[16:31], a[232:235], v[128:131], a[16:31]
    buffer_load_dwordx4 v24, s[8:11], s23 offen offset:0 lds
    v_exp_f32 v29, v77
    v_mfma_f32_32x32x16_bf16 a[32:47], a[240:243], v[128:131], a[32:47]
    buffer_load_dwordx4 v24, s[8:11], s23 offen offset:1024 lds
    v_mfma_f32_32x32x16_bf16 a[48:63], a[248:251], v[128:131], a[48:63]
    buffer_load_dwordx4 v24, s[8:11], s23 offen offset:2048 lds
    v_cvt_pk_bf16_f32 v149, v30, v31
    v_mfma_f32_32x32x16_bf16 a[0:15], a[228:231], v[132:135], a[0:15]
    buffer_load_dwordx4 v24, s[8:11], s23 offen offset:3072 lds
    v_mfma_f32_32x32x16_bf16 a[16:31], a[236:239], v[132:135], a[16:31]
    v_exp_f32 v30, v78
    v_add_f32 v27, v27, v28
    v_add_f32 v27, v27, v29
    v_exp_f32 v31, v79
    v_mfma_f32_32x32x16_bf16 a[32:47], a[244:247], v[132:135], a[32:47]
    buffer_load_dwordx4 v[172:175], v168, s[92:95], s96 offen
    v_cvt_pk_bf16_f32 v150, v28, v29
    v_add_f32 v27, v27, v30
    v_add_f32 v27, v27, v31
    v_mfma_f32_32x32x16_bf16 a[48:63], a[252:255], v[132:135], a[48:63]
    s_add_u32 s23, s23, 16384
    v_cvt_pk_bf16_f32 v151, v30, v31
    v_cmp_lt_f32 vcc, s31, v27
    s_cbranch_vccnz attn_kernel_slow_5_0
attn_kernel_ret_5_0:
    v_add_f32 v25, v25, v27
    v_mfma_f32_32x32x16_bf16 v[48:63], a[192:195], a[160:163], v[112:127]
    ds_read_b128 a[192:195], v8 offset:57344
    v_exp_f32 v28, v80
    v_exp_f32 v29, v81
    v_mfma_f32_32x32x16_bf16 v[48:63], a[196:199], a[164:167], v[48:63]
    ds_read_b128 a[196:199], v9 offset:57344
    v_exp_f32 v30, v82
    v_add_f32 v27, v28, v29
    v_exp_f32 v31, v83
    v_mfma_f32_32x32x16_bf16 v[48:63], a[200:203], a[168:171], v[48:63]
    ds_read_b128 a[200:203], v10 offset:57344
    v_cvt_pk_bf16_f32 v152, v28, v29
    v_exp_f32 v28, v84
    v_add_f32 v27, v27, v30
    v_mfma_f32_32x32x16_bf16 v[48:63], a[204:207], a[172:175], v[48:63]
    ds_read_b128 a[204:207], v11 offset:57344
    v_add_f32 v27, v27, v31
    v_exp_f32 v29, v85
    v_cvt_pk_bf16_f32 v153, v30, v31
    v_mfma_f32_32x32x16_bf16 v[48:63], a[208:211], a[176:179], v[48:63]
    ds_read_b128 a[208:211], v12 offset:57344
    v_exp_f32 v30, v86
    v_add_f32 v27, v27, v28
    v_add_f32 v27, v27, v29
    v_mfma_f32_32x32x16_bf16 v[48:63], a[212:215], a[180:183], v[48:63]
    ds_read_b128 a[212:215], v13 offset:57344
    v_exp_f32 v31, v87
    v_cvt_pk_bf16_f32 v154, v28, v29
    v_exp_f32 v28, v88
    v_mfma_f32_32x32x16_bf16 v[48:63], a[216:219], a[184:187], v[48:63]
    ds_read_b128 a[216:219], v14 offset:57344
    v_add_f32 v27, v27, v30
    v_add_f32 v27, v27, v31
    v_exp_f32 v29, v89
    v_mfma_f32_32x32x16_bf16 v[48:63], a[220:223], a[188:191], v[48:63]
    ds_read_b128 a[220:223], v15 offset:57344
    v_cvt_pk_bf16_f32 v155, v30, v31
    v_exp_f32 v30, v90
    v_add_f32 v27, v27, v28
    v_mfma_f32_32x32x16_bf16 a[64:79], a[224:227], v[136:139], a[64:79]
    ds_read_b64_tr_b16 a[224:225], v16 offset:40960
    ds_read_b64_tr_b16 a[226:227], v16 offset:43008
    v_add_f32 v27, v27, v29
    v_exp_f32 v31, v91
    v_mfma_f32_32x32x16_bf16 a[80:95], a[232:235], v[136:139], a[80:95]
    ds_read_b64_tr_b16 a[232:233], v17 offset:40960
    ds_read_b64_tr_b16 a[234:235], v17 offset:43008
    v_cvt_pk_bf16_f32 v156, v28, v29
    v_exp_f32 v28, v92
    v_mfma_f32_32x32x16_bf16 a[96:111], a[240:243], v[136:139], a[96:111]
    s_waitcnt lgkmcnt(4)
    ds_read_b64_tr_b16 a[240:241], v18 offset:40960
    ds_read_b64_tr_b16 a[242:243], v18 offset:43008
    v_add_f32 v27, v27, v30
    v_add_f32 v27, v27, v31
    v_mfma_f32_32x32x16_bf16 a[112:127], a[248:251], v[136:139], a[112:127]
    ds_read_b64_tr_b16 a[248:249], v19 offset:40960
    ds_read_b64_tr_b16 a[250:251], v19 offset:43008
    v_exp_f32 v29, v93
    v_cvt_pk_bf16_f32 v157, v30, v31
    v_mfma_f32_32x32x16_bf16 a[64:79], a[228:231], v[140:143], a[64:79]
    ds_read_b64_tr_b16 a[228:229], v16 offset:45056
    ds_read_b64_tr_b16 a[230:231], v16 offset:47104
    v_exp_f32 v30, v94
    v_add_f32 v27, v27, v28
    v_mfma_f32_32x32x16_bf16 a[80:95], a[236:239], v[140:143], a[80:95]
    ds_read_b64_tr_b16 a[236:237], v17 offset:45056
    ds_read_b64_tr_b16 a[238:239], v17 offset:47104
    v_add_f32 v27, v27, v29
    v_exp_f32 v31, v95
    v_cvt_pk_bf16_f32 v158, v28, v29
    v_mfma_f32_32x32x16_bf16 a[96:111], a[244:247], v[140:143], a[96:111]
    ds_read_b64_tr_b16 a[244:245], v18 offset:45056
    ds_read_b64_tr_b16 a[246:247], v18 offset:47104
    v_add_f32 v27, v27, v30
    v_add_f32 v27, v27, v31
    v_cvt_pk_bf16_f32 v159, v30, v31
    v_mfma_f32_32x32x16_bf16 a[112:127], a[252:255], v[140:143], a[112:127]
    ds_read_b64_tr_b16 a[252:253], v19 offset:45056
    ds_read_b64_tr_b16 a[254:255], v19 offset:47104
    v_cmp_lt_f32 vcc, s31, v27
    s_cbranch_vccnz attn_kernel_slow_5_1
attn_kernel_ret_5_1:
    v_add_f32 v26, v26, v27
    v_mfma_f32_32x32x16_bf16 v[64:79], a[192:195], a[128:131], v[96:111]
    v_exp_f32 v28, v32
    v_exp_f32 v29, v33
    v_mfma_f32_32x32x16_bf16 v[64:79], a[196:199], a[132:135], v[64:79]
    v_exp_f32 v30, v34
    v_add_f32 v27, v28, v29
    v_exp_f32 v31, v35
    v_cvt_pk_bf16_f32 v128, v28, v29
    v_mfma_f32_32x32x16_bf16 v[64:79], a[200:203], a[136:139], v[64:79]
    v_exp_f32 v28, v36
    v_add_f32 v27, v27, v30
    v_add_f32 v27, v27, v31
    v_mfma_f32_32x32x16_bf16 v[64:79], a[204:207], a[140:143], v[64:79]
    v_exp_f32 v29, v37
    v_cvt_pk_bf16_f32 v129, v30, v31
    v_exp_f32 v30, v38
    v_mfma_f32_32x32x16_bf16 v[64:79], a[208:211], a[144:147], v[64:79]
    v_add_f32 v27, v27, v28
    v_add_f32 v27, v27, v29
    v_exp_f32 v31, v39
    v_cvt_pk_bf16_f32 v130, v28, v29
    v_mfma_f32_32x32x16_bf16 v[64:79], a[212:215], a[148:151], v[64:79]
    v_exp_f32 v28, v40
    v_add_f32 v27, v27, v30
    v_add_f32 v27, v27, v31
    v_mfma_f32_32x32x16_bf16 v[64:79], a[216:219], a[152:155], v[64:79]
    v_exp_f32 v29, v41
    v_cvt_pk_bf16_f32 v131, v30, v31
    v_exp_f32 v30, v42
    v_mfma_f32_32x32x16_bf16 v[64:79], a[220:223], a[156:159], v[64:79]
    v_add_f32 v27, v27, v28
    v_add_f32 v27, v27, v29
    v_exp_f32 v31, v43
    v_cvt_pk_bf16_f32 v132, v28, v29
    s_waitcnt vmcnt(8) lgkmcnt(0)
    s_barrier
    v_mfma_f32_32x32x16_bf16 a[0:15], a[224:227], v[144:147], a[0:15]
    s_add_u32 m0, s21, 32768
    v_exp_f32 v28, v44
    v_add_f32 v27, v27, v30
    v_add_f32 v27, v27, v31
    v_mfma_f32_32x32x16_bf16 a[16:31], a[232:235], v[144:147], a[16:31]
    buffer_load_dwordx4 v20, s[4:7], s22 offen offset:0 lds
    v_mfma_f32_32x32x16_bf16 a[32:47], a[240:243], v[144:147], a[32:47]
    buffer_load_dwordx4 v21, s[4:7], s22 offen offset:1024 lds
    v_exp_f32 v29, v45
    v_mfma_f32_32x32x16_bf16 a[48:63], a[248:251], v[144:147], a[48:63]
    buffer_load_dwordx4 v22, s[4:7], s22 offen offset:2048 lds
    v_mfma_f32_32x32x16_bf16 a[0:15], a[228:231], v[148:151], a[0:15]
    buffer_load_dwordx4 v23, s[4:7], s22 offen offset:3072 lds
    v_cvt_pk_bf16_f32 v133, v30, v31
    v_mfma_f32_32x32x16_bf16 a[16:31], a[236:239], v[148:151], a[16:31]
    v_exp_f32 v30, v46
    v_add_f32 v27, v27, v28
    v_add_f32 v27, v27, v29
    v_mfma_f32_32x32x16_bf16 a[32:47], a[244:247], v[148:151], a[32:47]
    v_exp_f32 v31, v47
    v_cvt_pk_bf16_f32 v134, v28, v29
    v_add_f32 v27, v27, v30
    v_add_f32 v27, v27, v31
    v_mfma_f32_32x32x16_bf16 a[48:63], a[252:255], v[148:151], a[48:63]
    s_add_u32 s22, s22, 16384
    v_cvt_pk_bf16_f32 v135, v30, v31
    v_cmp_lt_f32 vcc, s31, v27
    s_cbranch_vccnz attn_kernel_slow_6_0
attn_kernel_ret_6_0:
    v_add_f32 v25, v25, v27
    v_mfma_f32_32x32x16_bf16 v[80:95], a[192:195], a[160:163], v[112:127]
    ds_read_b128 a[192:195], v8 offset:0
    v_exp_f32 v28, v48
    v_exp_f32 v29, v49
    v_mfma_f32_32x32x16_bf16 v[80:95], a[196:199], a[164:167], v[80:95]
    ds_read_b128 a[196:199], v9 offset:0
    v_exp_f32 v30, v50
    v_add_f32 v27, v28, v29
    v_exp_f32 v31, v51
    v_mfma_f32_32x32x16_bf16 v[80:95], a[200:203], a[168:171], v[80:95]
    ds_read_b128 a[200:203], v10 offset:0
    v_cvt_pk_bf16_f32 v136, v28, v29
    v_exp_f32 v28, v52
    v_add_f32 v27, v27, v30
    v_mfma_f32_32x32x16_bf16 v[80:95], a[204:207], a[172:175], v[80:95]
    ds_read_b128 a[204:207], v11 offset:0
    v_add_f32 v27, v27, v31
    v_exp_f32 v29, v53
    v_cvt_pk_bf16_f32 v137, v30, v31
    v_mfma_f32_32x32x16_bf16 v[80:95], a[208:211], a[176:179], v[80:95]
    ds_read_b128 a[208:211], v12 offset:0
    v_exp_f32 v30, v54
    v_add_f32 v27, v27, v28
    v_add_f32 v27, v27, v29
    v_mfma_f32_32x32x16_bf16 v[80:95], a[212:215], a[180:183], v[80:95]
    ds_read_b128 a[212:215], v13 offset:0
    v_exp_f32 v31, v55
    v_cvt_pk_bf16_f32 v138, v28, v29
    v_exp_f32 v28, v56
    v_mfma_f32_32x32x16_bf16 v[80:95], a[216:219], a[184:187], v[80:95]
    ds_read_b128 a[216:219], v14 offset:0
    v_add_f32 v27, v27, v30
    v_add_f32 v27, v27, v31
    v_exp_f32 v29, v57
    v_mfma_f32_32x32x16_bf16 v[80:95], a[220:223], a[188:191], v[80:95]
    ds_read_b128 a[220:223], v15 offset:0
    v_cvt_pk_bf16_f32 v139, v30, v31
    v_exp_f32 v30, v58
    v_add_f32 v27, v27, v28
    v_mfma_f32_32x32x16_bf16 a[64:79], a[224:227], v[152:155], a[64:79]
    ds_read_b64_tr_b16 a[224:225], v16 offset:49152
    ds_read_b64_tr_b16 a[226:227], v16 offset:51200
    v_add_f32 v27, v27, v29
    v_exp_f32 v31, v59
    v_mfma_f32_32x32x16_bf16 a[80:95], a[232:235], v[152:155], a[80:95]
    ds_read_b64_tr_b16 a[232:233], v17 offset:49152
    ds_read_b64_tr_b16 a[234:235], v17 offset:51200
    v_cvt_pk_bf16_f32 v140, v28, v29
    v_exp_f32 v28, v60
    v_mfma_f32_32x32x16_bf16 a[96:111], a[240:243], v[152:155], a[96:111]
    s_waitcnt lgkmcnt(4)
    ds_read_b64_tr_b16 a[240:241], v18 offset:49152
    ds_read_b64_tr_b16 a[242:243], v18 offset:51200
    v_add_f32 v27, v27, v30
    v_add_f32 v27, v27, v31
    v_mfma_f32_32x32x16_bf16 a[112:127], a[248:251], v[152:155], a[112:127]
    ds_read_b64_tr_b16 a[248:249], v19 offset:49152
    ds_read_b64_tr_b16 a[250:251], v19 offset:51200
    v_exp_f32 v29, v61
    v_cvt_pk_bf16_f32 v141, v30, v31
    v_mfma_f32_32x32x16_bf16 a[64:79], a[228:231], v[156:159], a[64:79]
    ds_read_b64_tr_b16 a[228:229], v16 offset:53248
    ds_read_b64_tr_b16 a[230:231], v16 offset:55296
    v_exp_f32 v30, v62
    v_add_f32 v27, v27, v28
    v_mfma_f32_32x32x16_bf16 a[80:95], a[236:239], v[156:159], a[80:95]
    ds_read_b64_tr_b16 a[236:237], v17 offset:53248
    ds_read_b64_tr_b16 a[238:239], v17 offset:55296
    v_add_f32 v27, v27, v29
    v_exp_f32 v31, v63
    v_cvt_pk_bf16_f32 v142, v28, v29
    v_mfma_f32_32x32x16_bf16 a[96:111], a[244:247], v[156:159], a[96:111]
    ds_read_b64_tr_b16 a[244:245], v18 offset:53248
    ds_read_b64_tr_b16 a[246:247], v18 offset:55296
    v_add_f32 v27, v27, v30
    v_add_f32 v27, v27, v31
    v_cvt_pk_bf16_f32 v143, v30, v31
    v_mfma_f32_32x32x16_bf16 a[112:127], a[252:255], v[156:159], a[112:127]
    ds_read_b64_tr_b16 a[252:253], v19 offset:53248
    ds_read_b64_tr_b16 a[254:255], v19 offset:55296
    v_cmp_lt_f32 vcc, s31, v27
    s_cbranch_vccnz attn_kernel_slow_6_1
attn_kernel_ret_6_1:
    v_add_f32 v26, v26, v27
    v_mfma_f32_32x32x16_bf16 v[32:47], a[192:195], a[128:131], v[96:111]
    v_exp_f32 v28, v64
    v_exp_f32 v29, v65
    v_mfma_f32_32x32x16_bf16 v[32:47], a[196:199], a[132:135], v[32:47]
    v_exp_f32 v30, v66
    v_add_f32 v27, v28, v29
    v_exp_f32 v31, v67
    v_cvt_pk_bf16_f32 v144, v28, v29
    v_mfma_f32_32x32x16_bf16 v[32:47], a[200:203], a[136:139], v[32:47]
    v_exp_f32 v28, v68
    v_add_f32 v27, v27, v30
    v_add_f32 v27, v27, v31
    v_mfma_f32_32x32x16_bf16 v[32:47], a[204:207], a[140:143], v[32:47]
    v_exp_f32 v29, v69
    v_cvt_pk_bf16_f32 v145, v30, v31
    v_exp_f32 v30, v70
    v_mfma_f32_32x32x16_bf16 v[32:47], a[208:211], a[144:147], v[32:47]
    v_add_f32 v27, v27, v28
    v_add_f32 v27, v27, v29
    v_exp_f32 v31, v71
    v_cvt_pk_bf16_f32 v146, v28, v29
    v_mfma_f32_32x32x16_bf16 v[32:47], a[212:215], a[148:151], v[32:47]
    v_exp_f32 v28, v72
    v_add_f32 v27, v27, v30
    v_add_f32 v27, v27, v31
    v_mfma_f32_32x32x16_bf16 v[32:47], a[216:219], a[152:155], v[32:47]
    v_exp_f32 v29, v73
    v_cvt_pk_bf16_f32 v147, v30, v31
    v_exp_f32 v30, v74
    v_add_f32 v27, v27, v28
    v_mfma_f32_32x32x16_bf16 v[32:47], a[220:223], a[156:159], v[32:47]
    v_add_f32 v27, v27, v29
    v_exp_f32 v31, v75
    v_cvt_pk_bf16_f32 v148, v28, v29
    s_waitcnt lgkmcnt(0)
    v_mfma_f32_32x32x16_bf16 a[0:15], a[224:227], v[128:131], a[0:15]
    s_add_u32 m0, s21, 81920
    v_exp_f32 v28, v76
    v_add_f32 v27, v27, v30
    v_add_f32 v27, v27, v31
    v_mfma_f32_32x32x16_bf16 a[16:31], a[232:235], v[128:131], a[16:31]
    buffer_load_dwordx4 v24, s[8:11], s23 offen offset:0 lds
    v_exp_f32 v29, v77
    v_mfma_f32_32x32x16_bf16 a[32:47], a[240:243], v[128:131], a[32:47]
    buffer_load_dwordx4 v24, s[8:11], s23 offen offset:1024 lds
    v_mfma_f32_32x32x16_bf16 a[48:63], a[248:251], v[128:131], a[48:63]
    buffer_load_dwordx4 v24, s[8:11], s23 offen offset:2048 lds
    v_cvt_pk_bf16_f32 v149, v30, v31
    v_mfma_f32_32x32x16_bf16 a[0:15], a[228:231], v[132:135], a[0:15]
    buffer_load_dwordx4 v24, s[8:11], s23 offen offset:3072 lds
    v_mfma_f32_32x32x16_bf16 a[16:31], a[236:239], v[132:135], a[16:31]
    v_exp_f32 v30, v78
    v_add_f32 v27, v27, v28
    v_add_f32 v27, v27, v29
    v_exp_f32 v31, v79
    v_mfma_f32_32x32x16_bf16 a[32:47], a[244:247], v[132:135], a[32:47]
    s_add_u32 s96, s96, 0x100000
    v_cvt_pk_bf16_f32 v150, v28, v29
    v_add_f32 v27, v27, v30
    v_add_f32 v27, v27, v31
    v_mfma_f32_32x32x16_bf16 a[48:63], a[252:255], v[132:135], a[48:63]
    s_add_u32 s23, s23, 16384
    v_cvt_pk_bf16_f32 v151, v30, v31
    v_cmp_lt_f32 vcc, s31, v27
    s_cbranch_vccnz attn_kernel_slow_7_0
attn_kernel_ret_7_0:
    v_add_f32 v25, v25, v27
    v_mfma_f32_32x32x16_bf16 v[48:63], a[192:195], a[160:163], v[112:127]
    ds_read_b128 a[192:195], v8 offset:8192
    v_exp_f32 v28, v80
    v_exp_f32 v29, v81
    v_mfma_f32_32x32x16_bf16 v[48:63], a[196:199], a[164:167], v[48:63]
    ds_read_b128 a[196:199], v9 offset:8192
    v_exp_f32 v30, v82
    v_add_f32 v27, v28, v29
    v_exp_f32 v31, v83
    v_mfma_f32_32x32x16_bf16 v[48:63], a[200:203], a[168:171], v[48:63]
    ds_read_b128 a[200:203], v10 offset:8192
    v_cvt_pk_bf16_f32 v152, v28, v29
    v_exp_f32 v28, v84
    v_add_f32 v27, v27, v30
    v_mfma_f32_32x32x16_bf16 v[48:63], a[204:207], a[172:175], v[48:63]
    ds_read_b128 a[204:207], v11 offset:8192
    v_add_f32 v27, v27, v31
    v_exp_f32 v29, v85
    v_cvt_pk_bf16_f32 v153, v30, v31
    v_mfma_f32_32x32x16_bf16 v[48:63], a[208:211], a[176:179], v[48:63]
    ds_read_b128 a[208:211], v12 offset:8192
    v_exp_f32 v30, v86
    v_add_f32 v27, v27, v28
    v_add_f32 v27, v27, v29
    v_mfma_f32_32x32x16_bf16 v[48:63], a[212:215], a[180:183], v[48:63]
    ds_read_b128 a[212:215], v13 offset:8192
    v_exp_f32 v31, v87
    v_cvt_pk_bf16_f32 v154, v28, v29
    v_exp_f32 v28, v88
    v_mfma_f32_32x32x16_bf16 v[48:63], a[216:219], a[184:187], v[48:63]
    ds_read_b128 a[216:219], v14 offset:8192
    v_add_f32 v27, v27, v30
    v_add_f32 v27, v27, v31
    v_exp_f32 v29, v89
    v_mfma_f32_32x32x16_bf16 v[48:63], a[220:223], a[188:191], v[48:63]
    ds_read_b128 a[220:223], v15 offset:8192
    v_cvt_pk_bf16_f32 v155, v30, v31
    v_exp_f32 v30, v90
    v_add_f32 v27, v27, v28
    v_mfma_f32_32x32x16_bf16 a[64:79], a[224:227], v[136:139], a[64:79]
    ds_read_b64_tr_b16 a[224:225], v16 offset:57344
    ds_read_b64_tr_b16 a[226:227], v16 offset:59392
    v_add_f32 v27, v27, v29
    v_exp_f32 v31, v91
    v_mfma_f32_32x32x16_bf16 a[80:95], a[232:235], v[136:139], a[80:95]
    ds_read_b64_tr_b16 a[232:233], v17 offset:57344
    ds_read_b64_tr_b16 a[234:235], v17 offset:59392
    v_cvt_pk_bf16_f32 v156, v28, v29
    v_exp_f32 v28, v92
    v_mfma_f32_32x32x16_bf16 a[96:111], a[240:243], v[136:139], a[96:111]
    s_waitcnt lgkmcnt(4)
    ds_read_b64_tr_b16 a[240:241], v18 offset:57344
    ds_read_b64_tr_b16 a[242:243], v18 offset:59392
    v_add_f32 v27, v27, v30
    v_add_f32 v27, v27, v31
    v_mfma_f32_32x32x16_bf16 a[112:127], a[248:251], v[136:139], a[112:127]
    ds_read_b64_tr_b16 a[248:249], v19 offset:57344
    ds_read_b64_tr_b16 a[250:251], v19 offset:59392
    v_exp_f32 v29, v93
    v_cvt_pk_bf16_f32 v157, v30, v31
    v_mfma_f32_32x32x16_bf16 a[64:79], a[228:231], v[140:143], a[64:79]
    ds_read_b64_tr_b16 a[228:229], v16 offset:61440
    ds_read_b64_tr_b16 a[230:231], v16 offset:63488
    v_exp_f32 v30, v94
    v_add_f32 v27, v27, v28
    v_mfma_f32_32x32x16_bf16 a[80:95], a[236:239], v[140:143], a[80:95]
    ds_read_b64_tr_b16 a[236:237], v17 offset:61440
    ds_read_b64_tr_b16 a[238:239], v17 offset:63488
    v_add_f32 v27, v27, v29
    v_exp_f32 v31, v95
    v_cvt_pk_bf16_f32 v158, v28, v29
    v_mfma_f32_32x32x16_bf16 a[96:111], a[244:247], v[140:143], a[96:111]
    ds_read_b64_tr_b16 a[244:245], v18 offset:61440
    ds_read_b64_tr_b16 a[246:247], v18 offset:63488
    v_add_f32 v27, v27, v30
    v_add_f32 v27, v27, v31
    v_cvt_pk_bf16_f32 v159, v30, v31
    v_mfma_f32_32x32x16_bf16 a[112:127], a[252:255], v[140:143], a[112:127]
    ds_read_b64_tr_b16 a[252:253], v19 offset:61440
    ds_read_b64_tr_b16 a[254:255], v19 offset:63488
    v_cmp_lt_f32 vcc, s31, v27
    s_cbranch_vccnz attn_kernel_slow_7_1
attn_kernel_ret_7_1:
    v_add_f32 v26, v26, v27
    s_add_u32 s30, s30, 1
    s_cmp_lt_u32 s30, 8
    s_cbranch_scc1 attn_kernel_loop
    s_lshr_b32 s96, s2, 3
    s_lshl_b32 s96, s96, 2
    s_add_u32 s96, s96, s20
    s_getpc_b64 s[84:85]
Lpc_5:
    s_sub_u32 s84, s84, Lpc_5-ln1_kernel
    s_subb_u32 s85, s85, 0
    s_mov_b32 s86, text_end-ln1_kernel
    s_mov_b32 s87, 0x20000
    s_lshl_b32 s96, s96, 10
    v_lshl_add_u32 v1, v2, 4, s96
    buffer_load_dwordx4 v[172:175], v1, s[84:87], 0 offen
    s_waitcnt lgkmcnt(0)
    v_mfma_f32_32x32x16_bf16 a[0:15], a[224:227], v[144:147], a[0:15]
    v_mfma_f32_32x32x16_bf16 a[16:31], a[232:235], v[144:147], a[16:31]
    v_mfma_f32_32x32x16_bf16 a[32:47], a[240:243], v[144:147], a[32:47]
    v_mfma_f32_32x32x16_bf16 a[48:63], a[248:251], v[144:147], a[48:63]
    v_mfma_f32_32x32x16_bf16 a[0:15], a[228:231], v[148:151], a[0:15]
    v_mfma_f32_32x32x16_bf16 a[16:31], a[236:239], v[148:151], a[16:31]
    v_mfma_f32_32x32x16_bf16 a[32:47], a[244:247], v[148:151], a[32:47]
    v_mfma_f32_32x32x16_bf16 a[48:63], a[252:255], v[148:151], a[48:63]
    v_mfma_f32_32x32x16_bf16 a[64:79], a[224:227], v[152:155], a[64:79]
    v_mfma_f32_32x32x16_bf16 a[80:95], a[232:235], v[152:155], a[80:95]
    v_mfma_f32_32x32x16_bf16 a[96:111], a[240:243], v[152:155], a[96:111]
    v_mfma_f32_32x32x16_bf16 a[112:127], a[248:251], v[152:155], a[112:127]
    v_mfma_f32_32x32x16_bf16 a[64:79], a[228:231], v[156:159], a[64:79]
    v_mfma_f32_32x32x16_bf16 a[80:95], a[236:239], v[156:159], a[80:95]
    v_mfma_f32_32x32x16_bf16 a[96:111], a[244:247], v[156:159], a[96:111]
    v_mfma_f32_32x32x16_bf16 a[112:127], a[252:255], v[156:159], a[112:127]
    v_mov_b32 v28, v25
    s_nop 1
    v_permlane32_swap_b32 v28, v25
    s_nop 1
    v_add_f32 v25, v25, v28
    v_rcp_f32 v25, v25
    v_mov_b32 v28, v26
    s_nop 1
    v_permlane32_swap_b32 v28, v26
    s_nop 1
    v_add_f32 v26, v26, v28
    v_rcp_f32 v26, v26
    s_lshr_b32 s34, s51, 5
    s_lshl_b32 s34, s34, 18
    s_lshl_b32 s35, s32, 13
    s_add_u32 s34, s34, s35
    s_nop 7
    v_accvgpr_read_b32 v36, a0
    v_accvgpr_read_b32 v37, a1
    v_accvgpr_read_b32 v38, a2
    v_accvgpr_read_b32 v39, a3
    v_accvgpr_read_b32 v40, a4
    v_accvgpr_read_b32 v41, a5
    v_accvgpr_read_b32 v42, a6
    v_accvgpr_read_b32 v43, a7
    v_mul_f32 v36, v36, v25
    v_mul_f32 v37, v37, v25
    v_mul_f32 v38, v38, v25
    v_mul_f32 v39, v39, v25
    v_mul_f32 v40, v40, v25
    v_mul_f32 v41, v41, v25
    v_mul_f32 v42, v42, v25
    v_mul_f32 v43, v43, v25
    v_cvt_pk_bf16_f32 v32, v36, v37
    v_cvt_pk_bf16_f32 v33, v38, v39
    v_cvt_pk_bf16_f32 v34, v40, v41
    v_cvt_pk_bf16_f32 v35, v42, v43
    s_nop 1
    v_permlane32_swap_b32 v32, v34
    v_permlane32_swap_b32 v33, v35
    s_add_u32 s35, s34, 0
    buffer_store_dwordx4 v[32:35], v168, s[16:19], s35 offen offset:0
    v_accvgpr_read_b32 v48, a8
    v_accvgpr_read_b32 v49, a9
    v_accvgpr_read_b32 v50, a10
    v_accvgpr_read_b32 v51, a11
    v_accvgpr_read_b32 v52, a12
    v_accvgpr_read_b32 v53, a13
    v_accvgpr_read_b32 v54, a14
    v_accvgpr_read_b32 v55, a15
    v_mul_f32 v48, v48, v25
    v_mul_f32 v49, v49, v25
    v_mul_f32 v50, v50, v25
    v_mul_f32 v51, v51, v25
    v_mul_f32 v52, v52, v25
    v_mul_f32 v53, v53, v25
    v_mul_f32 v54, v54, v25
    v_mul_f32 v55, v55, v25
    v_cvt_pk_bf16_f32 v44, v48, v49
    v_cvt_pk_bf16_f32 v45, v50, v51
    v_cvt_pk_bf16_f32 v46, v52, v53
    v_cvt_pk_bf16_f32 v47, v54, v55
    s_nop 1
    v_permlane32_swap_b32 v44, v46
    v_permlane32_swap_b32 v45, v47
    s_nop 0
    buffer_store_dwordx4 v[44:47], v168, s[16:19], s35 offen offset:1024
    v_accvgpr_read_b32 v60, a16
    v_accvgpr_read_b32 v61, a17
    v_accvgpr_read_b32 v62, a18
    v_accvgpr_read_b32 v63, a19
    v_accvgpr_read_b32 v64, a20
    v_accvgpr_read_b32 v65, a21
    v_accvgpr_read_b32 v66, a22
    v_accvgpr_read_b32 v67, a23
    v_mul_f32 v60, v60, v25
    v_mul_f32 v61, v61, v25
    v_mul_f32 v62, v62, v25
    v_mul_f32 v63, v63, v25
    v_mul_f32 v64, v64, v25
    v_mul_f32 v65, v65, v25
    v_mul_f32 v66, v66, v25
    v_mul_f32 v67, v67, v25
    v_cvt_pk_bf16_f32 v56, v60, v61
    v_cvt_pk_bf16_f32 v57, v62, v63
    v_cvt_pk_bf16_f32 v58, v64, v65
    v_cvt_pk_bf16_f32 v59, v66, v67
    s_nop 1
    v_permlane32_swap_b32 v56, v58
    v_permlane32_swap_b32 v57, v59
    s_nop 0
    buffer_store_dwordx4 v[56:59], v168, s[16:19], s35 offen offset:2048
    v_accvgpr_read_b32 v72, a24
    v_accvgpr_read_b32 v73, a25
    v_accvgpr_read_b32 v74, a26
    v_accvgpr_read_b32 v75, a27
    v_accvgpr_read_b32 v76, a28
    v_accvgpr_read_b32 v77, a29
    v_accvgpr_read_b32 v78, a30
    v_accvgpr_read_b32 v79, a31
    v_mul_f32 v72, v72, v25
    v_mul_f32 v73, v73, v25
    v_mul_f32 v74, v74, v25
    v_mul_f32 v75, v75, v25
    v_mul_f32 v76, v76, v25
    v_mul_f32 v77, v77, v25
    v_mul_f32 v78, v78, v25
    v_mul_f32 v79, v79, v25
    v_cvt_pk_bf16_f32 v68, v72, v73
    v_cvt_pk_bf16_f32 v69, v74, v75
    v_cvt_pk_bf16_f32 v70, v76, v77
    v_cvt_pk_bf16_f32 v71, v78, v79
    s_nop 1
    v_permlane32_swap_b32 v68, v70
    v_permlane32_swap_b32 v69, v71
    s_nop 0
    buffer_store_dwordx4 v[68:71], v168, s[16:19], s35 offen offset:3072
    v_accvgpr_read_b32 v36, a32
    v_accvgpr_read_b32 v37, a33
    v_accvgpr_read_b32 v38, a34
    v_accvgpr_read_b32 v39, a35
    v_accvgpr_read_b32 v40, a36
    v_accvgpr_read_b32 v41, a37
    v_accvgpr_read_b32 v42, a38
    v_accvgpr_read_b32 v43, a39
    v_mul_f32 v36, v36, v25
    v_mul_f32 v37, v37, v25
    v_mul_f32 v38, v38, v25
    v_mul_f32 v39, v39, v25
    v_mul_f32 v40, v40, v25
    v_mul_f32 v41, v41, v25
    v_mul_f32 v42, v42, v25
    v_mul_f32 v43, v43, v25
    v_cvt_pk_bf16_f32 v32, v36, v37
    v_cvt_pk_bf16_f32 v33, v38, v39
    v_cvt_pk_bf16_f32 v34, v40, v41
    v_cvt_pk_bf16_f32 v35, v42, v43
    s_nop 1
    v_permlane32_swap_b32 v32, v34
    v_permlane32_swap_b32 v33, v35
    s_add_u32 s35, s34, 4096
    buffer_store_dwordx4 v[32:35], v168, s[16:19], s35 offen offset:0
    v_accvgpr_read_b32 v48, a40
    v_accvgpr_read_b32 v49, a41
    v_accvgpr_read_b32 v50, a42
    v_accvgpr_read_b32 v51, a43
    v_accvgpr_read_b32 v52, a44
    v_accvgpr_read_b32 v53, a45
    v_accvgpr_read_b32 v54, a46
    v_accvgpr_read_b32 v55, a47
    v_mul_f32 v48, v48, v25
    v_mul_f32 v49, v49, v25
    v_mul_f32 v50, v50, v25
    v_mul_f32 v51, v51, v25
    v_mul_f32 v52, v52, v25
    v_mul_f32 v53, v53, v25
    v_mul_f32 v54, v54, v25
    v_mul_f32 v55, v55, v25
    v_cvt_pk_bf16_f32 v44, v48, v49
    v_cvt_pk_bf16_f32 v45, v50, v51
    v_cvt_pk_bf16_f32 v46, v52, v53
    v_cvt_pk_bf16_f32 v47, v54, v55
    s_nop 1
    v_permlane32_swap_b32 v44, v46
    v_permlane32_swap_b32 v45, v47
    s_nop 0
    buffer_store_dwordx4 v[44:47], v168, s[16:19], s35 offen offset:1024
    v_accvgpr_read_b32 v60, a48
    v_accvgpr_read_b32 v61, a49
    v_accvgpr_read_b32 v62, a50
    v_accvgpr_read_b32 v63, a51
    v_accvgpr_read_b32 v64, a52
    v_accvgpr_read_b32 v65, a53
    v_accvgpr_read_b32 v66, a54
    v_accvgpr_read_b32 v67, a55
    v_mul_f32 v60, v60, v25
    v_mul_f32 v61, v61, v25
    v_mul_f32 v62, v62, v25
    v_mul_f32 v63, v63, v25
    v_mul_f32 v64, v64, v25
    v_mul_f32 v65, v65, v25
    v_mul_f32 v66, v66, v25
    v_mul_f32 v67, v67, v25
    v_cvt_pk_bf16_f32 v56, v60, v61
    v_cvt_pk_bf16_f32 v57, v62, v63
    v_cvt_pk_bf16_f32 v58, v64, v65
    v_cvt_pk_bf16_f32 v59, v66, v67
    s_nop 1
    v_permlane32_swap_b32 v56, v58
    v_permlane32_swap_b32 v57, v59
    s_nop 0
    buffer_store_dwordx4 v[56:59], v168, s[16:19], s35 offen offset:2048
    v_accvgpr_read_b32 v72, a56
    v_accvgpr_read_b32 v73, a57
    v_accvgpr_read_b32 v74, a58
    v_accvgpr_read_b32 v75, a59
    v_accvgpr_read_b32 v76, a60
    v_accvgpr_read_b32 v77, a61
    v_accvgpr_read_b32 v78, a62
    v_accvgpr_read_b32 v79, a63
    v_mul_f32 v72, v72, v25
    v_mul_f32 v73, v73, v25
    v_mul_f32 v74, v74, v25
    v_mul_f32 v75, v75, v25
    v_mul_f32 v76, v76, v25
    v_mul_f32 v77, v77, v25
    v_mul_f32 v78, v78, v25
    v_mul_f32 v79, v79, v25
    v_cvt_pk_bf16_f32 v68, v72, v73
    v_cvt_pk_bf16_f32 v69, v74, v75
    v_cvt_pk_bf16_f32 v70, v76, v77
    v_cvt_pk_bf16_f32 v71, v78, v79
    s_nop 1
    v_permlane32_swap_b32 v68, v70
    v_permlane32_swap_b32 v69, v71
    s_nop 0
    buffer_store_dwordx4 v[68:71], v168, s[16:19], s35 offen offset:3072
    v_accvgpr_read_b32 v36, a64
    v_accvgpr_read_b32 v37, a65
    v_accvgpr_read_b32 v38, a66
    v_accvgpr_read_b32 v39, a67
    v_accvgpr_read_b32 v40, a68
    v_accvgpr_read_b32 v41, a69
    v_accvgpr_read_b32 v42, a70
    v_accvgpr_read_b32 v43, a71
    v_mul_f32 v36, v36, v26
    v_mul_f32 v37, v37, v26
    v_mul_f32 v38, v38, v26
    v_mul_f32 v39, v39, v26
    v_mul_f32 v40, v40, v26
    v_mul_f32 v41, v41, v26
    v_mul_f32 v42, v42, v26
    v_mul_f32 v43, v43, v26
    v_cvt_pk_bf16_f32 v32, v36, v37
    v_cvt_pk_bf16_f32 v33, v38, v39
    v_cvt_pk_bf16_f32 v34, v40, v41
    v_cvt_pk_bf16_f32 v35, v42, v43
    s_nop 1
    v_permlane32_swap_b32 v32, v34
    v_permlane32_swap_b32 v33, v35
    s_add_u32 s35, s34, 262144
    buffer_store_dwordx4 v[32:35], v168, s[16:19], s35 offen offset:0
    v_accvgpr_read_b32 v48, a72
    v_accvgpr_read_b32 v49, a73
    v_accvgpr_read_b32 v50, a74
    v_accvgpr_read_b32 v51, a75
    v_accvgpr_read_b32 v52, a76
    v_accvgpr_read_b32 v53, a77
    v_accvgpr_read_b32 v54, a78
    v_accvgpr_read_b32 v55, a79
    v_mul_f32 v48, v48, v26
    v_mul_f32 v49, v49, v26
    v_mul_f32 v50, v50, v26
    v_mul_f32 v51, v51, v26
    v_mul_f32 v52, v52, v26
    v_mul_f32 v53, v53, v26
    v_mul_f32 v54, v54, v26
    v_mul_f32 v55, v55, v26
    v_cvt_pk_bf16_f32 v44, v48, v49
    v_cvt_pk_bf16_f32 v45, v50, v51
    v_cvt_pk_bf16_f32 v46, v52, v53
    v_cvt_pk_bf16_f32 v47, v54, v55
    s_nop 1
    v_permlane32_swap_b32 v44, v46
    v_permlane32_swap_b32 v45, v47
    s_nop 0
    buffer_store_dwordx4 v[44:47], v168, s[16:19], s35 offen offset:1024
    v_accvgpr_read_b32 v60, a80
    v_accvgpr_read_b32 v61, a81
    v_accvgpr_read_b32 v62, a82
    v_accvgpr_read_b32 v63, a83
    v_accvgpr_read_b32 v64, a84
    v_accvgpr_read_b32 v65, a85
    v_accvgpr_read_b32 v66, a86
    v_accvgpr_read_b32 v67, a87
    v_mul_f32 v60, v60, v26
    v_mul_f32 v61, v61, v26
    v_mul_f32 v62, v62, v26
    v_mul_f32 v63, v63, v26
    v_mul_f32 v64, v64, v26
    v_mul_f32 v65, v65, v26
    v_mul_f32 v66, v66, v26
    v_mul_f32 v67, v67, v26
    v_cvt_pk_bf16_f32 v56, v60, v61
    v_cvt_pk_bf16_f32 v57, v62, v63
    v_cvt_pk_bf16_f32 v58, v64, v65
    v_cvt_pk_bf16_f32 v59, v66, v67
    s_nop 1
    v_permlane32_swap_b32 v56, v58
    v_permlane32_swap_b32 v57, v59
    s_nop 0
    buffer_store_dwordx4 v[56:59], v168, s[16:19], s35 offen offset:2048
    v_accvgpr_read_b32 v72, a88
    v_accvgpr_read_b32 v73, a89
    v_accvgpr_read_b32 v74, a90
    v_accvgpr_read_b32 v75, a91
    v_accvgpr_read_b32 v76, a92
    v_accvgpr_read_b32 v77, a93
    v_accvgpr_read_b32 v78, a94
    v_accvgpr_read_b32 v79, a95
    v_mul_f32 v72, v72, v26
    v_mul_f32 v73, v73, v26
    v_mul_f32 v74, v74, v26
    v_mul_f32 v75, v75, v26
    v_mul_f32 v76, v76, v26
    v_mul_f32 v77, v77, v26
    v_mul_f32 v78, v78, v26
    v_mul_f32 v79, v79, v26
    v_cvt_pk_bf16_f32 v68, v72, v73
    v_cvt_pk_bf16_f32 v69, v74, v75
    v_cvt_pk_bf16_f32 v70, v76, v77
    v_cvt_pk_bf16_f32 v71, v78, v79
    s_nop 1
    v_permlane32_swap_b32 v68, v70
    v_permlane32_swap_b32 v69, v71
    s_nop 0
    buffer_store_dwordx4 v[68:71], v168, s[16:19], s35 offen offset:3072
    v_accvgpr_read_b32 v36, a96
    v_accvgpr_read_b32 v37, a97
    v_accvgpr_read_b32 v38, a98
    v_accvgpr_read_b32 v39, a99
    v_accvgpr_read_b32 v40, a100
    v_accvgpr_read_b32 v41, a101
    v_accvgpr_read_b32 v42, a102
    v_accvgpr_read_b32 v43, a103
    v_mul_f32 v36, v36, v26
    v_mul_f32 v37, v37, v26
    v_mul_f32 v38, v38, v26
    v_mul_f32 v39, v39, v26
    v_mul_f32 v40, v40, v26
    v_mul_f32 v41, v41, v26
    v_mul_f32 v42, v42, v26
    v_mul_f32 v43, v43, v26
    v_cvt_pk_bf16_f32 v32, v36, v37
    v_cvt_pk_bf16_f32 v33, v38, v39
    v_cvt_pk_bf16_f32 v34, v40, v41
    v_cvt_pk_bf16_f32 v35, v42, v43
    s_nop 1
    v_permlane32_swap_b32 v32, v34
    v_permlane32_swap_b32 v33, v35
    s_add_u32 s35, s34, 266240
    buffer_store_dwordx4 v[32:35], v168, s[16:19], s35 offen offset:0
    v_accvgpr_read_b32 v48, a104
    v_accvgpr_read_b32 v49, a105
    v_accvgpr_read_b32 v50, a106
    v_accvgpr_read_b32 v51, a107
    v_accvgpr_read_b32 v52, a108
    v_accvgpr_read_b32 v53, a109
    v_accvgpr_read_b32 v54, a110
    v_accvgpr_read_b32 v55, a111
    v_mul_f32 v48, v48, v26
    v_mul_f32 v49, v49, v26
    v_mul_f32 v50, v50, v26
    v_mul_f32 v51, v51, v26
    v_mul_f32 v52, v52, v26
    v_mul_f32 v53, v53, v26
    v_mul_f32 v54, v54, v26
    v_mul_f32 v55, v55, v26
    v_cvt_pk_bf16_f32 v44, v48, v49
    v_cvt_pk_bf16_f32 v45, v50, v51
    v_cvt_pk_bf16_f32 v46, v52, v53
    v_cvt_pk_bf16_f32 v47, v54, v55
    s_nop 1
    v_permlane32_swap_b32 v44, v46
    v_permlane32_swap_b32 v45, v47
    s_nop 0
    buffer_store_dwordx4 v[44:47], v168, s[16:19], s35 offen offset:1024
    v_accvgpr_read_b32 v60, a112
    v_accvgpr_read_b32 v61, a113
    v_accvgpr_read_b32 v62, a114
    v_accvgpr_read_b32 v63, a115
    v_accvgpr_read_b32 v64, a116
    v_accvgpr_read_b32 v65, a117
    v_accvgpr_read_b32 v66, a118
    v_accvgpr_read_b32 v67, a119
    v_mul_f32 v60, v60, v26
    v_mul_f32 v61, v61, v26
    v_mul_f32 v62, v62, v26
    v_mul_f32 v63, v63, v26
    v_mul_f32 v64, v64, v26
    v_mul_f32 v65, v65, v26
    v_mul_f32 v66, v66, v26
    v_mul_f32 v67, v67, v26
    v_cvt_pk_bf16_f32 v56, v60, v61
    v_cvt_pk_bf16_f32 v57, v62, v63
    v_cvt_pk_bf16_f32 v58, v64, v65
    v_cvt_pk_bf16_f32 v59, v66, v67
    s_nop 1
    v_permlane32_swap_b32 v56, v58
    v_permlane32_swap_b32 v57, v59
    s_nop 0
    buffer_store_dwordx4 v[56:59], v168, s[16:19], s35 offen offset:2048
    v_accvgpr_read_b32 v72, a120
    v_accvgpr_read_b32 v73, a121
    v_accvgpr_read_b32 v74, a122
    v_accvgpr_read_b32 v75, a123
    v_accvgpr_read_b32 v76, a124
    v_accvgpr_read_b32 v77, a125
    v_accvgpr_read_b32 v78, a126
    v_accvgpr_read_b32 v79, a127
    v_mul_f32 v72, v72, v26
    v_mul_f32 v73, v73, v26
    v_mul_f32 v74, v74, v26
    v_mul_f32 v75, v75, v26
    v_mul_f32 v76, v76, v26
    v_mul_f32 v77, v77, v26
    v_mul_f32 v78, v78, v26
    v_mul_f32 v79, v79, v26
    v_cvt_pk_bf16_f32 v68, v72, v73
    v_cvt_pk_bf16_f32 v69, v74, v75
    v_cvt_pk_bf16_f32 v70, v76, v77
    v_cvt_pk_bf16_f32 v71, v78, v79
    s_nop 1
    v_permlane32_swap_b32 v68, v70
    v_permlane32_swap_b32 v69, v71
    s_nop 0
    buffer_store_dwordx4 v[68:71], v168, s[16:19], s35 offen offset:3072
attn_kernel_done:
    s_endpgm
attn_kernel_slow_0_0:
    s_nop 15
    s_nop 15
    v_max3_f32 v28, v32, v33, v34
    v_max3_f32 v28, v28, v35, v36
    v_max3_f32 v28, v28, v37, v38
    v_max3_f32 v28, v28, v39, v40
    v_max3_f32 v28, v28, v41, v42
    v_max3_f32 v28, v28, v43, v44
    v_max3_f32 v28, v28, v45, v46
    v_max_f32 v28, v28, v47
    v_mov_b32 v29, v28
    s_nop 1
    v_permlane32_swap_b32 v29, v28
    s_nop 1
    v_max_f32 v28, v28, v29
    v_ceil_f32 v28, v28
    v_max_f32 v28, 0, v28
    v_cvt_i32_f32 v29, v28
    v_sub_u32 v29, 0, v29
    v_ldexp_f32 v29, 1.0, v29
    v_accvgpr_read_b32 v30, a0
    v_mul_f32 v30, v30, v29
    v_accvgpr_write_b32 a0, v30
    v_accvgpr_read_b32 v30, a1
    v_mul_f32 v30, v30, v29
    v_accvgpr_write_b32 a1, v30
    v_accvgpr_read_b32 v30, a2
    v_mul_f32 v30, v30, v29
    v_accvgpr_write_b32 a2, v30
    v_accvgpr_read_b32 v30, a3
    v_mul_f32 v30, v30, v29
    v_accvgpr_write_b32 a3, v30
    v_accvgpr_read_b32 v30, a4
    v_mul_f32 v30, v30, v29
    v_accvgpr_write_b32 a4, v30
    v_accvgpr_read_b32 v30, a5
    v_mul_f32 v30, v30, v29
    v_accvgpr_write_b32 a5, v30
    v_accvgpr_read_b32 v30, a6
    v_mul_f32 v30, v30, v29
    v_accvgpr_write_b32 a6, v30
    v_accvgpr_read_b32 v30, a7
    v_mul_f32 v30, v30, v29
    v_accvgpr_write_b32 a7, v30
    v_accvgpr_read_b32 v30, a8
    v_mul_f32 v30, v30, v29
    v_accvgpr_write_b32 a8, v30
    v_accvgpr_read_b32 v30, a9
    v_mul_f32 v30, v30, v29
    v_accvgpr_write_b32 a9, v30
    v_accvgpr_read_b32 v30, a10
    v_mul_f32 v30, v30, v29
    v_accvgpr_write_b32 a10, v30
    v_accvgpr_read_b32 v30, a11
    v_mul_f32 v30, v30, v29
    v_accvgpr_write_b32 a11, v30
    v_accvgpr_read_b32 v30, a12
    v_mul_f32 v30, v30, v29
    v_accvgpr_write_b32 a12, v30
    v_accvgpr_read_b32 v30, a13
    v_mul_f32 v30, v30, v29
    v_accvgpr_write_b32 a13, v30
    v_accvgpr_read_b32 v30, a14
    v_mul_f32 v30, v30, v29
    v_accvgpr_write_b32 a14, v30
    v_accvgpr_read_b32 v30, a15
    v_mul_f32 v30, v30, v29
    v_accvgpr_write_b32 a15, v30
    v_accvgpr_read_b32 v30, a16
    v_mul_f32 v30, v30, v29
    v_accvgpr_write_b32 a16, v30
    v_accvgpr_read_b32 v30, a17
    v_mul_f32 v30, v30, v29
    v_accvgpr_write_b32 a17, v30
    v_accvgpr_read_b32 v30, a18
    v_mul_f32 v30, v30, v29
    v_accvgpr_write_b32 a18, v30
    v_accvgpr_read_b32 v30, a19
    v_mul_f32 v30, v30, v29
    v_accvgpr_write_b32 a19, v30
    v_accvgpr_read_b32 v30, a20
    v_mul_f32 v30, v30, v29
    v_accvgpr_write_b32 a20, v30
    v_accvgpr_read_b32 v30, a21
    v_mul_f32 v30, v30, v29
    v_accvgpr_write_b32 a21, v30
    v_accvgpr_read_b32 v30, a22
    v_mul_f32 v30, v30, v29
    v_accvgpr_write_b32 a22, v30
    v_accvgpr_read_b32 v30, a23
    v_mul_f32 v30, v30, v29
    v_accvgpr_write_b32 a23, v30
    v_accvgpr_read_b32 v30, a24
    v_mul_f32 v30, v30, v29
    v_accvgpr_write_b32 a24, v30
    v_accvgpr_read_b32 v30, a25
    v_mul_f32 v30, v30, v29
    v_accvgpr_write_b32 a25, v30
    v_accvgpr_read_b32 v30, a26
    v_mul_f32 v30, v30, v29
    v_accvgpr_write_b32 a26, v30
    v_accvgpr_read_b32 v30, a27
    v_mul_f32 v30, v30, v29
    v_accvgpr_write_b32 a27, v30
    v_accvgpr_read_b32 v30, a28
    v_mul_f32 v30, v30, v29
    v_accvgpr_write_b32 a28, v30
    v_accvgpr_read_b32 v30, a29
    v_mul_f32 v30, v30, v29
    v_accvgpr_write_b32 a29, v30
    v_accvgpr_read_b32 v30, a30
    v_mul_f32 v30, v30, v29
    v_accvgpr_write_b32 a30, v30
    v_accvgpr_read_b32 v30, a31
    v_mul_f32 v30, v30, v29
    v_accvgpr_write_b32 a31, v30
    v_accvgpr_read_b32 v30, a32
    v_mul_f32 v30, v30, v29
    v_accvgpr_write_b32 a32, v30
    v_accvgpr_read_b32 v30, a33
    v_mul_f32 v30, v30, v29
    v_accvgpr_write_b32 a33, v30
    v_accvgpr_read_b32 v30, a34
    v_mul_f32 v30, v30, v29
    v_accvgpr_write_b32 a34, v30
    v_accvgpr_read_b32 v30, a35
    v_mul_f32 v30, v30, v29
    v_accvgpr_write_b32 a35, v30
    v_accvgpr_read_b32 v30, a36
    v_mul_f32 v30, v30, v29
    v_accvgpr_write_b32 a36, v30
    v_accvgpr_read_b32 v30, a37
    v_mul_f32 v30, v30, v29
    v_accvgpr_write_b32 a37, v30
    v_accvgpr_read_b32 v30, a38
    v_mul_f32 v30, v30, v29
    v_accvgpr_write_b32 a38, v30
    v_accvgpr_read_b32 v30, a39
    v_mul_f32 v30, v30, v29
    v_accvgpr_write_b32 a39, v30
    v_accvgpr_read_b32 v30, a40
    v_mul_f32 v30, v30, v29
    v_accvgpr_write_b32 a40, v30
    v_accvgpr_read_b32 v30, a41
    v_mul_f32 v30, v30, v29
    v_accvgpr_write_b32 a41, v30
    v_accvgpr_read_b32 v30, a42
    v_mul_f32 v30, v30, v29
    v_accvgpr_write_b32 a42, v30
    v_accvgpr_read_b32 v30, a43
    v_mul_f32 v30, v30, v29
    v_accvgpr_write_b32 a43, v30
    v_accvgpr_read_b32 v30, a44
    v_mul_f32 v30, v30, v29
    v_accvgpr_write_b32 a44, v30
    v_accvgpr_read_b32 v30, a45
    v_mul_f32 v30, v30, v29
    v_accvgpr_write_b32 a45, v30
    v_accvgpr_read_b32 v30, a46
    v_mul_f32 v30, v30, v29
    v_accvgpr_write_b32 a46, v30
    v_accvgpr_read_b32 v30, a47
    v_mul_f32 v30, v30, v29
    v_accvgpr_write_b32 a47, v30
    v_accvgpr_read_b32 v30, a48
    v_mul_f32 v30, v30, v29
    v_accvgpr_write_b32 a48, v30
    v_accvgpr_read_b32 v30, a49
    v_mul_f32 v30, v30, v29
    v_accvgpr_write_b32 a49, v30
    v_accvgpr_read_b32 v30, a50
    v_mul_f32 v30, v30, v29
    v_accvgpr_write_b32 a50, v30
    v_accvgpr_read_b32 v30, a51
    v_mul_f32 v30, v30, v29
    v_accvgpr_write_b32 a51, v30
    v_accvgpr_read_b32 v30, a52
    v_mul_f32 v30, v30, v29
    v_accvgpr_write_b32 a52, v30
    v_accvgpr_read_b32 v30, a53
    v_mul_f32 v30, v30, v29
    v_accvgpr_write_b32 a53, v30
    v_accvgpr_read_b32 v30, a54
    v_mul_f32 v30, v30, v29
    v_accvgpr_write_b32 a54, v30
    v_accvgpr_read_b32 v30, a55
    v_mul_f32 v30, v30, v29
    v_accvgpr_write_b32 a55, v30
    v_accvgpr_read_b32 v30, a56
    v_mul_f32 v30, v30, v29
    v_accvgpr_write_b32 a56, v30
    v_accvgpr_read_b32 v30, a57
    v_mul_f32 v30, v30, v29
    v_accvgpr_write_b32 a57, v30
    v_accvgpr_read_b32 v30, a58
    v_mul_f32 v30, v30, v29
    v_accvgpr_write_b32 a58, v30
    v_accvgpr_read_b32 v30, a59
    v_mul_f32 v30, v30, v29
    v_accvgpr_write_b32 a59, v30
    v_accvgpr_read_b32 v30, a60
    v_mul_f32 v30, v30, v29
    v_accvgpr_write_b32 a60, v30
    v_accvgpr_read_b32 v30, a61
    v_mul_f32 v30, v30, v29
    v_accvgpr_write_b32 a61, v30
    v_accvgpr_read_b32 v30, a62
    v_mul_f32 v30, v30, v29
    v_accvgpr_write_b32 a62, v30
    v_accvgpr_read_b32 v30, a63
    v_mul_f32 v30, v30, v29
    v_accvgpr_write_b32 a63, v30
    v_mul_f32 v25, v25, v29
    v_sub_f32 v96, v96, v28
    v_sub_f32 v32, v32, v28
    v_sub_f32 v64, v64, v28
    v_sub_f32 v97, v97, v28
    v_sub_f32 v33, v33, v28
    v_sub_f32 v65, v65, v28
    v_sub_f32 v98, v98, v28
    v_sub_f32 v34, v34, v28
    v_sub_f32 v66, v66, v28
    v_sub_f32 v99, v99, v28
    v_sub_f32 v35, v35, v28
    v_sub_f32 v67, v67, v28
    v_sub_f32 v100, v100, v28
    v_sub_f32 v36, v36, v28
    v_sub_f32 v68, v68, v28
    v_sub_f32 v101, v101, v28
    v_sub_f32 v37, v37, v28
    v_sub_f32 v69, v69, v28
    v_sub_f32 v102, v102, v28
    v_sub_f32 v38, v38, v28
    v_sub_f32 v70, v70, v28
    v_sub_f32 v103, v103, v28
    v_sub_f32 v39, v39, v28
    v_sub_f32 v71, v71, v28
    v_sub_f32 v104, v104, v28
    v_sub_f32 v40, v40, v28
    v_sub_f32 v72, v72, v28
    v_sub_f32 v105, v105, v28
    v_sub_f32 v41, v41, v28
    v_sub_f32 v73, v73, v28
    v_sub_f32 v106, v106, v28
    v_sub_f32 v42, v42, v28
    v_sub_f32 v74, v74, v28
    v_sub_f32 v107, v107, v28
    v_sub_f32 v43, v43, v28
    v_sub_f32 v75, v75, v28
    v_sub_f32 v108, v108, v28
    v_sub_f32 v44, v44, v28
    v_sub_f32 v76, v76, v28
    v_sub_f32 v109, v109, v28
    v_sub_f32 v45, v45, v28
    v_sub_f32 v77, v77, v28
    v_sub_f32 v110, v110, v28
    v_sub_f32 v46, v46, v28
    v_sub_f32 v78, v78, v28
    v_sub_f32 v111, v111, v28
    v_sub_f32 v47, v47, v28
    v_sub_f32 v79, v79, v28
    v_exp_f32 v28, v32
    v_exp_f32 v29, v33
    v_exp_f32 v30, v34
    v_add_f32 v27, v28, v29
    v_exp_f32 v31, v35
    v_cvt_pk_bf16_f32 v128, v28, v29
    v_exp_f32 v28, v36
    v_add_f32 v27, v27, v30
    v_add_f32 v27, v27, v31
    v_exp_f32 v29, v37
    v_cvt_pk_bf16_f32 v129, v30, v31
    v_exp_f32 v30, v38
    v_add_f32 v27, v27, v28
    v_add_f32 v27, v27, v29
    v_exp_f32 v31, v39
    v_cvt_pk_bf16_f32 v130, v28, v29
    v_exp_f32 v28, v40
    v_add_f32 v27, v27, v30
    v_add_f32 v27, v27, v31
    v_exp_f32 v29, v41
    v_cvt_pk_bf16_f32 v131, v30, v31
    v_exp_f32 v30, v42
    v_add_f32 v27, v27, v28
    v_add_f32 v27, v27, v29
    v_exp_f32 v31, v43
    v_cvt_pk_bf16_f32 v132, v28, v29
    v_exp_f32 v28, v44
    v_add_f32 v27, v27, v30
    v_add_f32 v27, v27, v31
    v_exp_f32 v29, v45
    v_cvt_pk_bf16_f32 v133, v30, v31
    v_exp_f32 v30, v46
    v_add_f32 v27, v27, v28
    v_add_f32 v27, v27, v29
    v_exp_f32 v31, v47
    v_cvt_pk_bf16_f32 v134, v28, v29
    v_add_f32 v27, v27, v30
    v_add_f32 v27, v27, v31
    v_cvt_pk_bf16_f32 v135, v30, v31
    s_nop 1
    s_branch attn_kernel_ret_0_0
attn_kernel_slow_0_1:
    s_nop 15
    s_nop 15
    v_max3_f32 v28, v48, v49, v50
    v_max3_f32 v28, v28, v51, v52
    v_max3_f32 v28, v28, v53, v54
    v_max3_f32 v28, v28, v55, v56
    v_max3_f32 v28, v28, v57, v58
    v_max3_f32 v28, v28, v59, v60
    v_max3_f32 v28, v28, v61, v62
    v_max_f32 v28, v28, v63
    v_mov_b32 v29, v28
    s_nop 1
    v_permlane32_swap_b32 v29, v28
    s_nop 1
    v_max_f32 v28, v28, v29
    v_ceil_f32 v28, v28
    v_max_f32 v28, 0, v28
    v_cvt_i32_f32 v29, v28
    v_sub_u32 v29, 0, v29
    v_ldexp_f32 v29, 1.0, v29
    v_accvgpr_read_b32 v30, a64
    v_mul_f32 v30, v30, v29
    v_accvgpr_write_b32 a64, v30
    v_accvgpr_read_b32 v30, a65
    v_mul_f32 v30, v30, v29
    v_accvgpr_write_b32 a65, v30
    v_accvgpr_read_b32 v30, a66
    v_mul_f32 v30, v30, v29
    v_accvgpr_write_b32 a66, v30
    v_accvgpr_read_b32 v30, a67
    v_mul_f32 v30, v30, v29
    v_accvgpr_write_b32 a67, v30
    v_accvgpr_read_b32 v30, a68
    v_mul_f32 v30, v30, v29
    v_accvgpr_write_b32 a68, v30
    v_accvgpr_read_b32 v30, a69
    v_mul_f32 v30, v30, v29
    v_accvgpr_write_b32 a69, v30
    v_accvgpr_read_b32 v30, a70
    v_mul_f32 v30, v30, v29
    v_accvgpr_write_b32 a70, v30
    v_accvgpr_read_b32 v30, a71
    v_mul_f32 v30, v30, v29
    v_accvgpr_write_b32 a71, v30
    v_accvgpr_read_b32 v30, a72
    v_mul_f32 v30, v30, v29
    v_accvgpr_write_b32 a72, v30
    v_accvgpr_read_b32 v30, a73
    v_mul_f32 v30, v30, v29
    v_accvgpr_write_b32 a73, v30
    v_accvgpr_read_b32 v30, a74
    v_mul_f32 v30, v30, v29
    v_accvgpr_write_b32 a74, v30
    v_accvgpr_read_b32 v30, a75
    v_mul_f32 v30, v30, v29
    v_accvgpr_write_b32 a75, v30
    v_accvgpr_read_b32 v30, a76
    v_mul_f32 v30, v30, v29
    v_accvgpr_write_b32 a76, v30
    v_accvgpr_read_b32 v30, a77
    v_mul_f32 v30, v30, v29
    v_accvgpr_write_b32 a77, v30
    v_accvgpr_read_b32 v30, a78
    v_mul_f32 v30, v30, v29
    v_accvgpr_write_b32 a78, v30
    v_accvgpr_read_b32 v30, a79
    v_mul_f32 v30, v30, v29
    v_accvgpr_write_b32 a79, v30
    v_accvgpr_read_b32 v30, a80
    v_mul_f32 v30, v30, v29
    v_accvgpr_write_b32 a80, v30
    v_accvgpr_read_b32 v30, a81
    v_mul_f32 v30, v30, v29
    v_accvgpr_write_b32 a81, v30
    v_accvgpr_read_b32 v30, a82
    v_mul_f32 v30, v30, v29
    v_accvgpr_write_b32 a82, v30
    v_accvgpr_read_b32 v30, a83
    v_mul_f32 v30, v30, v29
    v_accvgpr_write_b32 a83, v30
    v_accvgpr_read_b32 v30, a84
    v_mul_f32 v30, v30, v29
    v_accvgpr_write_b32 a84, v30
    v_accvgpr_read_b32 v30, a85
    v_mul_f32 v30, v30, v29
    v_accvgpr_write_b32 a85, v30
    v_accvgpr_read_b32 v30, a86
    v_mul_f32 v30, v30, v29
    v_accvgpr_write_b32 a86, v30
    v_accvgpr_read_b32 v30, a87
    v_mul_f32 v30, v30, v29
    v_accvgpr_write_b32 a87, v30
    v_accvgpr_read_b32 v30, a88
    v_mul_f32 v30, v30, v29
    v_accvgpr_write_b32 a88, v30
    v_accvgpr_read_b32 v30, a89
    v_mul_f32 v30, v30, v29
    v_accvgpr_write_b32 a89, v30
    v_accvgpr_read_b32 v30, a90
    v_mul_f32 v30, v30, v29
    v_accvgpr_write_b32 a90, v30
    v_accvgpr_read_b32 v30, a91
    v_mul_f32 v30, v30, v29
    v_accvgpr_write_b32 a91, v30
    v_accvgpr_read_b32 v30, a92
    v_mul_f32 v30, v30, v29
    v_accvgpr_write_b32 a92, v30
    v_accvgpr_read_b32 v30, a93
    v_mul_f32 v30, v30, v29
    v_accvgpr_write_b32 a93, v30
    v_accvgpr_read_b32 v30, a94
    v_mul_f32 v30, v30, v29
    v_accvgpr_write_b32 a94, v30
    v_accvgpr_read_b32 v30, a95
    v_mul_f32 v30, v30, v29
    v_accvgpr_write_b32 a95, v30
    v_accvgpr_read_b32 v30, a96
    v_mul_f32 v30, v30, v29
    v_accvgpr_write_b32 a96, v30
    v_accvgpr_read_b32 v30, a97
    v_mul_f32 v30, v30, v29
    v_accvgpr_write_b32 a97, v30
    v_accvgpr_read_b32 v30, a98
    v_mul_f32 v30, v30, v29
    v_accvgpr_write_b32 a98, v30
    v_accvgpr_read_b32 v30, a99
    v_mul_f32 v30, v30, v29
    v_accvgpr_write_b32 a99, v30
    v_accvgpr_read_b32 v30, a100
    v_mul_f32 v30, v30, v29
    v_accvgpr_write_b32 a100, v30
    v_accvgpr_read_b32 v30, a101
    v_mul_f32 v30, v30, v29
    v_accvgpr_write_b32 a101, v30
    v_accvgpr_read_b32 v30, a102
    v_mul_f32 v30, v30, v29
    v_accvgpr_write_b32 a102, v30
    v_accvgpr_read_b32 v30, a103
    v_mul_f32 v30, v30, v29
    v_accvgpr_write_b32 a103, v30
    v_accvgpr_read_b32 v30, a104
    v_mul_f32 v30, v30, v29
    v_accvgpr_write_b32 a104, v30
    v_accvgpr_read_b32 v30, a105
    v_mul_f32 v30, v30, v29
    v_accvgpr_write_b32 a105, v30
    v_accvgpr_read_b32 v30, a106
    v_mul_f32 v30, v30, v29
    v_accvgpr_write_b32 a106, v30
    v_accvgpr_read_b32 v30, a107
    v_mul_f32 v30, v30, v29
    v_accvgpr_write_b32 a107, v30
    v_accvgpr_read_b32 v30, a108
    v_mul_f32 v30, v30, v29
    v_accvgpr_write_b32 a108, v30
    v_accvgpr_read_b32 v30, a109
    v_mul_f32 v30, v30, v29
    v_accvgpr_write_b32 a109, v30
    v_accvgpr_read_b32 v30, a110
    v_mul_f32 v30, v30, v29
    v_accvgpr_write_b32 a110, v30
    v_accvgpr_read_b32 v30, a111
    v_mul_f32 v30, v30, v29
    v_accvgpr_write_b32 a111, v30
    v_accvgpr_read_b32 v30, a112
    v_mul_f32 v30, v30, v29
    v_accvgpr_write_b32 a112, v30
    v_accvgpr_read_b32 v30, a113
    v_mul_f32 v30, v30, v29
    v_accvgpr_write_b32 a113, v30
    v_accvgpr_read_b32 v30, a114
    v_mul_f32 v30, v30, v29
    v_accvgpr_write_b32 a114, v30
    v_accvgpr_read_b32 v30, a115
    v_mul_f32 v30, v30, v29
    v_accvgpr_write_b32 a115, v30
    v_accvgpr_read_b32 v30, a116
    v_mul_f32 v30, v30, v29
    v_accvgpr_write_b32 a116, v30
    v_accvgpr_read_b32 v30, a117
    v_mul_f32 v30, v30, v29
    v_accvgpr_write_b32 a117, v30
    v_accvgpr_read_b32 v30, a118
    v_mul_f32 v30, v30, v29
    v_accvgpr_write_b32 a118, v30
    v_accvgpr_read_b32 v30, a119
    v_mul_f32 v30, v30, v29
    v_accvgpr_write_b32 a119, v30
    v_accvgpr_read_b32 v30, a120
    v_mul_f32 v30, v30, v29
    v_accvgpr_write_b32 a120, v30
    v_accvgpr_read_b32 v30, a121
    v_mul_f32 v30, v30, v29
    v_accvgpr_write_b32 a121, v30
    v_accvgpr_read_b32 v30, a122
    v_mul_f32 v30, v30, v29
    v_accvgpr_write_b32 a122, v30
    v_accvgpr_read_b32 v30, a123
    v_mul_f32 v30, v30, v29
    v_accvgpr_write_b32 a123, v30
    v_accvgpr_read_b32 v30, a124
    v_mul_f32 v30, v30, v29
    v_accvgpr_write_b32 a124, v30
    v_accvgpr_read_b32 v30, a125
    v_mul_f32 v30, v30, v29
    v_accvgpr_write_b32 a125, v30
    v_accvgpr_read_b32 v30, a126
    v_mul_f32 v30, v30, v29
    v_accvgpr_write_b32 a126, v30
    v_accvgpr_read_b32 v30, a127
    v_mul_f32 v30, v30, v29
    v_accvgpr_write_b32 a127, v30
    v_mul_f32 v26, v26, v29
    v_sub_f32 v112, v112, v28
    v_sub_f32 v48, v48, v28
    v_sub_f32 v80, v80, v28
    v_sub_f32 v113, v113, v28
    v_sub_f32 v49, v49, v28
    v_sub_f32 v81, v81, v28
    v_sub_f32 v114, v114, v28
    v_sub_f32 v50, v50, v28
    v_sub_f32 v82, v82, v28
    v_sub_f32 v115, v115, v28
    v_sub_f32 v51, v51, v28
    v_sub_f32 v83, v83, v28
    v_sub_f32 v116, v116, v28
    v_sub_f32 v52, v52, v28
    v_sub_f32 v84, v84, v28
    v_sub_f32 v117, v117, v28
    v_sub_f32 v53, v53, v28
    v_sub_f32 v85, v85, v28
    v_sub_f32 v118, v118, v28
    v_sub_f32 v54, v54, v28
    v_sub_f32 v86, v86, v28
    v_sub_f32 v119, v119, v28
    v_sub_f32 v55, v55, v28
    v_sub_f32 v87, v87, v28
    v_sub_f32 v120, v120, v28
    v_sub_f32 v56, v56, v28
    v_sub_f32 v88, v88, v28
    v_sub_f32 v121, v121, v28
    v_sub_f32 v57, v57, v28
    v_sub_f32 v89, v89, v28
    v_sub_f32 v122, v122, v28
    v_sub_f32 v58, v58, v28
    v_sub_f32 v90, v90, v28
    v_sub_f32 v123, v123, v28
    v_sub_f32 v59, v59, v28
    v_sub_f32 v91, v91, v28
    v_sub_f32 v124, v124, v28
    v_sub_f32 v60, v60, v28
    v_sub_f32 v92, v92, v28
    v_sub_f32 v125, v125, v28
    v_sub_f32 v61, v61, v28
    v_sub_f32 v93, v93, v28
    v_sub_f32 v126, v126, v28
    v_sub_f32 v62, v62, v28
    v_sub_f32 v94, v94, v28
    v_sub_f32 v127, v127, v28
    v_sub_f32 v63, v63, v28
    v_sub_f32 v95, v95, v28
    v_exp_f32 v28, v48
    v_exp_f32 v29, v49
    v_exp_f32 v30, v50
    v_add_f32 v27, v28, v29
    v_exp_f32 v31, v51
    v_cvt_pk_bf16_f32 v136, v28, v29
    v_exp_f32 v28, v52
    v_add_f32 v27, v27, v30
    v_add_f32 v27, v27, v31
    v_exp_f32 v29, v53
    v_cvt_pk_bf16_f32 v137, v30, v31
    v_exp_f32 v30, v54
    v_add_f32 v27, v27, v28
    v_add_f32 v27, v27, v29
    v_exp_f32 v31, v55
    v_cvt_pk_bf16_f32 v138, v28, v29
    v_exp_f32 v28, v56
    v_add_f32 v27, v27, v30
    v_add_f32 v27, v27, v31
    v_exp_f32 v29, v57
    v_cvt_pk_bf16_f32 v139, v30, v31
    v_exp_f32 v30, v58
    v_add_f32 v27, v27, v28
    v_add_f32 v27, v27, v29
    v_exp_f32 v31, v59
    v_cvt_pk_bf16_f32 v140, v28, v29
    v_exp_f32 v28, v60
    v_add_f32 v27, v27, v30
    v_add_f32 v27, v27, v31
    v_exp_f32 v29, v61
    v_cvt_pk_bf16_f32 v141, v30, v31
    v_exp_f32 v30, v62
    v_add_f32 v27, v27, v28
    v_add_f32 v27, v27, v29
    v_exp_f32 v31, v63
    v_cvt_pk_bf16_f32 v142, v28, v29
    v_add_f32 v27, v27, v30
    v_add_f32 v27, v27, v31
    v_cvt_pk_bf16_f32 v143, v30, v31
    s_nop 1
    s_branch attn_kernel_ret_0_1
attn_kernel_slow_1_0:
    s_nop 15
    s_nop 15
    v_max3_f32 v28, v64, v65, v66
    v_max3_f32 v28, v28, v67, v68
    v_max3_f32 v28, v28, v69, v70
    v_max3_f32 v28, v28, v71, v72
    v_max3_f32 v28, v28, v73, v74
    v_max3_f32 v28, v28, v75, v76
    v_max3_f32 v28, v28, v77, v78
    v_max_f32 v28, v28, v79
    v_mov_b32 v29, v28
    s_nop 1
    v_permlane32_swap_b32 v29, v28
    s_nop 1
    v_max_f32 v28, v28, v29
    v_ceil_f32 v28, v28
    v_max_f32 v28, 0, v28
    v_cvt_i32_f32 v29, v28
    v_sub_u32 v29, 0, v29
    v_ldexp_f32 v29, 1.0, v29
    v_accvgpr_read_b32 v30, a0
    v_mul_f32 v30, v30, v29
    v_accvgpr_write_b32 a0, v30
    v_accvgpr_read_b32 v30, a1
    v_mul_f32 v30, v30, v29
    v_accvgpr_write_b32 a1, v30
    v_accvgpr_read_b32 v30, a2
    v_mul_f32 v30, v30, v29
    v_accvgpr_write_b32 a2, v30
    v_accvgpr_read_b32 v30, a3
    v_mul_f32 v30, v30, v29
    v_accvgpr_write_b32 a3, v30
    v_accvgpr_read_b32 v30, a4
    v_mul_f32 v30, v30, v29
    v_accvgpr_write_b32 a4, v30
    v_accvgpr_read_b32 v30, a5
    v_mul_f32 v30, v30, v29
    v_accvgpr_write_b32 a5, v30
    v_accvgpr_read_b32 v30, a6
    v_mul_f32 v30, v30, v29
    v_accvgpr_write_b32 a6, v30
    v_accvgpr_read_b32 v30, a7
    v_mul_f32 v30, v30, v29
    v_accvgpr_write_b32 a7, v30
    v_accvgpr_read_b32 v30, a8
    v_mul_f32 v30, v30, v29
    v_accvgpr_write_b32 a8, v30
    v_accvgpr_read_b32 v30, a9
    v_mul_f32 v30, v30, v29
    v_accvgpr_write_b32 a9, v30
    v_accvgpr_read_b32 v30, a10
    v_mul_f32 v30, v30, v29
    v_accvgpr_write_b32 a10, v30
    v_accvgpr_read_b32 v30, a11
    v_mul_f32 v30, v30, v29
    v_accvgpr_write_b32 a11, v30
    v_accvgpr_read_b32 v30, a12
    v_mul_f32 v30, v30, v29
    v_accvgpr_write_b32 a12, v30
    v_accvgpr_read_b32 v30, a13
    v_mul_f32 v30, v30, v29
    v_accvgpr_write_b32 a13, v30
    v_accvgpr_read_b32 v30, a14
    v_mul_f32 v30, v30, v29
    v_accvgpr_write_b32 a14, v30
    v_accvgpr_read_b32 v30, a15
    v_mul_f32 v30, v30, v29
    v_accvgpr_write_b32 a15, v30
    v_accvgpr_read_b32 v30, a16
    v_mul_f32 v30, v30, v29
    v_accvgpr_write_b32 a16, v30
    v_accvgpr_read_b32 v30, a17
    v_mul_f32 v30, v30, v29
    v_accvgpr_write_b32 a17, v30
    v_accvgpr_read_b32 v30, a18
    v_mul_f32 v30, v30, v29
    v_accvgpr_write_b32 a18, v30
    v_accvgpr_read_b32 v30, a19
    v_mul_f32 v30, v30, v29
    v_accvgpr_write_b32 a19, v30
    v_accvgpr_read_b32 v30, a20
    v_mul_f32 v30, v30, v29
    v_accvgpr_write_b32 a20, v30
    v_accvgpr_read_b32 v30, a21
    v_mul_f32 v30, v30, v29
    v_accvgpr_write_b32 a21, v30
    v_accvgpr_read_b32 v30, a22
    v_mul_f32 v30, v30, v29
    v_accvgpr_write_b32 a22, v30
    v_accvgpr_read_b32 v30, a23
    v_mul_f32 v30, v30, v29
    v_accvgpr_write_b32 a23, v30
    v_accvgpr_read_b32 v30, a24
    v_mul_f32 v30, v30, v29
    v_accvgpr_write_b32 a24, v30
    v_accvgpr_read_b32 v30, a25
    v_mul_f32 v30, v30, v29
    v_accvgpr_write_b32 a25, v30
    v_accvgpr_read_b32 v30, a26
    v_mul_f32 v30, v30, v29
    v_accvgpr_write_b32 a26, v30
    v_accvgpr_read_b32 v30, a27
    v_mul_f32 v30, v30, v29
    v_accvgpr_write_b32 a27, v30
    v_accvgpr_read_b32 v30, a28
    v_mul_f32 v30, v30, v29
    v_accvgpr_write_b32 a28, v30
    v_accvgpr_read_b32 v30, a29
    v_mul_f32 v30, v30, v29
    v_accvgpr_write_b32 a29, v30
    v_accvgpr_read_b32 v30, a30
    v_mul_f32 v30, v30, v29
    v_accvgpr_write_b32 a30, v30
    v_accvgpr_read_b32 v30, a31
    v_mul_f32 v30, v30, v29
    v_accvgpr_write_b32 a31, v30
    v_accvgpr_read_b32 v30, a32
    v_mul_f32 v30, v30, v29
    v_accvgpr_write_b32 a32, v30
    v_accvgpr_read_b32 v30, a33
    v_mul_f32 v30, v30, v29
    v_accvgpr_write_b32 a33, v30
    v_accvgpr_read_b32 v30, a34
    v_mul_f32 v30, v30, v29
    v_accvgpr_write_b32 a34, v30
    v_accvgpr_read_b32 v30, a35
    v_mul_f32 v30, v30, v29
    v_accvgpr_write_b32 a35, v30
    v_accvgpr_read_b32 v30, a36
    v_mul_f32 v30, v30, v29
    v_accvgpr_write_b32 a36, v30
    v_accvgpr_read_b32 v30, a37
    v_mul_f32 v30, v30, v29
    v_accvgpr_write_b32 a37, v30
    v_accvgpr_read_b32 v30, a38
    v_mul_f32 v30, v30, v29
    v_accvgpr_write_b32 a38, v30
    v_accvgpr_read_b32 v30, a39
    v_mul_f32 v30, v30, v29
    v_accvgpr_write_b32 a39, v30
    v_accvgpr_read_b32 v30, a40
    v_mul_f32 v30, v30, v29
    v_accvgpr_write_b32 a40, v30
    v_accvgpr_read_b32 v30, a41
    v_mul_f32 v30, v30, v29
    v_accvgpr_write_b32 a41, v30
    v_accvgpr_read_b32 v30, a42
    v_mul_f32 v30, v30, v29
    v_accvgpr_write_b32 a42, v30
    v_accvgpr_read_b32 v30, a43
    v_mul_f32 v30, v30, v29
    v_accvgpr_write_b32 a43, v30
    v_accvgpr_read_b32 v30, a44
    v_mul_f32 v30, v30, v29
    v_accvgpr_write_b32 a44, v30
    v_accvgpr_read_b32 v30, a45
    v_mul_f32 v30, v30, v29
    v_accvgpr_write_b32 a45, v30
    v_accvgpr_read_b32 v30, a46
    v_mul_f32 v30, v30, v29
    v_accvgpr_write_b32 a46, v30
    v_accvgpr_read_b32 v30, a47
    v_mul_f32 v30, v30, v29
    v_accvgpr_write_b32 a47, v30
    v_accvgpr_read_b32 v30, a48
    v_mul_f32 v30, v30, v29
    v_accvgpr_write_b32 a48, v30
    v_accvgpr_read_b32 v30, a49
    v_mul_f32 v30, v30, v29
    v_accvgpr_write_b32 a49, v30
    v_accvgpr_read_b32 v30, a50
    v_mul_f32 v30, v30, v29
    v_accvgpr_write_b32 a50, v30
    v_accvgpr_read_b32 v30, a51
    v_mul_f32 v30, v30, v29
    v_accvgpr_write_b32 a51, v30
    v_accvgpr_read_b32 v30, a52
    v_mul_f32 v30, v30, v29
    v_accvgpr_write_b32 a52, v30
    v_accvgpr_read_b32 v30, a53
    v_mul_f32 v30, v30, v29
    v_accvgpr_write_b32 a53, v30
    v_accvgpr_read_b32 v30, a54
    v_mul_f32 v30, v30, v29
    v_accvgpr_write_b32 a54, v30
    v_accvgpr_read_b32 v30, a55
    v_mul_f32 v30, v30, v29
    v_accvgpr_write_b32 a55, v30
    v_accvgpr_read_b32 v30, a56
    v_mul_f32 v30, v30, v29
    v_accvgpr_write_b32 a56, v30
    v_accvgpr_read_b32 v30, a57
    v_mul_f32 v30, v30, v29
    v_accvgpr_write_b32 a57, v30
    v_accvgpr_read_b32 v30, a58
    v_mul_f32 v30, v30, v29
    v_accvgpr_write_b32 a58, v30
    v_accvgpr_read_b32 v30, a59
    v_mul_f32 v30, v30, v29
    v_accvgpr_write_b32 a59, v30
    v_accvgpr_read_b32 v30, a60
    v_mul_f32 v30, v30, v29
    v_accvgpr_write_b32 a60, v30
    v_accvgpr_read_b32 v30, a61
    v_mul_f32 v30, v30, v29
    v_accvgpr_write_b32 a61, v30
    v_accvgpr_read_b32 v30, a62
    v_mul_f32 v30, v30, v29
    v_accvgpr_write_b32 a62, v30
    v_accvgpr_read_b32 v30, a63
    v_mul_f32 v30, v30, v29
    v_accvgpr_write_b32 a63, v30
    v_mul_f32 v25, v25, v29
    v_sub_f32 v96, v96, v28
    v_sub_f32 v64, v64, v28
    v_sub_f32 v32, v32, v28
    v_sub_f32 v97, v97, v28
    v_sub_f32 v65, v65, v28
    v_sub_f32 v33, v33, v28
    v_sub_f32 v98, v98, v28
    v_sub_f32 v66, v66, v28
    v_sub_f32 v34, v34, v28
    v_sub_f32 v99, v99, v28
    v_sub_f32 v67, v67, v28
    v_sub_f32 v35, v35, v28
    v_sub_f32 v100, v100, v28
    v_sub_f32 v68, v68, v28
    v_sub_f32 v36, v36, v28
    v_sub_f32 v101, v101, v28
    v_sub_f32 v69, v69, v28
    v_sub_f32 v37, v37, v28
    v_sub_f32 v102, v102, v28
    v_sub_f32 v70, v70, v28
    v_sub_f32 v38, v38, v28
    v_sub_f32 v103, v103, v28
    v_sub_f32 v71, v71, v28
    v_sub_f32 v39, v39, v28
    v_sub_f32 v104, v104, v28
    v_sub_f32 v72, v72, v28
    v_sub_f32 v40, v40, v28
    v_sub_f32 v105, v105, v28
    v_sub_f32 v73, v73, v28
    v_sub_f32 v41, v41, v28
    v_sub_f32 v106, v106, v28
    v_sub_f32 v74, v74, v28
    v_sub_f32 v42, v42, v28
    v_sub_f32 v107, v107, v28
    v_sub_f32 v75, v75, v28
    v_sub_f32 v43, v43, v28
    v_sub_f32 v108, v108, v28
    v_sub_f32 v76, v76, v28
    v_sub_f32 v44, v44, v28
    v_sub_f32 v109, v109, v28
    v_sub_f32 v77, v77, v28
    v_sub_f32 v45, v45, v28
    v_sub_f32 v110, v110, v28
    v_sub_f32 v78, v78, v28
    v_sub_f32 v46, v46, v28
    v_sub_f32 v111, v111, v28
    v_sub_f32 v79, v79, v28
    v_sub_f32 v47, v47, v28
    v_exp_f32 v28, v64
    v_exp_f32 v29, v65
    v_exp_f32 v30, v66
    v_add_f32 v27, v28, v29
    v_exp_f32 v31, v67
    v_cvt_pk_bf16_f32 v144, v28, v29
    v_exp_f32 v28, v68
    v_add_f32 v27, v27, v30
    v_add_f32 v27, v27, v31
    v_exp_f32 v29, v69
    v_cvt_pk_bf16_f32 v145, v30, v31
    v_exp_f32 v30, v70
    v_add_f32 v27, v27, v28
    v_add_f32 v27, v27, v29
    v_exp_f32 v31, v71
    v_cvt_pk_bf16_f32 v146, v28, v29
    v_exp_f32 v28, v72
    v_add_f32 v27, v27, v30
    v_add_f32 v27, v27, v31
    v_exp_f32 v29, v73
    v_cvt_pk_bf16_f32 v147, v30, v31
    v_exp_f32 v30, v74
    v_add_f32 v27, v27, v28
    v_add_f32 v27, v27, v29
    v_exp_f32 v31, v75
    v_cvt_pk_bf16_f32 v148, v28, v29
    v_exp_f32 v28, v76
    v_add_f32 v27, v27, v30
    v_add_f32 v27, v27, v31
    v_exp_f32 v29, v77
    v_cvt_pk_bf16_f32 v149, v30, v31
    v_exp_f32 v30, v78
    v_add_f32 v27, v27, v28
    v_add_f32 v27, v27, v29
    v_exp_f32 v31, v79
    v_cvt_pk_bf16_f32 v150, v28, v29
    v_add_f32 v27, v27, v30
    v_add_f32 v27, v27, v31
    v_cvt_pk_bf16_f32 v151, v30, v31
    s_nop 1
    s_branch attn_kernel_ret_1_0
attn_kernel_slow_1_1:
    s_nop 15
    s_nop 15
    v_max3_f32 v28, v80, v81, v82
    v_max3_f32 v28, v28, v83, v84
    v_max3_f32 v28, v28, v85, v86
    v_max3_f32 v28, v28, v87, v88
    v_max3_f32 v28, v28, v89, v90
    v_max3_f32 v28, v28, v91, v92
    v_max3_f32 v28, v28, v93, v94
    v_max_f32 v28, v28, v95
    v_mov_b32 v29, v28
    s_nop 1
    v_permlane32_swap_b32 v29, v28
    s_nop 1
    v_max_f32 v28, v28, v29
    v_ceil_f32 v28, v28
    v_max_f32 v28, 0, v28
    v_cvt_i32_f32 v29, v28
    v_sub_u32 v29, 0, v29
    v_ldexp_f32 v29, 1.0, v29
    v_accvgpr_read_b32 v30, a64
    v_mul_f32 v30, v30, v29
    v_accvgpr_write_b32 a64, v30
    v_accvgpr_read_b32 v30, a65
    v_mul_f32 v30, v30, v29
    v_accvgpr_write_b32 a65, v30
    v_accvgpr_read_b32 v30, a66
    v_mul_f32 v30, v30, v29
    v_accvgpr_write_b32 a66, v30
    v_accvgpr_read_b32 v30, a67
    v_mul_f32 v30, v30, v29
    v_accvgpr_write_b32 a67, v30
    v_accvgpr_read_b32 v30, a68
    v_mul_f32 v30, v30, v29
    v_accvgpr_write_b32 a68, v30
    v_accvgpr_read_b32 v30, a69
    v_mul_f32 v30, v30, v29
    v_accvgpr_write_b32 a69, v30
    v_accvgpr_read_b32 v30, a70
    v_mul_f32 v30, v30, v29
    v_accvgpr_write_b32 a70, v30
    v_accvgpr_read_b32 v30, a71
    v_mul_f32 v30, v30, v29
    v_accvgpr_write_b32 a71, v30
    v_accvgpr_read_b32 v30, a72
    v_mul_f32 v30, v30, v29
    v_accvgpr_write_b32 a72, v30
    v_accvgpr_read_b32 v30, a73
    v_mul_f32 v30, v30, v29
    v_accvgpr_write_b32 a73, v30
    v_accvgpr_read_b32 v30, a74
    v_mul_f32 v30, v30, v29
    v_accvgpr_write_b32 a74, v30
    v_accvgpr_read_b32 v30, a75
    v_mul_f32 v30, v30, v29
    v_accvgpr_write_b32 a75, v30
    v_accvgpr_read_b32 v30, a76
    v_mul_f32 v30, v30, v29
    v_accvgpr_write_b32 a76, v30
    v_accvgpr_read_b32 v30, a77
    v_mul_f32 v30, v30, v29
    v_accvgpr_write_b32 a77, v30
    v_accvgpr_read_b32 v30, a78
    v_mul_f32 v30, v30, v29
    v_accvgpr_write_b32 a78, v30
    v_accvgpr_read_b32 v30, a79
    v_mul_f32 v30, v30, v29
    v_accvgpr_write_b32 a79, v30
    v_accvgpr_read_b32 v30, a80
    v_mul_f32 v30, v30, v29
    v_accvgpr_write_b32 a80, v30
    v_accvgpr_read_b32 v30, a81
    v_mul_f32 v30, v30, v29
    v_accvgpr_write_b32 a81, v30
    v_accvgpr_read_b32 v30, a82
    v_mul_f32 v30, v30, v29
    v_accvgpr_write_b32 a82, v30
    v_accvgpr_read_b32 v30, a83
    v_mul_f32 v30, v30, v29
    v_accvgpr_write_b32 a83, v30
    v_accvgpr_read_b32 v30, a84
    v_mul_f32 v30, v30, v29
    v_accvgpr_write_b32 a84, v30
    v_accvgpr_read_b32 v30, a85
    v_mul_f32 v30, v30, v29
    v_accvgpr_write_b32 a85, v30
    v_accvgpr_read_b32 v30, a86
    v_mul_f32 v30, v30, v29
    v_accvgpr_write_b32 a86, v30
    v_accvgpr_read_b32 v30, a87
    v_mul_f32 v30, v30, v29
    v_accvgpr_write_b32 a87, v30
    v_accvgpr_read_b32 v30, a88
    v_mul_f32 v30, v30, v29
    v_accvgpr_write_b32 a88, v30
    v_accvgpr_read_b32 v30, a89
    v_mul_f32 v30, v30, v29
    v_accvgpr_write_b32 a89, v30
    v_accvgpr_read_b32 v30, a90
    v_mul_f32 v30, v30, v29
    v_accvgpr_write_b32 a90, v30
    v_accvgpr_read_b32 v30, a91
    v_mul_f32 v30, v30, v29
    v_accvgpr_write_b32 a91, v30
    v_accvgpr_read_b32 v30, a92
    v_mul_f32 v30, v30, v29
    v_accvgpr_write_b32 a92, v30
    v_accvgpr_read_b32 v30, a93
    v_mul_f32 v30, v30, v29
    v_accvgpr_write_b32 a93, v30
    v_accvgpr_read_b32 v30, a94
    v_mul_f32 v30, v30, v29
    v_accvgpr_write_b32 a94, v30
    v_accvgpr_read_b32 v30, a95
    v_mul_f32 v30, v30, v29
    v_accvgpr_write_b32 a95, v30
    v_accvgpr_read_b32 v30, a96
    v_mul_f32 v30, v30, v29
    v_accvgpr_write_b32 a96, v30
    v_accvgpr_read_b32 v30, a97
    v_mul_f32 v30, v30, v29
    v_accvgpr_write_b32 a97, v30
    v_accvgpr_read_b32 v30, a98
    v_mul_f32 v30, v30, v29
    v_accvgpr_write_b32 a98, v30
    v_accvgpr_read_b32 v30, a99
    v_mul_f32 v30, v30, v29
    v_accvgpr_write_b32 a99, v30
    v_accvgpr_read_b32 v30, a100
    v_mul_f32 v30, v30, v29
    v_accvgpr_write_b32 a100, v30
    v_accvgpr_read_b32 v30, a101
    v_mul_f32 v30, v30, v29
    v_accvgpr_write_b32 a101, v30
    v_accvgpr_read_b32 v30, a102
    v_mul_f32 v30, v30, v29
    v_accvgpr_write_b32 a102, v30
    v_accvgpr_read_b32 v30, a103
    v_mul_f32 v30, v30, v29
    v_accvgpr_write_b32 a103, v30
    v_accvgpr_read_b32 v30, a104
    v_mul_f32 v30, v30, v29
    v_accvgpr_write_b32 a104, v30
    v_accvgpr_read_b32 v30, a105
    v_mul_f32 v30, v30, v29
    v_accvgpr_write_b32 a105, v30
    v_accvgpr_read_b32 v30, a106
    v_mul_f32 v30, v30, v29
    v_accvgpr_write_b32 a106, v30
    v_accvgpr_read_b32 v30, a107
    v_mul_f32 v30, v30, v29
    v_accvgpr_write_b32 a107, v30
    v_accvgpr_read_b32 v30, a108
    v_mul_f32 v30, v30, v29
    v_accvgpr_write_b32 a108, v30
    v_accvgpr_read_b32 v30, a109
    v_mul_f32 v30, v30, v29
    v_accvgpr_write_b32 a109, v30
    v_accvgpr_read_b32 v30, a110
    v_mul_f32 v30, v30, v29
    v_accvgpr_write_b32 a110, v30
    v_accvgpr_read_b32 v30, a111
    v_mul_f32 v30, v30, v29
    v_accvgpr_write_b32 a111, v30
    v_accvgpr_read_b32 v30, a112
    v_mul_f32 v30, v30, v29
    v_accvgpr_write_b32 a112, v30
    v_accvgpr_read_b32 v30, a113
    v_mul_f32 v30, v30, v29
    v_accvgpr_write_b32 a113, v30
    v_accvgpr_read_b32 v30, a114
    v_mul_f32 v30, v30, v29
    v_accvgpr_write_b32 a114, v30
    v_accvgpr_read_b32 v30, a115
    v_mul_f32 v30, v30, v29
    v_accvgpr_write_b32 a115, v30
    v_accvgpr_read_b32 v30, a116
    v_mul_f32 v30, v30, v29
    v_accvgpr_write_b32 a116, v30
    v_accvgpr_read_b32 v30, a117
    v_mul_f32 v30, v30, v29
    v_accvgpr_write_b32 a117, v30
    v_accvgpr_read_b32 v30, a118
    v_mul_f32 v30, v30, v29
    v_accvgpr_write_b32 a118, v30
    v_accvgpr_read_b32 v30, a119
    v_mul_f32 v30, v30, v29
    v_accvgpr_write_b32 a119, v30
    v_accvgpr_read_b32 v30, a120
    v_mul_f32 v30, v30, v29
    v_accvgpr_write_b32 a120, v30
    v_accvgpr_read_b32 v30, a121
    v_mul_f32 v30, v30, v29
    v_accvgpr_write_b32 a121, v30
    v_accvgpr_read_b32 v30, a122
    v_mul_f32 v30, v30, v29
    v_accvgpr_write_b32 a122, v30
    v_accvgpr_read_b32 v30, a123
    v_mul_f32 v30, v30, v29
    v_accvgpr_write_b32 a123, v30
    v_accvgpr_read_b32 v30, a124
    v_mul_f32 v30, v30, v29
    v_accvgpr_write_b32 a124, v30
    v_accvgpr_read_b32 v30, a125
    v_mul_f32 v30, v30, v29
    v_accvgpr_write_b32 a125, v30
    v_accvgpr_read_b32 v30, a126
    v_mul_f32 v30, v30, v29
    v_accvgpr_write_b32 a126, v30
    v_accvgpr_read_b32 v30, a127
    v_mul_f32 v30, v30, v29
    v_accvgpr_write_b32 a127, v30
    v_mul_f32 v26, v26, v29
    v_sub_f32 v112, v112, v28
    v_sub_f32 v80, v80, v28
    v_sub_f32 v48, v48, v28
    v_sub_f32 v113, v113, v28
    v_sub_f32 v81, v81, v28
    v_sub_f32 v49, v49, v28
    v_sub_f32 v114, v114, v28
    v_sub_f32 v82, v82, v28
    v_sub_f32 v50, v50, v28
    v_sub_f32 v115, v115, v28
    v_sub_f32 v83, v83, v28
    v_sub_f32 v51, v51, v28
    v_sub_f32 v116, v116, v28
    v_sub_f32 v84, v84, v28
    v_sub_f32 v52, v52, v28
    v_sub_f32 v117, v117, v28
    v_sub_f32 v85, v85, v28
    v_sub_f32 v53, v53, v28
    v_sub_f32 v118, v118, v28
    v_sub_f32 v86, v86, v28
    v_sub_f32 v54, v54, v28
    v_sub_f32 v119, v119, v28
    v_sub_f32 v87, v87, v28
    v_sub_f32 v55, v55, v28
    v_sub_f32 v120, v120, v28
    v_sub_f32 v88, v88, v28
    v_sub_f32 v56, v56, v28
    v_sub_f32 v121, v121, v28
    v_sub_f32 v89, v89, v28
    v_sub_f32 v57, v57, v28
    v_sub_f32 v122, v122, v28
    v_sub_f32 v90, v90, v28
    v_sub_f32 v58, v58, v28
    v_sub_f32 v123, v123, v28
    v_sub_f32 v91, v91, v28
    v_sub_f32 v59, v59, v28
    v_sub_f32 v124, v124, v28
    v_sub_f32 v92, v92, v28
    v_sub_f32 v60, v60, v28
    v_sub_f32 v125, v125, v28
    v_sub_f32 v93, v93, v28
    v_sub_f32 v61, v61, v28
    v_sub_f32 v126, v126, v28
    v_sub_f32 v94, v94, v28
    v_sub_f32 v62, v62, v28
    v_sub_f32 v127, v127, v28
    v_sub_f32 v95, v95, v28
    v_sub_f32 v63, v63, v28
    v_exp_f32 v28, v80
    v_exp_f32 v29, v81
    v_exp_f32 v30, v82
    v_add_f32 v27, v28, v29
    v_exp_f32 v31, v83
    v_cvt_pk_bf16_f32 v152, v28, v29
    v_exp_f32 v28, v84
    v_add_f32 v27, v27, v30
    v_add_f32 v27, v27, v31
    v_exp_f32 v29, v85
    v_cvt_pk_bf16_f32 v153, v30, v31
    v_exp_f32 v30, v86
    v_add_f32 v27, v27, v28
    v_add_f32 v27, v27, v29
    v_exp_f32 v31, v87
    v_cvt_pk_bf16_f32 v154, v28, v29
    v_exp_f32 v28, v88
    v_add_f32 v27, v27, v30
    v_add_f32 v27, v27, v31
    v_exp_f32 v29, v89
    v_cvt_pk_bf16_f32 v155, v30, v31
    v_exp_f32 v30, v90
    v_add_f32 v27, v27, v28
    v_add_f32 v27, v27, v29
    v_exp_f32 v31, v91
    v_cvt_pk_bf16_f32 v156, v28, v29
    v_exp_f32 v28, v92
    v_add_f32 v27, v27, v30
    v_add_f32 v27, v27, v31
    v_exp_f32 v29, v93
    v_cvt_pk_bf16_f32 v157, v30, v31
    v_exp_f32 v30, v94
    v_add_f32 v27, v27, v28
    v_add_f32 v27, v27, v29
    v_exp_f32 v31, v95
    v_cvt_pk_bf16_f32 v158, v28, v29
    v_add_f32 v27, v27, v30
    v_add_f32 v27, v27, v31
    v_cvt_pk_bf16_f32 v159, v30, v31
    s_nop 1
    s_branch attn_kernel_ret_1_1
attn_kernel_slow_2_0:
    s_nop 15
    s_nop 15
    v_max3_f32 v28, v32, v33, v34
    v_max3_f32 v28, v28, v35, v36
    v_max3_f32 v28, v28, v37, v38
    v_max3_f32 v28, v28, v39, v40
    v_max3_f32 v28, v28, v41, v42
    v_max3_f32 v28, v28, v43, v44
    v_max3_f32 v28, v28, v45, v46
    v_max_f32 v28, v28, v47
    v_mov_b32 v29, v28
    s_nop 1
    v_permlane32_swap_b32 v29, v28
    s_nop 1
    v_max_f32 v28, v28, v29
    v_ceil_f32 v28, v28
    v_max_f32 v28, 0, v28
    v_cvt_i32_f32 v29, v28
    v_sub_u32 v29, 0, v29
    v_ldexp_f32 v29, 1.0, v29
    v_accvgpr_read_b32 v30, a0
    v_mul_f32 v30, v30, v29
    v_accvgpr_write_b32 a0, v30
    v_accvgpr_read_b32 v30, a1
    v_mul_f32 v30, v30, v29
    v_accvgpr_write_b32 a1, v30
    v_accvgpr_read_b32 v30, a2
    v_mul_f32 v30, v30, v29
    v_accvgpr_write_b32 a2, v30
    v_accvgpr_read_b32 v30, a3
    v_mul_f32 v30, v30, v29
    v_accvgpr_write_b32 a3, v30
    v_accvgpr_read_b32 v30, a4
    v_mul_f32 v30, v30, v29
    v_accvgpr_write_b32 a4, v30
    v_accvgpr_read_b32 v30, a5
    v_mul_f32 v30, v30, v29
    v_accvgpr_write_b32 a5, v30
    v_accvgpr_read_b32 v30, a6
    v_mul_f32 v30, v30, v29
    v_accvgpr_write_b32 a6, v30
    v_accvgpr_read_b32 v30, a7
    v_mul_f32 v30, v30, v29
    v_accvgpr_write_b32 a7, v30
    v_accvgpr_read_b32 v30, a8
    v_mul_f32 v30, v30, v29
    v_accvgpr_write_b32 a8, v30
    v_accvgpr_read_b32 v30, a9
    v_mul_f32 v30, v30, v29
    v_accvgpr_write_b32 a9, v30
    v_accvgpr_read_b32 v30, a10
    v_mul_f32 v30, v30, v29
    v_accvgpr_write_b32 a10, v30
    v_accvgpr_read_b32 v30, a11
    v_mul_f32 v30, v30, v29
    v_accvgpr_write_b32 a11, v30
    v_accvgpr_read_b32 v30, a12
    v_mul_f32 v30, v30, v29
    v_accvgpr_write_b32 a12, v30
    v_accvgpr_read_b32 v30, a13
    v_mul_f32 v30, v30, v29
    v_accvgpr_write_b32 a13, v30
    v_accvgpr_read_b32 v30, a14
    v_mul_f32 v30, v30, v29
    v_accvgpr_write_b32 a14, v30
    v_accvgpr_read_b32 v30, a15
    v_mul_f32 v30, v30, v29
    v_accvgpr_write_b32 a15, v30
    v_accvgpr_read_b32 v30, a16
    v_mul_f32 v30, v30, v29
    v_accvgpr_write_b32 a16, v30
    v_accvgpr_read_b32 v30, a17
    v_mul_f32 v30, v30, v29
    v_accvgpr_write_b32 a17, v30
    v_accvgpr_read_b32 v30, a18
    v_mul_f32 v30, v30, v29
    v_accvgpr_write_b32 a18, v30
    v_accvgpr_read_b32 v30, a19
    v_mul_f32 v30, v30, v29
    v_accvgpr_write_b32 a19, v30
    v_accvgpr_read_b32 v30, a20
    v_mul_f32 v30, v30, v29
    v_accvgpr_write_b32 a20, v30
    v_accvgpr_read_b32 v30, a21
    v_mul_f32 v30, v30, v29
    v_accvgpr_write_b32 a21, v30
    v_accvgpr_read_b32 v30, a22
    v_mul_f32 v30, v30, v29
    v_accvgpr_write_b32 a22, v30
    v_accvgpr_read_b32 v30, a23
    v_mul_f32 v30, v30, v29
    v_accvgpr_write_b32 a23, v30
    v_accvgpr_read_b32 v30, a24
    v_mul_f32 v30, v30, v29
    v_accvgpr_write_b32 a24, v30
    v_accvgpr_read_b32 v30, a25
    v_mul_f32 v30, v30, v29
    v_accvgpr_write_b32 a25, v30
    v_accvgpr_read_b32 v30, a26
    v_mul_f32 v30, v30, v29
    v_accvgpr_write_b32 a26, v30
    v_accvgpr_read_b32 v30, a27
    v_mul_f32 v30, v30, v29
    v_accvgpr_write_b32 a27, v30
    v_accvgpr_read_b32 v30, a28
    v_mul_f32 v30, v30, v29
    v_accvgpr_write_b32 a28, v30
    v_accvgpr_read_b32 v30, a29
    v_mul_f32 v30, v30, v29
    v_accvgpr_write_b32 a29, v30
    v_accvgpr_read_b32 v30, a30
    v_mul_f32 v30, v30, v29
    v_accvgpr_write_b32 a30, v30
    v_accvgpr_read_b32 v30, a31
    v_mul_f32 v30, v30, v29
    v_accvgpr_write_b32 a31, v30
    v_accvgpr_read_b32 v30, a32
    v_mul_f32 v30, v30, v29
    v_accvgpr_write_b32 a32, v30
    v_accvgpr_read_b32 v30, a33
    v_mul_f32 v30, v30, v29
    v_accvgpr_write_b32 a33, v30
    v_accvgpr_read_b32 v30, a34
    v_mul_f32 v30, v30, v29
    v_accvgpr_write_b32 a34, v30
    v_accvgpr_read_b32 v30, a35
    v_mul_f32 v30, v30, v29
    v_accvgpr_write_b32 a35, v30
    v_accvgpr_read_b32 v30, a36
    v_mul_f32 v30, v30, v29
    v_accvgpr_write_b32 a36, v30
    v_accvgpr_read_b32 v30, a37
    v_mul_f32 v30, v30, v29
    v_accvgpr_write_b32 a37, v30
    v_accvgpr_read_b32 v30, a38
    v_mul_f32 v30, v30, v29
    v_accvgpr_write_b32 a38, v30
    v_accvgpr_read_b32 v30, a39
    v_mul_f32 v30, v30, v29
    v_accvgpr_write_b32 a39, v30
    v_accvgpr_read_b32 v30, a40
    v_mul_f32 v30, v30, v29
    v_accvgpr_write_b32 a40, v30
    v_accvgpr_read_b32 v30, a41
    v_mul_f32 v30, v30, v29
    v_accvgpr_write_b32 a41, v30
    v_accvgpr_read_b32 v30, a42
    v_mul_f32 v30, v30, v29
    v_accvgpr_write_b32 a42, v30
    v_accvgpr_read_b32 v30, a43
    v_mul_f32 v30, v30, v29
    v_accvgpr_write_b32 a43, v30
    v_accvgpr_read_b32 v30, a44
    v_mul_f32 v30, v30, v29
    v_accvgpr_write_b32 a44, v30
    v_accvgpr_read_b32 v30, a45
    v_mul_f32 v30, v30, v29
    v_accvgpr_write_b32 a45, v30
    v_accvgpr_read_b32 v30, a46
    v_mul_f32 v30, v30, v29
    v_accvgpr_write_b32 a46, v30
    v_accvgpr_read_b32 v30, a47
    v_mul_f32 v30, v30, v29
    v_accvgpr_write_b32 a47, v30
    v_accvgpr_read_b32 v30, a48
    v_mul_f32 v30, v30, v29
    v_accvgpr_write_b32 a48, v30
    v_accvgpr_read_b32 v30, a49
    v_mul_f32 v30, v30, v29
    v_accvgpr_write_b32 a49, v30
    v_accvgpr_read_b32 v30, a50
    v_mul_f32 v30, v30, v29
    v_accvgpr_write_b32 a50, v30
    v_accvgpr_read_b32 v30, a51
    v_mul_f32 v30, v30, v29
    v_accvgpr_write_b32 a51, v30
    v_accvgpr_read_b32 v30, a52
    v_mul_f32 v30, v30, v29
    v_accvgpr_write_b32 a52, v30
    v_accvgpr_read_b32 v30, a53
    v_mul_f32 v30, v30, v29
    v_accvgpr_write_b32 a53, v30
    v_accvgpr_read_b32 v30, a54
    v_mul_f32 v30, v30, v29
    v_accvgpr_write_b32 a54, v30
    v_accvgpr_read_b32 v30, a55
    v_mul_f32 v30, v30, v29
    v_accvgpr_write_b32 a55, v30
    v_accvgpr_read_b32 v30, a56
    v_mul_f32 v30, v30, v29
    v_accvgpr_write_b32 a56, v30
    v_accvgpr_read_b32 v30, a57
    v_mul_f32 v30, v30, v29
    v_accvgpr_write_b32 a57, v30
    v_accvgpr_read_b32 v30, a58
    v_mul_f32 v30, v30, v29
    v_accvgpr_write_b32 a58, v30
    v_accvgpr_read_b32 v30, a59
    v_mul_f32 v30, v30, v29
    v_accvgpr_write_b32 a59, v30
    v_accvgpr_read_b32 v30, a60
    v_mul_f32 v30, v30, v29
    v_accvgpr_write_b32 a60, v30
    v_accvgpr_read_b32 v30, a61
    v_mul_f32 v30, v30, v29
    v_accvgpr_write_b32 a61, v30
    v_accvgpr_read_b32 v30, a62
    v_mul_f32 v30, v30, v29
    v_accvgpr_write_b32 a62, v30
    v_accvgpr_read_b32 v30, a63
    v_mul_f32 v30, v30, v29
    v_accvgpr_write_b32 a63, v30
    v_mul_f32 v25, v25, v29
    v_sub_f32 v96, v96, v28
    v_sub_f32 v32, v32, v28
    v_sub_f32 v64, v64, v28
    v_sub_f32 v97, v97, v28
    v_sub_f32 v33, v33, v28
    v_sub_f32 v65, v65, v28
    v_sub_f32 v98, v98, v28
    v_sub_f32 v34, v34, v28
    v_sub_f32 v66, v66, v28
    v_sub_f32 v99, v99, v28
    v_sub_f32 v35, v35, v28
    v_sub_f32 v67, v67, v28
    v_sub_f32 v100, v100, v28
    v_sub_f32 v36, v36, v28
    v_sub_f32 v68, v68, v28
    v_sub_f32 v101, v101, v28
    v_sub_f32 v37, v37, v28
    v_sub_f32 v69, v69, v28
    v_sub_f32 v102, v102, v28
    v_sub_f32 v38, v38, v28
    v_sub_f32 v70, v70, v28
    v_sub_f32 v103, v103, v28
    v_sub_f32 v39, v39, v28
    v_sub_f32 v71, v71, v28
    v_sub_f32 v104, v104, v28
    v_sub_f32 v40, v40, v28
    v_sub_f32 v72, v72, v28
    v_sub_f32 v105, v105, v28
    v_sub_f32 v41, v41, v28
    v_sub_f32 v73, v73, v28
    v_sub_f32 v106, v106, v28
    v_sub_f32 v42, v42, v28
    v_sub_f32 v74, v74, v28
    v_sub_f32 v107, v107, v28
    v_sub_f32 v43, v43, v28
    v_sub_f32 v75, v75, v28
    v_sub_f32 v108, v108, v28
    v_sub_f32 v44, v44, v28
    v_sub_f32 v76, v76, v28
    v_sub_f32 v109, v109, v28
    v_sub_f32 v45, v45, v28
    v_sub_f32 v77, v77, v28
    v_sub_f32 v110, v110, v28
    v_sub_f32 v46, v46, v28
    v_sub_f32 v78, v78, v28
    v_sub_f32 v111, v111, v28
    v_sub_f32 v47, v47, v28
    v_sub_f32 v79, v79, v28
    v_exp_f32 v28, v32
    v_exp_f32 v29, v33
    v_exp_f32 v30, v34
    v_add_f32 v27, v28, v29
    v_exp_f32 v31, v35
    v_cvt_pk_bf16_f32 v128, v28, v29
    v_exp_f32 v28, v36
    v_add_f32 v27, v27, v30
    v_add_f32 v27, v27, v31
    v_exp_f32 v29, v37
    v_cvt_pk_bf16_f32 v129, v30, v31
    v_exp_f32 v30, v38
    v_add_f32 v27, v27, v28
    v_add_f32 v27, v27, v29
    v_exp_f32 v31, v39
    v_cvt_pk_bf16_f32 v130, v28, v29
    v_exp_f32 v28, v40
    v_add_f32 v27, v27, v30
    v_add_f32 v27, v27, v31
    v_exp_f32 v29, v41
    v_cvt_pk_bf16_f32 v131, v30, v31
    v_exp_f32 v30, v42
    v_add_f32 v27, v27, v28
    v_add_f32 v27, v27, v29
    v_exp_f32 v31, v43
    v_cvt_pk_bf16_f32 v132, v28, v29
    v_exp_f32 v28, v44
    v_add_f32 v27, v27, v30
    v_add_f32 v27, v27, v31
    v_exp_f32 v29, v45
    v_cvt_pk_bf16_f32 v133, v30, v31
    v_exp_f32 v30, v46
    v_add_f32 v27, v27, v28
    v_add_f32 v27, v27, v29
    v_exp_f32 v31, v47
    v_cvt_pk_bf16_f32 v134, v28, v29
    v_add_f32 v27, v27, v30
    v_add_f32 v27, v27, v31
    v_cvt_pk_bf16_f32 v135, v30, v31
    s_nop 1
    s_branch attn_kernel_ret_2_0
attn_kernel_slow_2_1:
    s_nop 15
    s_nop 15
    v_max3_f32 v28, v48, v49, v50
    v_max3_f32 v28, v28, v51, v52
    v_max3_f32 v28, v28, v53, v54
    v_max3_f32 v28, v28, v55, v56
    v_max3_f32 v28, v28, v57, v58
    v_max3_f32 v28, v28, v59, v60
    v_max3_f32 v28, v28, v61, v62
    v_max_f32 v28, v28, v63
    v_mov_b32 v29, v28
    s_nop 1
    v_permlane32_swap_b32 v29, v28
    s_nop 1
    v_max_f32 v28, v28, v29
    v_ceil_f32 v28, v28
    v_max_f32 v28, 0, v28
    v_cvt_i32_f32 v29, v28
    v_sub_u32 v29, 0, v29
    v_ldexp_f32 v29, 1.0, v29
    v_accvgpr_read_b32 v30, a64
    v_mul_f32 v30, v30, v29
    v_accvgpr_write_b32 a64, v30
    v_accvgpr_read_b32 v30, a65
    v_mul_f32 v30, v30, v29
    v_accvgpr_write_b32 a65, v30
    v_accvgpr_read_b32 v30, a66
    v_mul_f32 v30, v30, v29
    v_accvgpr_write_b32 a66, v30
    v_accvgpr_read_b32 v30, a67
    v_mul_f32 v30, v30, v29
    v_accvgpr_write_b32 a67, v30
    v_accvgpr_read_b32 v30, a68
    v_mul_f32 v30, v30, v29
    v_accvgpr_write_b32 a68, v30
    v_accvgpr_read_b32 v30, a69
    v_mul_f32 v30, v30, v29
    v_accvgpr_write_b32 a69, v30
    v_accvgpr_read_b32 v30, a70
    v_mul_f32 v30, v30, v29
    v_accvgpr_write_b32 a70, v30
    v_accvgpr_read_b32 v30, a71
    v_mul_f32 v30, v30, v29
    v_accvgpr_write_b32 a71, v30
    v_accvgpr_read_b32 v30, a72
    v_mul_f32 v30, v30, v29
    v_accvgpr_write_b32 a72, v30
    v_accvgpr_read_b32 v30, a73
    v_mul_f32 v30, v30, v29
    v_accvgpr_write_b32 a73, v30
    v_accvgpr_read_b32 v30, a74
    v_mul_f32 v30, v30, v29
    v_accvgpr_write_b32 a74, v30
    v_accvgpr_read_b32 v30, a75
    v_mul_f32 v30, v30, v29
    v_accvgpr_write_b32 a75, v30
    v_accvgpr_read_b32 v30, a76
    v_mul_f32 v30, v30, v29
    v_accvgpr_write_b32 a76, v30
    v_accvgpr_read_b32 v30, a77
    v_mul_f32 v30, v30, v29
    v_accvgpr_write_b32 a77, v30
    v_accvgpr_read_b32 v30, a78
    v_mul_f32 v30, v30, v29
    v_accvgpr_write_b32 a78, v30
    v_accvgpr_read_b32 v30, a79
    v_mul_f32 v30, v30, v29
    v_accvgpr_write_b32 a79, v30
    v_accvgpr_read_b32 v30, a80
    v_mul_f32 v30, v30, v29
    v_accvgpr_write_b32 a80, v30
    v_accvgpr_read_b32 v30, a81
    v_mul_f32 v30, v30, v29
    v_accvgpr_write_b32 a81, v30
    v_accvgpr_read_b32 v30, a82
    v_mul_f32 v30, v30, v29
    v_accvgpr_write_b32 a82, v30
    v_accvgpr_read_b32 v30, a83
    v_mul_f32 v30, v30, v29
    v_accvgpr_write_b32 a83, v30
    v_accvgpr_read_b32 v30, a84
    v_mul_f32 v30, v30, v29
    v_accvgpr_write_b32 a84, v30
    v_accvgpr_read_b32 v30, a85
    v_mul_f32 v30, v30, v29
    v_accvgpr_write_b32 a85, v30
    v_accvgpr_read_b32 v30, a86
    v_mul_f32 v30, v30, v29
    v_accvgpr_write_b32 a86, v30
    v_accvgpr_read_b32 v30, a87
    v_mul_f32 v30, v30, v29
    v_accvgpr_write_b32 a87, v30
    v_accvgpr_read_b32 v30, a88
    v_mul_f32 v30, v30, v29
    v_accvgpr_write_b32 a88, v30
    v_accvgpr_read_b32 v30, a89
    v_mul_f32 v30, v30, v29
    v_accvgpr_write_b32 a89, v30
    v_accvgpr_read_b32 v30, a90
    v_mul_f32 v30, v30, v29
    v_accvgpr_write_b32 a90, v30
    v_accvgpr_read_b32 v30, a91
    v_mul_f32 v30, v30, v29
    v_accvgpr_write_b32 a91, v30
    v_accvgpr_read_b32 v30, a92
    v_mul_f32 v30, v30, v29
    v_accvgpr_write_b32 a92, v30
    v_accvgpr_read_b32 v30, a93
    v_mul_f32 v30, v30, v29
    v_accvgpr_write_b32 a93, v30
    v_accvgpr_read_b32 v30, a94
    v_mul_f32 v30, v30, v29
    v_accvgpr_write_b32 a94, v30
    v_accvgpr_read_b32 v30, a95
    v_mul_f32 v30, v30, v29
    v_accvgpr_write_b32 a95, v30
    v_accvgpr_read_b32 v30, a96
    v_mul_f32 v30, v30, v29
    v_accvgpr_write_b32 a96, v30
    v_accvgpr_read_b32 v30, a97
    v_mul_f32 v30, v30, v29
    v_accvgpr_write_b32 a97, v30
    v_accvgpr_read_b32 v30, a98
    v_mul_f32 v30, v30, v29
    v_accvgpr_write_b32 a98, v30
    v_accvgpr_read_b32 v30, a99
    v_mul_f32 v30, v30, v29
    v_accvgpr_write_b32 a99, v30
    v_accvgpr_read_b32 v30, a100
    v_mul_f32 v30, v30, v29
    v_accvgpr_write_b32 a100, v30
    v_accvgpr_read_b32 v30, a101
    v_mul_f32 v30, v30, v29
    v_accvgpr_write_b32 a101, v30
    v_accvgpr_read_b32 v30, a102
    v_mul_f32 v30, v30, v29
    v_accvgpr_write_b32 a102, v30
    v_accvgpr_read_b32 v30, a103
    v_mul_f32 v30, v30, v29
    v_accvgpr_write_b32 a103, v30
    v_accvgpr_read_b32 v30, a104
    v_mul_f32 v30, v30, v29
    v_accvgpr_write_b32 a104, v30
    v_accvgpr_read_b32 v30, a105
    v_mul_f32 v30, v30, v29
    v_accvgpr_write_b32 a105, v30
    v_accvgpr_read_b32 v30, a106
    v_mul_f32 v30, v30, v29
    v_accvgpr_write_b32 a106, v30
    v_accvgpr_read_b32 v30, a107
    v_mul_f32 v30, v30, v29
    v_accvgpr_write_b32 a107, v30
    v_accvgpr_read_b32 v30, a108
    v_mul_f32 v30, v30, v29
    v_accvgpr_write_b32 a108, v30
    v_accvgpr_read_b32 v30, a109
    v_mul_f32 v30, v30, v29
    v_accvgpr_write_b32 a109, v30
    v_accvgpr_read_b32 v30, a110
    v_mul_f32 v30, v30, v29
    v_accvgpr_write_b32 a110, v30
    v_accvgpr_read_b32 v30, a111
    v_mul_f32 v30, v30, v29
    v_accvgpr_write_b32 a111, v30
    v_accvgpr_read_b32 v30, a112
    v_mul_f32 v30, v30, v29
    v_accvgpr_write_b32 a112, v30
    v_accvgpr_read_b32 v30, a113
    v_mul_f32 v30, v30, v29
    v_accvgpr_write_b32 a113, v30
    v_accvgpr_read_b32 v30, a114
    v_mul_f32 v30, v30, v29
    v_accvgpr_write_b32 a114, v30
    v_accvgpr_read_b32 v30, a115
    v_mul_f32 v30, v30, v29
    v_accvgpr_write_b32 a115, v30
    v_accvgpr_read_b32 v30, a116
    v_mul_f32 v30, v30, v29
    v_accvgpr_write_b32 a116, v30
    v_accvgpr_read_b32 v30, a117
    v_mul_f32 v30, v30, v29
    v_accvgpr_write_b32 a117, v30
    v_accvgpr_read_b32 v30, a118
    v_mul_f32 v30, v30, v29
    v_accvgpr_write_b32 a118, v30
    v_accvgpr_read_b32 v30, a119
    v_mul_f32 v30, v30, v29
    v_accvgpr_write_b32 a119, v30
    v_accvgpr_read_b32 v30, a120
    v_mul_f32 v30, v30, v29
    v_accvgpr_write_b32 a120, v30
    v_accvgpr_read_b32 v30, a121
    v_mul_f32 v30, v30, v29
    v_accvgpr_write_b32 a121, v30
    v_accvgpr_read_b32 v30, a122
    v_mul_f32 v30, v30, v29
    v_accvgpr_write_b32 a122, v30
    v_accvgpr_read_b32 v30, a123
    v_mul_f32 v30, v30, v29
    v_accvgpr_write_b32 a123, v30
    v_accvgpr_read_b32 v30, a124
    v_mul_f32 v30, v30, v29
    v_accvgpr_write_b32 a124, v30
    v_accvgpr_read_b32 v30, a125
    v_mul_f32 v30, v30, v29
    v_accvgpr_write_b32 a125, v30
    v_accvgpr_read_b32 v30, a126
    v_mul_f32 v30, v30, v29
    v_accvgpr_write_b32 a126, v30
    v_accvgpr_read_b32 v30, a127
    v_mul_f32 v30, v30, v29
    v_accvgpr_write_b32 a127, v30
    v_mul_f32 v26, v26, v29
    v_sub_f32 v112, v112, v28
    v_sub_f32 v48, v48, v28
    v_sub_f32 v80, v80, v28
    v_sub_f32 v113, v113, v28
    v_sub_f32 v49, v49, v28
    v_sub_f32 v81, v81, v28
    v_sub_f32 v114, v114, v28
    v_sub_f32 v50, v50, v28
    v_sub_f32 v82, v82, v28
    v_sub_f32 v115, v115, v28
    v_sub_f32 v51, v51, v28
    v_sub_f32 v83, v83, v28
    v_sub_f32 v116, v116, v28
    v_sub_f32 v52, v52, v28
    v_sub_f32 v84, v84, v28
    v_sub_f32 v117, v117, v28
    v_sub_f32 v53, v53, v28
    v_sub_f32 v85, v85, v28
    v_sub_f32 v118, v118, v28
    v_sub_f32 v54, v54, v28
    v_sub_f32 v86, v86, v28
    v_sub_f32 v119, v119, v28
    v_sub_f32 v55, v55, v28
    v_sub_f32 v87, v87, v28
    v_sub_f32 v120, v120, v28
    v_sub_f32 v56, v56, v28
    v_sub_f32 v88, v88, v28
    v_sub_f32 v121, v121, v28
    v_sub_f32 v57, v57, v28
    v_sub_f32 v89, v89, v28
    v_sub_f32 v122, v122, v28
    v_sub_f32 v58, v58, v28
    v_sub_f32 v90, v90, v28
    v_sub_f32 v123, v123, v28
    v_sub_f32 v59, v59, v28
    v_sub_f32 v91, v91, v28
    v_sub_f32 v124, v124, v28
    v_sub_f32 v60, v60, v28
    v_sub_f32 v92, v92, v28
    v_sub_f32 v125, v125, v28
    v_sub_f32 v61, v61, v28
    v_sub_f32 v93, v93, v28
    v_sub_f32 v126, v126, v28
    v_sub_f32 v62, v62, v28
    v_sub_f32 v94, v94, v28
    v_sub_f32 v127, v127, v28
    v_sub_f32 v63, v63, v28
    v_sub_f32 v95, v95, v28
    v_exp_f32 v28, v48
    v_exp_f32 v29, v49
    v_exp_f32 v30, v50
    v_add_f32 v27, v28, v29
    v_exp_f32 v31, v51
    v_cvt_pk_bf16_f32 v136, v28, v29
    v_exp_f32 v28, v52
    v_add_f32 v27, v27, v30
    v_add_f32 v27, v27, v31
    v_exp_f32 v29, v53
    v_cvt_pk_bf16_f32 v137, v30, v31
    v_exp_f32 v30, v54
    v_add_f32 v27, v27, v28
    v_add_f32 v27, v27, v29
    v_exp_f32 v31, v55
    v_cvt_pk_bf16_f32 v138, v28, v29
    v_exp_f32 v28, v56
    v_add_f32 v27, v27, v30
    v_add_f32 v27, v27, v31
    v_exp_f32 v29, v57
    v_cvt_pk_bf16_f32 v139, v30, v31
    v_exp_f32 v30, v58
    v_add_f32 v27, v27, v28
    v_add_f32 v27, v27, v29
    v_exp_f32 v31, v59
    v_cvt_pk_bf16_f32 v140, v28, v29
    v_exp_f32 v28, v60
    v_add_f32 v27, v27, v30
    v_add_f32 v27, v27, v31
    v_exp_f32 v29, v61
    v_cvt_pk_bf16_f32 v141, v30, v31
    v_exp_f32 v30, v62
    v_add_f32 v27, v27, v28
    v_add_f32 v27, v27, v29
    v_exp_f32 v31, v63
    v_cvt_pk_bf16_f32 v142, v28, v29
    v_add_f32 v27, v27, v30
    v_add_f32 v27, v27, v31
    v_cvt_pk_bf16_f32 v143, v30, v31
    s_nop 1
    s_branch attn_kernel_ret_2_1
attn_kernel_slow_3_0:
    s_nop 15
    s_nop 15
    v_max3_f32 v28, v64, v65, v66
    v_max3_f32 v28, v28, v67, v68
    v_max3_f32 v28, v28, v69, v70
    v_max3_f32 v28, v28, v71, v72
    v_max3_f32 v28, v28, v73, v74
    v_max3_f32 v28, v28, v75, v76
    v_max3_f32 v28, v28, v77, v78
    v_max_f32 v28, v28, v79
    v_mov_b32 v29, v28
    s_nop 1
    v_permlane32_swap_b32 v29, v28
    s_nop 1
    v_max_f32 v28, v28, v29
    v_ceil_f32 v28, v28
    v_max_f32 v28, 0, v28
    v_cvt_i32_f32 v29, v28
    v_sub_u32 v29, 0, v29
    v_ldexp_f32 v29, 1.0, v29
    v_accvgpr_read_b32 v30, a0
    v_mul_f32 v30, v30, v29
    v_accvgpr_write_b32 a0, v30
    v_accvgpr_read_b32 v30, a1
    v_mul_f32 v30, v30, v29
    v_accvgpr_write_b32 a1, v30
    v_accvgpr_read_b32 v30, a2
    v_mul_f32 v30, v30, v29
    v_accvgpr_write_b32 a2, v30
    v_accvgpr_read_b32 v30, a3
    v_mul_f32 v30, v30, v29
    v_accvgpr_write_b32 a3, v30
    v_accvgpr_read_b32 v30, a4
    v_mul_f32 v30, v30, v29
    v_accvgpr_write_b32 a4, v30
    v_accvgpr_read_b32 v30, a5
    v_mul_f32 v30, v30, v29
    v_accvgpr_write_b32 a5, v30
    v_accvgpr_read_b32 v30, a6
    v_mul_f32 v30, v30, v29
    v_accvgpr_write_b32 a6, v30
    v_accvgpr_read_b32 v30, a7
    v_mul_f32 v30, v30, v29
    v_accvgpr_write_b32 a7, v30
    v_accvgpr_read_b32 v30, a8
    v_mul_f32 v30, v30, v29
    v_accvgpr_write_b32 a8, v30
    v_accvgpr_read_b32 v30, a9
    v_mul_f32 v30, v30, v29
    v_accvgpr_write_b32 a9, v30
    v_accvgpr_read_b32 v30, a10
    v_mul_f32 v30, v30, v29
    v_accvgpr_write_b32 a10, v30
    v_accvgpr_read_b32 v30, a11
    v_mul_f32 v30, v30, v29
    v_accvgpr_write_b32 a11, v30
    v_accvgpr_read_b32 v30, a12
    v_mul_f32 v30, v30, v29
    v_accvgpr_write_b32 a12, v30
    v_accvgpr_read_b32 v30, a13
    v_mul_f32 v30, v30, v29
    v_accvgpr_write_b32 a13, v30
    v_accvgpr_read_b32 v30, a14
    v_mul_f32 v30, v30, v29
    v_accvgpr_write_b32 a14, v30
    v_accvgpr_read_b32 v30, a15
    v_mul_f32 v30, v30, v29
    v_accvgpr_write_b32 a15, v30
    v_accvgpr_read_b32 v30, a16
    v_mul_f32 v30, v30, v29
    v_accvgpr_write_b32 a16, v30
    v_accvgpr_read_b32 v30, a17
    v_mul_f32 v30, v30, v29
    v_accvgpr_write_b32 a17, v30
    v_accvgpr_read_b32 v30, a18
    v_mul_f32 v30, v30, v29
    v_accvgpr_write_b32 a18, v30
    v_accvgpr_read_b32 v30, a19
    v_mul_f32 v30, v30, v29
    v_accvgpr_write_b32 a19, v30
    v_accvgpr_read_b32 v30, a20
    v_mul_f32 v30, v30, v29
    v_accvgpr_write_b32 a20, v30
    v_accvgpr_read_b32 v30, a21
    v_mul_f32 v30, v30, v29
    v_accvgpr_write_b32 a21, v30
    v_accvgpr_read_b32 v30, a22
    v_mul_f32 v30, v30, v29
    v_accvgpr_write_b32 a22, v30
    v_accvgpr_read_b32 v30, a23
    v_mul_f32 v30, v30, v29
    v_accvgpr_write_b32 a23, v30
    v_accvgpr_read_b32 v30, a24
    v_mul_f32 v30, v30, v29
    v_accvgpr_write_b32 a24, v30
    v_accvgpr_read_b32 v30, a25
    v_mul_f32 v30, v30, v29
    v_accvgpr_write_b32 a25, v30
    v_accvgpr_read_b32 v30, a26
    v_mul_f32 v30, v30, v29
    v_accvgpr_write_b32 a26, v30
    v_accvgpr_read_b32 v30, a27
    v_mul_f32 v30, v30, v29
    v_accvgpr_write_b32 a27, v30
    v_accvgpr_read_b32 v30, a28
    v_mul_f32 v30, v30, v29
    v_accvgpr_write_b32 a28, v30
    v_accvgpr_read_b32 v30, a29
    v_mul_f32 v30, v30, v29
    v_accvgpr_write_b32 a29, v30
    v_accvgpr_read_b32 v30, a30
    v_mul_f32 v30, v30, v29
    v_accvgpr_write_b32 a30, v30
    v_accvgpr_read_b32 v30, a31
    v_mul_f32 v30, v30, v29
    v_accvgpr_write_b32 a31, v30
    v_accvgpr_read_b32 v30, a32
    v_mul_f32 v30, v30, v29
    v_accvgpr_write_b32 a32, v30
    v_accvgpr_read_b32 v30, a33
    v_mul_f32 v30, v30, v29
    v_accvgpr_write_b32 a33, v30
    v_accvgpr_read_b32 v30, a34
    v_mul_f32 v30, v30, v29
    v_accvgpr_write_b32 a34, v30
    v_accvgpr_read_b32 v30, a35
    v_mul_f32 v30, v30, v29
    v_accvgpr_write_b32 a35, v30
    v_accvgpr_read_b32 v30, a36
    v_mul_f32 v30, v30, v29
    v_accvgpr_write_b32 a36, v30
    v_accvgpr_read_b32 v30, a37
    v_mul_f32 v30, v30, v29
    v_accvgpr_write_b32 a37, v30
    v_accvgpr_read_b32 v30, a38
    v_mul_f32 v30, v30, v29
    v_accvgpr_write_b32 a38, v30
    v_accvgpr_read_b32 v30, a39
    v_mul_f32 v30, v30, v29
    v_accvgpr_write_b32 a39, v30
    v_accvgpr_read_b32 v30, a40
    v_mul_f32 v30, v30, v29
    v_accvgpr_write_b32 a40, v30
    v_accvgpr_read_b32 v30, a41
    v_mul_f32 v30, v30, v29
    v_accvgpr_write_b32 a41, v30
    v_accvgpr_read_b32 v30, a42
    v_mul_f32 v30, v30, v29
    v_accvgpr_write_b32 a42, v30
    v_accvgpr_read_b32 v30, a43
    v_mul_f32 v30, v30, v29
    v_accvgpr_write_b32 a43, v30
    v_accvgpr_read_b32 v30, a44
    v_mul_f32 v30, v30, v29
    v_accvgpr_write_b32 a44, v30
    v_accvgpr_read_b32 v30, a45
    v_mul_f32 v30, v30, v29
    v_accvgpr_write_b32 a45, v30
    v_accvgpr_read_b32 v30, a46
    v_mul_f32 v30, v30, v29
    v_accvgpr_write_b32 a46, v30
    v_accvgpr_read_b32 v30, a47
    v_mul_f32 v30, v30, v29
    v_accvgpr_write_b32 a47, v30
    v_accvgpr_read_b32 v30, a48
    v_mul_f32 v30, v30, v29
    v_accvgpr_write_b32 a48, v30
    v_accvgpr_read_b32 v30, a49
    v_mul_f32 v30, v30, v29
    v_accvgpr_write_b32 a49, v30
    v_accvgpr_read_b32 v30, a50
    v_mul_f32 v30, v30, v29
    v_accvgpr_write_b32 a50, v30
    v_accvgpr_read_b32 v30, a51
    v_mul_f32 v30, v30, v29
    v_accvgpr_write_b32 a51, v30
    v_accvgpr_read_b32 v30, a52
    v_mul_f32 v30, v30, v29
    v_accvgpr_write_b32 a52, v30
    v_accvgpr_read_b32 v30, a53
    v_mul_f32 v30, v30, v29
    v_accvgpr_write_b32 a53, v30
    v_accvgpr_read_b32 v30, a54
    v_mul_f32 v30, v30, v29
    v_accvgpr_write_b32 a54, v30
    v_accvgpr_read_b32 v30, a55
    v_mul_f32 v30, v30, v29
    v_accvgpr_write_b32 a55, v30
    v_accvgpr_read_b32 v30, a56
    v_mul_f32 v30, v30, v29
    v_accvgpr_write_b32 a56, v30
    v_accvgpr_read_b32 v30, a57
    v_mul_f32 v30, v30, v29
    v_accvgpr_write_b32 a57, v30
    v_accvgpr_read_b32 v30, a58
    v_mul_f32 v30, v30, v29
    v_accvgpr_write_b32 a58, v30
    v_accvgpr_read_b32 v30, a59
    v_mul_f32 v30, v30, v29
    v_accvgpr_write_b32 a59, v30
    v_accvgpr_read_b32 v30, a60
    v_mul_f32 v30, v30, v29
    v_accvgpr_write_b32 a60, v30
    v_accvgpr_read_b32 v30, a61
    v_mul_f32 v30, v30, v29
    v_accvgpr_write_b32 a61, v30
    v_accvgpr_read_b32 v30, a62
    v_mul_f32 v30, v30, v29
    v_accvgpr_write_b32 a62, v30
    v_accvgpr_read_b32 v30, a63
    v_mul_f32 v30, v30, v29
    v_accvgpr_write_b32 a63, v30
    v_mul_f32 v25, v25, v29
    v_sub_f32 v96, v96, v28
    v_sub_f32 v64, v64, v28
    v_sub_f32 v32, v32, v28
    v_sub_f32 v97, v97, v28
    v_sub_f32 v65, v65, v28
    v_sub_f32 v33, v33, v28
    v_sub_f32 v98, v98, v28
    v_sub_f32 v66, v66, v28
    v_sub_f32 v34, v34, v28
    v_sub_f32 v99, v99, v28
    v_sub_f32 v67, v67, v28
    v_sub_f32 v35, v35, v28
    v_sub_f32 v100, v100, v28
    v_sub_f32 v68, v68, v28
    v_sub_f32 v36, v36, v28
    v_sub_f32 v101, v101, v28
    v_sub_f32 v69, v69, v28
    v_sub_f32 v37, v37, v28
    v_sub_f32 v102, v102, v28
    v_sub_f32 v70, v70, v28
    v_sub_f32 v38, v38, v28
    v_sub_f32 v103, v103, v28
    v_sub_f32 v71, v71, v28
    v_sub_f32 v39, v39, v28
    v_sub_f32 v104, v104, v28
    v_sub_f32 v72, v72, v28
    v_sub_f32 v40, v40, v28
    v_sub_f32 v105, v105, v28
    v_sub_f32 v73, v73, v28
    v_sub_f32 v41, v41, v28
    v_sub_f32 v106, v106, v28
    v_sub_f32 v74, v74, v28
    v_sub_f32 v42, v42, v28
    v_sub_f32 v107, v107, v28
    v_sub_f32 v75, v75, v28
    v_sub_f32 v43, v43, v28
    v_sub_f32 v108, v108, v28
    v_sub_f32 v76, v76, v28
    v_sub_f32 v44, v44, v28
    v_sub_f32 v109, v109, v28
    v_sub_f32 v77, v77, v28
    v_sub_f32 v45, v45, v28
    v_sub_f32 v110, v110, v28
    v_sub_f32 v78, v78, v28
    v_sub_f32 v46, v46, v28
    v_sub_f32 v111, v111, v28
    v_sub_f32 v79, v79, v28
    v_sub_f32 v47, v47, v28
    v_exp_f32 v28, v64
    v_exp_f32 v29, v65
    v_exp_f32 v30, v66
    v_add_f32 v27, v28, v29
    v_exp_f32 v31, v67
    v_cvt_pk_bf16_f32 v144, v28, v29
    v_exp_f32 v28, v68
    v_add_f32 v27, v27, v30
    v_add_f32 v27, v27, v31
    v_exp_f32 v29, v69
    v_cvt_pk_bf16_f32 v145, v30, v31
    v_exp_f32 v30, v70
    v_add_f32 v27, v27, v28
    v_add_f32 v27, v27, v29
    v_exp_f32 v31, v71
    v_cvt_pk_bf16_f32 v146, v28, v29
    v_exp_f32 v28, v72
    v_add_f32 v27, v27, v30
    v_add_f32 v27, v27, v31
    v_exp_f32 v29, v73
    v_cvt_pk_bf16_f32 v147, v30, v31
    v_exp_f32 v30, v74
    v_add_f32 v27, v27, v28
    v_add_f32 v27, v27, v29
    v_exp_f32 v31, v75
    v_cvt_pk_bf16_f32 v148, v28, v29
    v_exp_f32 v28, v76
    v_add_f32 v27, v27, v30
    v_add_f32 v27, v27, v31
    v_exp_f32 v29, v77
    v_cvt_pk_bf16_f32 v149, v30, v31
    v_exp_f32 v30, v78
    v_add_f32 v27, v27, v28
    v_add_f32 v27, v27, v29
    v_exp_f32 v31, v79
    v_cvt_pk_bf16_f32 v150, v28, v29
    v_add_f32 v27, v27, v30
    v_add_f32 v27, v27, v31
    v_cvt_pk_bf16_f32 v151, v30, v31
    s_nop 1
    s_branch attn_kernel_ret_3_0
attn_kernel_slow_3_1:
    s_nop 15
    s_nop 15
    v_max3_f32 v28, v80, v81, v82
    v_max3_f32 v28, v28, v83, v84
    v_max3_f32 v28, v28, v85, v86
    v_max3_f32 v28, v28, v87, v88
    v_max3_f32 v28, v28, v89, v90
    v_max3_f32 v28, v28, v91, v92
    v_max3_f32 v28, v28, v93, v94
    v_max_f32 v28, v28, v95
    v_mov_b32 v29, v28
    s_nop 1
    v_permlane32_swap_b32 v29, v28
    s_nop 1
    v_max_f32 v28, v28, v29
    v_ceil_f32 v28, v28
    v_max_f32 v28, 0, v28
    v_cvt_i32_f32 v29, v28
    v_sub_u32 v29, 0, v29
    v_ldexp_f32 v29, 1.0, v29
    v_accvgpr_read_b32 v30, a64
    v_mul_f32 v30, v30, v29
    v_accvgpr_write_b32 a64, v30
    v_accvgpr_read_b32 v30, a65
    v_mul_f32 v30, v30, v29
    v_accvgpr_write_b32 a65, v30
    v_accvgpr_read_b32 v30, a66
    v_mul_f32 v30, v30, v29
    v_accvgpr_write_b32 a66, v30
    v_accvgpr_read_b32 v30, a67
    v_mul_f32 v30, v30, v29
    v_accvgpr_write_b32 a67, v30
    v_accvgpr_read_b32 v30, a68
    v_mul_f32 v30, v30, v29
    v_accvgpr_write_b32 a68, v30
    v_accvgpr_read_b32 v30, a69
    v_mul_f32 v30, v30, v29
    v_accvgpr_write_b32 a69, v30
    v_accvgpr_read_b32 v30, a70
    v_mul_f32 v30, v30, v29
    v_accvgpr_write_b32 a70, v30
    v_accvgpr_read_b32 v30, a71
    v_mul_f32 v30, v30, v29
    v_accvgpr_write_b32 a71, v30
    v_accvgpr_read_b32 v30, a72
    v_mul_f32 v30, v30, v29
    v_accvgpr_write_b32 a72, v30
    v_accvgpr_read_b32 v30, a73
    v_mul_f32 v30, v30, v29
    v_accvgpr_write_b32 a73, v30
    v_accvgpr_read_b32 v30, a74
    v_mul_f32 v30, v30, v29
    v_accvgpr_write_b32 a74, v30
    v_accvgpr_read_b32 v30, a75
    v_mul_f32 v30, v30, v29
    v_accvgpr_write_b32 a75, v30
    v_accvgpr_read_b32 v30, a76
    v_mul_f32 v30, v30, v29
    v_accvgpr_write_b32 a76, v30
    v_accvgpr_read_b32 v30, a77
    v_mul_f32 v30, v30, v29
    v_accvgpr_write_b32 a77, v30
    v_accvgpr_read_b32 v30, a78
    v_mul_f32 v30, v30, v29
    v_accvgpr_write_b32 a78, v30
    v_accvgpr_read_b32 v30, a79
    v_mul_f32 v30, v30, v29
    v_accvgpr_write_b32 a79, v30
    v_accvgpr_read_b32 v30, a80
    v_mul_f32 v30, v30, v29
    v_accvgpr_write_b32 a80, v30
    v_accvgpr_read_b32 v30, a81
    v_mul_f32 v30, v30, v29
    v_accvgpr_write_b32 a81, v30
    v_accvgpr_read_b32 v30, a82
    v_mul_f32 v30, v30, v29
    v_accvgpr_write_b32 a82, v30
    v_accvgpr_read_b32 v30, a83
    v_mul_f32 v30, v30, v29
    v_accvgpr_write_b32 a83, v30
    v_accvgpr_read_b32 v30, a84
    v_mul_f32 v30, v30, v29
    v_accvgpr_write_b32 a84, v30
    v_accvgpr_read_b32 v30, a85
    v_mul_f32 v30, v30, v29
    v_accvgpr_write_b32 a85, v30
    v_accvgpr_read_b32 v30, a86
    v_mul_f32 v30, v30, v29
    v_accvgpr_write_b32 a86, v30
    v_accvgpr_read_b32 v30, a87
    v_mul_f32 v30, v30, v29
    v_accvgpr_write_b32 a87, v30
    v_accvgpr_read_b32 v30, a88
    v_mul_f32 v30, v30, v29
    v_accvgpr_write_b32 a88, v30
    v_accvgpr_read_b32 v30, a89
    v_mul_f32 v30, v30, v29
    v_accvgpr_write_b32 a89, v30
    v_accvgpr_read_b32 v30, a90
    v_mul_f32 v30, v30, v29
    v_accvgpr_write_b32 a90, v30
    v_accvgpr_read_b32 v30, a91
    v_mul_f32 v30, v30, v29
    v_accvgpr_write_b32 a91, v30
    v_accvgpr_read_b32 v30, a92
    v_mul_f32 v30, v30, v29
    v_accvgpr_write_b32 a92, v30
    v_accvgpr_read_b32 v30, a93
    v_mul_f32 v30, v30, v29
    v_accvgpr_write_b32 a93, v30
    v_accvgpr_read_b32 v30, a94
    v_mul_f32 v30, v30, v29
    v_accvgpr_write_b32 a94, v30
    v_accvgpr_read_b32 v30, a95
    v_mul_f32 v30, v30, v29
    v_accvgpr_write_b32 a95, v30
    v_accvgpr_read_b32 v30, a96
    v_mul_f32 v30, v30, v29
    v_accvgpr_write_b32 a96, v30
    v_accvgpr_read_b32 v30, a97
    v_mul_f32 v30, v30, v29
    v_accvgpr_write_b32 a97, v30
    v_accvgpr_read_b32 v30, a98
    v_mul_f32 v30, v30, v29
    v_accvgpr_write_b32 a98, v30
    v_accvgpr_read_b32 v30, a99
    v_mul_f32 v30, v30, v29
    v_accvgpr_write_b32 a99, v30
    v_accvgpr_read_b32 v30, a100
    v_mul_f32 v30, v30, v29
    v_accvgpr_write_b32 a100, v30
    v_accvgpr_read_b32 v30, a101
    v_mul_f32 v30, v30, v29
    v_accvgpr_write_b32 a101, v30
    v_accvgpr_read_b32 v30, a102
    v_mul_f32 v30, v30, v29
    v_accvgpr_write_b32 a102, v30
    v_accvgpr_read_b32 v30, a103
    v_mul_f32 v30, v30, v29
    v_accvgpr_write_b32 a103, v30
    v_accvgpr_read_b32 v30, a104
    v_mul_f32 v30, v30, v29
    v_accvgpr_write_b32 a104, v30
    v_accvgpr_read_b32 v30, a105
    v_mul_f32 v30, v30, v29
    v_accvgpr_write_b32 a105, v30
    v_accvgpr_read_b32 v30, a106
    v_mul_f32 v30, v30, v29
    v_accvgpr_write_b32 a106, v30
    v_accvgpr_read_b32 v30, a107
    v_mul_f32 v30, v30, v29
    v_accvgpr_write_b32 a107, v30
    v_accvgpr_read_b32 v30, a108
    v_mul_f32 v30, v30, v29
    v_accvgpr_write_b32 a108, v30
    v_accvgpr_read_b32 v30, a109
    v_mul_f32 v30, v30, v29
    v_accvgpr_write_b32 a109, v30
    v_accvgpr_read_b32 v30, a110
    v_mul_f32 v30, v30, v29
    v_accvgpr_write_b32 a110, v30
    v_accvgpr_read_b32 v30, a111
    v_mul_f32 v30, v30, v29
    v_accvgpr_write_b32 a111, v30
    v_accvgpr_read_b32 v30, a112
    v_mul_f32 v30, v30, v29
    v_accvgpr_write_b32 a112, v30
    v_accvgpr_read_b32 v30, a113
    v_mul_f32 v30, v30, v29
    v_accvgpr_write_b32 a113, v30
    v_accvgpr_read_b32 v30, a114
    v_mul_f32 v30, v30, v29
    v_accvgpr_write_b32 a114, v30
    v_accvgpr_read_b32 v30, a115
    v_mul_f32 v30, v30, v29
    v_accvgpr_write_b32 a115, v30
    v_accvgpr_read_b32 v30, a116
    v_mul_f32 v30, v30, v29
    v_accvgpr_write_b32 a116, v30
    v_accvgpr_read_b32 v30, a117
    v_mul_f32 v30, v30, v29
    v_accvgpr_write_b32 a117, v30
    v_accvgpr_read_b32 v30, a118
    v_mul_f32 v30, v30, v29
    v_accvgpr_write_b32 a118, v30
    v_accvgpr_read_b32 v30, a119
    v_mul_f32 v30, v30, v29
    v_accvgpr_write_b32 a119, v30
    v_accvgpr_read_b32 v30, a120
    v_mul_f32 v30, v30, v29
    v_accvgpr_write_b32 a120, v30
    v_accvgpr_read_b32 v30, a121
    v_mul_f32 v30, v30, v29
    v_accvgpr_write_b32 a121, v30
    v_accvgpr_read_b32 v30, a122
    v_mul_f32 v30, v30, v29
    v_accvgpr_write_b32 a122, v30
    v_accvgpr_read_b32 v30, a123
    v_mul_f32 v30, v30, v29
    v_accvgpr_write_b32 a123, v30
    v_accvgpr_read_b32 v30, a124
    v_mul_f32 v30, v30, v29
    v_accvgpr_write_b32 a124, v30
    v_accvgpr_read_b32 v30, a125
    v_mul_f32 v30, v30, v29
    v_accvgpr_write_b32 a125, v30
    v_accvgpr_read_b32 v30, a126
    v_mul_f32 v30, v30, v29
    v_accvgpr_write_b32 a126, v30
    v_accvgpr_read_b32 v30, a127
    v_mul_f32 v30, v30, v29
    v_accvgpr_write_b32 a127, v30
    v_mul_f32 v26, v26, v29
    v_sub_f32 v112, v112, v28
    v_sub_f32 v80, v80, v28
    v_sub_f32 v48, v48, v28
    v_sub_f32 v113, v113, v28
    v_sub_f32 v81, v81, v28
    v_sub_f32 v49, v49, v28
    v_sub_f32 v114, v114, v28
    v_sub_f32 v82, v82, v28
    v_sub_f32 v50, v50, v28
    v_sub_f32 v115, v115, v28
    v_sub_f32 v83, v83, v28
    v_sub_f32 v51, v51, v28
    v_sub_f32 v116, v116, v28
    v_sub_f32 v84, v84, v28
    v_sub_f32 v52, v52, v28
    v_sub_f32 v117, v117, v28
    v_sub_f32 v85, v85, v28
    v_sub_f32 v53, v53, v28
    v_sub_f32 v118, v118, v28
    v_sub_f32 v86, v86, v28
    v_sub_f32 v54, v54, v28
    v_sub_f32 v119, v119, v28
    v_sub_f32 v87, v87, v28
    v_sub_f32 v55, v55, v28
    v_sub_f32 v120, v120, v28
    v_sub_f32 v88, v88, v28
    v_sub_f32 v56, v56, v28
    v_sub_f32 v121, v121, v28
    v_sub_f32 v89, v89, v28
    v_sub_f32 v57, v57, v28
    v_sub_f32 v122, v122, v28
    v_sub_f32 v90, v90, v28
    v_sub_f32 v58, v58, v28
    v_sub_f32 v123, v123, v28
    v_sub_f32 v91, v91, v28
    v_sub_f32 v59, v59, v28
    v_sub_f32 v124, v124, v28
    v_sub_f32 v92, v92, v28
    v_sub_f32 v60, v60, v28
    v_sub_f32 v125, v125, v28
    v_sub_f32 v93, v93, v28
    v_sub_f32 v61, v61, v28
    v_sub_f32 v126, v126, v28
    v_sub_f32 v94, v94, v28
    v_sub_f32 v62, v62, v28
    v_sub_f32 v127, v127, v28
    v_sub_f32 v95, v95, v28
    v_sub_f32 v63, v63, v28
    v_exp_f32 v28, v80
    v_exp_f32 v29, v81
    v_exp_f32 v30, v82
    v_add_f32 v27, v28, v29
    v_exp_f32 v31, v83
    v_cvt_pk_bf16_f32 v152, v28, v29
    v_exp_f32 v28, v84
    v_add_f32 v27, v27, v30
    v_add_f32 v27, v27, v31
    v_exp_f32 v29, v85
    v_cvt_pk_bf16_f32 v153, v30, v31
    v_exp_f32 v30, v86
    v_add_f32 v27, v27, v28
    v_add_f32 v27, v27, v29
    v_exp_f32 v31, v87
    v_cvt_pk_bf16_f32 v154, v28, v29
    v_exp_f32 v28, v88
    v_add_f32 v27, v27, v30
    v_add_f32 v27, v27, v31
    v_exp_f32 v29, v89
    v_cvt_pk_bf16_f32 v155, v30, v31
    v_exp_f32 v30, v90
    v_add_f32 v27, v27, v28
    v_add_f32 v27, v27, v29
    v_exp_f32 v31, v91
    v_cvt_pk_bf16_f32 v156, v28, v29
    v_exp_f32 v28, v92
    v_add_f32 v27, v27, v30
    v_add_f32 v27, v27, v31
    v_exp_f32 v29, v93
    v_cvt_pk_bf16_f32 v157, v30, v31
    v_exp_f32 v30, v94
    v_add_f32 v27, v27, v28
    v_add_f32 v27, v27, v29
    v_exp_f32 v31, v95
    v_cvt_pk_bf16_f32 v158, v28, v29
    v_add_f32 v27, v27, v30
    v_add_f32 v27, v27, v31
    v_cvt_pk_bf16_f32 v159, v30, v31
    s_nop 1
    s_branch attn_kernel_ret_3_1
attn_kernel_slow_4_0:
    s_nop 15
    s_nop 15
    v_max3_f32 v28, v32, v33, v34
    v_max3_f32 v28, v28, v35, v36
    v_max3_f32 v28, v28, v37, v38
    v_max3_f32 v28, v28, v39, v40
    v_max3_f32 v28, v28, v41, v42
    v_max3_f32 v28, v28, v43, v44
    v_max3_f32 v28, v28, v45, v46
    v_max_f32 v28, v28, v47
    v_mov_b32 v29, v28
    s_nop 1
    v_permlane32_swap_b32 v29, v28
    s_nop 1
    v_max_f32 v28, v28, v29
    v_ceil_f32 v28, v28
    v_max_f32 v28, 0, v28
    v_cvt_i32_f32 v29, v28
    v_sub_u32 v29, 0, v29
    v_ldexp_f32 v29, 1.0, v29
    v_accvgpr_read_b32 v30, a0
    v_mul_f32 v30, v30, v29
    v_accvgpr_write_b32 a0, v30
    v_accvgpr_read_b32 v30, a1
    v_mul_f32 v30, v30, v29
    v_accvgpr_write_b32 a1, v30
    v_accvgpr_read_b32 v30, a2
    v_mul_f32 v30, v30, v29
    v_accvgpr_write_b32 a2, v30
    v_accvgpr_read_b32 v30, a3
    v_mul_f32 v30, v30, v29
    v_accvgpr_write_b32 a3, v30
    v_accvgpr_read_b32 v30, a4
    v_mul_f32 v30, v30, v29
    v_accvgpr_write_b32 a4, v30
    v_accvgpr_read_b32 v30, a5
    v_mul_f32 v30, v30, v29
    v_accvgpr_write_b32 a5, v30
    v_accvgpr_read_b32 v30, a6
    v_mul_f32 v30, v30, v29
    v_accvgpr_write_b32 a6, v30
    v_accvgpr_read_b32 v30, a7
    v_mul_f32 v30, v30, v29
    v_accvgpr_write_b32 a7, v30
    v_accvgpr_read_b32 v30, a8
    v_mul_f32 v30, v30, v29
    v_accvgpr_write_b32 a8, v30
    v_accvgpr_read_b32 v30, a9
    v_mul_f32 v30, v30, v29
    v_accvgpr_write_b32 a9, v30
    v_accvgpr_read_b32 v30, a10
    v_mul_f32 v30, v30, v29
    v_accvgpr_write_b32 a10, v30
    v_accvgpr_read_b32 v30, a11
    v_mul_f32 v30, v30, v29
    v_accvgpr_write_b32 a11, v30
    v_accvgpr_read_b32 v30, a12
    v_mul_f32 v30, v30, v29
    v_accvgpr_write_b32 a12, v30
    v_accvgpr_read_b32 v30, a13
    v_mul_f32 v30, v30, v29
    v_accvgpr_write_b32 a13, v30
    v_accvgpr_read_b32 v30, a14
    v_mul_f32 v30, v30, v29
    v_accvgpr_write_b32 a14, v30
    v_accvgpr_read_b32 v30, a15
    v_mul_f32 v30, v30, v29
    v_accvgpr_write_b32 a15, v30
    v_accvgpr_read_b32 v30, a16
    v_mul_f32 v30, v30, v29
    v_accvgpr_write_b32 a16, v30
    v_accvgpr_read_b32 v30, a17
    v_mul_f32 v30, v30, v29
    v_accvgpr_write_b32 a17, v30
    v_accvgpr_read_b32 v30, a18
    v_mul_f32 v30, v30, v29
    v_accvgpr_write_b32 a18, v30
    v_accvgpr_read_b32 v30, a19
    v_mul_f32 v30, v30, v29
    v_accvgpr_write_b32 a19, v30
    v_accvgpr_read_b32 v30, a20
    v_mul_f32 v30, v30, v29
    v_accvgpr_write_b32 a20, v30
    v_accvgpr_read_b32 v30, a21
    v_mul_f32 v30, v30, v29
    v_accvgpr_write_b32 a21, v30
    v_accvgpr_read_b32 v30, a22
    v_mul_f32 v30, v30, v29
    v_accvgpr_write_b32 a22, v30
    v_accvgpr_read_b32 v30, a23
    v_mul_f32 v30, v30, v29
    v_accvgpr_write_b32 a23, v30
    v_accvgpr_read_b32 v30, a24
    v_mul_f32 v30, v30, v29
    v_accvgpr_write_b32 a24, v30
    v_accvgpr_read_b32 v30, a25
    v_mul_f32 v30, v30, v29
    v_accvgpr_write_b32 a25, v30
    v_accvgpr_read_b32 v30, a26
    v_mul_f32 v30, v30, v29
    v_accvgpr_write_b32 a26, v30
    v_accvgpr_read_b32 v30, a27
    v_mul_f32 v30, v30, v29
    v_accvgpr_write_b32 a27, v30
    v_accvgpr_read_b32 v30, a28
    v_mul_f32 v30, v30, v29
    v_accvgpr_write_b32 a28, v30
    v_accvgpr_read_b32 v30, a29
    v_mul_f32 v30, v30, v29
    v_accvgpr_write_b32 a29, v30
    v_accvgpr_read_b32 v30, a30
    v_mul_f32 v30, v30, v29
    v_accvgpr_write_b32 a30, v30
    v_accvgpr_read_b32 v30, a31
    v_mul_f32 v30, v30, v29
    v_accvgpr_write_b32 a31, v30
    v_accvgpr_read_b32 v30, a32
    v_mul_f32 v30, v30, v29
    v_accvgpr_write_b32 a32, v30
    v_accvgpr_read_b32 v30, a33
    v_mul_f32 v30, v30, v29
    v_accvgpr_write_b32 a33, v30
    v_accvgpr_read_b32 v30, a34
    v_mul_f32 v30, v30, v29
    v_accvgpr_write_b32 a34, v30
    v_accvgpr_read_b32 v30, a35
    v_mul_f32 v30, v30, v29
    v_accvgpr_write_b32 a35, v30
    v_accvgpr_read_b32 v30, a36
    v_mul_f32 v30, v30, v29
    v_accvgpr_write_b32 a36, v30
    v_accvgpr_read_b32 v30, a37
    v_mul_f32 v30, v30, v29
    v_accvgpr_write_b32 a37, v30
    v_accvgpr_read_b32 v30, a38
    v_mul_f32 v30, v30, v29
    v_accvgpr_write_b32 a38, v30
    v_accvgpr_read_b32 v30, a39
    v_mul_f32 v30, v30, v29
    v_accvgpr_write_b32 a39, v30
    v_accvgpr_read_b32 v30, a40
    v_mul_f32 v30, v30, v29
    v_accvgpr_write_b32 a40, v30
    v_accvgpr_read_b32 v30, a41
    v_mul_f32 v30, v30, v29
    v_accvgpr_write_b32 a41, v30
    v_accvgpr_read_b32 v30, a42
    v_mul_f32 v30, v30, v29
    v_accvgpr_write_b32 a42, v30
    v_accvgpr_read_b32 v30, a43
    v_mul_f32 v30, v30, v29
    v_accvgpr_write_b32 a43, v30
    v_accvgpr_read_b32 v30, a44
    v_mul_f32 v30, v30, v29
    v_accvgpr_write_b32 a44, v30
    v_accvgpr_read_b32 v30, a45
    v_mul_f32 v30, v30, v29
    v_accvgpr_write_b32 a45, v30
    v_accvgpr_read_b32 v30, a46
    v_mul_f32 v30, v30, v29
    v_accvgpr_write_b32 a46, v30
    v_accvgpr_read_b32 v30, a47
    v_mul_f32 v30, v30, v29
    v_accvgpr_write_b32 a47, v30
    v_accvgpr_read_b32 v30, a48
    v_mul_f32 v30, v30, v29
    v_accvgpr_write_b32 a48, v30
    v_accvgpr_read_b32 v30, a49
    v_mul_f32 v30, v30, v29
    v_accvgpr_write_b32 a49, v30
    v_accvgpr_read_b32 v30, a50
    v_mul_f32 v30, v30, v29
    v_accvgpr_write_b32 a50, v30
    v_accvgpr_read_b32 v30, a51
    v_mul_f32 v30, v30, v29
    v_accvgpr_write_b32 a51, v30
    v_accvgpr_read_b32 v30, a52
    v_mul_f32 v30, v30, v29
    v_accvgpr_write_b32 a52, v30
    v_accvgpr_read_b32 v30, a53
    v_mul_f32 v30, v30, v29
    v_accvgpr_write_b32 a53, v30
    v_accvgpr_read_b32 v30, a54
    v_mul_f32 v30, v30, v29
    v_accvgpr_write_b32 a54, v30
    v_accvgpr_read_b32 v30, a55
    v_mul_f32 v30, v30, v29
    v_accvgpr_write_b32 a55, v30
    v_accvgpr_read_b32 v30, a56
    v_mul_f32 v30, v30, v29
    v_accvgpr_write_b32 a56, v30
    v_accvgpr_read_b32 v30, a57
    v_mul_f32 v30, v30, v29
    v_accvgpr_write_b32 a57, v30
    v_accvgpr_read_b32 v30, a58
    v_mul_f32 v30, v30, v29
    v_accvgpr_write_b32 a58, v30
    v_accvgpr_read_b32 v30, a59
    v_mul_f32 v30, v30, v29
    v_accvgpr_write_b32 a59, v30
    v_accvgpr_read_b32 v30, a60
    v_mul_f32 v30, v30, v29
    v_accvgpr_write_b32 a60, v30
    v_accvgpr_read_b32 v30, a61
    v_mul_f32 v30, v30, v29
    v_accvgpr_write_b32 a61, v30
    v_accvgpr_read_b32 v30, a62
    v_mul_f32 v30, v30, v29
    v_accvgpr_write_b32 a62, v30
    v_accvgpr_read_b32 v30, a63
    v_mul_f32 v30, v30, v29
    v_accvgpr_write_b32 a63, v30
    v_mul_f32 v25, v25, v29
    v_sub_f32 v96, v96, v28
    v_sub_f32 v32, v32, v28
    v_sub_f32 v64, v64, v28
    v_sub_f32 v97, v97, v28
    v_sub_f32 v33, v33, v28
    v_sub_f32 v65, v65, v28
    v_sub_f32 v98, v98, v28
    v_sub_f32 v34, v34, v28
    v_sub_f32 v66, v66, v28
    v_sub_f32 v99, v99, v28
    v_sub_f32 v35, v35, v28
    v_sub_f32 v67, v67, v28
    v_sub_f32 v100, v100, v28
    v_sub_f32 v36, v36, v28
    v_sub_f32 v68, v68, v28
    v_sub_f32 v101, v101, v28
    v_sub_f32 v37, v37, v28
    v_sub_f32 v69, v69, v28
    v_sub_f32 v102, v102, v28
    v_sub_f32 v38, v38, v28
    v_sub_f32 v70, v70, v28
    v_sub_f32 v103, v103, v28
    v_sub_f32 v39, v39, v28
    v_sub_f32 v71, v71, v28
    v_sub_f32 v104, v104, v28
    v_sub_f32 v40, v40, v28
    v_sub_f32 v72, v72, v28
    v_sub_f32 v105, v105, v28
    v_sub_f32 v41, v41, v28
    v_sub_f32 v73, v73, v28
    v_sub_f32 v106, v106, v28
    v_sub_f32 v42, v42, v28
    v_sub_f32 v74, v74, v28
    v_sub_f32 v107, v107, v28
    v_sub_f32 v43, v43, v28
    v_sub_f32 v75, v75, v28
    v_sub_f32 v108, v108, v28
    v_sub_f32 v44, v44, v28
    v_sub_f32 v76, v76, v28
    v_sub_f32 v109, v109, v28
    v_sub_f32 v45, v45, v28
    v_sub_f32 v77, v77, v28
    v_sub_f32 v110, v110, v28
    v_sub_f32 v46, v46, v28
    v_sub_f32 v78, v78, v28
    v_sub_f32 v111, v111, v28
    v_sub_f32 v47, v47, v28
    v_sub_f32 v79, v79, v28
    v_exp_f32 v28, v32
    v_exp_f32 v29, v33
    v_exp_f32 v30, v34
    v_add_f32 v27, v28, v29
    v_exp_f32 v31, v35
    v_cvt_pk_bf16_f32 v128, v28, v29
    v_exp_f32 v28, v36
    v_add_f32 v27, v27, v30
    v_add_f32 v27, v27, v31
    v_exp_f32 v29, v37
    v_cvt_pk_bf16_f32 v129, v30, v31
    v_exp_f32 v30, v38
    v_add_f32 v27, v27, v28
    v_add_f32 v27, v27, v29
    v_exp_f32 v31, v39
    v_cvt_pk_bf16_f32 v130, v28, v29
    v_exp_f32 v28, v40
    v_add_f32 v27, v27, v30
    v_add_f32 v27, v27, v31
    v_exp_f32 v29, v41
    v_cvt_pk_bf16_f32 v131, v30, v31
    v_exp_f32 v30, v42
    v_add_f32 v27, v27, v28
    v_add_f32 v27, v27, v29
    v_exp_f32 v31, v43
    v_cvt_pk_bf16_f32 v132, v28, v29
    v_exp_f32 v28, v44
    v_add_f32 v27, v27, v30
    v_add_f32 v27, v27, v31
    v_exp_f32 v29, v45
    v_cvt_pk_bf16_f32 v133, v30, v31
    v_exp_f32 v30, v46
    v_add_f32 v27, v27, v28
    v_add_f32 v27, v27, v29
    v_exp_f32 v31, v47
    v_cvt_pk_bf16_f32 v134, v28, v29
    v_add_f32 v27, v27, v30
    v_add_f32 v27, v27, v31
    v_cvt_pk_bf16_f32 v135, v30, v31
    s_nop 1
    s_branch attn_kernel_ret_4_0
attn_kernel_slow_4_1:
    s_nop 15
    s_nop 15
    v_max3_f32 v28, v48, v49, v50
    v_max3_f32 v28, v28, v51, v52
    v_max3_f32 v28, v28, v53, v54
    v_max3_f32 v28, v28, v55, v56
    v_max3_f32 v28, v28, v57, v58
    v_max3_f32 v28, v28, v59, v60
    v_max3_f32 v28, v28, v61, v62
    v_max_f32 v28, v28, v63
    v_mov_b32 v29, v28
    s_nop 1
    v_permlane32_swap_b32 v29, v28
    s_nop 1
    v_max_f32 v28, v28, v29
    v_ceil_f32 v28, v28
    v_max_f32 v28, 0, v28
    v_cvt_i32_f32 v29, v28
    v_sub_u32 v29, 0, v29
    v_ldexp_f32 v29, 1.0, v29
    v_accvgpr_read_b32 v30, a64
    v_mul_f32 v30, v30, v29
    v_accvgpr_write_b32 a64, v30
    v_accvgpr_read_b32 v30, a65
    v_mul_f32 v30, v30, v29
    v_accvgpr_write_b32 a65, v30
    v_accvgpr_read_b32 v30, a66
    v_mul_f32 v30, v30, v29
    v_accvgpr_write_b32 a66, v30
    v_accvgpr_read_b32 v30, a67
    v_mul_f32 v30, v30, v29
    v_accvgpr_write_b32 a67, v30
    v_accvgpr_read_b32 v30, a68
    v_mul_f32 v30, v30, v29
    v_accvgpr_write_b32 a68, v30
    v_accvgpr_read_b32 v30, a69
    v_mul_f32 v30, v30, v29
    v_accvgpr_write_b32 a69, v30
    v_accvgpr_read_b32 v30, a70
    v_mul_f32 v30, v30, v29
    v_accvgpr_write_b32 a70, v30
    v_accvgpr_read_b32 v30, a71
    v_mul_f32 v30, v30, v29
    v_accvgpr_write_b32 a71, v30
    v_accvgpr_read_b32 v30, a72
    v_mul_f32 v30, v30, v29
    v_accvgpr_write_b32 a72, v30
    v_accvgpr_read_b32 v30, a73
    v_mul_f32 v30, v30, v29
    v_accvgpr_write_b32 a73, v30
    v_accvgpr_read_b32 v30, a74
    v_mul_f32 v30, v30, v29
    v_accvgpr_write_b32 a74, v30
    v_accvgpr_read_b32 v30, a75
    v_mul_f32 v30, v30, v29
    v_accvgpr_write_b32 a75, v30
    v_accvgpr_read_b32 v30, a76
    v_mul_f32 v30, v30, v29
    v_accvgpr_write_b32 a76, v30
    v_accvgpr_read_b32 v30, a77
    v_mul_f32 v30, v30, v29
    v_accvgpr_write_b32 a77, v30
    v_accvgpr_read_b32 v30, a78
    v_mul_f32 v30, v30, v29
    v_accvgpr_write_b32 a78, v30
    v_accvgpr_read_b32 v30, a79
    v_mul_f32 v30, v30, v29
    v_accvgpr_write_b32 a79, v30
    v_accvgpr_read_b32 v30, a80
    v_mul_f32 v30, v30, v29
    v_accvgpr_write_b32 a80, v30
    v_accvgpr_read_b32 v30, a81
    v_mul_f32 v30, v30, v29
    v_accvgpr_write_b32 a81, v30
    v_accvgpr_read_b32 v30, a82
    v_mul_f32 v30, v30, v29
    v_accvgpr_write_b32 a82, v30
    v_accvgpr_read_b32 v30, a83
    v_mul_f32 v30, v30, v29
    v_accvgpr_write_b32 a83, v30
    v_accvgpr_read_b32 v30, a84
    v_mul_f32 v30, v30, v29
    v_accvgpr_write_b32 a84, v30
    v_accvgpr_read_b32 v30, a85
    v_mul_f32 v30, v30, v29
    v_accvgpr_write_b32 a85, v30
    v_accvgpr_read_b32 v30, a86
    v_mul_f32 v30, v30, v29
    v_accvgpr_write_b32 a86, v30
    v_accvgpr_read_b32 v30, a87
    v_mul_f32 v30, v30, v29
    v_accvgpr_write_b32 a87, v30
    v_accvgpr_read_b32 v30, a88
    v_mul_f32 v30, v30, v29
    v_accvgpr_write_b32 a88, v30
    v_accvgpr_read_b32 v30, a89
    v_mul_f32 v30, v30, v29
    v_accvgpr_write_b32 a89, v30
    v_accvgpr_read_b32 v30, a90
    v_mul_f32 v30, v30, v29
    v_accvgpr_write_b32 a90, v30
    v_accvgpr_read_b32 v30, a91
    v_mul_f32 v30, v30, v29
    v_accvgpr_write_b32 a91, v30
    v_accvgpr_read_b32 v30, a92
    v_mul_f32 v30, v30, v29
    v_accvgpr_write_b32 a92, v30
    v_accvgpr_read_b32 v30, a93
    v_mul_f32 v30, v30, v29
    v_accvgpr_write_b32 a93, v30
    v_accvgpr_read_b32 v30, a94
    v_mul_f32 v30, v30, v29
    v_accvgpr_write_b32 a94, v30
    v_accvgpr_read_b32 v30, a95
    v_mul_f32 v30, v30, v29
    v_accvgpr_write_b32 a95, v30
    v_accvgpr_read_b32 v30, a96
    v_mul_f32 v30, v30, v29
    v_accvgpr_write_b32 a96, v30
    v_accvgpr_read_b32 v30, a97
    v_mul_f32 v30, v30, v29
    v_accvgpr_write_b32 a97, v30
    v_accvgpr_read_b32 v30, a98
    v_mul_f32 v30, v30, v29
    v_accvgpr_write_b32 a98, v30
    v_accvgpr_read_b32 v30, a99
    v_mul_f32 v30, v30, v29
    v_accvgpr_write_b32 a99, v30
    v_accvgpr_read_b32 v30, a100
    v_mul_f32 v30, v30, v29
    v_accvgpr_write_b32 a100, v30
    v_accvgpr_read_b32 v30, a101
    v_mul_f32 v30, v30, v29
    v_accvgpr_write_b32 a101, v30
    v_accvgpr_read_b32 v30, a102
    v_mul_f32 v30, v30, v29
    v_accvgpr_write_b32 a102, v30
    v_accvgpr_read_b32 v30, a103
    v_mul_f32 v30, v30, v29
    v_accvgpr_write_b32 a103, v30
    v_accvgpr_read_b32 v30, a104
    v_mul_f32 v30, v30, v29
    v_accvgpr_write_b32 a104, v30
    v_accvgpr_read_b32 v30, a105
    v_mul_f32 v30, v30, v29
    v_accvgpr_write_b32 a105, v30
    v_accvgpr_read_b32 v30, a106
    v_mul_f32 v30, v30, v29
    v_accvgpr_write_b32 a106, v30
    v_accvgpr_read_b32 v30, a107
    v_mul_f32 v30, v30, v29
    v_accvgpr_write_b32 a107, v30
    v_accvgpr_read_b32 v30, a108
    v_mul_f32 v30, v30, v29
    v_accvgpr_write_b32 a108, v30
    v_accvgpr_read_b32 v30, a109
    v_mul_f32 v30, v30, v29
    v_accvgpr_write_b32 a109, v30
    v_accvgpr_read_b32 v30, a110
    v_mul_f32 v30, v30, v29
    v_accvgpr_write_b32 a110, v30
    v_accvgpr_read_b32 v30, a111
    v_mul_f32 v30, v30, v29
    v_accvgpr_write_b32 a111, v30
    v_accvgpr_read_b32 v30, a112
    v_mul_f32 v30, v30, v29
    v_accvgpr_write_b32 a112, v30
    v_accvgpr_read_b32 v30, a113
    v_mul_f32 v30, v30, v29
    v_accvgpr_write_b32 a113, v30
    v_accvgpr_read_b32 v30, a114
    v_mul_f32 v30, v30, v29
    v_accvgpr_write_b32 a114, v30
    v_accvgpr_read_b32 v30, a115
    v_mul_f32 v30, v30, v29
    v_accvgpr_write_b32 a115, v30
    v_accvgpr_read_b32 v30, a116
    v_mul_f32 v30, v30, v29
    v_accvgpr_write_b32 a116, v30
    v_accvgpr_read_b32 v30, a117
    v_mul_f32 v30, v30, v29
    v_accvgpr_write_b32 a117, v30
    v_accvgpr_read_b32 v30, a118
    v_mul_f32 v30, v30, v29
    v_accvgpr_write_b32 a118, v30
    v_accvgpr_read_b32 v30, a119
    v_mul_f32 v30, v30, v29
    v_accvgpr_write_b32 a119, v30
    v_accvgpr_read_b32 v30, a120
    v_mul_f32 v30, v30, v29
    v_accvgpr_write_b32 a120, v30
    v_accvgpr_read_b32 v30, a121
    v_mul_f32 v30, v30, v29
    v_accvgpr_write_b32 a121, v30
    v_accvgpr_read_b32 v30, a122
    v_mul_f32 v30, v30, v29
    v_accvgpr_write_b32 a122, v30
    v_accvgpr_read_b32 v30, a123
    v_mul_f32 v30, v30, v29
    v_accvgpr_write_b32 a123, v30
    v_accvgpr_read_b32 v30, a124
    v_mul_f32 v30, v30, v29
    v_accvgpr_write_b32 a124, v30
    v_accvgpr_read_b32 v30, a125
    v_mul_f32 v30, v30, v29
    v_accvgpr_write_b32 a125, v30
    v_accvgpr_read_b32 v30, a126
    v_mul_f32 v30, v30, v29
    v_accvgpr_write_b32 a126, v30
    v_accvgpr_read_b32 v30, a127
    v_mul_f32 v30, v30, v29
    v_accvgpr_write_b32 a127, v30
    v_mul_f32 v26, v26, v29
    v_sub_f32 v112, v112, v28
    v_sub_f32 v48, v48, v28
    v_sub_f32 v80, v80, v28
    v_sub_f32 v113, v113, v28
    v_sub_f32 v49, v49, v28
    v_sub_f32 v81, v81, v28
    v_sub_f32 v114, v114, v28
    v_sub_f32 v50, v50, v28
    v_sub_f32 v82, v82, v28
    v_sub_f32 v115, v115, v28
    v_sub_f32 v51, v51, v28
    v_sub_f32 v83, v83, v28
    v_sub_f32 v116, v116, v28
    v_sub_f32 v52, v52, v28
    v_sub_f32 v84, v84, v28
    v_sub_f32 v117, v117, v28
    v_sub_f32 v53, v53, v28
    v_sub_f32 v85, v85, v28
    v_sub_f32 v118, v118, v28
    v_sub_f32 v54, v54, v28
    v_sub_f32 v86, v86, v28
    v_sub_f32 v119, v119, v28
    v_sub_f32 v55, v55, v28
    v_sub_f32 v87, v87, v28
    v_sub_f32 v120, v120, v28
    v_sub_f32 v56, v56, v28
    v_sub_f32 v88, v88, v28
    v_sub_f32 v121, v121, v28
    v_sub_f32 v57, v57, v28
    v_sub_f32 v89, v89, v28
    v_sub_f32 v122, v122, v28
    v_sub_f32 v58, v58, v28
    v_sub_f32 v90, v90, v28
    v_sub_f32 v123, v123, v28
    v_sub_f32 v59, v59, v28
    v_sub_f32 v91, v91, v28
    v_sub_f32 v124, v124, v28
    v_sub_f32 v60, v60, v28
    v_sub_f32 v92, v92, v28
    v_sub_f32 v125, v125, v28
    v_sub_f32 v61, v61, v28
    v_sub_f32 v93, v93, v28
    v_sub_f32 v126, v126, v28
    v_sub_f32 v62, v62, v28
    v_sub_f32 v94, v94, v28
    v_sub_f32 v127, v127, v28
    v_sub_f32 v63, v63, v28
    v_sub_f32 v95, v95, v28
    v_exp_f32 v28, v48
    v_exp_f32 v29, v49
    v_exp_f32 v30, v50
    v_add_f32 v27, v28, v29
    v_exp_f32 v31, v51
    v_cvt_pk_bf16_f32 v136, v28, v29
    v_exp_f32 v28, v52
    v_add_f32 v27, v27, v30
    v_add_f32 v27, v27, v31
    v_exp_f32 v29, v53
    v_cvt_pk_bf16_f32 v137, v30, v31
    v_exp_f32 v30, v54
    v_add_f32 v27, v27, v28
    v_add_f32 v27, v27, v29
    v_exp_f32 v31, v55
    v_cvt_pk_bf16_f32 v138, v28, v29
    v_exp_f32 v28, v56
    v_add_f32 v27, v27, v30
    v_add_f32 v27, v27, v31
    v_exp_f32 v29, v57
    v_cvt_pk_bf16_f32 v139, v30, v31
    v_exp_f32 v30, v58
    v_add_f32 v27, v27, v28
    v_add_f32 v27, v27, v29
    v_exp_f32 v31, v59
    v_cvt_pk_bf16_f32 v140, v28, v29
    v_exp_f32 v28, v60
    v_add_f32 v27, v27, v30
    v_add_f32 v27, v27, v31
    v_exp_f32 v29, v61
    v_cvt_pk_bf16_f32 v141, v30, v31
    v_exp_f32 v30, v62
    v_add_f32 v27, v27, v28
    v_add_f32 v27, v27, v29
    v_exp_f32 v31, v63
    v_cvt_pk_bf16_f32 v142, v28, v29
    v_add_f32 v27, v27, v30
    v_add_f32 v27, v27, v31
    v_cvt_pk_bf16_f32 v143, v30, v31
    s_nop 1
    s_branch attn_kernel_ret_4_1
attn_kernel_slow_5_0:
    s_nop 15
    s_nop 15
    v_max3_f32 v28, v64, v65, v66
    v_max3_f32 v28, v28, v67, v68
    v_max3_f32 v28, v28, v69, v70
    v_max3_f32 v28, v28, v71, v72
    v_max3_f32 v28, v28, v73, v74
    v_max3_f32 v28, v28, v75, v76
    v_max3_f32 v28, v28, v77, v78
    v_max_f32 v28, v28, v79
    v_mov_b32 v29, v28
    s_nop 1
    v_permlane32_swap_b32 v29, v28
    s_nop 1
    v_max_f32 v28, v28, v29
    v_ceil_f32 v28, v28
    v_max_f32 v28, 0, v28
    v_cvt_i32_f32 v29, v28
    v_sub_u32 v29, 0, v29
    v_ldexp_f32 v29, 1.0, v29
    v_accvgpr_read_b32 v30, a0
    v_mul_f32 v30, v30, v29
    v_accvgpr_write_b32 a0, v30
    v_accvgpr_read_b32 v30, a1
    v_mul_f32 v30, v30, v29
    v_accvgpr_write_b32 a1, v30
    v_accvgpr_read_b32 v30, a2
    v_mul_f32 v30, v30, v29
    v_accvgpr_write_b32 a2, v30
    v_accvgpr_read_b32 v30, a3
    v_mul_f32 v30, v30, v29
    v_accvgpr_write_b32 a3, v30
    v_accvgpr_read_b32 v30, a4
    v_mul_f32 v30, v30, v29
    v_accvgpr_write_b32 a4, v30
    v_accvgpr_read_b32 v30, a5
    v_mul_f32 v30, v30, v29
    v_accvgpr_write_b32 a5, v30
    v_accvgpr_read_b32 v30, a6
    v_mul_f32 v30, v30, v29
    v_accvgpr_write_b32 a6, v30
    v_accvgpr_read_b32 v30, a7
    v_mul_f32 v30, v30, v29
    v_accvgpr_write_b32 a7, v30
    v_accvgpr_read_b32 v30, a8
    v_mul_f32 v30, v30, v29
    v_accvgpr_write_b32 a8, v30
    v_accvgpr_read_b32 v30, a9
    v_mul_f32 v30, v30, v29
    v_accvgpr_write_b32 a9, v30
    v_accvgpr_read_b32 v30, a10
    v_mul_f32 v30, v30, v29
    v_accvgpr_write_b32 a10, v30
    v_accvgpr_read_b32 v30, a11
    v_mul_f32 v30, v30, v29
    v_accvgpr_write_b32 a11, v30
    v_accvgpr_read_b32 v30, a12
    v_mul_f32 v30, v30, v29
    v_accvgpr_write_b32 a12, v30
    v_accvgpr_read_b32 v30, a13
    v_mul_f32 v30, v30, v29
    v_accvgpr_write_b32 a13, v30
    v_accvgpr_read_b32 v30, a14
    v_mul_f32 v30, v30, v29
    v_accvgpr_write_b32 a14, v30
    v_accvgpr_read_b32 v30, a15
    v_mul_f32 v30, v30, v29
    v_accvgpr_write_b32 a15, v30
    v_accvgpr_read_b32 v30, a16
    v_mul_f32 v30, v30, v29
    v_accvgpr_write_b32 a16, v30
    v_accvgpr_read_b32 v30, a17
    v_mul_f32 v30, v30, v29
    v_accvgpr_write_b32 a17, v30
    v_accvgpr_read_b32 v30, a18
    v_mul_f32 v30, v30, v29
    v_accvgpr_write_b32 a18, v30
    v_accvgpr_read_b32 v30, a19
    v_mul_f32 v30, v30, v29
    v_accvgpr_write_b32 a19, v30
    v_accvgpr_read_b32 v30, a20
    v_mul_f32 v30, v30, v29
    v_accvgpr_write_b32 a20, v30
    v_accvgpr_read_b32 v30, a21
    v_mul_f32 v30, v30, v29
    v_accvgpr_write_b32 a21, v30
    v_accvgpr_read_b32 v30, a22
    v_mul_f32 v30, v30, v29
    v_accvgpr_write_b32 a22, v30
    v_accvgpr_read_b32 v30, a23
    v_mul_f32 v30, v30, v29
    v_accvgpr_write_b32 a23, v30
    v_accvgpr_read_b32 v30, a24
    v_mul_f32 v30, v30, v29
    v_accvgpr_write_b32 a24, v30
    v_accvgpr_read_b32 v30, a25
    v_mul_f32 v30, v30, v29
    v_accvgpr_write_b32 a25, v30
    v_accvgpr_read_b32 v30, a26
    v_mul_f32 v30, v30, v29
    v_accvgpr_write_b32 a26, v30
    v_accvgpr_read_b32 v30, a27
    v_mul_f32 v30, v30, v29
    v_accvgpr_write_b32 a27, v30
    v_accvgpr_read_b32 v30, a28
    v_mul_f32 v30, v30, v29
    v_accvgpr_write_b32 a28, v30
    v_accvgpr_read_b32 v30, a29
    v_mul_f32 v30, v30, v29
    v_accvgpr_write_b32 a29, v30
    v_accvgpr_read_b32 v30, a30
    v_mul_f32 v30, v30, v29
    v_accvgpr_write_b32 a30, v30
    v_accvgpr_read_b32 v30, a31
    v_mul_f32 v30, v30, v29
    v_accvgpr_write_b32 a31, v30
    v_accvgpr_read_b32 v30, a32
    v_mul_f32 v30, v30, v29
    v_accvgpr_write_b32 a32, v30
    v_accvgpr_read_b32 v30, a33
    v_mul_f32 v30, v30, v29
    v_accvgpr_write_b32 a33, v30
    v_accvgpr_read_b32 v30, a34
    v_mul_f32 v30, v30, v29
    v_accvgpr_write_b32 a34, v30
    v_accvgpr_read_b32 v30, a35
    v_mul_f32 v30, v30, v29
    v_accvgpr_write_b32 a35, v30
    v_accvgpr_read_b32 v30, a36
    v_mul_f32 v30, v30, v29
    v_accvgpr_write_b32 a36, v30
    v_accvgpr_read_b32 v30, a37
    v_mul_f32 v30, v30, v29
    v_accvgpr_write_b32 a37, v30
    v_accvgpr_read_b32 v30, a38
    v_mul_f32 v30, v30, v29
    v_accvgpr_write_b32 a38, v30
    v_accvgpr_read_b32 v30, a39
    v_mul_f32 v30, v30, v29
    v_accvgpr_write_b32 a39, v30
    v_accvgpr_read_b32 v30, a40
    v_mul_f32 v30, v30, v29
    v_accvgpr_write_b32 a40, v30
    v_accvgpr_read_b32 v30, a41
    v_mul_f32 v30, v30, v29
    v_accvgpr_write_b32 a41, v30
    v_accvgpr_read_b32 v30, a42
    v_mul_f32 v30, v30, v29
    v_accvgpr_write_b32 a42, v30
    v_accvgpr_read_b32 v30, a43
    v_mul_f32 v30, v30, v29
    v_accvgpr_write_b32 a43, v30
    v_accvgpr_read_b32 v30, a44
    v_mul_f32 v30, v30, v29
    v_accvgpr_write_b32 a44, v30
    v_accvgpr_read_b32 v30, a45
    v_mul_f32 v30, v30, v29
    v_accvgpr_write_b32 a45, v30
    v_accvgpr_read_b32 v30, a46
    v_mul_f32 v30, v30, v29
    v_accvgpr_write_b32 a46, v30
    v_accvgpr_read_b32 v30, a47
    v_mul_f32 v30, v30, v29
    v_accvgpr_write_b32 a47, v30
    v_accvgpr_read_b32 v30, a48
    v_mul_f32 v30, v30, v29
    v_accvgpr_write_b32 a48, v30
    v_accvgpr_read_b32 v30, a49
    v_mul_f32 v30, v30, v29
    v_accvgpr_write_b32 a49, v30
    v_accvgpr_read_b32 v30, a50
    v_mul_f32 v30, v30, v29
    v_accvgpr_write_b32 a50, v30
    v_accvgpr_read_b32 v30, a51
    v_mul_f32 v30, v30, v29
    v_accvgpr_write_b32 a51, v30
    v_accvgpr_read_b32 v30, a52
    v_mul_f32 v30, v30, v29
    v_accvgpr_write_b32 a52, v30
    v_accvgpr_read_b32 v30, a53
    v_mul_f32 v30, v30, v29
    v_accvgpr_write_b32 a53, v30
    v_accvgpr_read_b32 v30, a54
    v_mul_f32 v30, v30, v29
    v_accvgpr_write_b32 a54, v30
    v_accvgpr_read_b32 v30, a55
    v_mul_f32 v30, v30, v29
    v_accvgpr_write_b32 a55, v30
    v_accvgpr_read_b32 v30, a56
    v_mul_f32 v30, v30, v29
    v_accvgpr_write_b32 a56, v30
    v_accvgpr_read_b32 v30, a57
    v_mul_f32 v30, v30, v29
    v_accvgpr_write_b32 a57, v30
    v_accvgpr_read_b32 v30, a58
    v_mul_f32 v30, v30, v29
    v_accvgpr_write_b32 a58, v30
    v_accvgpr_read_b32 v30, a59
    v_mul_f32 v30, v30, v29
    v_accvgpr_write_b32 a59, v30
    v_accvgpr_read_b32 v30, a60
    v_mul_f32 v30, v30, v29
    v_accvgpr_write_b32 a60, v30
    v_accvgpr_read_b32 v30, a61
    v_mul_f32 v30, v30, v29
    v_accvgpr_write_b32 a61, v30
    v_accvgpr_read_b32 v30, a62
    v_mul_f32 v30, v30, v29
    v_accvgpr_write_b32 a62, v30
    v_accvgpr_read_b32 v30, a63
    v_mul_f32 v30, v30, v29
    v_accvgpr_write_b32 a63, v30
    v_mul_f32 v25, v25, v29
    v_sub_f32 v96, v96, v28
    v_sub_f32 v64, v64, v28
    v_sub_f32 v32, v32, v28
    v_sub_f32 v97, v97, v28
    v_sub_f32 v65, v65, v28
    v_sub_f32 v33, v33, v28
    v_sub_f32 v98, v98, v28
    v_sub_f32 v66, v66, v28
    v_sub_f32 v34, v34, v28
    v_sub_f32 v99, v99, v28
    v_sub_f32 v67, v67, v28
    v_sub_f32 v35, v35, v28
    v_sub_f32 v100, v100, v28
    v_sub_f32 v68, v68, v28
    v_sub_f32 v36, v36, v28
    v_sub_f32 v101, v101, v28
    v_sub_f32 v69, v69, v28
    v_sub_f32 v37, v37, v28
    v_sub_f32 v102, v102, v28
    v_sub_f32 v70, v70, v28
    v_sub_f32 v38, v38, v28
    v_sub_f32 v103, v103, v28
    v_sub_f32 v71, v71, v28
    v_sub_f32 v39, v39, v28
    v_sub_f32 v104, v104, v28
    v_sub_f32 v72, v72, v28
    v_sub_f32 v40, v40, v28
    v_sub_f32 v105, v105, v28
    v_sub_f32 v73, v73, v28
    v_sub_f32 v41, v41, v28
    v_sub_f32 v106, v106, v28
    v_sub_f32 v74, v74, v28
    v_sub_f32 v42, v42, v28
    v_sub_f32 v107, v107, v28
    v_sub_f32 v75, v75, v28
    v_sub_f32 v43, v43, v28
    v_sub_f32 v108, v108, v28
    v_sub_f32 v76, v76, v28
    v_sub_f32 v44, v44, v28
    v_sub_f32 v109, v109, v28
    v_sub_f32 v77, v77, v28
    v_sub_f32 v45, v45, v28
    v_sub_f32 v110, v110, v28
    v_sub_f32 v78, v78, v28
    v_sub_f32 v46, v46, v28
    v_sub_f32 v111, v111, v28
    v_sub_f32 v79, v79, v28
    v_sub_f32 v47, v47, v28
    v_exp_f32 v28, v64
    v_exp_f32 v29, v65
    v_exp_f32 v30, v66
    v_add_f32 v27, v28, v29
    v_exp_f32 v31, v67
    v_cvt_pk_bf16_f32 v144, v28, v29
    v_exp_f32 v28, v68
    v_add_f32 v27, v27, v30
    v_add_f32 v27, v27, v31
    v_exp_f32 v29, v69
    v_cvt_pk_bf16_f32 v145, v30, v31
    v_exp_f32 v30, v70
    v_add_f32 v27, v27, v28
    v_add_f32 v27, v27, v29
    v_exp_f32 v31, v71
    v_cvt_pk_bf16_f32 v146, v28, v29
    v_exp_f32 v28, v72
    v_add_f32 v27, v27, v30
    v_add_f32 v27, v27, v31
    v_exp_f32 v29, v73
    v_cvt_pk_bf16_f32 v147, v30, v31
    v_exp_f32 v30, v74
    v_add_f32 v27, v27, v28
    v_add_f32 v27, v27, v29
    v_exp_f32 v31, v75
    v_cvt_pk_bf16_f32 v148, v28, v29
    v_exp_f32 v28, v76
    v_add_f32 v27, v27, v30
    v_add_f32 v27, v27, v31
    v_exp_f32 v29, v77
    v_cvt_pk_bf16_f32 v149, v30, v31
    v_exp_f32 v30, v78
    v_add_f32 v27, v27, v28
    v_add_f32 v27, v27, v29
    v_exp_f32 v31, v79
    v_cvt_pk_bf16_f32 v150, v28, v29
    v_add_f32 v27, v27, v30
    v_add_f32 v27, v27, v31
    v_cvt_pk_bf16_f32 v151, v30, v31
    s_nop 1
    s_branch attn_kernel_ret_5_0
attn_kernel_slow_5_1:
    s_nop 15
    s_nop 15
    v_max3_f32 v28, v80, v81, v82
    v_max3_f32 v28, v28, v83, v84
    v_max3_f32 v28, v28, v85, v86
    v_max3_f32 v28, v28, v87, v88
    v_max3_f32 v28, v28, v89, v90
    v_max3_f32 v28, v28, v91, v92
    v_max3_f32 v28, v28, v93, v94
    v_max_f32 v28, v28, v95
    v_mov_b32 v29, v28
    s_nop 1
    v_permlane32_swap_b32 v29, v28
    s_nop 1
    v_max_f32 v28, v28, v29
    v_ceil_f32 v28, v28
    v_max_f32 v28, 0, v28
    v_cvt_i32_f32 v29, v28
    v_sub_u32 v29, 0, v29
    v_ldexp_f32 v29, 1.0, v29
    v_accvgpr_read_b32 v30, a64
    v_mul_f32 v30, v30, v29
    v_accvgpr_write_b32 a64, v30
    v_accvgpr_read_b32 v30, a65
    v_mul_f32 v30, v30, v29
    v_accvgpr_write_b32 a65, v30
    v_accvgpr_read_b32 v30, a66
    v_mul_f32 v30, v30, v29
    v_accvgpr_write_b32 a66, v30
    v_accvgpr_read_b32 v30, a67
    v_mul_f32 v30, v30, v29
    v_accvgpr_write_b32 a67, v30
    v_accvgpr_read_b32 v30, a68
    v_mul_f32 v30, v30, v29
    v_accvgpr_write_b32 a68, v30
    v_accvgpr_read_b32 v30, a69
    v_mul_f32 v30, v30, v29
    v_accvgpr_write_b32 a69, v30
    v_accvgpr_read_b32 v30, a70
    v_mul_f32 v30, v30, v29
    v_accvgpr_write_b32 a70, v30
    v_accvgpr_read_b32 v30, a71
    v_mul_f32 v30, v30, v29
    v_accvgpr_write_b32 a71, v30
    v_accvgpr_read_b32 v30, a72
    v_mul_f32 v30, v30, v29
    v_accvgpr_write_b32 a72, v30
    v_accvgpr_read_b32 v30, a73
    v_mul_f32 v30, v30, v29
    v_accvgpr_write_b32 a73, v30
    v_accvgpr_read_b32 v30, a74
    v_mul_f32 v30, v30, v29
    v_accvgpr_write_b32 a74, v30
    v_accvgpr_read_b32 v30, a75
    v_mul_f32 v30, v30, v29
    v_accvgpr_write_b32 a75, v30
    v_accvgpr_read_b32 v30, a76
    v_mul_f32 v30, v30, v29
    v_accvgpr_write_b32 a76, v30
    v_accvgpr_read_b32 v30, a77
    v_mul_f32 v30, v30, v29
    v_accvgpr_write_b32 a77, v30
    v_accvgpr_read_b32 v30, a78
    v_mul_f32 v30, v30, v29
    v_accvgpr_write_b32 a78, v30
    v_accvgpr_read_b32 v30, a79
    v_mul_f32 v30, v30, v29
    v_accvgpr_write_b32 a79, v30
    v_accvgpr_read_b32 v30, a80
    v_mul_f32 v30, v30, v29
    v_accvgpr_write_b32 a80, v30
    v_accvgpr_read_b32 v30, a81
    v_mul_f32 v30, v30, v29
    v_accvgpr_write_b32 a81, v30
    v_accvgpr_read_b32 v30, a82
    v_mul_f32 v30, v30, v29
    v_accvgpr_write_b32 a82, v30
    v_accvgpr_read_b32 v30, a83
    v_mul_f32 v30, v30, v29
    v_accvgpr_write_b32 a83, v30
    v_accvgpr_read_b32 v30, a84
    v_mul_f32 v30, v30, v29
    v_accvgpr_write_b32 a84, v30
    v_accvgpr_read_b32 v30, a85
    v_mul_f32 v30, v30, v29
    v_accvgpr_write_b32 a85, v30
    v_accvgpr_read_b32 v30, a86
    v_mul_f32 v30, v30, v29
    v_accvgpr_write_b32 a86, v30
    v_accvgpr_read_b32 v30, a87
    v_mul_f32 v30, v30, v29
    v_accvgpr_write_b32 a87, v30
    v_accvgpr_read_b32 v30, a88
    v_mul_f32 v30, v30, v29
    v_accvgpr_write_b32 a88, v30
    v_accvgpr_read_b32 v30, a89
    v_mul_f32 v30, v30, v29
    v_accvgpr_write_b32 a89, v30
    v_accvgpr_read_b32 v30, a90
    v_mul_f32 v30, v30, v29
    v_accvgpr_write_b32 a90, v30
    v_accvgpr_read_b32 v30, a91
    v_mul_f32 v30, v30, v29
    v_accvgpr_write_b32 a91, v30
    v_accvgpr_read_b32 v30, a92
    v_mul_f32 v30, v30, v29
    v_accvgpr_write_b32 a92, v30
    v_accvgpr_read_b32 v30, a93
    v_mul_f32 v30, v30, v29
    v_accvgpr_write_b32 a93, v30
    v_accvgpr_read_b32 v30, a94
    v_mul_f32 v30, v30, v29
    v_accvgpr_write_b32 a94, v30
    v_accvgpr_read_b32 v30, a95
    v_mul_f32 v30, v30, v29
    v_accvgpr_write_b32 a95, v30
    v_accvgpr_read_b32 v30, a96
    v_mul_f32 v30, v30, v29
    v_accvgpr_write_b32 a96, v30
    v_accvgpr_read_b32 v30, a97
    v_mul_f32 v30, v30, v29
    v_accvgpr_write_b32 a97, v30
    v_accvgpr_read_b32 v30, a98
    v_mul_f32 v30, v30, v29
    v_accvgpr_write_b32 a98, v30
    v_accvgpr_read_b32 v30, a99
    v_mul_f32 v30, v30, v29
    v_accvgpr_write_b32 a99, v30
    v_accvgpr_read_b32 v30, a100
    v_mul_f32 v30, v30, v29
    v_accvgpr_write_b32 a100, v30
    v_accvgpr_read_b32 v30, a101
    v_mul_f32 v30, v30, v29
    v_accvgpr_write_b32 a101, v30
    v_accvgpr_read_b32 v30, a102
    v_mul_f32 v30, v30, v29
    v_accvgpr_write_b32 a102, v30
    v_accvgpr_read_b32 v30, a103
    v_mul_f32 v30, v30, v29
    v_accvgpr_write_b32 a103, v30
    v_accvgpr_read_b32 v30, a104
    v_mul_f32 v30, v30, v29
    v_accvgpr_write_b32 a104, v30
    v_accvgpr_read_b32 v30, a105
    v_mul_f32 v30, v30, v29
    v_accvgpr_write_b32 a105, v30
    v_accvgpr_read_b32 v30, a106
    v_mul_f32 v30, v30, v29
    v_accvgpr_write_b32 a106, v30
    v_accvgpr_read_b32 v30, a107
    v_mul_f32 v30, v30, v29
    v_accvgpr_write_b32 a107, v30
    v_accvgpr_read_b32 v30, a108
    v_mul_f32 v30, v30, v29
    v_accvgpr_write_b32 a108, v30
    v_accvgpr_read_b32 v30, a109
    v_mul_f32 v30, v30, v29
    v_accvgpr_write_b32 a109, v30
    v_accvgpr_read_b32 v30, a110
    v_mul_f32 v30, v30, v29
    v_accvgpr_write_b32 a110, v30
    v_accvgpr_read_b32 v30, a111
    v_mul_f32 v30, v30, v29
    v_accvgpr_write_b32 a111, v30
    v_accvgpr_read_b32 v30, a112
    v_mul_f32 v30, v30, v29
    v_accvgpr_write_b32 a112, v30
    v_accvgpr_read_b32 v30, a113
    v_mul_f32 v30, v30, v29
    v_accvgpr_write_b32 a113, v30
    v_accvgpr_read_b32 v30, a114
    v_mul_f32 v30, v30, v29
    v_accvgpr_write_b32 a114, v30
    v_accvgpr_read_b32 v30, a115
    v_mul_f32 v30, v30, v29
    v_accvgpr_write_b32 a115, v30
    v_accvgpr_read_b32 v30, a116
    v_mul_f32 v30, v30, v29
    v_accvgpr_write_b32 a116, v30
    v_accvgpr_read_b32 v30, a117
    v_mul_f32 v30, v30, v29
    v_accvgpr_write_b32 a117, v30
    v_accvgpr_read_b32 v30, a118
    v_mul_f32 v30, v30, v29
    v_accvgpr_write_b32 a118, v30
    v_accvgpr_read_b32 v30, a119
    v_mul_f32 v30, v30, v29
    v_accvgpr_write_b32 a119, v30
    v_accvgpr_read_b32 v30, a120
    v_mul_f32 v30, v30, v29
    v_accvgpr_write_b32 a120, v30
    v_accvgpr_read_b32 v30, a121
    v_mul_f32 v30, v30, v29
    v_accvgpr_write_b32 a121, v30
    v_accvgpr_read_b32 v30, a122
    v_mul_f32 v30, v30, v29
    v_accvgpr_write_b32 a122, v30
    v_accvgpr_read_b32 v30, a123
    v_mul_f32 v30, v30, v29
    v_accvgpr_write_b32 a123, v30
    v_accvgpr_read_b32 v30, a124
    v_mul_f32 v30, v30, v29
    v_accvgpr_write_b32 a124, v30
    v_accvgpr_read_b32 v30, a125
    v_mul_f32 v30, v30, v29
    v_accvgpr_write_b32 a125, v30
    v_accvgpr_read_b32 v30, a126
    v_mul_f32 v30, v30, v29
    v_accvgpr_write_b32 a126, v30
    v_accvgpr_read_b32 v30, a127
    v_mul_f32 v30, v30, v29
    v_accvgpr_write_b32 a127, v30
    v_mul_f32 v26, v26, v29
    v_sub_f32 v112, v112, v28
    v_sub_f32 v80, v80, v28
    v_sub_f32 v48, v48, v28
    v_sub_f32 v113, v113, v28
    v_sub_f32 v81, v81, v28
    v_sub_f32 v49, v49, v28
    v_sub_f32 v114, v114, v28
    v_sub_f32 v82, v82, v28
    v_sub_f32 v50, v50, v28
    v_sub_f32 v115, v115, v28
    v_sub_f32 v83, v83, v28
    v_sub_f32 v51, v51, v28
    v_sub_f32 v116, v116, v28
    v_sub_f32 v84, v84, v28
    v_sub_f32 v52, v52, v28
    v_sub_f32 v117, v117, v28
    v_sub_f32 v85, v85, v28
    v_sub_f32 v53, v53, v28
    v_sub_f32 v118, v118, v28
    v_sub_f32 v86, v86, v28
    v_sub_f32 v54, v54, v28
    v_sub_f32 v119, v119, v28
    v_sub_f32 v87, v87, v28
    v_sub_f32 v55, v55, v28
    v_sub_f32 v120, v120, v28
    v_sub_f32 v88, v88, v28
    v_sub_f32 v56, v56, v28
    v_sub_f32 v121, v121, v28
    v_sub_f32 v89, v89, v28
    v_sub_f32 v57, v57, v28
    v_sub_f32 v122, v122, v28
    v_sub_f32 v90, v90, v28
    v_sub_f32 v58, v58, v28
    v_sub_f32 v123, v123, v28
    v_sub_f32 v91, v91, v28
    v_sub_f32 v59, v59, v28
    v_sub_f32 v124, v124, v28
    v_sub_f32 v92, v92, v28
    v_sub_f32 v60, v60, v28
    v_sub_f32 v125, v125, v28
    v_sub_f32 v93, v93, v28
    v_sub_f32 v61, v61, v28
    v_sub_f32 v126, v126, v28
    v_sub_f32 v94, v94, v28
    v_sub_f32 v62, v62, v28
    v_sub_f32 v127, v127, v28
    v_sub_f32 v95, v95, v28
    v_sub_f32 v63, v63, v28
    v_exp_f32 v28, v80
    v_exp_f32 v29, v81
    v_exp_f32 v30, v82
    v_add_f32 v27, v28, v29
    v_exp_f32 v31, v83
    v_cvt_pk_bf16_f32 v152, v28, v29
    v_exp_f32 v28, v84
    v_add_f32 v27, v27, v30
    v_add_f32 v27, v27, v31
    v_exp_f32 v29, v85
    v_cvt_pk_bf16_f32 v153, v30, v31
    v_exp_f32 v30, v86
    v_add_f32 v27, v27, v28
    v_add_f32 v27, v27, v29
    v_exp_f32 v31, v87
    v_cvt_pk_bf16_f32 v154, v28, v29
    v_exp_f32 v28, v88
    v_add_f32 v27, v27, v30
    v_add_f32 v27, v27, v31
    v_exp_f32 v29, v89
    v_cvt_pk_bf16_f32 v155, v30, v31
    v_exp_f32 v30, v90
    v_add_f32 v27, v27, v28
    v_add_f32 v27, v27, v29
    v_exp_f32 v31, v91
    v_cvt_pk_bf16_f32 v156, v28, v29
    v_exp_f32 v28, v92
    v_add_f32 v27, v27, v30
    v_add_f32 v27, v27, v31
    v_exp_f32 v29, v93
    v_cvt_pk_bf16_f32 v157, v30, v31
    v_exp_f32 v30, v94
    v_add_f32 v27, v27, v28
    v_add_f32 v27, v27, v29
    v_exp_f32 v31, v95
    v_cvt_pk_bf16_f32 v158, v28, v29
    v_add_f32 v27, v27, v30
    v_add_f32 v27, v27, v31
    v_cvt_pk_bf16_f32 v159, v30, v31
    s_nop 1
    s_branch attn_kernel_ret_5_1
attn_kernel_slow_6_0:
    s_nop 15
    s_nop 15
    v_max3_f32 v28, v32, v33, v34
    v_max3_f32 v28, v28, v35, v36
    v_max3_f32 v28, v28, v37, v38
    v_max3_f32 v28, v28, v39, v40
    v_max3_f32 v28, v28, v41, v42
    v_max3_f32 v28, v28, v43, v44
    v_max3_f32 v28, v28, v45, v46
    v_max_f32 v28, v28, v47
    v_mov_b32 v29, v28
    s_nop 1
    v_permlane32_swap_b32 v29, v28
    s_nop 1
    v_max_f32 v28, v28, v29
    v_ceil_f32 v28, v28
    v_max_f32 v28, 0, v28
    v_cvt_i32_f32 v29, v28
    v_sub_u32 v29, 0, v29
    v_ldexp_f32 v29, 1.0, v29
    v_accvgpr_read_b32 v30, a0
    v_mul_f32 v30, v30, v29
    v_accvgpr_write_b32 a0, v30
    v_accvgpr_read_b32 v30, a1
    v_mul_f32 v30, v30, v29
    v_accvgpr_write_b32 a1, v30
    v_accvgpr_read_b32 v30, a2
    v_mul_f32 v30, v30, v29
    v_accvgpr_write_b32 a2, v30
    v_accvgpr_read_b32 v30, a3
    v_mul_f32 v30, v30, v29
    v_accvgpr_write_b32 a3, v30
    v_accvgpr_read_b32 v30, a4
    v_mul_f32 v30, v30, v29
    v_accvgpr_write_b32 a4, v30
    v_accvgpr_read_b32 v30, a5
    v_mul_f32 v30, v30, v29
    v_accvgpr_write_b32 a5, v30
    v_accvgpr_read_b32 v30, a6
    v_mul_f32 v30, v30, v29
    v_accvgpr_write_b32 a6, v30
    v_accvgpr_read_b32 v30, a7
    v_mul_f32 v30, v30, v29
    v_accvgpr_write_b32 a7, v30
    v_accvgpr_read_b32 v30, a8
    v_mul_f32 v30, v30, v29
    v_accvgpr_write_b32 a8, v30
    v_accvgpr_read_b32 v30, a9
    v_mul_f32 v30, v30, v29
    v_accvgpr_write_b32 a9, v30
    v_accvgpr_read_b32 v30, a10
    v_mul_f32 v30, v30, v29
    v_accvgpr_write_b32 a10, v30
    v_accvgpr_read_b32 v30, a11
    v_mul_f32 v30, v30, v29
    v_accvgpr_write_b32 a11, v30
    v_accvgpr_read_b32 v30, a12
    v_mul_f32 v30, v30, v29
    v_accvgpr_write_b32 a12, v30
    v_accvgpr_read_b32 v30, a13
    v_mul_f32 v30, v30, v29
    v_accvgpr_write_b32 a13, v30
    v_accvgpr_read_b32 v30, a14
    v_mul_f32 v30, v30, v29
    v_accvgpr_write_b32 a14, v30
    v_accvgpr_read_b32 v30, a15
    v_mul_f32 v30, v30, v29
    v_accvgpr_write_b32 a15, v30
    v_accvgpr_read_b32 v30, a16
    v_mul_f32 v30, v30, v29
    v_accvgpr_write_b32 a16, v30
    v_accvgpr_read_b32 v30, a17
    v_mul_f32 v30, v30, v29
    v_accvgpr_write_b32 a17, v30
    v_accvgpr_read_b32 v30, a18
    v_mul_f32 v30, v30, v29
    v_accvgpr_write_b32 a18, v30
    v_accvgpr_read_b32 v30, a19
    v_mul_f32 v30, v30, v29
    v_accvgpr_write_b32 a19, v30
    v_accvgpr_read_b32 v30, a20
    v_mul_f32 v30, v30, v29
    v_accvgpr_write_b32 a20, v30
    v_accvgpr_read_b32 v30, a21
    v_mul_f32 v30, v30, v29
    v_accvgpr_write_b32 a21, v30
    v_accvgpr_read_b32 v30, a22
    v_mul_f32 v30, v30, v29
    v_accvgpr_write_b32 a22, v30
    v_accvgpr_read_b32 v30, a23
    v_mul_f32 v30, v30, v29
    v_accvgpr_write_b32 a23, v30
    v_accvgpr_read_b32 v30, a24
    v_mul_f32 v30, v30, v29
    v_accvgpr_write_b32 a24, v30
    v_accvgpr_read_b32 v30, a25
    v_mul_f32 v30, v30, v29
    v_accvgpr_write_b32 a25, v30
    v_accvgpr_read_b32 v30, a26
    v_mul_f32 v30, v30, v29
    v_accvgpr_write_b32 a26, v30
    v_accvgpr_read_b32 v30, a27
    v_mul_f32 v30, v30, v29
    v_accvgpr_write_b32 a27, v30
    v_accvgpr_read_b32 v30, a28
    v_mul_f32 v30, v30, v29
    v_accvgpr_write_b32 a28, v30
    v_accvgpr_read_b32 v30, a29
    v_mul_f32 v30, v30, v29
    v_accvgpr_write_b32 a29, v30
    v_accvgpr_read_b32 v30, a30
    v_mul_f32 v30, v30, v29
    v_accvgpr_write_b32 a30, v30
    v_accvgpr_read_b32 v30, a31
    v_mul_f32 v30, v30, v29
    v_accvgpr_write_b32 a31, v30
    v_accvgpr_read_b32 v30, a32
    v_mul_f32 v30, v30, v29
    v_accvgpr_write_b32 a32, v30
    v_accvgpr_read_b32 v30, a33
    v_mul_f32 v30, v30, v29
    v_accvgpr_write_b32 a33, v30
    v_accvgpr_read_b32 v30, a34
    v_mul_f32 v30, v30, v29
    v_accvgpr_write_b32 a34, v30
    v_accvgpr_read_b32 v30, a35
    v_mul_f32 v30, v30, v29
    v_accvgpr_write_b32 a35, v30
    v_accvgpr_read_b32 v30, a36
    v_mul_f32 v30, v30, v29
    v_accvgpr_write_b32 a36, v30
    v_accvgpr_read_b32 v30, a37
    v_mul_f32 v30, v30, v29
    v_accvgpr_write_b32 a37, v30
    v_accvgpr_read_b32 v30, a38
    v_mul_f32 v30, v30, v29
    v_accvgpr_write_b32 a38, v30
    v_accvgpr_read_b32 v30, a39
    v_mul_f32 v30, v30, v29
    v_accvgpr_write_b32 a39, v30
    v_accvgpr_read_b32 v30, a40
    v_mul_f32 v30, v30, v29
    v_accvgpr_write_b32 a40, v30
    v_accvgpr_read_b32 v30, a41
    v_mul_f32 v30, v30, v29
    v_accvgpr_write_b32 a41, v30
    v_accvgpr_read_b32 v30, a42
    v_mul_f32 v30, v30, v29
    v_accvgpr_write_b32 a42, v30
    v_accvgpr_read_b32 v30, a43
    v_mul_f32 v30, v30, v29
    v_accvgpr_write_b32 a43, v30
    v_accvgpr_read_b32 v30, a44
    v_mul_f32 v30, v30, v29
    v_accvgpr_write_b32 a44, v30
    v_accvgpr_read_b32 v30, a45
    v_mul_f32 v30, v30, v29
    v_accvgpr_write_b32 a45, v30
    v_accvgpr_read_b32 v30, a46
    v_mul_f32 v30, v30, v29
    v_accvgpr_write_b32 a46, v30
    v_accvgpr_read_b32 v30, a47
    v_mul_f32 v30, v30, v29
    v_accvgpr_write_b32 a47, v30
    v_accvgpr_read_b32 v30, a48
    v_mul_f32 v30, v30, v29
    v_accvgpr_write_b32 a48, v30
    v_accvgpr_read_b32 v30, a49
    v_mul_f32 v30, v30, v29
    v_accvgpr_write_b32 a49, v30
    v_accvgpr_read_b32 v30, a50
    v_mul_f32 v30, v30, v29
    v_accvgpr_write_b32 a50, v30
    v_accvgpr_read_b32 v30, a51
    v_mul_f32 v30, v30, v29
    v_accvgpr_write_b32 a51, v30
    v_accvgpr_read_b32 v30, a52
    v_mul_f32 v30, v30, v29
    v_accvgpr_write_b32 a52, v30
    v_accvgpr_read_b32 v30, a53
    v_mul_f32 v30, v30, v29
    v_accvgpr_write_b32 a53, v30
    v_accvgpr_read_b32 v30, a54
    v_mul_f32 v30, v30, v29
    v_accvgpr_write_b32 a54, v30
    v_accvgpr_read_b32 v30, a55
    v_mul_f32 v30, v30, v29
    v_accvgpr_write_b32 a55, v30
    v_accvgpr_read_b32 v30, a56
    v_mul_f32 v30, v30, v29
    v_accvgpr_write_b32 a56, v30
    v_accvgpr_read_b32 v30, a57
    v_mul_f32 v30, v30, v29
    v_accvgpr_write_b32 a57, v30
    v_accvgpr_read_b32 v30, a58
    v_mul_f32 v30, v30, v29
    v_accvgpr_write_b32 a58, v30
    v_accvgpr_read_b32 v30, a59
    v_mul_f32 v30, v30, v29
    v_accvgpr_write_b32 a59, v30
    v_accvgpr_read_b32 v30, a60
    v_mul_f32 v30, v30, v29
    v_accvgpr_write_b32 a60, v30
    v_accvgpr_read_b32 v30, a61
    v_mul_f32 v30, v30, v29
    v_accvgpr_write_b32 a61, v30
    v_accvgpr_read_b32 v30, a62
    v_mul_f32 v30, v30, v29
    v_accvgpr_write_b32 a62, v30
    v_accvgpr_read_b32 v30, a63
    v_mul_f32 v30, v30, v29
    v_accvgpr_write_b32 a63, v30
    v_mul_f32 v25, v25, v29
    v_sub_f32 v96, v96, v28
    v_sub_f32 v32, v32, v28
    v_sub_f32 v64, v64, v28
    v_sub_f32 v97, v97, v28
    v_sub_f32 v33, v33, v28
    v_sub_f32 v65, v65, v28
    v_sub_f32 v98, v98, v28
    v_sub_f32 v34, v34, v28
    v_sub_f32 v66, v66, v28
    v_sub_f32 v99, v99, v28
    v_sub_f32 v35, v35, v28
    v_sub_f32 v67, v67, v28
    v_sub_f32 v100, v100, v28
    v_sub_f32 v36, v36, v28
    v_sub_f32 v68, v68, v28
    v_sub_f32 v101, v101, v28
    v_sub_f32 v37, v37, v28
    v_sub_f32 v69, v69, v28
    v_sub_f32 v102, v102, v28
    v_sub_f32 v38, v38, v28
    v_sub_f32 v70, v70, v28
    v_sub_f32 v103, v103, v28
    v_sub_f32 v39, v39, v28
    v_sub_f32 v71, v71, v28
    v_sub_f32 v104, v104, v28
    v_sub_f32 v40, v40, v28
    v_sub_f32 v72, v72, v28
    v_sub_f32 v105, v105, v28
    v_sub_f32 v41, v41, v28
    v_sub_f32 v73, v73, v28
    v_sub_f32 v106, v106, v28
    v_sub_f32 v42, v42, v28
    v_sub_f32 v74, v74, v28
    v_sub_f32 v107, v107, v28
    v_sub_f32 v43, v43, v28
    v_sub_f32 v75, v75, v28
    v_sub_f32 v108, v108, v28
    v_sub_f32 v44, v44, v28
    v_sub_f32 v76, v76, v28
    v_sub_f32 v109, v109, v28
    v_sub_f32 v45, v45, v28
    v_sub_f32 v77, v77, v28
    v_sub_f32 v110, v110, v28
    v_sub_f32 v46, v46, v28
    v_sub_f32 v78, v78, v28
    v_sub_f32 v111, v111, v28
    v_sub_f32 v47, v47, v28
    v_sub_f32 v79, v79, v28
    v_exp_f32 v28, v32
    v_exp_f32 v29, v33
    v_exp_f32 v30, v34
    v_add_f32 v27, v28, v29
    v_exp_f32 v31, v35
    v_cvt_pk_bf16_f32 v128, v28, v29
    v_exp_f32 v28, v36
    v_add_f32 v27, v27, v30
    v_add_f32 v27, v27, v31
    v_exp_f32 v29, v37
    v_cvt_pk_bf16_f32 v129, v30, v31
    v_exp_f32 v30, v38
    v_add_f32 v27, v27, v28
    v_add_f32 v27, v27, v29
    v_exp_f32 v31, v39
    v_cvt_pk_bf16_f32 v130, v28, v29
    v_exp_f32 v28, v40
    v_add_f32 v27, v27, v30
    v_add_f32 v27, v27, v31
    v_exp_f32 v29, v41
    v_cvt_pk_bf16_f32 v131, v30, v31
    v_exp_f32 v30, v42
    v_add_f32 v27, v27, v28
    v_add_f32 v27, v27, v29
    v_exp_f32 v31, v43
    v_cvt_pk_bf16_f32 v132, v28, v29
    v_exp_f32 v28, v44
    v_add_f32 v27, v27, v30
    v_add_f32 v27, v27, v31
    v_exp_f32 v29, v45
    v_cvt_pk_bf16_f32 v133, v30, v31
    v_exp_f32 v30, v46
    v_add_f32 v27, v27, v28
    v_add_f32 v27, v27, v29
    v_exp_f32 v31, v47
    v_cvt_pk_bf16_f32 v134, v28, v29
    v_add_f32 v27, v27, v30
    v_add_f32 v27, v27, v31
    v_cvt_pk_bf16_f32 v135, v30, v31
    s_nop 1
    s_branch attn_kernel_ret_6_0
attn_kernel_slow_6_1:
    s_nop 15
    s_nop 15
    v_max3_f32 v28, v48, v49, v50
    v_max3_f32 v28, v28, v51, v52
    v_max3_f32 v28, v28, v53, v54
    v_max3_f32 v28, v28, v55, v56
    v_max3_f32 v28, v28, v57, v58
    v_max3_f32 v28, v28, v59, v60
    v_max3_f32 v28, v28, v61, v62
    v_max_f32 v28, v28, v63
    v_mov_b32 v29, v28
    s_nop 1
    v_permlane32_swap_b32 v29, v28
    s_nop 1
    v_max_f32 v28, v28, v29
    v_ceil_f32 v28, v28
    v_max_f32 v28, 0, v28
    v_cvt_i32_f32 v29, v28
    v_sub_u32 v29, 0, v29
    v_ldexp_f32 v29, 1.0, v29
    v_accvgpr_read_b32 v30, a64
    v_mul_f32 v30, v30, v29
    v_accvgpr_write_b32 a64, v30
    v_accvgpr_read_b32 v30, a65
    v_mul_f32 v30, v30, v29
    v_accvgpr_write_b32 a65, v30
    v_accvgpr_read_b32 v30, a66
    v_mul_f32 v30, v30, v29
    v_accvgpr_write_b32 a66, v30
    v_accvgpr_read_b32 v30, a67
    v_mul_f32 v30, v30, v29
    v_accvgpr_write_b32 a67, v30
    v_accvgpr_read_b32 v30, a68
    v_mul_f32 v30, v30, v29
    v_accvgpr_write_b32 a68, v30
    v_accvgpr_read_b32 v30, a69
    v_mul_f32 v30, v30, v29
    v_accvgpr_write_b32 a69, v30
    v_accvgpr_read_b32 v30, a70
    v_mul_f32 v30, v30, v29
    v_accvgpr_write_b32 a70, v30
    v_accvgpr_read_b32 v30, a71
    v_mul_f32 v30, v30, v29
    v_accvgpr_write_b32 a71, v30
    v_accvgpr_read_b32 v30, a72
    v_mul_f32 v30, v30, v29
    v_accvgpr_write_b32 a72, v30
    v_accvgpr_read_b32 v30, a73
    v_mul_f32 v30, v30, v29
    v_accvgpr_write_b32 a73, v30
    v_accvgpr_read_b32 v30, a74
    v_mul_f32 v30, v30, v29
    v_accvgpr_write_b32 a74, v30
    v_accvgpr_read_b32 v30, a75
    v_mul_f32 v30, v30, v29
    v_accvgpr_write_b32 a75, v30
    v_accvgpr_read_b32 v30, a76
    v_mul_f32 v30, v30, v29
    v_accvgpr_write_b32 a76, v30
    v_accvgpr_read_b32 v30, a77
    v_mul_f32 v30, v30, v29
    v_accvgpr_write_b32 a77, v30
    v_accvgpr_read_b32 v30, a78
    v_mul_f32 v30, v30, v29
    v_accvgpr_write_b32 a78, v30
    v_accvgpr_read_b32 v30, a79
    v_mul_f32 v30, v30, v29
    v_accvgpr_write_b32 a79, v30
    v_accvgpr_read_b32 v30, a80
    v_mul_f32 v30, v30, v29
    v_accvgpr_write_b32 a80, v30
    v_accvgpr_read_b32 v30, a81
    v_mul_f32 v30, v30, v29
    v_accvgpr_write_b32 a81, v30
    v_accvgpr_read_b32 v30, a82
    v_mul_f32 v30, v30, v29
    v_accvgpr_write_b32 a82, v30
    v_accvgpr_read_b32 v30, a83
    v_mul_f32 v30, v30, v29
    v_accvgpr_write_b32 a83, v30
    v_accvgpr_read_b32 v30, a84
    v_mul_f32 v30, v30, v29
    v_accvgpr_write_b32 a84, v30
    v_accvgpr_read_b32 v30, a85
    v_mul_f32 v30, v30, v29
    v_accvgpr_write_b32 a85, v30
    v_accvgpr_read_b32 v30, a86
    v_mul_f32 v30, v30, v29
    v_accvgpr_write_b32 a86, v30
    v_accvgpr_read_b32 v30, a87
    v_mul_f32 v30, v30, v29
    v_accvgpr_write_b32 a87, v30
    v_accvgpr_read_b32 v30, a88
    v_mul_f32 v30, v30, v29
    v_accvgpr_write_b32 a88, v30
    v_accvgpr_read_b32 v30, a89
    v_mul_f32 v30, v30, v29
    v_accvgpr_write_b32 a89, v30
    v_accvgpr_read_b32 v30, a90
    v_mul_f32 v30, v30, v29
    v_accvgpr_write_b32 a90, v30
    v_accvgpr_read_b32 v30, a91
    v_mul_f32 v30, v30, v29
    v_accvgpr_write_b32 a91, v30
    v_accvgpr_read_b32 v30, a92
    v_mul_f32 v30, v30, v29
    v_accvgpr_write_b32 a92, v30
    v_accvgpr_read_b32 v30, a93
    v_mul_f32 v30, v30, v29
    v_accvgpr_write_b32 a93, v30
    v_accvgpr_read_b32 v30, a94
    v_mul_f32 v30, v30, v29
    v_accvgpr_write_b32 a94, v30
    v_accvgpr_read_b32 v30, a95
    v_mul_f32 v30, v30, v29
    v_accvgpr_write_b32 a95, v30
    v_accvgpr_read_b32 v30, a96
    v_mul_f32 v30, v30, v29
    v_accvgpr_write_b32 a96, v30
    v_accvgpr_read_b32 v30, a97
    v_mul_f32 v30, v30, v29
    v_accvgpr_write_b32 a97, v30
    v_accvgpr_read_b32 v30, a98
    v_mul_f32 v30, v30, v29
    v_accvgpr_write_b32 a98, v30
    v_accvgpr_read_b32 v30, a99
    v_mul_f32 v30, v30, v29
    v_accvgpr_write_b32 a99, v30
    v_accvgpr_read_b32 v30, a100
    v_mul_f32 v30, v30, v29
    v_accvgpr_write_b32 a100, v30
    v_accvgpr_read_b32 v30, a101
    v_mul_f32 v30, v30, v29
    v_accvgpr_write_b32 a101, v30
    v_accvgpr_read_b32 v30, a102
    v_mul_f32 v30, v30, v29
    v_accvgpr_write_b32 a102, v30
    v_accvgpr_read_b32 v30, a103
    v_mul_f32 v30, v30, v29
    v_accvgpr_write_b32 a103, v30
    v_accvgpr_read_b32 v30, a104
    v_mul_f32 v30, v30, v29
    v_accvgpr_write_b32 a104, v30
    v_accvgpr_read_b32 v30, a105
    v_mul_f32 v30, v30, v29
    v_accvgpr_write_b32 a105, v30
    v_accvgpr_read_b32 v30, a106
    v_mul_f32 v30, v30, v29
    v_accvgpr_write_b32 a106, v30
    v_accvgpr_read_b32 v30, a107
    v_mul_f32 v30, v30, v29
    v_accvgpr_write_b32 a107, v30
    v_accvgpr_read_b32 v30, a108
    v_mul_f32 v30, v30, v29
    v_accvgpr_write_b32 a108, v30
    v_accvgpr_read_b32 v30, a109
    v_mul_f32 v30, v30, v29
    v_accvgpr_write_b32 a109, v30
    v_accvgpr_read_b32 v30, a110
    v_mul_f32 v30, v30, v29
    v_accvgpr_write_b32 a110, v30
    v_accvgpr_read_b32 v30, a111
    v_mul_f32 v30, v30, v29
    v_accvgpr_write_b32 a111, v30
    v_accvgpr_read_b32 v30, a112
    v_mul_f32 v30, v30, v29
    v_accvgpr_write_b32 a112, v30
    v_accvgpr_read_b32 v30, a113
    v_mul_f32 v30, v30, v29
    v_accvgpr_write_b32 a113, v30
    v_accvgpr_read_b32 v30, a114
    v_mul_f32 v30, v30, v29
    v_accvgpr_write_b32 a114, v30
    v_accvgpr_read_b32 v30, a115
    v_mul_f32 v30, v30, v29
    v_accvgpr_write_b32 a115, v30
    v_accvgpr_read_b32 v30, a116
    v_mul_f32 v30, v30, v29
    v_accvgpr_write_b32 a116, v30
    v_accvgpr_read_b32 v30, a117
    v_mul_f32 v30, v30, v29
    v_accvgpr_write_b32 a117, v30
    v_accvgpr_read_b32 v30, a118
    v_mul_f32 v30, v30, v29
    v_accvgpr_write_b32 a118, v30
    v_accvgpr_read_b32 v30, a119
    v_mul_f32 v30, v30, v29
    v_accvgpr_write_b32 a119, v30
    v_accvgpr_read_b32 v30, a120
    v_mul_f32 v30, v30, v29
    v_accvgpr_write_b32 a120, v30
    v_accvgpr_read_b32 v30, a121
    v_mul_f32 v30, v30, v29
    v_accvgpr_write_b32 a121, v30
    v_accvgpr_read_b32 v30, a122
    v_mul_f32 v30, v30, v29
    v_accvgpr_write_b32 a122, v30
    v_accvgpr_read_b32 v30, a123
    v_mul_f32 v30, v30, v29
    v_accvgpr_write_b32 a123, v30
    v_accvgpr_read_b32 v30, a124
    v_mul_f32 v30, v30, v29
    v_accvgpr_write_b32 a124, v30
    v_accvgpr_read_b32 v30, a125
    v_mul_f32 v30, v30, v29
    v_accvgpr_write_b32 a125, v30
    v_accvgpr_read_b32 v30, a126
    v_mul_f32 v30, v30, v29
    v_accvgpr_write_b32 a126, v30
    v_accvgpr_read_b32 v30, a127
    v_mul_f32 v30, v30, v29
    v_accvgpr_write_b32 a127, v30
    v_mul_f32 v26, v26, v29
    v_sub_f32 v112, v112, v28
    v_sub_f32 v48, v48, v28
    v_sub_f32 v80, v80, v28
    v_sub_f32 v113, v113, v28
    v_sub_f32 v49, v49, v28
    v_sub_f32 v81, v81, v28
    v_sub_f32 v114, v114, v28
    v_sub_f32 v50, v50, v28
    v_sub_f32 v82, v82, v28
    v_sub_f32 v115, v115, v28
    v_sub_f32 v51, v51, v28
    v_sub_f32 v83, v83, v28
    v_sub_f32 v116, v116, v28
    v_sub_f32 v52, v52, v28
    v_sub_f32 v84, v84, v28
    v_sub_f32 v117, v117, v28
    v_sub_f32 v53, v53, v28
    v_sub_f32 v85, v85, v28
    v_sub_f32 v118, v118, v28
    v_sub_f32 v54, v54, v28
    v_sub_f32 v86, v86, v28
    v_sub_f32 v119, v119, v28
    v_sub_f32 v55, v55, v28
    v_sub_f32 v87, v87, v28
    v_sub_f32 v120, v120, v28
    v_sub_f32 v56, v56, v28
    v_sub_f32 v88, v88, v28
    v_sub_f32 v121, v121, v28
    v_sub_f32 v57, v57, v28
    v_sub_f32 v89, v89, v28
    v_sub_f32 v122, v122, v28
    v_sub_f32 v58, v58, v28
    v_sub_f32 v90, v90, v28
    v_sub_f32 v123, v123, v28
    v_sub_f32 v59, v59, v28
    v_sub_f32 v91, v91, v28
    v_sub_f32 v124, v124, v28
    v_sub_f32 v60, v60, v28
    v_sub_f32 v92, v92, v28
    v_sub_f32 v125, v125, v28
    v_sub_f32 v61, v61, v28
    v_sub_f32 v93, v93, v28
    v_sub_f32 v126, v126, v28
    v_sub_f32 v62, v62, v28
    v_sub_f32 v94, v94, v28
    v_sub_f32 v127, v127, v28
    v_sub_f32 v63, v63, v28
    v_sub_f32 v95, v95, v28
    v_exp_f32 v28, v48
    v_exp_f32 v29, v49
    v_exp_f32 v30, v50
    v_add_f32 v27, v28, v29
    v_exp_f32 v31, v51
    v_cvt_pk_bf16_f32 v136, v28, v29
    v_exp_f32 v28, v52
    v_add_f32 v27, v27, v30
    v_add_f32 v27, v27, v31
    v_exp_f32 v29, v53
    v_cvt_pk_bf16_f32 v137, v30, v31
    v_exp_f32 v30, v54
    v_add_f32 v27, v27, v28
    v_add_f32 v27, v27, v29
    v_exp_f32 v31, v55
    v_cvt_pk_bf16_f32 v138, v28, v29
    v_exp_f32 v28, v56
    v_add_f32 v27, v27, v30
    v_add_f32 v27, v27, v31
    v_exp_f32 v29, v57
    v_cvt_pk_bf16_f32 v139, v30, v31
    v_exp_f32 v30, v58
    v_add_f32 v27, v27, v28
    v_add_f32 v27, v27, v29
    v_exp_f32 v31, v59
    v_cvt_pk_bf16_f32 v140, v28, v29
    v_exp_f32 v28, v60
    v_add_f32 v27, v27, v30
    v_add_f32 v27, v27, v31
    v_exp_f32 v29, v61
    v_cvt_pk_bf16_f32 v141, v30, v31
    v_exp_f32 v30, v62
    v_add_f32 v27, v27, v28
    v_add_f32 v27, v27, v29
    v_exp_f32 v31, v63
    v_cvt_pk_bf16_f32 v142, v28, v29
    v_add_f32 v27, v27, v30
    v_add_f32 v27, v27, v31
    v_cvt_pk_bf16_f32 v143, v30, v31
    s_nop 1
    s_branch attn_kernel_ret_6_1
attn_kernel_slow_7_0:
    s_nop 15
    s_nop 15
    v_max3_f32 v28, v64, v65, v66
    v_max3_f32 v28, v28, v67, v68
    v_max3_f32 v28, v28, v69, v70
    v_max3_f32 v28, v28, v71, v72
    v_max3_f32 v28, v28, v73, v74
    v_max3_f32 v28, v28, v75, v76
    v_max3_f32 v28, v28, v77, v78
    v_max_f32 v28, v28, v79
    v_mov_b32 v29, v28
    s_nop 1
    v_permlane32_swap_b32 v29, v28
    s_nop 1
    v_max_f32 v28, v28, v29
    v_ceil_f32 v28, v28
    v_max_f32 v28, 0, v28
    v_cvt_i32_f32 v29, v28
    v_sub_u32 v29, 0, v29
    v_ldexp_f32 v29, 1.0, v29
    v_accvgpr_read_b32 v30, a0
    v_mul_f32 v30, v30, v29
    v_accvgpr_write_b32 a0, v30
    v_accvgpr_read_b32 v30, a1
    v_mul_f32 v30, v30, v29
    v_accvgpr_write_b32 a1, v30
    v_accvgpr_read_b32 v30, a2
    v_mul_f32 v30, v30, v29
    v_accvgpr_write_b32 a2, v30
    v_accvgpr_read_b32 v30, a3
    v_mul_f32 v30, v30, v29
    v_accvgpr_write_b32 a3, v30
    v_accvgpr_read_b32 v30, a4
    v_mul_f32 v30, v30, v29
    v_accvgpr_write_b32 a4, v30
    v_accvgpr_read_b32 v30, a5
    v_mul_f32 v30, v30, v29
    v_accvgpr_write_b32 a5, v30
    v_accvgpr_read_b32 v30, a6
    v_mul_f32 v30, v30, v29
    v_accvgpr_write_b32 a6, v30
    v_accvgpr_read_b32 v30, a7
    v_mul_f32 v30, v30, v29
    v_accvgpr_write_b32 a7, v30
    v_accvgpr_read_b32 v30, a8
    v_mul_f32 v30, v30, v29
    v_accvgpr_write_b32 a8, v30
    v_accvgpr_read_b32 v30, a9
    v_mul_f32 v30, v30, v29
    v_accvgpr_write_b32 a9, v30
    v_accvgpr_read_b32 v30, a10
    v_mul_f32 v30, v30, v29
    v_accvgpr_write_b32 a10, v30
    v_accvgpr_read_b32 v30, a11
    v_mul_f32 v30, v30, v29
    v_accvgpr_write_b32 a11, v30
    v_accvgpr_read_b32 v30, a12
    v_mul_f32 v30, v30, v29
    v_accvgpr_write_b32 a12, v30
    v_accvgpr_read_b32 v30, a13
    v_mul_f32 v30, v30, v29
    v_accvgpr_write_b32 a13, v30
    v_accvgpr_read_b32 v30, a14
    v_mul_f32 v30, v30, v29
    v_accvgpr_write_b32 a14, v30
    v_accvgpr_read_b32 v30, a15
    v_mul_f32 v30, v30, v29
    v_accvgpr_write_b32 a15, v30
    v_accvgpr_read_b32 v30, a16
    v_mul_f32 v30, v30, v29
    v_accvgpr_write_b32 a16, v30
    v_accvgpr_read_b32 v30, a17
    v_mul_f32 v30, v30, v29
    v_accvgpr_write_b32 a17, v30
    v_accvgpr_read_b32 v30, a18
    v_mul_f32 v30, v30, v29
    v_accvgpr_write_b32 a18, v30
    v_accvgpr_read_b32 v30, a19
    v_mul_f32 v30, v30, v29
    v_accvgpr_write_b32 a19, v30
    v_accvgpr_read_b32 v30, a20
    v_mul_f32 v30, v30, v29
    v_accvgpr_write_b32 a20, v30
    v_accvgpr_read_b32 v30, a21
    v_mul_f32 v30, v30, v29
    v_accvgpr_write_b32 a21, v30
    v_accvgpr_read_b32 v30, a22
    v_mul_f32 v30, v30, v29
    v_accvgpr_write_b32 a22, v30
    v_accvgpr_read_b32 v30, a23
    v_mul_f32 v30, v30, v29
    v_accvgpr_write_b32 a23, v30
    v_accvgpr_read_b32 v30, a24
    v_mul_f32 v30, v30, v29
    v_accvgpr_write_b32 a24, v30
    v_accvgpr_read_b32 v30, a25
    v_mul_f32 v30, v30, v29
    v_accvgpr_write_b32 a25, v30
    v_accvgpr_read_b32 v30, a26
    v_mul_f32 v30, v30, v29
    v_accvgpr_write_b32 a26, v30
    v_accvgpr_read_b32 v30, a27
    v_mul_f32 v30, v30, v29
    v_accvgpr_write_b32 a27, v30
    v_accvgpr_read_b32 v30, a28
    v_mul_f32 v30, v30, v29
    v_accvgpr_write_b32 a28, v30
    v_accvgpr_read_b32 v30, a29
    v_mul_f32 v30, v30, v29
    v_accvgpr_write_b32 a29, v30
    v_accvgpr_read_b32 v30, a30
    v_mul_f32 v30, v30, v29
    v_accvgpr_write_b32 a30, v30
    v_accvgpr_read_b32 v30, a31
    v_mul_f32 v30, v30, v29
    v_accvgpr_write_b32 a31, v30
    v_accvgpr_read_b32 v30, a32
    v_mul_f32 v30, v30, v29
    v_accvgpr_write_b32 a32, v30
    v_accvgpr_read_b32 v30, a33
    v_mul_f32 v30, v30, v29
    v_accvgpr_write_b32 a33, v30
    v_accvgpr_read_b32 v30, a34
    v_mul_f32 v30, v30, v29
    v_accvgpr_write_b32 a34, v30
    v_accvgpr_read_b32 v30, a35
    v_mul_f32 v30, v30, v29
    v_accvgpr_write_b32 a35, v30
    v_accvgpr_read_b32 v30, a36
    v_mul_f32 v30, v30, v29
    v_accvgpr_write_b32 a36, v30
    v_accvgpr_read_b32 v30, a37
    v_mul_f32 v30, v30, v29
    v_accvgpr_write_b32 a37, v30
    v_accvgpr_read_b32 v30, a38
    v_mul_f32 v30, v30, v29
    v_accvgpr_write_b32 a38, v30
    v_accvgpr_read_b32 v30, a39
    v_mul_f32 v30, v30, v29
    v_accvgpr_write_b32 a39, v30
    v_accvgpr_read_b32 v30, a40
    v_mul_f32 v30, v30, v29
    v_accvgpr_write_b32 a40, v30
    v_accvgpr_read_b32 v30, a41
    v_mul_f32 v30, v30, v29
    v_accvgpr_write_b32 a41, v30
    v_accvgpr_read_b32 v30, a42
    v_mul_f32 v30, v30, v29
    v_accvgpr_write_b32 a42, v30
    v_accvgpr_read_b32 v30, a43
    v_mul_f32 v30, v30, v29
    v_accvgpr_write_b32 a43, v30
    v_accvgpr_read_b32 v30, a44
    v_mul_f32 v30, v30, v29
    v_accvgpr_write_b32 a44, v30
    v_accvgpr_read_b32 v30, a45
    v_mul_f32 v30, v30, v29
    v_accvgpr_write_b32 a45, v30
    v_accvgpr_read_b32 v30, a46
    v_mul_f32 v30, v30, v29
    v_accvgpr_write_b32 a46, v30
    v_accvgpr_read_b32 v30, a47
    v_mul_f32 v30, v30, v29
    v_accvgpr_write_b32 a47, v30
    v_accvgpr_read_b32 v30, a48
    v_mul_f32 v30, v30, v29
    v_accvgpr_write_b32 a48, v30
    v_accvgpr_read_b32 v30, a49
    v_mul_f32 v30, v30, v29
    v_accvgpr_write_b32 a49, v30
    v_accvgpr_read_b32 v30, a50
    v_mul_f32 v30, v30, v29
    v_accvgpr_write_b32 a50, v30
    v_accvgpr_read_b32 v30, a51
    v_mul_f32 v30, v30, v29
    v_accvgpr_write_b32 a51, v30
    v_accvgpr_read_b32 v30, a52
    v_mul_f32 v30, v30, v29
    v_accvgpr_write_b32 a52, v30
    v_accvgpr_read_b32 v30, a53
    v_mul_f32 v30, v30, v29
    v_accvgpr_write_b32 a53, v30
    v_accvgpr_read_b32 v30, a54
    v_mul_f32 v30, v30, v29
    v_accvgpr_write_b32 a54, v30
    v_accvgpr_read_b32 v30, a55
    v_mul_f32 v30, v30, v29
    v_accvgpr_write_b32 a55, v30
    v_accvgpr_read_b32 v30, a56
    v_mul_f32 v30, v30, v29
    v_accvgpr_write_b32 a56, v30
    v_accvgpr_read_b32 v30, a57
    v_mul_f32 v30, v30, v29
    v_accvgpr_write_b32 a57, v30
    v_accvgpr_read_b32 v30, a58
    v_mul_f32 v30, v30, v29
    v_accvgpr_write_b32 a58, v30
    v_accvgpr_read_b32 v30, a59
    v_mul_f32 v30, v30, v29
    v_accvgpr_write_b32 a59, v30
    v_accvgpr_read_b32 v30, a60
    v_mul_f32 v30, v30, v29
    v_accvgpr_write_b32 a60, v30
    v_accvgpr_read_b32 v30, a61
    v_mul_f32 v30, v30, v29
    v_accvgpr_write_b32 a61, v30
    v_accvgpr_read_b32 v30, a62
    v_mul_f32 v30, v30, v29
    v_accvgpr_write_b32 a62, v30
    v_accvgpr_read_b32 v30, a63
    v_mul_f32 v30, v30, v29
    v_accvgpr_write_b32 a63, v30
    v_mul_f32 v25, v25, v29
    v_sub_f32 v96, v96, v28
    v_sub_f32 v64, v64, v28
    v_sub_f32 v32, v32, v28
    v_sub_f32 v97, v97, v28
    v_sub_f32 v65, v65, v28
    v_sub_f32 v33, v33, v28
    v_sub_f32 v98, v98, v28
    v_sub_f32 v66, v66, v28
    v_sub_f32 v34, v34, v28
    v_sub_f32 v99, v99, v28
    v_sub_f32 v67, v67, v28
    v_sub_f32 v35, v35, v28
    v_sub_f32 v100, v100, v28
    v_sub_f32 v68, v68, v28
    v_sub_f32 v36, v36, v28
    v_sub_f32 v101, v101, v28
    v_sub_f32 v69, v69, v28
    v_sub_f32 v37, v37, v28
    v_sub_f32 v102, v102, v28
    v_sub_f32 v70, v70, v28
    v_sub_f32 v38, v38, v28
    v_sub_f32 v103, v103, v28
    v_sub_f32 v71, v71, v28
    v_sub_f32 v39, v39, v28
    v_sub_f32 v104, v104, v28
    v_sub_f32 v72, v72, v28
    v_sub_f32 v40, v40, v28
    v_sub_f32 v105, v105, v28
    v_sub_f32 v73, v73, v28
    v_sub_f32 v41, v41, v28
    v_sub_f32 v106, v106, v28
    v_sub_f32 v74, v74, v28
    v_sub_f32 v42, v42, v28
    v_sub_f32 v107, v107, v28
    v_sub_f32 v75, v75, v28
    v_sub_f32 v43, v43, v28
    v_sub_f32 v108, v108, v28
    v_sub_f32 v76, v76, v28
    v_sub_f32 v44, v44, v28
    v_sub_f32 v109, v109, v28
    v_sub_f32 v77, v77, v28
    v_sub_f32 v45, v45, v28
    v_sub_f32 v110, v110, v28
    v_sub_f32 v78, v78, v28
    v_sub_f32 v46, v46, v28
    v_sub_f32 v111, v111, v28
    v_sub_f32 v79, v79, v28
    v_sub_f32 v47, v47, v28
    v_exp_f32 v28, v64
    v_exp_f32 v29, v65
    v_exp_f32 v30, v66
    v_add_f32 v27, v28, v29
    v_exp_f32 v31, v67
    v_cvt_pk_bf16_f32 v144, v28, v29
    v_exp_f32 v28, v68
    v_add_f32 v27, v27, v30
    v_add_f32 v27, v27, v31
    v_exp_f32 v29, v69
    v_cvt_pk_bf16_f32 v145, v30, v31
    v_exp_f32 v30, v70
    v_add_f32 v27, v27, v28
    v_add_f32 v27, v27, v29
    v_exp_f32 v31, v71
    v_cvt_pk_bf16_f32 v146, v28, v29
    v_exp_f32 v28, v72
    v_add_f32 v27, v27, v30
    v_add_f32 v27, v27, v31
    v_exp_f32 v29, v73
    v_cvt_pk_bf16_f32 v147, v30, v31
    v_exp_f32 v30, v74
    v_add_f32 v27, v27, v28
    v_add_f32 v27, v27, v29
    v_exp_f32 v31, v75
    v_cvt_pk_bf16_f32 v148, v28, v29
    v_exp_f32 v28, v76
    v_add_f32 v27, v27, v30
    v_add_f32 v27, v27, v31
    v_exp_f32 v29, v77
    v_cvt_pk_bf16_f32 v149, v30, v31
    v_exp_f32 v30, v78
    v_add_f32 v27, v27, v28
    v_add_f32 v27, v27, v29
    v_exp_f32 v31, v79
    v_cvt_pk_bf16_f32 v150, v28, v29
    v_add_f32 v27, v27, v30
    v_add_f32 v27, v27, v31
    v_cvt_pk_bf16_f32 v151, v30, v31
    s_nop 1
    s_branch attn_kernel_ret_7_0
attn_kernel_slow_7_1:
    s_nop 15
    s_nop 15
    v_max3_f32 v28, v80, v81, v82
    v_max3_f32 v28, v28, v83, v84
    v_max3_f32 v28, v28, v85, v86
    v_max3_f32 v28, v28, v87, v88
    v_max3_f32 v28, v28, v89, v90
    v_max3_f32 v28, v28, v91, v92
    v_max3_f32 v28, v28, v93, v94
    v_max_f32 v28, v28, v95
    v_mov_b32 v29, v28
    s_nop 1
    v_permlane32_swap_b32 v29, v28
    s_nop 1
    v_max_f32 v28, v28, v29
    v_ceil_f32 v28, v28
    v_max_f32 v28, 0, v28
    v_cvt_i32_f32 v29, v28
    v_sub_u32 v29, 0, v29
    v_ldexp_f32 v29, 1.0, v29
    v_accvgpr_read_b32 v30, a64
    v_mul_f32 v30, v30, v29
    v_accvgpr_write_b32 a64, v30
    v_accvgpr_read_b32 v30, a65
    v_mul_f32 v30, v30, v29
    v_accvgpr_write_b32 a65, v30
    v_accvgpr_read_b32 v30, a66
    v_mul_f32 v30, v30, v29
    v_accvgpr_write_b32 a66, v30
    v_accvgpr_read_b32 v30, a67
    v_mul_f32 v30, v30, v29
    v_accvgpr_write_b32 a67, v30
    v_accvgpr_read_b32 v30, a68
    v_mul_f32 v30, v30, v29
    v_accvgpr_write_b32 a68, v30
    v_accvgpr_read_b32 v30, a69
    v_mul_f32 v30, v30, v29
    v_accvgpr_write_b32 a69, v30
    v_accvgpr_read_b32 v30, a70
    v_mul_f32 v30, v30, v29
    v_accvgpr_write_b32 a70, v30
    v_accvgpr_read_b32 v30, a71
    v_mul_f32 v30, v30, v29
    v_accvgpr_write_b32 a71, v30
    v_accvgpr_read_b32 v30, a72
    v_mul_f32 v30, v30, v29
    v_accvgpr_write_b32 a72, v30
    v_accvgpr_read_b32 v30, a73
    v_mul_f32 v30, v30, v29
    v_accvgpr_write_b32 a73, v30
    v_accvgpr_read_b32 v30, a74
    v_mul_f32 v30, v30, v29
    v_accvgpr_write_b32 a74, v30
    v_accvgpr_read_b32 v30, a75
    v_mul_f32 v30, v30, v29
    v_accvgpr_write_b32 a75, v30
    v_accvgpr_read_b32 v30, a76
    v_mul_f32 v30, v30, v29
    v_accvgpr_write_b32 a76, v30
    v_accvgpr_read_b32 v30, a77
    v_mul_f32 v30, v30, v29
    v_accvgpr_write_b32 a77, v30
    v_accvgpr_read_b32 v30, a78
    v_mul_f32 v30, v30, v29
    v_accvgpr_write_b32 a78, v30
    v_accvgpr_read_b32 v30, a79
    v_mul_f32 v30, v30, v29
    v_accvgpr_write_b32 a79, v30
    v_accvgpr_read_b32 v30, a80
    v_mul_f32 v30, v30, v29
    v_accvgpr_write_b32 a80, v30
    v_accvgpr_read_b32 v30, a81
    v_mul_f32 v30, v30, v29
    v_accvgpr_write_b32 a81, v30
    v_accvgpr_read_b32 v30, a82
    v_mul_f32 v30, v30, v29
    v_accvgpr_write_b32 a82, v30
    v_accvgpr_read_b32 v30, a83
    v_mul_f32 v30, v30, v29
    v_accvgpr_write_b32 a83, v30
    v_accvgpr_read_b32 v30, a84
    v_mul_f32 v30, v30, v29
    v_accvgpr_write_b32 a84, v30
    v_accvgpr_read_b32 v30, a85
    v_mul_f32 v30, v30, v29
    v_accvgpr_write_b32 a85, v30
    v_accvgpr_read_b32 v30, a86
    v_mul_f32 v30, v30, v29
    v_accvgpr_write_b32 a86, v30
    v_accvgpr_read_b32 v30, a87
    v_mul_f32 v30, v30, v29
    v_accvgpr_write_b32 a87, v30
    v_accvgpr_read_b32 v30, a88
    v_mul_f32 v30, v30, v29
    v_accvgpr_write_b32 a88, v30
    v_accvgpr_read_b32 v30, a89
    v_mul_f32 v30, v30, v29
    v_accvgpr_write_b32 a89, v30
    v_accvgpr_read_b32 v30, a90
    v_mul_f32 v30, v30, v29
    v_accvgpr_write_b32 a90, v30
    v_accvgpr_read_b32 v30, a91
    v_mul_f32 v30, v30, v29
    v_accvgpr_write_b32 a91, v30
    v_accvgpr_read_b32 v30, a92
    v_mul_f32 v30, v30, v29
    v_accvgpr_write_b32 a92, v30
    v_accvgpr_read_b32 v30, a93
    v_mul_f32 v30, v30, v29
    v_accvgpr_write_b32 a93, v30
    v_accvgpr_read_b32 v30, a94
    v_mul_f32 v30, v30, v29
    v_accvgpr_write_b32 a94, v30
    v_accvgpr_read_b32 v30, a95
    v_mul_f32 v30, v30, v29
    v_accvgpr_write_b32 a95, v30
    v_accvgpr_read_b32 v30, a96
    v_mul_f32 v30, v30, v29
    v_accvgpr_write_b32 a96, v30
    v_accvgpr_read_b32 v30, a97
    v_mul_f32 v30, v30, v29
    v_accvgpr_write_b32 a97, v30
    v_accvgpr_read_b32 v30, a98
    v_mul_f32 v30, v30, v29
    v_accvgpr_write_b32 a98, v30
    v_accvgpr_read_b32 v30, a99
    v_mul_f32 v30, v30, v29
    v_accvgpr_write_b32 a99, v30
    v_accvgpr_read_b32 v30, a100
    v_mul_f32 v30, v30, v29
    v_accvgpr_write_b32 a100, v30
    v_accvgpr_read_b32 v30, a101
    v_mul_f32 v30, v30, v29
    v_accvgpr_write_b32 a101, v30
    v_accvgpr_read_b32 v30, a102
    v_mul_f32 v30, v30, v29
    v_accvgpr_write_b32 a102, v30
    v_accvgpr_read_b32 v30, a103
    v_mul_f32 v30, v30, v29
    v_accvgpr_write_b32 a103, v30
    v_accvgpr_read_b32 v30, a104
    v_mul_f32 v30, v30, v29
    v_accvgpr_write_b32 a104, v30
    v_accvgpr_read_b32 v30, a105
    v_mul_f32 v30, v30, v29
    v_accvgpr_write_b32 a105, v30
    v_accvgpr_read_b32 v30, a106
    v_mul_f32 v30, v30, v29
    v_accvgpr_write_b32 a106, v30
    v_accvgpr_read_b32 v30, a107
    v_mul_f32 v30, v30, v29
    v_accvgpr_write_b32 a107, v30
    v_accvgpr_read_b32 v30, a108
    v_mul_f32 v30, v30, v29
    v_accvgpr_write_b32 a108, v30
    v_accvgpr_read_b32 v30, a109
    v_mul_f32 v30, v30, v29
    v_accvgpr_write_b32 a109, v30
    v_accvgpr_read_b32 v30, a110
    v_mul_f32 v30, v30, v29
    v_accvgpr_write_b32 a110, v30
    v_accvgpr_read_b32 v30, a111
    v_mul_f32 v30, v30, v29
    v_accvgpr_write_b32 a111, v30
    v_accvgpr_read_b32 v30, a112
    v_mul_f32 v30, v30, v29
    v_accvgpr_write_b32 a112, v30
    v_accvgpr_read_b32 v30, a113
    v_mul_f32 v30, v30, v29
    v_accvgpr_write_b32 a113, v30
    v_accvgpr_read_b32 v30, a114
    v_mul_f32 v30, v30, v29
    v_accvgpr_write_b32 a114, v30
    v_accvgpr_read_b32 v30, a115
    v_mul_f32 v30, v30, v29
    v_accvgpr_write_b32 a115, v30
    v_accvgpr_read_b32 v30, a116
    v_mul_f32 v30, v30, v29
    v_accvgpr_write_b32 a116, v30
    v_accvgpr_read_b32 v30, a117
    v_mul_f32 v30, v30, v29
    v_accvgpr_write_b32 a117, v30
    v_accvgpr_read_b32 v30, a118
    v_mul_f32 v30, v30, v29
    v_accvgpr_write_b32 a118, v30
    v_accvgpr_read_b32 v30, a119
    v_mul_f32 v30, v30, v29
    v_accvgpr_write_b32 a119, v30
    v_accvgpr_read_b32 v30, a120
    v_mul_f32 v30, v30, v29
    v_accvgpr_write_b32 a120, v30
    v_accvgpr_read_b32 v30, a121
    v_mul_f32 v30, v30, v29
    v_accvgpr_write_b32 a121, v30
    v_accvgpr_read_b32 v30, a122
    v_mul_f32 v30, v30, v29
    v_accvgpr_write_b32 a122, v30
    v_accvgpr_read_b32 v30, a123
    v_mul_f32 v30, v30, v29
    v_accvgpr_write_b32 a123, v30
    v_accvgpr_read_b32 v30, a124
    v_mul_f32 v30, v30, v29
    v_accvgpr_write_b32 a124, v30
    v_accvgpr_read_b32 v30, a125
    v_mul_f32 v30, v30, v29
    v_accvgpr_write_b32 a125, v30
    v_accvgpr_read_b32 v30, a126
    v_mul_f32 v30, v30, v29
    v_accvgpr_write_b32 a126, v30
    v_accvgpr_read_b32 v30, a127
    v_mul_f32 v30, v30, v29
    v_accvgpr_write_b32 a127, v30
    v_mul_f32 v26, v26, v29
    v_sub_f32 v112, v112, v28
    v_sub_f32 v80, v80, v28
    v_sub_f32 v48, v48, v28
    v_sub_f32 v113, v113, v28
    v_sub_f32 v81, v81, v28
    v_sub_f32 v49, v49, v28
    v_sub_f32 v114, v114, v28
    v_sub_f32 v82, v82, v28
    v_sub_f32 v50, v50, v28
    v_sub_f32 v115, v115, v28
    v_sub_f32 v83, v83, v28
    v_sub_f32 v51, v51, v28
    v_sub_f32 v116, v116, v28
    v_sub_f32 v84, v84, v28
    v_sub_f32 v52, v52, v28
    v_sub_f32 v117, v117, v28
    v_sub_f32 v85, v85, v28
    v_sub_f32 v53, v53, v28
    v_sub_f32 v118, v118, v28
    v_sub_f32 v86, v86, v28
    v_sub_f32 v54, v54, v28
    v_sub_f32 v119, v119, v28
    v_sub_f32 v87, v87, v28
    v_sub_f32 v55, v55, v28
    v_sub_f32 v120, v120, v28
    v_sub_f32 v88, v88, v28
    v_sub_f32 v56, v56, v28
    v_sub_f32 v121, v121, v28
    v_sub_f32 v89, v89, v28
    v_sub_f32 v57, v57, v28
    v_sub_f32 v122, v122, v28
    v_sub_f32 v90, v90, v28
    v_sub_f32 v58, v58, v28
    v_sub_f32 v123, v123, v28
    v_sub_f32 v91, v91, v28
    v_sub_f32 v59, v59, v28
    v_sub_f32 v124, v124, v28
    v_sub_f32 v92, v92, v28
    v_sub_f32 v60, v60, v28
    v_sub_f32 v125, v125, v28
    v_sub_f32 v93, v93, v28
    v_sub_f32 v61, v61, v28
    v_sub_f32 v126, v126, v28
    v_sub_f32 v94, v94, v28
    v_sub_f32 v62, v62, v28
    v_sub_f32 v127, v127, v28
    v_sub_f32 v95, v95, v28
    v_sub_f32 v63, v63, v28
    v_exp_f32 v28, v80
    v_exp_f32 v29, v81
    v_exp_f32 v30, v82
    v_add_f32 v27, v28, v29
    v_exp_f32 v31, v83
    v_cvt_pk_bf16_f32 v152, v28, v29
    v_exp_f32 v28, v84
    v_add_f32 v27, v27, v30
    v_add_f32 v27, v27, v31
    v_exp_f32 v29, v85
    v_cvt_pk_bf16_f32 v153, v30, v31
    v_exp_f32 v30, v86
    v_add_f32 v27, v27, v28
    v_add_f32 v27, v27, v29
    v_exp_f32 v31, v87
    v_cvt_pk_bf16_f32 v154, v28, v29
    v_exp_f32 v28, v88
    v_add_f32 v27, v27, v30
    v_add_f32 v27, v27, v31
    v_exp_f32 v29, v89
    v_cvt_pk_bf16_f32 v155, v30, v31
    v_exp_f32 v30, v90
    v_add_f32 v27, v27, v28
    v_add_f32 v27, v27, v29
    v_exp_f32 v31, v91
    v_cvt_pk_bf16_f32 v156, v28, v29
    v_exp_f32 v28, v92
    v_add_f32 v27, v27, v30
    v_add_f32 v27, v27, v31
    v_exp_f32 v29, v93
    v_cvt_pk_bf16_f32 v157, v30, v31
    v_exp_f32 v30, v94
    v_add_f32 v27, v27, v28
    v_add_f32 v27, v27, v29
    v_exp_f32 v31, v95
    v_cvt_pk_bf16_f32 v158, v28, v29
    v_add_f32 v27, v27, v30
    v_add_f32 v27, v27, v31
    v_cvt_pk_bf16_f32 v159, v30, v31
    s_nop 1
    s_branch attn_kernel_ret_7_1
.globl spwo_kernel
.p2align 8
.type spwo_kernel,@function
spwo_kernel:
    s_cmp_ge_u32 s2, 248
    s_cbranch_scc1 spwo_kernel_done
    s_lshr_b32 s40, s2, 3
    s_and_b32 s41, s2, 7
    s_cmp_lt_u32 s40, 15
    s_cbranch_scc1 spwo_kernel_wo
    s_sub_u32 s40, s40, 15
    s_and_b32 s42, s41, 1
    s_lshl_b32 s43, s42, 2
    s_sub_u32 s44, 16, s43
    s_cmp_ge_u32 s40, s44
    s_cbranch_scc1 spwo_kernel_done
    s_load_dwordx2 s[4:5], s[0:1], 56
    s_load_dwordx2 s[8:9], s[0:1], 96
    s_load_dwordx2 s[12:13], s[0:1], 96
    s_load_dwordx2 s[16:17], s[0:1], 96
    s_load_dwordx2 s[20:21], s[0:1], 64
    v_lshrrev_b32 v1, 6, v0
    v_and_b32 v2, 63, v0
    s_nop 0
    v_readfirstlane_b32 s24, v1
    s_waitcnt lgkmcnt(0)
    s_mov_b32 s6, 8388608
    s_mov_b32 s7, 0x20000
    s_add_u32 s8, s8, 12582912
    s_addc_u32 s9, s9, 0
    s_mov_b32 s10, 3538944
    s_mov_b32 s11, 0x20000
    s_add_u32 s12, s12, 16777216
    s_addc_u32 s13, s13, 0
    s_mov_b32 s14, 3538944
    s_mov_b32 s15, 0x20000
    s_add_u32 s16, s16, 4194304
    s_addc_u32 s17, s17, 0
    s_mov_b32 s18, 7077888
    s_mov_b32 s19, 0x20000
    s_mov_b32 s22, 4096
    s_mov_b32 s23, 0x20000
    s_lshr_b32 s29, s41, 1
    s_lshl_b32 s29, s29, 2
    s_and_b32 s31, s40, 3
    s_add_u32 s29, s29, s31
    s_lshl_b32 s29, s29, 7
    s_lshr_b32 s30, s40, 2
    s_add_u32 s30, s30, s43
    s_lshl_b32 s30, s30, 7
    s_mov_b32 s37, 0
    s_and_b32 s33, s24, 1
    s_lshr_b32 s32, s24, 1
    s_lshr_b32 s38, s29, 5
    s_mul_i32 s31, s32, 2
    s_add_u32 s38, s38, s31
    v_lshrrev_b32 v3, 3, v2
    v_and_b32 v4, 7, v2
    s_mul_i32 s31, s24, 32
    v_add_u32 v3, s31, v3
    s_mov_b32 s34, 4096
    v_add_u32 v5, 0, v3
    v_bfe_u32 v6, v5, 1, 3
    v_xor_b32 v6, v6, v4
    v_add_u32 v5, s29, v5
    v_mul_lo_u32 v5, v5, s34
    v_lshl_add_u32 v5, v6, 4, v5
    v_mov_b32 v16, v5
    v_add_u32 v5, 8, v3
    v_bfe_u32 v6, v5, 1, 3
    v_xor_b32 v6, v6, v4
    v_add_u32 v5, s29, v5
    v_mul_lo_u32 v5, v5, s34
    v_lshl_add_u32 v5, v6, 4, v5
    v_subrev_u32 v5, 1024, v5
    v_mov_b32 v17, v5
    v_add_u32 v5, 16, v3
    v_bfe_u32 v6, v5, 1, 3
    v_xor_b32 v6, v6, v4
    v_add_u32 v5, s29, v5
    v_mul_lo_u32 v5, v5, s34
    v_lshl_add_u32 v5, v6, 4, v5
    v_subrev_u32 v5, 2048, v5
    v_mov_b32 v18, v5
    v_add_u32 v5, 24, v3
    v_bfe_u32 v6, v5, 1, 3
    v_xor_b32 v6, v6, v4
    v_add_u32 v5, s29, v5
    v_mul_lo_u32 v5, v5, s34
    v_lshl_add_u32 v5, v6, 4, v5
    v_subrev_u32 v5, 3072, v5
    v_mov_b32 v19, v5
    s_lshl_b32 s26, s37, 7
    v_lshrrev_b32 v3, 4, v2
    v_and_b32 v4, 15, v2
    s_mul_i32 s31, s24, 16
    v_add_u32 v3, s31, v3
    s_mov_b32 s34, 1728
    s_lshl_b32 s35, s30, 1
    v_add_u32 v5, 0, v3
    v_and_b32 v6, 3, v5
    v_lshlrev_b32 v6, 2, v6
    v_xor_b32 v6, v6, v4
    v_mul_lo_u32 v5, v5, s34
    v_lshl_add_u32 v5, v6, 4, v5
    v_add_u32 v5, s35, v5
    v_mov_b32 v20, v5
    v_add_u32 v5, 4, v3
    v_and_b32 v6, 3, v5
    v_lshlrev_b32 v6, 2, v6
    v_xor_b32 v6, v6, v4
    v_mul_lo_u32 v5, v5, s34
    v_lshl_add_u32 v5, v6, 4, v5
    v_add_u32 v5, s35, v5
    v_subrev_u32 v5, 1024, v5
    v_mov_b32 v21, v5
    v_add_u32 v5, 8, v3
    v_and_b32 v6, 3, v5
    v_lshlrev_b32 v6, 2, v6
    v_xor_b32 v6, v6, v4
    v_mul_lo_u32 v5, v5, s34
    v_lshl_add_u32 v5, v6, 4, v5
    v_add_u32 v5, s35, v5
    v_subrev_u32 v5, 2048, v5
    v_mov_b32 v22, v5
    v_add_u32 v5, 12, v3
    v_and_b32 v6, 3, v5
    v_lshlrev_b32 v6, 2, v6
    v_xor_b32 v6, v6, v4
    v_mul_lo_u32 v5, v5, s34
    v_lshl_add_u32 v5, v6, 4, v5
    v_add_u32 v5, s35, v5
    v_subrev_u32 v5, 3072, v5
    v_mov_b32 v23, v5
    s_mul_i32 s25, s24, 4096
    s_mul_i32 s36, s24, 4096
    s_mul_i32 s27, s37, 110592
    s_add_u32 m0, s25, 0
    s_nop 0
    buffer_load_dwordx4 v16, s[4:7], s26 offen offset:0 lds
    buffer_load_dwordx4 v17, s[4:7], s26 offen offset:1024 lds
    buffer_load_dwordx4 v18, s[4:7], s26 offen offset:2048 lds
    buffer_load_dwordx4 v19, s[4:7], s26 offen offset:3072 lds
    s_add_u32 m0, s36, 65536
    s_add_u32 s26, s26, 128
    buffer_load_dwordx4 v20, s[8:11], s27 offen offset:0 lds
    buffer_load_dwordx4 v21, s[8:11], s27 offen offset:1024 lds
    buffer_load_dwordx4 v22, s[8:11], s27 offen offset:2048 lds
    buffer_load_dwordx4 v23, s[8:11], s27 offen offset:3072 lds
    s_add_u32 s27, s27, 110592
    v_and_b32 v3, 31, v2
    v_lshrrev_b32 v4, 5, v2
    v_bfe_u32 v5, v3, 1, 3
    s_mul_i32 s31, s32, 8192
    v_add_u32 v6, 0, v4
    v_xor_b32 v6, v6, v5
    v_lshlrev_b32 v6, 4, v6
    v_lshl_add_u32 v6, v3, 7, v6
    v_add_u32 v8, s31, v6
    v_add_u32 v6, 2, v4
    v_xor_b32 v6, v6, v5
    v_lshlrev_b32 v6, 4, v6
    v_lshl_add_u32 v6, v3, 7, v6
    v_add_u32 v9, s31, v6
    v_add_u32 v6, 4, v4
    v_xor_b32 v6, v6, v5
    v_lshlrev_b32 v6, 4, v6
    v_lshl_add_u32 v6, v3, 7, v6
    v_add_u32 v10, s31, v6
    v_add_u32 v6, 6, v4
    v_xor_b32 v6, v6, v5
    v_lshlrev_b32 v6, 4, v6
    v_lshl_add_u32 v6, v3, 7, v6
    v_add_u32 v11, s31, v6
    v_bfe_u32 v5, v2, 2, 2
    v_lshl_add_u32 v6, v4, 3, v5
    v_mul_u32_u24 v6, 256, v6
    v_and_b32 v7, 3, v2
    v_lshl_add_u32 v6, v7, 3, v6
    v_bfe_u32 v7, v2, 4, 1
    v_lshl_add_u32 v6, v7, 5, v6
    v_add_u32 v6, 65536, v6
    s_mul_i32 s31, s33, 2
    s_add_u32 s34, s31, 0
    v_xor_b32 v7, s34, v5
    v_lshl_add_u32 v12, v7, 6, v6
    s_add_u32 s34, s31, 1
    v_xor_b32 v7, s34, v5
    v_lshl_add_u32 v13, v7, 6, v6
    s_mul_i32 s31, s33, 64
    s_add_u32 s39, s30, s31
    v_lshlrev_b32 v26, 4, v2
    s_lshl_b32 s31, s38, 5
    v_add_u32 v5, s31, v3
    v_lshlrev_b32 v25, 1, v5
    buffer_load_ushort v176, v25, s[20:23], 0 offen offset:0
    s_add_u32 s31, s38, 0
    s_mul_i32 s31, s31, 108
    s_lshr_b32 s34, s39, 4
    s_add_u32 s31, s31, s34
    s_add_u32 s31, s31, 0
    s_lshl_b32 s31, s31, 10
    buffer_load_dwordx4 v[144:147], v26, s[16:19], s31 offen offset:0
    buffer_load_dwordx4 v[148:151], v26, s[16:19], s31 offen offset:1024
    s_add_u32 s31, s38, 0
    s_mul_i32 s31, s31, 108
    s_lshr_b32 s34, s39, 4
    s_add_u32 s31, s31, s34
    s_add_u32 s31, s31, 2
    s_lshl_b32 s31, s31, 10
    buffer_load_dwordx4 v[152:155], v26, s[16:19], s31 offen offset:0
    buffer_load_dwordx4 v[156:159], v26, s[16:19], s31 offen offset:1024
    buffer_load_ushort v177, v25, s[20:23], 0 offen offset:64
    s_add_u32 s31, s38, 1
    s_mul_i32 s31, s31, 108
    s_lshr_b32 s34, s39, 4
    s_add_u32 s31, s31, s34
    s_add_u32 s31, s31, 0
    s_lshl_b32 s31, s31, 10
    buffer_load_dwordx4 v[160:163], v26, s[16:19], s31 offen offset:0
    buffer_load_dwordx4 v[164:167], v26, s[16:19], s31 offen offset:1024
    s_add_u32 s31, s38, 1
    s_mul_i32 s31, s31, 108
    s_lshr_b32 s34, s39, 4
    s_add_u32 s31, s31, s34
    s_add_u32 s31, s31, 2
    s_lshl_b32 s31, s31, 10
    buffer_load_dwordx4 v[168:171], v26, s[16:19], s31 offen offset:0
    buffer_load_dwordx4 v[172:175], v26, s[16:19], s31 offen offset:1024
    s_add_u32 m0, s25, 16384
    s_nop 0
    buffer_load_dwordx4 v16, s[4:7], s26 offen offset:0 lds
    buffer_load_dwordx4 v17, s[4:7], s26 offen offset:1024 lds
    buffer_load_dwordx4 v18, s[4:7], s26 offen offset:2048 lds
    buffer_load_dwordx4 v19, s[4:7], s26 offen offset:3072 lds
    s_add_u32 m0, s36, 81920
    s_add_u32 s26, s26, 128
    buffer_load_dwordx4 v20, s[8:11], s27 offen offset:0 lds
    buffer_load_dwordx4 v21, s[8:11], s27 offen offset:1024 lds
    buffer_load_dwordx4 v22, s[8:11], s27 offen offset:2048 lds
    buffer_load_dwordx4 v23, s[8:11], s27 offen offset:3072 lds
    s_add_u32 s27, s27, 110592
    v_mov_b32 v48, 0
    v_mov_b32 v49, 0
    v_mov_b32 v50, 0
    v_mov_b32 v51, 0
    v_mov_b32 v52, 0
    v_mov_b32 v53, 0
    v_mov_b32 v54, 0
    v_mov_b32 v55, 0
    v_mov_b32 v56, 0
    v_mov_b32 v57, 0
    v_mov_b32 v58, 0
    v_mov_b32 v59, 0
    v_mov_b32 v60, 0
    v_mov_b32 v61, 0
    v_mov_b32 v62, 0
    v_mov_b32 v63, 0
    v_mov_b32 v64, 0
    v_mov_b32 v65, 0
    v_mov_b32 v66, 0
    v_mov_b32 v67, 0
    v_mov_b32 v68, 0
    v_mov_b32 v69, 0
    v_mov_b32 v70, 0
    v_mov_b32 v71, 0
    v_mov_b32 v72, 0
    v_mov_b32 v73, 0
    v_mov_b32 v74, 0
    v_mov_b32 v75, 0
    v_mov_b32 v76, 0
    v_mov_b32 v77, 0
    v_mov_b32 v78, 0
    v_mov_b32 v79, 0
    v_mov_b32 v80, 0
    v_mov_b32 v81, 0
    v_mov_b32 v82, 0
    v_mov_b32 v83, 0
    v_mov_b32 v84, 0
    v_mov_b32 v85, 0
    v_mov_b32 v86, 0
    v_mov_b32 v87, 0
    v_mov_b32 v88, 0
    v_mov_b32 v89, 0
    v_mov_b32 v90, 0
    v_mov_b32 v91, 0
    v_mov_b32 v92, 0
    v_mov_b32 v93, 0
    v_mov_b32 v94, 0
    v_mov_b32 v95, 0
    v_mov_b32 v96, 0
    v_mov_b32 v97, 0
    v_mov_b32 v98, 0
    v_mov_b32 v99, 0
    v_mov_b32 v100, 0
    v_mov_b32 v101, 0
    v_mov_b32 v102, 0
    v_mov_b32 v103, 0
    v_mov_b32 v104, 0
    v_mov_b32 v105, 0
    v_mov_b32 v106, 0
    v_mov_b32 v107, 0
    v_mov_b32 v108, 0
    v_mov_b32 v109, 0
    v_mov_b32 v110, 0
    v_mov_b32 v111, 0
    s_add_u32 m0, s25, 32768
    s_nop 0
    buffer_load_dwordx4 v16, s[4:7], s26 offen offset:0 lds
    buffer_load_dwordx4 v17, s[4:7], s26 offen offset:1024 lds
    buffer_load_dwordx4 v18, s[4:7], s26 offen offset:2048 lds
    buffer_load_dwordx4 v19, s[4:7], s26 offen offset:3072 lds
    s_add_u32 m0, s36, 98304
    s_add_u32 s26, s26, 128
    buffer_load_dwordx4 v20, s[8:11], s27 offen offset:0 lds
    buffer_load_dwordx4 v21, s[8:11], s27 offen offset:1024 lds
    buffer_load_dwordx4 v22, s[8:11], s27 offen offset:2048 lds
    buffer_load_dwordx4 v23, s[8:11], s27 offen offset:3072 lds
    s_add_u32 s27, s27, 110592
    s_add_u32 m0, s25, 49152
    s_nop 0
    buffer_load_dwordx4 v16, s[4:7], s26 offen offset:0 lds
    buffer_load_dwordx4 v17, s[4:7], s26 offen offset:1024 lds
    buffer_load_dwordx4 v18, s[4:7], s26 offen offset:2048 lds
    buffer_load_dwordx4 v19, s[4:7], s26 offen offset:3072 lds
    s_add_u32 m0, s36, 114688
    s_add_u32 s26, s26, 128
    buffer_load_dwordx4 v20, s[8:11], s27 offen offset:0 lds
    buffer_load_dwordx4 v21, s[8:11], s27 offen offset:1024 lds
    buffer_load_dwordx4 v22, s[8:11], s27 offen offset:2048 lds
    buffer_load_dwordx4 v23, s[8:11], s27 offen offset:3072 lds
    s_add_u32 s27, s27, 110592
    s_waitcnt vmcnt(34)
    s_barrier
    ds_read_b128 v[112:115], v8 offset:0
    ds_read_b128 v[116:119], v8 offset:4096
    ds_read_b64_tr_b16 v[120:121], v12 offset:0
    ds_read_b64_tr_b16 v[122:123], v12 offset:1024
    ds_read_b64_tr_b16 v[124:125], v13 offset:0
    ds_read_b64_tr_b16 v[126:127], v13 offset:1024
    s_waitcnt lgkmcnt(0)
    v_mfma_f32_32x32x16_bf16 v[48:63], v[120:123], v[112:115], v[48:63]
    ds_read_b128 v[128:131], v9 offset:0
    ds_read_b128 v[132:135], v9 offset:4096
    ds_read_b64_tr_b16 v[136:137], v12 offset:4096
    v_mfma_f32_32x32x16_bf16 v[64:79], v[124:127], v[112:115], v[64:79]
    ds_read_b64_tr_b16 v[138:139], v12 offset:5120
    ds_read_b64_tr_b16 v[140:141], v13 offset:4096
    ds_read_b64_tr_b16 v[142:143], v13 offset:5120
    v_mfma_f32_32x32x16_bf16 v[80:95], v[120:123], v[116:119], v[80:95]
    v_mfma_f32_32x32x16_bf16 v[96:111], v[124:127], v[116:119], v[96:111]
    s_waitcnt lgkmcnt(0)
    v_mfma_f32_32x32x16_bf16 v[48:63], v[136:139], v[128:131], v[48:63]
    ds_read_b128 v[112:115], v10 offset:0
    ds_read_b128 v[116:119], v10 offset:4096
    ds_read_b64_tr_b16 v[120:121], v12 offset:8192
    v_mfma_f32_32x32x16_bf16 v[64:79], v[140:143], v[128:131], v[64:79]
    ds_read_b64_tr_b16 v[122:123], v12 offset:9216
    ds_read_b64_tr_b16 v[124:125], v13 offset:8192
    ds_read_b64_tr_b16 v[126:127], v13 offset:9216
    v_mfma_f32_32x32x16_bf16 v[80:95], v[136:139], v[132:135], v[80:95]
    v_mfma_f32_32x32x16_bf16 v[96:111], v[140:143], v[132:135], v[96:111]
    s_waitcnt lgkmcnt(0)
    v_mfma_f32_32x32x16_bf16 v[48:63], v[120:123], v[112:115], v[48:63]
    ds_read_b128 v[128:131], v11 offset:0
    ds_read_b128 v[132:135], v11 offset:4096
    ds_read_b64_tr_b16 v[136:137], v12 offset:12288
    v_mfma_f32_32x32x16_bf16 v[64:79], v[124:127], v[112:115], v[64:79]
    ds_read_b64_tr_b16 v[138:139], v12 offset:13312
    ds_read_b64_tr_b16 v[140:141], v13 offset:12288
    ds_read_b64_tr_b16 v[142:143], v13 offset:13312
    v_mfma_f32_32x32x16_bf16 v[80:95], v[120:123], v[116:119], v[80:95]
    v_mfma_f32_32x32x16_bf16 v[96:111], v[124:127], v[116:119], v[96:111]
    s_waitcnt vmcnt(16) lgkmcnt(0)
    s_barrier
    v_mfma_f32_32x32x16_bf16 v[48:63], v[136:139], v[128:131], v[48:63]
    ds_read_b128 v[112:115], v8 offset:16384
    ds_read_b128 v[116:119], v8 offset:20480
    ds_read_b64_tr_b16 v[120:121], v12 offset:16384
    v_mfma_f32_32x32x16_bf16 v[64:79], v[140:143], v[128:131], v[64:79]
    ds_read_b64_tr_b16 v[122:123], v12 offset:17408
    ds_read_b64_tr_b16 v[124:125], v13 offset:16384
    ds_read_b64_tr_b16 v[126:127], v13 offset:17408
    v_mfma_f32_32x32x16_bf16 v[80:95], v[136:139], v[132:135], v[80:95]
    s_add_u32 m0, s25, 0
    s_nop 0
    buffer_load_dwordx4 v16, s[4:7], s26 offen offset:0 lds
    v_mfma_f32_32x32x16_bf16 v[96:111], v[140:143], v[132:135], v[96:111]
    buffer_load_dwordx4 v17, s[4:7], s26 offen offset:1024 lds
    s_waitcnt lgkmcnt(0)
    v_mfma_f32_32x32x16_bf16 v[48:63], v[120:123], v[112:115], v[48:63]
    ds_read_b128 v[128:131], v9 offset:16384
    ds_read_b128 v[132:135], v9 offset:20480
    ds_read_b64_tr_b16 v[136:137], v12 offset:20480
    v_mfma_f32_32x32x16_bf16 v[64:79], v[124:127], v[112:115], v[64:79]
    ds_read_b64_tr_b16 v[138:139], v12 offset:21504
    ds_read_b64_tr_b16 v[140:141], v13 offset:20480
    ds_read_b64_tr_b16 v[142:143], v13 offset:21504
    v_mfma_f32_32x32x16_bf16 v[80:95], v[120:123], v[116:119], v[80:95]
    buffer_load_dwordx4 v18, s[4:7], s26 offen offset:2048 lds
    v_mfma_f32_32x32x16_bf16 v[96:111], v[124:127], v[116:119], v[96:111]
    buffer_load_dwordx4 v19, s[4:7], s26 offen offset:3072 lds
    s_waitcnt lgkmcnt(0)
    v_mfma_f32_32x32x16_bf16 v[48:63], v[136:139], v[128:131], v[48:63]
    ds_read_b128 v[112:115], v10 offset:16384
    ds_read_b128 v[116:119], v10 offset:20480
    ds_read_b64_tr_b16 v[120:121], v12 offset:24576
    v_mfma_f32_32x32x16_bf16 v[64:79], v[140:143], v[128:131], v[64:79]
    ds_read_b64_tr_b16 v[122:123], v12 offset:25600
    ds_read_b64_tr_b16 v[124:125], v13 offset:24576
    ds_read_b64_tr_b16 v[126:127], v13 offset:25600
    v_mfma_f32_32x32x16_bf16 v[80:95], v[136:139], v[132:135], v[80:95]
    s_add_u32 m0, s36, 65536
    s_add_u32 s26, s26, 128
    buffer_load_dwordx4 v20, s[8:11], s27 offen offset:0 lds
    v_mfma_f32_32x32x16_bf16 v[96:111], v[140:143], v[132:135], v[96:111]
    buffer_load_dwordx4 v21, s[8:11], s27 offen offset:1024 lds
    s_waitcnt lgkmcnt(0)
    v_mfma_f32_32x32x16_bf16 v[48:63], v[120:123], v[112:115], v[48:63]
    ds_read_b128 v[128:131], v11 offset:16384
    ds_read_b128 v[132:135], v11 offset:20480
    ds_read_b64_tr_b16 v[136:137], v12 offset:28672
    v_mfma_f32_32x32x16_bf16 v[64:79], v[124:127], v[112:115], v[64:79]
    ds_read_b64_tr_b16 v[138:139], v12 offset:29696
    ds_read_b64_tr_b16 v[140:141], v13 offset:28672
    ds_read_b64_tr_b16 v[142:143], v13 offset:29696
    v_mfma_f32_32x32x16_bf16 v[80:95], v[120:123], v[116:119], v[80:95]
    buffer_load_dwordx4 v22, s[8:11], s27 offen offset:2048 lds
    v_mfma_f32_32x32x16_bf16 v[96:111], v[124:127], v[116:119], v[96:111]
    buffer_load_dwordx4 v23, s[8:11], s27 offen offset:3072 lds
    s_add_u32 s27, s27, 110592
    s_waitcnt vmcnt(16) lgkmcnt(0)
    s_barrier
    v_mfma_f32_32x32x16_bf16 v[48:63], v[136:139], v[128:131], v[48:63]
    ds_read_b128 v[112:115], v8 offset:32768
    ds_read_b128 v[116:119], v8 offset:36864
    ds_read_b64_tr_b16 v[120:121], v12 offset:32768
    v_mfma_f32_32x32x16_bf16 v[64:79], v[140:143], v[128:131], v[64:79]
    ds_read_b64_tr_b16 v[122:123], v12 offset:33792
    ds_read_b64_tr_b16 v[124:125], v13 offset:32768
    ds_read_b64_tr_b16 v[126:127], v13 offset:33792
    v_mfma_f32_32x32x16_bf16 v[80:95], v[136:139], v[132:135], v[80:95]
    s_add_u32 m0, s25, 16384
    s_nop 0
    buffer_load_dwordx4 v16, s[4:7], s26 offen offset:0 lds
    v_mfma_f32_32x32x16_bf16 v[96:111], v[140:143], v[132:135], v[96:111]
    buffer_load_dwordx4 v17, s[4:7], s26 offen offset:1024 lds
    s_waitcnt lgkmcnt(0)
    v_mfma_f32_32x32x16_bf16 v[48:63], v[120:123], v[112:115], v[48:63]
    ds_read_b128 v[128:131], v9 offset:32768
    ds_read_b128 v[132:135], v9 offset:36864
    ds_read_b64_tr_b16 v[136:137], v12 offset:36864
    v_mfma_f32_32x32x16_bf16 v[64:79], v[124:127], v[112:115], v[64:79]
    ds_read_b64_tr_b16 v[138:139], v12 offset:37888
    ds_read_b64_tr_b16 v[140:141], v13 offset:36864
    ds_read_b64_tr_b16 v[142:143], v13 offset:37888
    v_mfma_f32_32x32x16_bf16 v[80:95], v[120:123], v[116:119], v[80:95]
    buffer_load_dwordx4 v18, s[4:7], s26 offen offset:2048 lds
    v_mfma_f32_32x32x16_bf16 v[96:111], v[124:127], v[116:119], v[96:111]
    buffer_load_dwordx4 v19, s[4:7], s26 offen offset:3072 lds
    s_waitcnt lgkmcnt(0)
    v_mfma_f32_32x32x16_bf16 v[48:63], v[136:139], v[128:131], v[48:63]
    ds_read_b128 v[112:115], v10 offset:32768
    ds_read_b128 v[116:119], v10 offset:36864
    ds_read_b64_tr_b16 v[120:121], v12 offset:40960
    v_mfma_f32_32x32x16_bf16 v[64:79], v[140:143], v[128:131], v[64:79]
    ds_read_b64_tr_b16 v[122:123], v12 offset:41984
    ds_read_b64_tr_b16 v[124:125], v13 offset:40960
    ds_read_b64_tr_b16 v[126:127], v13 offset:41984
    v_mfma_f32_32x32x16_bf16 v[80:95], v[136:139], v[132:135], v[80:95]
    s_add_u32 m0, s36, 81920
    s_add_u32 s26, s26, 128
    buffer_load_dwordx4 v20, s[8:11], s27 offen offset:0 lds
    v_mfma_f32_32x32x16_bf16 v[96:111], v[140:143], v[132:135], v[96:111]
    buffer_load_dwordx4 v21, s[8:11], s27 offen offset:1024 lds
    s_waitcnt lgkmcnt(0)
    v_mfma_f32_32x32x16_bf16 v[48:63], v[120:123], v[112:115], v[48:63]
    ds_read_b128 v[128:131], v11 offset:32768
    ds_read_b128 v[132:135], v11 offset:36864
    ds_read_b64_tr_b16 v[136:137], v12 offset:45056
    v_mfma_f32_32x32x16_bf16 v[64:79], v[124:127], v[112:115], v[64:79]
    ds_read_b64_tr_b16 v[138:139], v12 offset:46080
    ds_read_b64_tr_b16 v[140:141], v13 offset:45056
    ds_read_b64_tr_b16 v[142:143], v13 offset:46080
    v_mfma_f32_32x32x16_bf16 v[80:95], v[120:123], v[116:119], v[80:95]
    buffer_load_dwordx4 v22, s[8:11], s27 offen offset:2048 lds
    v_mfma_f32_32x32x16_bf16 v[96:111], v[124:127], v[116:119], v[96:111]
    buffer_load_dwordx4 v23, s[8:11], s27 offen offset:3072 lds
    s_add_u32 s27, s27, 110592
    s_waitcnt vmcnt(16) lgkmcnt(0)
    s_barrier
    v_mfma_f32_32x32x16_bf16 v[48:63], v[136:139], v[128:131], v[48:63]
    ds_read_b128 v[112:115], v8 offset:49152
    ds_read_b128 v[116:119], v8 offset:53248
    ds_read_b64_tr_b16 v[120:121], v12 offset:49152
    v_mfma_f32_32x32x16_bf16 v[64:79], v[140:143], v[128:131], v[64:79]
    ds_read_b64_tr_b16 v[122:123], v12 offset:50176
    ds_read_b64_tr_b16 v[124:125], v13 offset:49152
    ds_read_b64_tr_b16 v[126:127], v13 offset:50176
    v_mfma_f32_32x32x16_bf16 v[80:95], v[136:139], v[132:135], v[80:95]
    s_add_u32 m0, s25, 32768
    s_nop 0
    buffer_load_dwordx4 v16, s[4:7], s26 offen offset:0 lds
    v_mfma_f32_32x32x16_bf16 v[96:111], v[140:143], v[132:135], v[96:111]
    buffer_load_dwordx4 v17, s[4:7], s26 offen offset:1024 lds
    s_waitcnt lgkmcnt(0)
    v_mfma_f32_32x32x16_bf16 v[48:63], v[120:123], v[112:115], v[48:63]
    ds_read_b128 v[128:131], v9 offset:49152
    ds_read_b128 v[132:135], v9 offset:53248
    ds_read_b64_tr_b16 v[136:137], v12 offset:53248
    v_mfma_f32_32x32x16_bf16 v[64:79], v[124:127], v[112:115], v[64:79]
    ds_read_b64_tr_b16 v[138:139], v12 offset:54272
    ds_read_b64_tr_b16 v[140:141], v13 offset:53248
    ds_read_b64_tr_b16 v[142:143], v13 offset:54272
    v_mfma_f32_32x32x16_bf16 v[80:95], v[120:123], v[116:119], v[80:95]
    buffer_load_dwordx4 v18, s[4:7], s26 offen offset:2048 lds
    v_mfma_f32_32x32x16_bf16 v[96:111], v[124:127], v[116:119], v[96:111]
    buffer_load_dwordx4 v19, s[4:7], s26 offen offset:3072 lds
    s_waitcnt lgkmcnt(0)
    v_mfma_f32_32x32x16_bf16 v[48:63], v[136:139], v[128:131], v[48:63]
    ds_read_b128 v[112:115], v10 offset:49152
    ds_read_b128 v[116:119], v10 offset:53248
    ds_read_b64_tr_b16 v[120:121], v12 offset:57344
    v_mfma_f32_32x32x16_bf16 v[64:79], v[140:143], v[128:131], v[64:79]
    ds_read_b64_tr_b16 v[122:123], v12 offset:58368
    ds_read_b64_tr_b16 v[124:125], v13 offset:57344
    ds_read_b64_tr_b16 v[126:127], v13 offset:58368
    v_mfma_f32_32x32x16_bf16 v[80:95], v[136:139], v[132:135], v[80:95]
    s_add_u32 m0, s36, 98304
    s_add_u32 s26, s26, 128
    buffer_load_dwordx4 v20, s[8:11], s27 offen offset:0 lds
    v_mfma_f32_32x32x16_bf16 v[96:111], v[140:143], v[132:135], v[96:111]
    buffer_load_dwordx4 v21, s[8:11], s27 offen offset:1024 lds
    s_waitcnt lgkmcnt(0)
    v_mfma_f32_32x32x16_bf16 v[48:63], v[120:123], v[112:115], v[48:63]
    ds_read_b128 v[128:131], v11 offset:49152
    ds_read_b128 v[132:135], v11 offset:53248
    ds_read_b64_tr_b16 v[136:137], v12 offset:61440
    v_mfma_f32_32x32x16_bf16 v[64:79], v[124:127], v[112:115], v[64:79]
    ds_read_b64_tr_b16 v[138:139], v12 offset:62464
    ds_read_b64_tr_b16 v[140:141], v13 offset:61440
    ds_read_b64_tr_b16 v[142:143], v13 offset:62464
    v_mfma_f32_32x32x16_bf16 v[80:95], v[120:123], v[116:119], v[80:95]
    buffer_load_dwordx4 v22, s[8:11], s27 offen offset:2048 lds
    v_mfma_f32_32x32x16_bf16 v[96:111], v[124:127], v[116:119], v[96:111]
    buffer_load_dwordx4 v23, s[8:11], s27 offen offset:3072 lds
    s_add_u32 s27, s27, 110592
    s_waitcnt vmcnt(16) lgkmcnt(0)
    s_barrier
    v_mfma_f32_32x32x16_bf16 v[48:63], v[136:139], v[128:131], v[48:63]
    ds_read_b128 v[112:115], v8 offset:0
    ds_read_b128 v[116:119], v8 offset:4096
    ds_read_b64_tr_b16 v[120:121], v12 offset:0
    v_mfma_f32_32x32x16_bf16 v[64:79], v[140:143], v[128:131], v[64:79]
    ds_read_b64_tr_b16 v[122:123], v12 offset:1024
    ds_read_b64_tr_b16 v[124:125], v13 offset:0
    ds_read_b64_tr_b16 v[126:127], v13 offset:1024
    v_mfma_f32_32x32x16_bf16 v[80:95], v[136:139], v[132:135], v[80:95]
    s_add_u32 m0, s25, 49152
    s_nop 0
    buffer_load_dwordx4 v16, s[4:7], s26 offen offset:0 lds
    v_mfma_f32_32x32x16_bf16 v[96:111], v[140:143], v[132:135], v[96:111]
    buffer_load_dwordx4 v17, s[4:7], s26 offen offset:1024 lds
    s_mov_b32 s28, 1
.p2align 6
spwo_kernel_sp_loop:
    s_waitcnt lgkmcnt(0)
    v_mfma_f32_32x32x16_bf16 v[48:63], v[120:123], v[112:115], v[48:63]
    ds_read_b128 v[128:131], v9 offset:0
    ds_read_b128 v[132:135], v9 offset:4096
    ds_read_b64_tr_b16 v[136:137], v12 offset:4096
    v_mfma_f32_32x32x16_bf16 v[64:79], v[124:127], v[112:115], v[64:79]
    ds_read_b64_tr_b16 v[138:139], v12 offset:5120
    ds_read_b64_tr_b16 v[140:141], v13 offset:4096
    ds_read_b64_tr_b16 v[142:143], v13 offset:5120
    v_mfma_f32_32x32x16_bf16 v[80:95], v[120:123], v[116:119], v[80:95]
    buffer_load_dwordx4 v18, s[4:7], s26 offen offset:2048 lds
    v_mfma_f32_32x32x16_bf16 v[96:111], v[124:127], v[116:119], v[96:111]
    buffer_load_dwordx4 v19, s[4:7], s26 offen offset:3072 lds
    s_waitcnt lgkmcnt(0)
    v_mfma_f32_32x32x16_bf16 v[48:63], v[136:139], v[128:131], v[48:63]
    ds_read_b128 v[112:115], v10 offset:0
    ds_read_b128 v[116:119], v10 offset:4096
    ds_read_b64_tr_b16 v[120:121], v12 offset:8192
    v_mfma_f32_32x32x16_bf16 v[64:79], v[140:143], v[128:131], v[64:79]
    ds_read_b64_tr_b16 v[122:123], v12 offset:9216
    ds_read_b64_tr_b16 v[124:125], v13 offset:8192
    ds_read_b64_tr_b16 v[126:127], v13 offset:9216
    v_mfma_f32_32x32x16_bf16 v[80:95], v[136:139], v[132:135], v[80:95]
    s_add_u32 m0, s36, 114688
    s_add_u32 s26, s26, 128
    buffer_load_dwordx4 v20, s[8:11], s27 offen offset:0 lds
    v_mfma_f32_32x32x16_bf16 v[96:111], v[140:143], v[132:135], v[96:111]
    buffer_load_dwordx4 v21, s[8:11], s27 offen offset:1024 lds
    s_waitcnt lgkmcnt(0)
    v_mfma_f32_32x32x16_bf16 v[48:63], v[120:123], v[112:115], v[48:63]
    ds_read_b128 v[128:131], v11 offset:0
    ds_read_b128 v[132:135], v11 offset:4096
    ds_read_b64_tr_b16 v[136:137], v12 offset:12288
    v_mfma_f32_32x32x16_bf16 v[64:79], v[124:127], v[112:115], v[64:79]
    ds_read_b64_tr_b16 v[138:139], v12 offset:13312
    ds_read_b64_tr_b16 v[140:141], v13 offset:12288
    ds_read_b64_tr_b16 v[142:143], v13 offset:13312
    v_mfma_f32_32x32x16_bf16 v[80:95], v[120:123], v[116:119], v[80:95]
    buffer_load_dwordx4 v22, s[8:11], s27 offen offset:2048 lds
    v_mfma_f32_32x32x16_bf16 v[96:111], v[124:127], v[116:119], v[96:111]
    buffer_load_dwordx4 v23, s[8:11], s27 offen offset:3072 lds
    s_add_u32 s27, s27, 110592
    s_waitcnt vmcnt(16) lgkmcnt(0)
    s_barrier
    v_mfma_f32_32x32x16_bf16 v[48:63], v[136:139], v[128:131], v[48:63]
    ds_read_b128 v[112:115], v8 offset:16384
    ds_read_b128 v[116:119], v8 offset:20480
    ds_read_b64_tr_b16 v[120:121], v12 offset:16384
    v_mfma_f32_32x32x16_bf16 v[64:79], v[140:143], v[128:131], v[64:79]
    ds_read_b64_tr_b16 v[122:123], v12 offset:17408
    ds_read_b64_tr_b16 v[124:125], v13 offset:16384
    ds_read_b64_tr_b16 v[126:127], v13 offset:17408
    v_mfma_f32_32x32x16_bf16 v[80:95], v[136:139], v[132:135], v[80:95]
    s_add_u32 m0, s25, 0
    s_nop 0
    buffer_load_dwordx4 v16, s[4:7], s26 offen offset:0 lds
    v_mfma_f32_32x32x16_bf16 v[96:111], v[140:143], v[132:135], v[96:111]
    buffer_load_dwordx4 v17, s[4:7], s26 offen offset:1024 lds
    s_waitcnt lgkmcnt(0)
    v_mfma_f32_32x32x16_bf16 v[48:63], v[120:123], v[112:115], v[48:63]
    ds_read_b128 v[128:131], v9 offset:16384
    ds_read_b128 v[132:135], v9 offset:20480
    ds_read_b64_tr_b16 v[136:137], v12 offset:20480
    v_mfma_f32_32x32x16_bf16 v[64:79], v[124:127], v[112:115], v[64:79]
    ds_read_b64_tr_b16 v[138:139], v12 offset:21504
    ds_read_b64_tr_b16 v[140:141], v13 offset:20480
    ds_read_b64_tr_b16 v[142:143], v13 offset:21504
    v_mfma_f32_32x32x16_bf16 v[80:95], v[120:123], v[116:119], v[80:95]
    buffer_load_dwordx4 v18, s[4:7], s26 offen offset:2048 lds
    v_mfma_f32_32x32x16_bf16 v[96:111], v[124:127], v[116:119], v[96:111]
    buffer_load_dwordx4 v19, s[4:7], s26 offen offset:3072 lds
    s_waitcnt lgkmcnt(0)
    v_mfma_f32_32x32x16_bf16 v[48:63], v[136:139], v[128:131], v[48:63]
    ds_read_b128 v[112:115], v10 offset:16384
    ds_read_b128 v[116:119], v10 offset:20480
    ds_read_b64_tr_b16 v[120:121], v12 offset:24576
    v_mfma_f32_32x32x16_bf16 v[64:79], v[140:143], v[128:131], v[64:79]
    ds_read_b64_tr_b16 v[122:123], v12 offset:25600
    ds_read_b64_tr_b16 v[124:125], v13 offset:24576
    ds_read_b64_tr_b16 v[126:127], v13 offset:25600
    v_mfma_f32_32x32x16_bf16 v[80:95], v[136:139], v[132:135], v[80:95]
    s_add_u32 m0, s36, 65536
    s_add_u32 s26, s26, 128
    buffer_load_dwordx4 v20, s[8:11], s27 offen offset:0 lds
    v_mfma_f32_32x32x16_bf16 v[96:111], v[140:143], v[132:135], v[96:111]
    buffer_load_dwordx4 v21, s[8:11], s27 offen offset:1024 lds
    s_waitcnt lgkmcnt(0)
    v_mfma_f32_32x32x16_bf16 v[48:63], v[120:123], v[112:115], v[48:63]
    ds_read_b128 v[128:131], v11 offset:16384
    ds_read_b128 v[132:135], v11 offset:20480
    ds_read_b64_tr_b16 v[136:137], v12 offset:28672
    v_mfma_f32_32x32x16_bf16 v[64:79], v[124:127], v[112:115], v[64:79]
    ds_read_b64_tr_b16 v[138:139], v12 offset:29696
    ds_read_b64_tr_b16 v[140:141], v13 offset:28672
    ds_read_b64_tr_b16 v[142:143], v13 offset:29696
    v_mfma_f32_32x32x16_bf16 v[80:95], v[120:123], v[116:119], v[80:95]
    buffer_load_dwordx4 v22, s[8:11], s27 offen offset:2048 lds
    v_mfma_f32_32x32x16_bf16 v[96:111], v[124:127], v[116:119], v[96:111]
    buffer_load_dwordx4 v23, s[8:11], s27 offen offset:3072 lds
    s_add_u32 s27, s27, 110592
    s_waitcnt vmcnt(16) lgkmcnt(0)
    s_barrier
    v_mfma_f32_32x32x16_bf16 v[48:63], v[136:139], v[128:131], v[48:63]
    ds_read_b128 v[112:115], v8 offset:32768
    ds_read_b128 v[116:119], v8 offset:36864
    ds_read_b64_tr_b16 v[120:121], v12 offset:32768
    v_mfma_f32_32x32x16_bf16 v[64:79], v[140:143], v[128:131], v[64:79]
    ds_read_b64_tr_b16 v[122:123], v12 offset:33792
    ds_read_b64_tr_b16 v[124:125], v13 offset:32768
    ds_read_b64_tr_b16 v[126:127], v13 offset:33792
    v_mfma_f32_32x32x16_bf16 v[80:95], v[136:139], v[132:135], v[80:95]
    s_add_u32 m0, s25, 16384
    s_nop 0
    buffer_load_dwordx4 v16, s[4:7], s26 offen offset:0 lds
    v_mfma_f32_32x32x16_bf16 v[96:111], v[140:143], v[132:135], v[96:111]
    buffer_load_dwordx4 v17, s[4:7], s26 offen offset:1024 lds
    s_waitcnt lgkmcnt(0)
    v_mfma_f32_32x32x16_bf16 v[48:63], v[120:123], v[112:115], v[48:63]
    ds_read_b128 v[128:131], v9 offset:32768
    ds_read_b128 v[132:135], v9 offset:36864
    ds_read_b64_tr_b16 v[136:137], v12 offset:36864
    v_mfma_f32_32x32x16_bf16 v[64:79], v[124:127], v[112:115], v[64:79]
    ds_read_b64_tr_b16 v[138:139], v12 offset:37888
    ds_read_b64_tr_b16 v[140:141], v13 offset:36864
    ds_read_b64_tr_b16 v[142:143], v13 offset:37888
    v_mfma_f32_32x32x16_bf16 v[80:95], v[120:123], v[116:119], v[80:95]
    buffer_load_dwordx4 v18, s[4:7], s26 offen offset:2048 lds
    v_mfma_f32_32x32x16_bf16 v[96:111], v[124:127], v[116:119], v[96:111]
    buffer_load_dwordx4 v19, s[4:7], s26 offen offset:3072 lds
    s_waitcnt lgkmcnt(0)
    v_mfma_f32_32x32x16_bf16 v[48:63], v[136:139], v[128:131], v[48:63]
    ds_read_b128 v[112:115], v10 offset:32768
    ds_read_b128 v[116:119], v10 offset:36864
    ds_read_b64_tr_b16 v[120:121], v12 offset:40960
    v_mfma_f32_32x32x16_bf16 v[64:79], v[140:143], v[128:131], v[64:79]
    ds_read_b64_tr_b16 v[122:123], v12 offset:41984
    ds_read_b64_tr_b16 v[124:125], v13 offset:40960
    ds_read_b64_tr_b16 v[126:127], v13 offset:41984
    v_mfma_f32_32x32x16_bf16 v[80:95], v[136:139], v[132:135], v[80:95]
    s_add_u32 m0, s36, 81920
    s_add_u32 s26, s26, 128
    buffer_load_dwordx4 v20, s[8:11], s27 offen offset:0 lds
    v_mfma_f32_32x32x16_bf16 v[96:111], v[140:143], v[132:135], v[96:111]
    buffer_load_dwordx4 v21, s[8:11], s27 offen offset:1024 lds
    s_waitcnt lgkmcnt(0)
    v_mfma_f32_32x32x16_bf16 v[48:63], v[120:123], v[112:115], v[48:63]
    ds_read_b128 v[128:131], v11 offset:32768
    ds_read_b128 v[132:135], v11 offset:36864
    ds_read_b64_tr_b16 v[136:137], v12 offset:45056
    v_mfma_f32_32x32x16_bf16 v[64:79], v[124:127], v[112:115], v[64:79]
    ds_read_b64_tr_b16 v[138:139], v12 offset:46080
    ds_read_b64_tr_b16 v[140:141], v13 offset:45056
    ds_read_b64_tr_b16 v[142:143], v13 offset:46080
    v_mfma_f32_32x32x16_bf16 v[80:95], v[120:123], v[116:119], v[80:95]
    buffer_load_dwordx4 v22, s[8:11], s27 offen offset:2048 lds
    v_mfma_f32_32x32x16_bf16 v[96:111], v[124:127], v[116:119], v[96:111]
    buffer_load_dwordx4 v23, s[8:11], s27 offen offset:3072 lds
    s_add_u32 s27, s27, 110592
    s_waitcnt vmcnt(16) lgkmcnt(0)
    s_barrier
    v_mfma_f32_32x32x16_bf16 v[48:63], v[136:139], v[128:131], v[48:63]
    ds_read_b128 v[112:115], v8 offset:49152
    ds_read_b128 v[116:119], v8 offset:53248
    ds_read_b64_tr_b16 v[120:121], v12 offset:49152
    v_mfma_f32_32x32x16_bf16 v[64:79], v[140:143], v[128:131], v[64:79]
    ds_read_b64_tr_b16 v[122:123], v12 offset:50176
    ds_read_b64_tr_b16 v[124:125], v13 offset:49152
    ds_read_b64_tr_b16 v[126:127], v13 offset:50176
    v_mfma_f32_32x32x16_bf16 v[80:95], v[136:139], v[132:135], v[80:95]
    s_add_u32 m0, s25, 32768
    s_nop 0
    buffer_load_dwordx4 v16, s[4:7], s26 offen offset:0 lds
    v_mfma_f32_32x32x16_bf16 v[96:111], v[140:143], v[132:135], v[96:111]
    buffer_load_dwordx4 v17, s[4:7], s26 offen offset:1024 lds
    s_waitcnt lgkmcnt(0)
    v_mfma_f32_32x32x16_bf16 v[48:63], v[120:123], v[112:115], v[48:63]
    ds_read_b128 v[128:131], v9 offset:49152
    ds_read_b128 v[132:135], v9 offset:53248
    ds_read_b64_tr_b16 v[136:137], v12 offset:53248
    v_mfma_f32_32x32x16_bf16 v[64:79], v[124:127], v[112:115], v[64:79]
    ds_read_b64_tr_b16 v[138:139], v12 offset:54272
    ds_read_b64_tr_b16 v[140:141], v13 offset:53248
    ds_read_b64_tr_b16 v[142:143], v13 offset:54272
    v_mfma_f32_32x32x16_bf16 v[80:95], v[120:123], v[116:119], v[80:95]
    buffer_load_dwordx4 v18, s[4:7], s26 offen offset:2048 lds
    v_mfma_f32_32x32x16_bf16 v[96:111], v[124:127], v[116:119], v[96:111]
    buffer_load_dwordx4 v19, s[4:7], s26 offen offset:3072 lds
    s_waitcnt lgkmcnt(0)
    v_mfma_f32_32x32x16_bf16 v[48:63], v[136:139], v[128:131], v[48:63]
    ds_read_b128 v[112:115], v10 offset:49152
    ds_read_b128 v[116:119], v10 offset:53248
    ds_read_b64_tr_b16 v[120:121], v12 offset:57344
    v_mfma_f32_32x32x16_bf16 v[64:79], v[140:143], v[128:131], v[64:79]
    ds_read_b64_tr_b16 v[122:123], v12 offset:58368
    ds_read_b64_tr_b16 v[124:125], v13 offset:57344
    ds_read_b64_tr_b16 v[126:127], v13 offset:58368
    v_mfma_f32_32x32x16_bf16 v[80:95], v[136:139], v[132:135], v[80:95]
    s_add_u32 m0, s36, 98304
    s_add_u32 s26, s26, 128
    buffer_load_dwordx4 v20, s[8:11], s27 offen offset:0 lds
    v_mfma_f32_32x32x16_bf16 v[96:111], v[140:143], v[132:135], v[96:111]
    buffer_load_dwordx4 v21, s[8:11], s27 offen offset:1024 lds
    s_waitcnt lgkmcnt(0)
    v_mfma_f32_32x32x16_bf16 v[48:63], v[120:123], v[112:115], v[48:63]
    ds_read_b128 v[128:131], v11 offset:49152
    ds_read_b128 v[132:135], v11 offset:53248
    ds_read_b64_tr_b16 v[136:137], v12 offset:61440
    v_mfma_f32_32x32x16_bf16 v[64:79], v[124:127], v[112:115], v[64:79]
    ds_read_b64_tr_b16 v[138:139], v12 offset:62464
    ds_read_b64_tr_b16 v[140:141], v13 offset:61440
    ds_read_b64_tr_b16 v[142:143], v13 offset:62464
    v_mfma_f32_32x32x16_bf16 v[80:95], v[120:123], v[116:119], v[80:95]
    buffer_load_dwordx4 v22, s[8:11], s27 offen offset:2048 lds
    v_mfma_f32_32x32x16_bf16 v[96:111], v[124:127], v[116:119], v[96:111]
    buffer_load_dwordx4 v23, s[8:11], s27 offen offset:3072 lds
    s_add_u32 s27, s27, 110592
    s_waitcnt vmcnt(16) lgkmcnt(0)
    s_barrier
    v_mfma_f32_32x32x16_bf16 v[48:63], v[136:139], v[128:131], v[48:63]
    ds_read_b128 v[112:115], v8 offset:0
    ds_read_b128 v[116:119], v8 offset:4096
    ds_read_b64_tr_b16 v[120:121], v12 offset:0
    v_mfma_f32_32x32x16_bf16 v[64:79], v[140:143], v[128:131], v[64:79]
    ds_read_b64_tr_b16 v[122:123], v12 offset:1024
    ds_read_b64_tr_b16 v[124:125], v13 offset:0
    ds_read_b64_tr_b16 v[126:127], v13 offset:1024
    v_mfma_f32_32x32x16_bf16 v[80:95], v[136:139], v[132:135], v[80:95]
    s_add_u32 m0, s25, 49152
    s_nop 0
    buffer_load_dwordx4 v16, s[4:7], s26 offen offset:0 lds
    v_mfma_f32_32x32x16_bf16 v[96:111], v[140:143], v[132:135], v[96:111]
    buffer_load_dwordx4 v17, s[4:7], s26 offen offset:1024 lds
    s_add_u32 s28, s28, 1
    s_cmp_lt_u32 s28, 7
    s_cbranch_scc1 spwo_kernel_sp_loop
    s_waitcnt lgkmcnt(0)
    v_mfma_f32_32x32x16_bf16 v[48:63], v[120:123], v[112:115], v[48:63]
    ds_read_b128 v[128:131], v9 offset:0
    ds_read_b128 v[132:135], v9 offset:4096
    ds_read_b64_tr_b16 v[136:137], v12 offset:4096
    v_mfma_f32_32x32x16_bf16 v[64:79], v[124:127], v[112:115], v[64:79]
    ds_read_b64_tr_b16 v[138:139], v12 offset:5120
    ds_read_b64_tr_b16 v[140:141], v13 offset:4096
    ds_read_b64_tr_b16 v[142:143], v13 offset:5120
    v_mfma_f32_32x32x16_bf16 v[80:95], v[120:123], v[116:119], v[80:95]
    buffer_load_dwordx4 v18, s[4:7], s26 offen offset:2048 lds
    v_mfma_f32_32x32x16_bf16 v[96:111], v[124:127], v[116:119], v[96:111]
    buffer_load_dwordx4 v19, s[4:7], s26 offen offset:3072 lds
    s_waitcnt lgkmcnt(0)
    v_mfma_f32_32x32x16_bf16 v[48:63], v[136:139], v[128:131], v[48:63]
    ds_read_b128 v[112:115], v10 offset:0
    ds_read_b128 v[116:119], v10 offset:4096
    ds_read_b64_tr_b16 v[120:121], v12 offset:8192
    v_mfma_f32_32x32x16_bf16 v[64:79], v[140:143], v[128:131], v[64:79]
    ds_read_b64_tr_b16 v[122:123], v12 offset:9216
    ds_read_b64_tr_b16 v[124:125], v13 offset:8192
    ds_read_b64_tr_b16 v[126:127], v13 offset:9216
    v_mfma_f32_32x32x16_bf16 v[80:95], v[136:139], v[132:135], v[80:95]
    s_add_u32 m0, s36, 114688
    s_add_u32 s26, s26, 128
    buffer_load_dwordx4 v20, s[8:11], s27 offen offset:0 lds
    v_mfma_f32_32x32x16_bf16 v[96:111], v[140:143], v[132:135], v[96:111]
    buffer_load_dwordx4 v21, s[8:11], s27 offen offset:1024 lds
    s_waitcnt lgkmcnt(0)
    v_mfma_f32_32x32x16_bf16 v[48:63], v[120:123], v[112:115], v[48:63]
    ds_read_b128 v[128:131], v11 offset:0
    ds_read_b128 v[132:135], v11 offset:4096
    ds_read_b64_tr_b16 v[136:137], v12 offset:12288
    v_mfma_f32_32x32x16_bf16 v[64:79], v[124:127], v[112:115], v[64:79]
    ds_read_b64_tr_b16 v[138:139], v12 offset:13312
    ds_read_b64_tr_b16 v[140:141], v13 offset:12288
    ds_read_b64_tr_b16 v[142:143], v13 offset:13312
    v_mfma_f32_32x32x16_bf16 v[80:95], v[120:123], v[116:119], v[80:95]
    buffer_load_dwordx4 v22, s[8:11], s27 offen offset:2048 lds
    v_mfma_f32_32x32x16_bf16 v[96:111], v[124:127], v[116:119], v[96:111]
    buffer_load_dwordx4 v23, s[8:11], s27 offen offset:3072 lds
    s_add_u32 s27, s27, 110592
    s_waitcnt vmcnt(16) lgkmcnt(0)
    s_barrier
    v_mfma_f32_32x32x16_bf16 v[48:63], v[136:139], v[128:131], v[48:63]
    ds_read_b128 v[112:115], v8 offset:16384
    ds_read_b128 v[116:119], v8 offset:20480
    ds_read_b64_tr_b16 v[120:121], v12 offset:16384
    v_mfma_f32_32x32x16_bf16 v[64:79], v[140:143], v[128:131], v[64:79]
    ds_read_b64_tr_b16 v[122:123], v12 offset:17408
    ds_read_b64_tr_b16 v[124:125], v13 offset:16384
    ds_read_b64_tr_b16 v[126:127], v13 offset:17408
    v_mfma_f32_32x32x16_bf16 v[80:95], v[136:139], v[132:135], v[80:95]
    v_mfma_f32_32x32x16_bf16 v[96:111], v[140:143], v[132:135], v[96:111]
    s_waitcnt lgkmcnt(0)
    v_mfma_f32_32x32x16_bf16 v[48:63], v[120:123], v[112:115], v[48:63]
    ds_read_b128 v[128:131], v9 offset:16384
    ds_read_b128 v[132:135], v9 offset:20480
    ds_read_b64_tr_b16 v[136:137], v12 offset:20480
    v_mfma_f32_32x32x16_bf16 v[64:79], v[124:127], v[112:115], v[64:79]
    ds_read_b64_tr_b16 v[138:139], v12 offset:21504
    ds_read_b64_tr_b16 v[140:141], v13 offset:20480
    ds_read_b64_tr_b16 v[142:143], v13 offset:21504
    v_mfma_f32_32x32x16_bf16 v[80:95], v[120:123], v[116:119], v[80:95]
    v_mfma_f32_32x32x16_bf16 v[96:111], v[124:127], v[116:119], v[96:111]
    s_waitcnt lgkmcnt(0)
    v_mfma_f32_32x32x16_bf16 v[48:63], v[136:139], v[128:131], v[48:63]
    ds_read_b128 v[112:115], v10 offset:16384
    ds_read_b128 v[116:119], v10 offset:20480
    ds_read_b64_tr_b16 v[120:121], v12 offset:24576
    v_mfma_f32_32x32x16_bf16 v[64:79], v[140:143], v[128:131], v[64:79]
    ds_read_b64_tr_b16 v[122:123], v12 offset:25600
    ds_read_b64_tr_b16 v[124:125], v13 offset:24576
    ds_read_b64_tr_b16 v[126:127], v13 offset:25600
    v_mfma_f32_32x32x16_bf16 v[80:95], v[136:139], v[132:135], v[80:95]
    v_mfma_f32_32x32x16_bf16 v[96:111], v[140:143], v[132:135], v[96:111]
    s_waitcnt lgkmcnt(0)
    v_mfma_f32_32x32x16_bf16 v[48:63], v[120:123], v[112:115], v[48:63]
    ds_read_b128 v[128:131], v11 offset:16384
    ds_read_b128 v[132:135], v11 offset:20480
    ds_read_b64_tr_b16 v[136:137], v12 offset:28672
    v_mfma_f32_32x32x16_bf16 v[64:79], v[124:127], v[112:115], v[64:79]
    ds_read_b64_tr_b16 v[138:139], v12 offset:29696
    ds_read_b64_tr_b16 v[140:141], v13 offset:28672
    ds_read_b64_tr_b16 v[142:143], v13 offset:29696
    v_mfma_f32_32x32x16_bf16 v[80:95], v[120:123], v[116:119], v[80:95]
    v_mfma_f32_32x32x16_bf16 v[96:111], v[124:127], v[116:119], v[96:111]
    s_waitcnt vmcnt(8) lgkmcnt(0)
    s_barrier
    v_mfma_f32_32x32x16_bf16 v[48:63], v[136:139], v[128:131], v[48:63]
    ds_read_b128 v[112:115], v8 offset:32768
    ds_read_b128 v[116:119], v8 offset:36864
    ds_read_b64_tr_b16 v[120:121], v12 offset:32768
    v_mfma_f32_32x32x16_bf16 v[64:79], v[140:143], v[128:131], v[64:79]
    ds_read_b64_tr_b16 v[122:123], v12 offset:33792
    ds_read_b64_tr_b16 v[124:125], v13 offset:32768
    ds_read_b64_tr_b16 v[126:127], v13 offset:33792
    v_mfma_f32_32x32x16_bf16 v[80:95], v[136:139], v[132:135], v[80:95]
    v_mfma_f32_32x32x16_bf16 v[96:111], v[140:143], v[132:135], v[96:111]
    s_waitcnt lgkmcnt(0)
    v_mfma_f32_32x32x16_bf16 v[48:63], v[120:123], v[112:115], v[48:63]
    ds_read_b128 v[128:131], v9 offset:32768
    ds_read_b128 v[132:135], v9 offset:36864
    ds_read_b64_tr_b16 v[136:137], v12 offset:36864
    v_mfma_f32_32x32x16_bf16 v[64:79], v[124:127], v[112:115], v[64:79]
    ds_read_b64_tr_b16 v[138:139], v12 offset:37888
    ds_read_b64_tr_b16 v[140:141], v13 offset:36864
    ds_read_b64_tr_b16 v[142:143], v13 offset:37888
    v_mfma_f32_32x32x16_bf16 v[80:95], v[120:123], v[116:119], v[80:95]
    v_mfma_f32_32x32x16_bf16 v[96:111], v[124:127], v[116:119], v[96:111]
    s_waitcnt lgkmcnt(0)
    v_mfma_f32_32x32x16_bf16 v[48:63], v[136:139], v[128:131], v[48:63]
    ds_read_b128 v[112:115], v10 offset:32768
    ds_read_b128 v[116:119], v10 offset:36864
    ds_read_b64_tr_b16 v[120:121], v12 offset:40960
    v_mfma_f32_32x32x16_bf16 v[64:79], v[140:143], v[128:131], v[64:79]
    ds_read_b64_tr_b16 v[122:123], v12 offset:41984
    ds_read_b64_tr_b16 v[124:125], v13 offset:40960
    ds_read_b64_tr_b16 v[126:127], v13 offset:41984
    v_mfma_f32_32x32x16_bf16 v[80:95], v[136:139], v[132:135], v[80:95]
    v_mfma_f32_32x32x16_bf16 v[96:111], v[140:143], v[132:135], v[96:111]
    s_waitcnt lgkmcnt(0)
    v_mfma_f32_32x32x16_bf16 v[48:63], v[120:123], v[112:115], v[48:63]
    ds_read_b128 v[128:131], v11 offset:32768
    ds_read_b128 v[132:135], v11 offset:36864
    ds_read_b64_tr_b16 v[136:137], v12 offset:45056
    v_mfma_f32_32x32x16_bf16 v[64:79], v[124:127], v[112:115], v[64:79]
    ds_read_b64_tr_b16 v[138:139], v12 offset:46080
    ds_read_b64_tr_b16 v[140:141], v13 offset:45056
    ds_read_b64_tr_b16 v[142:143], v13 offset:46080
    v_mfma_f32_32x32x16_bf16 v[80:95], v[120:123], v[116:119], v[80:95]
    v_mfma_f32_32x32x16_bf16 v[96:111], v[124:127], v[116:119], v[96:111]
    s_waitcnt vmcnt(0) lgkmcnt(0)
    s_barrier
    v_mfma_f32_32x32x16_bf16 v[48:63], v[136:139], v[128:131], v[48:63]
    ds_read_b128 v[112:115], v8 offset:49152
    ds_read_b128 v[116:119], v8 offset:53248
    ds_read_b64_tr_b16 v[120:121], v12 offset:49152
    v_mfma_f32_32x32x16_bf16 v[64:79], v[140:143], v[128:131], v[64:79]
    ds_read_b64_tr_b16 v[122:123], v12 offset:50176
    ds_read_b64_tr_b16 v[124:125], v13 offset:49152
    ds_read_b64_tr_b16 v[126:127], v13 offset:50176
    v_mfma_f32_32x32x16_bf16 v[80:95], v[136:139], v[132:135], v[80:95]
    v_mfma_f32_32x32x16_bf16 v[96:111], v[140:143], v[132:135], v[96:111]
    s_waitcnt lgkmcnt(0)
    v_mfma_f32_32x32x16_bf16 v[48:63], v[120:123], v[112:115], v[48:63]
    ds_read_b128 v[128:131], v9 offset:49152
    ds_read_b128 v[132:135], v9 offset:53248
    ds_read_b64_tr_b16 v[136:137], v12 offset:53248
    v_mfma_f32_32x32x16_bf16 v[64:79], v[124:127], v[112:115], v[64:79]
    ds_read_b64_tr_b16 v[138:139], v12 offset:54272
    ds_read_b64_tr_b16 v[140:141], v13 offset:53248
    ds_read_b64_tr_b16 v[142:143], v13 offset:54272
    v_mfma_f32_32x32x16_bf16 v[80:95], v[120:123], v[116:119], v[80:95]
    v_mfma_f32_32x32x16_bf16 v[96:111], v[124:127], v[116:119], v[96:111]
    s_waitcnt lgkmcnt(0)
    v_mfma_f32_32x32x16_bf16 v[48:63], v[136:139], v[128:131], v[48:63]
    ds_read_b128 v[112:115], v10 offset:49152
    ds_read_b128 v[116:119], v10 offset:53248
    ds_read_b64_tr_b16 v[120:121], v12 offset:57344
    v_mfma_f32_32x32x16_bf16 v[64:79], v[140:143], v[128:131], v[64:79]
    ds_read_b64_tr_b16 v[122:123], v12 offset:58368
    ds_read_b64_tr_b16 v[124:125], v13 offset:57344
    ds_read_b64_tr_b16 v[126:127], v13 offset:58368
    v_mfma_f32_32x32x16_bf16 v[80:95], v[136:139], v[132:135], v[80:95]
    v_mfma_f32_32x32x16_bf16 v[96:111], v[140:143], v[132:135], v[96:111]
    s_waitcnt lgkmcnt(0)
    v_mfma_f32_32x32x16_bf16 v[48:63], v[120:123], v[112:115], v[48:63]
    ds_read_b128 v[128:131], v11 offset:49152
    ds_read_b128 v[132:135], v11 offset:53248
    ds_read_b64_tr_b16 v[136:137], v12 offset:61440
    v_mfma_f32_32x32x16_bf16 v[64:79], v[124:127], v[112:115], v[64:79]
    ds_read_b64_tr_b16 v[138:139], v12 offset:62464
    ds_read_b64_tr_b16 v[140:141], v13 offset:61440
    ds_read_b64_tr_b16 v[142:143], v13 offset:62464
    v_mfma_f32_32x32x16_bf16 v[80:95], v[120:123], v[116:119], v[80:95]
    v_mfma_f32_32x32x16_bf16 v[96:111], v[124:127], v[116:119], v[96:111]
    s_waitcnt lgkmcnt(0)
    v_mfma_f32_32x32x16_bf16 v[48:63], v[136:139], v[128:131], v[48:63]
    v_mfma_f32_32x32x16_bf16 v[64:79], v[140:143], v[128:131], v[64:79]
    v_mfma_f32_32x32x16_bf16 v[80:95], v[136:139], v[132:135], v[80:95]
    v_mfma_f32_32x32x16_bf16 v[96:111], v[140:143], v[132:135], v[96:111]
    s_nop 15
    s_mov_b32 s27, 0xffff0000
    s_waitcnt vmcnt(0)
    s_lshr_b32 s46, s2, 3
    s_mul_i32 s46, s46, 4
    s_add_u32 s46, s46, s24
    s_getpc_b64 s[48:49]
Lpc_6:
    s_sub_u32 s48, s48, Lpc_6-ln1_kernel
    s_subb_u32 s49, s49, 0
    s_mov_b32 s50, text_end-ln1_kernel
    s_mov_b32 s51, 0x20000
    s_lshl_b32 s46, s46, 10
    v_lshl_add_u32 v1, v2, 4, s46
    buffer_load_dwordx4 v[40:43], v1, s[48:51], 0 offen
    v_lshlrev_b32 v7, 16, v176
    s_add_u32 s31, s39, 0
    s_cmp_ge_u32 s31, 864
    s_cbranch_scc1 spwo_kernel_sp_skip_7
    v_cvt_pk_bf16_f32 v28, v48, v49
    v_lshlrev_b32 v48, 16, v28
    v_and_b32 v49, s27, v28
    v_cvt_pk_bf16_f32 v32, v50, v51
    v_lshlrev_b32 v50, 16, v32
    v_and_b32 v51, s27, v32
    v_add_f32 v48, v48, v7
    v_add_f32 v49, v49, v7
    v_add_f32 v50, v50, v7
    v_add_f32 v51, v51, v7
    v_cvt_pk_bf16_f32 v48, v48, v49
    v_cvt_pk_bf16_f32 v49, v50, v51
    v_cvt_pk_bf16_f32 v28, v52, v53
    v_lshlrev_b32 v52, 16, v28
    v_and_b32 v53, s27, v28
    v_cvt_pk_bf16_f32 v32, v54, v55
    v_lshlrev_b32 v54, 16, v32
    v_and_b32 v55, s27, v32
    v_add_f32 v52, v52, v7
    v_add_f32 v53, v53, v7
    v_add_f32 v54, v54, v7
    v_add_f32 v55, v55, v7
    v_cvt_pk_bf16_f32 v50, v52, v53
    v_cvt_pk_bf16_f32 v51, v54, v55
    v_cvt_pk_bf16_f32 v28, v56, v57
    v_lshlrev_b32 v56, 16, v28
    v_and_b32 v57, s27, v28
    v_cvt_pk_bf16_f32 v32, v58, v59
    v_lshlrev_b32 v58, 16, v32
    v_and_b32 v59, s27, v32
    v_add_f32 v56, v56, v7
    v_add_f32 v57, v57, v7
    v_add_f32 v58, v58, v7
    v_add_f32 v59, v59, v7
    v_cvt_pk_bf16_f32 v52, v56, v57
    v_cvt_pk_bf16_f32 v53, v58, v59
    v_cvt_pk_bf16_f32 v28, v60, v61
    v_lshlrev_b32 v60, 16, v28
    v_and_b32 v61, s27, v28
    v_cvt_pk_bf16_f32 v32, v62, v63
    v_lshlrev_b32 v62, 16, v32
    v_and_b32 v63, s27, v32
    v_add_f32 v60, v60, v7
    v_add_f32 v61, v61, v7
    v_add_f32 v62, v62, v7
    v_add_f32 v63, v63, v7
    v_cvt_pk_bf16_f32 v54, v60, v61
    v_cvt_pk_bf16_f32 v55, v62, v63
    s_nop 1
    v_permlane32_swap_b32 v48, v50
    v_permlane32_swap_b32 v49, v51
    v_permlane32_swap_b32 v52, v54
    v_permlane32_swap_b32 v53, v55
    s_nop 1
    v_lshlrev_b32 v28, 16, v48
    v_and_b32 v29, s27, v48
    v_lshlrev_b32 v30, 16, v144
    v_and_b32 v31, s27, v144
    v_lshlrev_b32 v32, 16, v49
    v_and_b32 v33, s27, v49
    v_lshlrev_b32 v34, 16, v145
    v_and_b32 v35, s27, v145
    v_mul_f32 v28, v28, v30
    v_mul_f32 v29, v29, v31
    v_mul_f32 v32, v32, v34
    v_mul_f32 v33, v33, v35
    v_cvt_pk_bf16_f32 v48, v28, v29
    v_cvt_pk_bf16_f32 v49, v32, v33
    v_lshlrev_b32 v28, 16, v50
    v_and_b32 v29, s27, v50
    v_lshlrev_b32 v30, 16, v146
    v_and_b32 v31, s27, v146
    v_lshlrev_b32 v32, 16, v51
    v_and_b32 v33, s27, v51
    v_lshlrev_b32 v34, 16, v147
    v_and_b32 v35, s27, v147
    v_mul_f32 v28, v28, v30
    v_mul_f32 v29, v29, v31
    v_mul_f32 v32, v32, v34
    v_mul_f32 v33, v33, v35
    v_cvt_pk_bf16_f32 v50, v28, v29
    v_cvt_pk_bf16_f32 v51, v32, v33
    v_lshlrev_b32 v28, 16, v52
    v_and_b32 v29, s27, v52
    v_lshlrev_b32 v30, 16, v148
    v_and_b32 v31, s27, v148
    v_lshlrev_b32 v32, 16, v53
    v_and_b32 v33, s27, v53
    v_lshlrev_b32 v34, 16, v149
    v_and_b32 v35, s27, v149
    v_mul_f32 v28, v28, v30
    v_mul_f32 v29, v29, v31
    v_mul_f32 v32, v32, v34
    v_mul_f32 v33, v33, v35
    v_cvt_pk_bf16_f32 v52, v28, v29
    v_cvt_pk_bf16_f32 v53, v32, v33
    v_lshlrev_b32 v28, 16, v54
    v_and_b32 v29, s27, v54
    v_lshlrev_b32 v30, 16, v150
    v_and_b32 v31, s27, v150
    v_lshlrev_b32 v32, 16, v55
    v_and_b32 v33, s27, v55
    v_lshlrev_b32 v34, 16, v151
    v_and_b32 v35, s27, v151
    v_mul_f32 v28, v28, v30
    v_mul_f32 v29, v29, v31
    v_mul_f32 v32, v32, v34
    v_mul_f32 v33, v33, v35
    v_cvt_pk_bf16_f32 v54, v28, v29
    v_cvt_pk_bf16_f32 v55, v32, v33
    s_add_u32 s31, s38, 0
    s_mul_i32 s31, s31, 54
    s_lshr_b32 s34, s39, 4
    s_add_u32 s31, s31, s34
    s_add_u32 s31, s31, 0
    s_lshl_b32 s31, s31, 10
    buffer_store_dwordx4 v[48:51], v26, s[12:15], s31 offen offset:0
    buffer_store_dwordx4 v[52:55], v26, s[12:15], s31 offen offset:1024
spwo_kernel_sp_skip_7:
    s_add_u32 s31, s39, 32
    s_cmp_ge_u32 s31, 864
    s_cbranch_scc1 spwo_kernel_sp_skip_8
    v_cvt_pk_bf16_f32 v28, v64, v65
    v_lshlrev_b32 v64, 16, v28
    v_and_b32 v65, s27, v28
    v_cvt_pk_bf16_f32 v32, v66, v67
    v_lshlrev_b32 v66, 16, v32
    v_and_b32 v67, s27, v32
    v_add_f32 v64, v64, v7
    v_add_f32 v65, v65, v7
    v_add_f32 v66, v66, v7
    v_add_f32 v67, v67, v7
    v_cvt_pk_bf16_f32 v64, v64, v65
    v_cvt_pk_bf16_f32 v65, v66, v67
    v_cvt_pk_bf16_f32 v28, v68, v69
    v_lshlrev_b32 v68, 16, v28
    v_and_b32 v69, s27, v28
    v_cvt_pk_bf16_f32 v32, v70, v71
    v_lshlrev_b32 v70, 16, v32
    v_and_b32 v71, s27, v32
    v_add_f32 v68, v68, v7
    v_add_f32 v69, v69, v7
    v_add_f32 v70, v70, v7
    v_add_f32 v71, v71, v7
    v_cvt_pk_bf16_f32 v66, v68, v69
    v_cvt_pk_bf16_f32 v67, v70, v71
    v_cvt_pk_bf16_f32 v28, v72, v73
    v_lshlrev_b32 v72, 16, v28
    v_and_b32 v73, s27, v28
    v_cvt_pk_bf16_f32 v32, v74, v75
    v_lshlrev_b32 v74, 16, v32
    v_and_b32 v75, s27, v32
    v_add_f32 v72, v72, v7
    v_add_f32 v73, v73, v7
    v_add_f32 v74, v74, v7
    v_add_f32 v75, v75, v7
    v_cvt_pk_bf16_f32 v68, v72, v73
    v_cvt_pk_bf16_f32 v69, v74, v75
    v_cvt_pk_bf16_f32 v28, v76, v77
    v_lshlrev_b32 v76, 16, v28
    v_and_b32 v77, s27, v28
    v_cvt_pk_bf16_f32 v32, v78, v79
    v_lshlrev_b32 v78, 16, v32
    v_and_b32 v79, s27, v32
    v_add_f32 v76, v76, v7
    v_add_f32 v77, v77, v7
    v_add_f32 v78, v78, v7
    v_add_f32 v79, v79, v7
    v_cvt_pk_bf16_f32 v70, v76, v77
    v_cvt_pk_bf16_f32 v71, v78, v79
    s_nop 1
    v_permlane32_swap_b32 v64, v66
    v_permlane32_swap_b32 v65, v67
    v_permlane32_swap_b32 v68, v70
    v_permlane32_swap_b32 v69, v71
    s_nop 1
    v_lshlrev_b32 v28, 16, v64
    v_and_b32 v29, s27, v64
    v_lshlrev_b32 v30, 16, v152
    v_and_b32 v31, s27, v152
    v_lshlrev_b32 v32, 16, v65
    v_and_b32 v33, s27, v65
    v_lshlrev_b32 v34, 16, v153
    v_and_b32 v35, s27, v153
    v_mul_f32 v28, v28, v30
    v_mul_f32 v29, v29, v31
    v_mul_f32 v32, v32, v34
    v_mul_f32 v33, v33, v35
    v_cvt_pk_bf16_f32 v64, v28, v29
    v_cvt_pk_bf16_f32 v65, v32, v33
    v_lshlrev_b32 v28, 16, v66
    v_and_b32 v29, s27, v66
    v_lshlrev_b32 v30, 16, v154
    v_and_b32 v31, s27, v154
    v_lshlrev_b32 v32, 16, v67
    v_and_b32 v33, s27, v67
    v_lshlrev_b32 v34, 16, v155
    v_and_b32 v35, s27, v155
    v_mul_f32 v28, v28, v30
    v_mul_f32 v29, v29, v31
    v_mul_f32 v32, v32, v34
    v_mul_f32 v33, v33, v35
    v_cvt_pk_bf16_f32 v66, v28, v29
    v_cvt_pk_bf16_f32 v67, v32, v33
    v_lshlrev_b32 v28, 16, v68
    v_and_b32 v29, s27, v68
    v_lshlrev_b32 v30, 16, v156
    v_and_b32 v31, s27, v156
    v_lshlrev_b32 v32, 16, v69
    v_and_b32 v33, s27, v69
    v_lshlrev_b32 v34, 16, v157
    v_and_b32 v35, s27, v157
    v_mul_f32 v28, v28, v30
    v_mul_f32 v29, v29, v31
    v_mul_f32 v32, v32, v34
    v_mul_f32 v33, v33, v35
    v_cvt_pk_bf16_f32 v68, v28, v29
    v_cvt_pk_bf16_f32 v69, v32, v33
    v_lshlrev_b32 v28, 16, v70
    v_and_b32 v29, s27, v70
    v_lshlrev_b32 v30, 16, v158
    v_and_b32 v31, s27, v158
    v_lshlrev_b32 v32, 16, v71
    v_and_b32 v33, s27, v71
    v_lshlrev_b32 v34, 16, v159
    v_and_b32 v35, s27, v159
    v_mul_f32 v28, v28, v30
    v_mul_f32 v29, v29, v31
    v_mul_f32 v32, v32, v34
    v_mul_f32 v33, v33, v35
    v_cvt_pk_bf16_f32 v70, v28, v29
    v_cvt_pk_bf16_f32 v71, v32, v33
    s_add_u32 s31, s38, 0
    s_mul_i32 s31, s31, 54
    s_lshr_b32 s34, s39, 4
    s_add_u32 s31, s31, s34
    s_add_u32 s31, s31, 2
    s_lshl_b32 s31, s31, 10
    buffer_store_dwordx4 v[64:67], v26, s[12:15], s31 offen offset:0
    buffer_store_dwordx4 v[68:71], v26, s[12:15], s31 offen offset:1024
spwo_kernel_sp_skip_8:
    v_lshlrev_b32 v7, 16, v177
    s_add_u32 s31, s39, 0
    s_cmp_ge_u32 s31, 864
    s_cbranch_scc1 spwo_kernel_sp_skip_9
    v_cvt_pk_bf16_f32 v28, v80, v81
    v_lshlrev_b32 v80, 16, v28
    v_and_b32 v81, s27, v28
    v_cvt_pk_bf16_f32 v32, v82, v83
    v_lshlrev_b32 v82, 16, v32
    v_and_b32 v83, s27, v32
    v_add_f32 v80, v80, v7
    v_add_f32 v81, v81, v7
    v_add_f32 v82, v82, v7
    v_add_f32 v83, v83, v7
    v_cvt_pk_bf16_f32 v80, v80, v81
    v_cvt_pk_bf16_f32 v81, v82, v83
    v_cvt_pk_bf16_f32 v28, v84, v85
    v_lshlrev_b32 v84, 16, v28
    v_and_b32 v85, s27, v28
    v_cvt_pk_bf16_f32 v32, v86, v87
    v_lshlrev_b32 v86, 16, v32
    v_and_b32 v87, s27, v32
    v_add_f32 v84, v84, v7
    v_add_f32 v85, v85, v7
    v_add_f32 v86, v86, v7
    v_add_f32 v87, v87, v7
    v_cvt_pk_bf16_f32 v82, v84, v85
    v_cvt_pk_bf16_f32 v83, v86, v87
    v_cvt_pk_bf16_f32 v28, v88, v89
    v_lshlrev_b32 v88, 16, v28
    v_and_b32 v89, s27, v28
    v_cvt_pk_bf16_f32 v32, v90, v91
    v_lshlrev_b32 v90, 16, v32
    v_and_b32 v91, s27, v32
    v_add_f32 v88, v88, v7
    v_add_f32 v89, v89, v7
    v_add_f32 v90, v90, v7
    v_add_f32 v91, v91, v7
    v_cvt_pk_bf16_f32 v84, v88, v89
    v_cvt_pk_bf16_f32 v85, v90, v91
    v_cvt_pk_bf16_f32 v28, v92, v93
    v_lshlrev_b32 v92, 16, v28
    v_and_b32 v93, s27, v28
    v_cvt_pk_bf16_f32 v32, v94, v95
    v_lshlrev_b32 v94, 16, v32
    v_and_b32 v95, s27, v32
    v_add_f32 v92, v92, v7
    v_add_f32 v93, v93, v7
    v_add_f32 v94, v94, v7
    v_add_f32 v95, v95, v7
    v_cvt_pk_bf16_f32 v86, v92, v93
    v_cvt_pk_bf16_f32 v87, v94, v95
    s_nop 1
    v_permlane32_swap_b32 v80, v82
    v_permlane32_swap_b32 v81, v83
    v_permlane32_swap_b32 v84, v86
    v_permlane32_swap_b32 v85, v87
    s_nop 1
    v_lshlrev_b32 v28, 16, v80
    v_and_b32 v29, s27, v80
    v_lshlrev_b32 v30, 16, v160
    v_and_b32 v31, s27, v160
    v_lshlrev_b32 v32, 16, v81
    v_and_b32 v33, s27, v81
    v_lshlrev_b32 v34, 16, v161
    v_and_b32 v35, s27, v161
    v_mul_f32 v28, v28, v30
    v_mul_f32 v29, v29, v31
    v_mul_f32 v32, v32, v34
    v_mul_f32 v33, v33, v35
    v_cvt_pk_bf16_f32 v80, v28, v29
    v_cvt_pk_bf16_f32 v81, v32, v33
    v_lshlrev_b32 v28, 16, v82
    v_and_b32 v29, s27, v82
    v_lshlrev_b32 v30, 16, v162
    v_and_b32 v31, s27, v162
    v_lshlrev_b32 v32, 16, v83
    v_and_b32 v33, s27, v83
    v_lshlrev_b32 v34, 16, v163
    v_and_b32 v35, s27, v163
    v_mul_f32 v28, v28, v30
    v_mul_f32 v29, v29, v31
    v_mul_f32 v32, v32, v34
    v_mul_f32 v33, v33, v35
    v_cvt_pk_bf16_f32 v82, v28, v29
    v_cvt_pk_bf16_f32 v83, v32, v33
    v_lshlrev_b32 v28, 16, v84
    v_and_b32 v29, s27, v84
    v_lshlrev_b32 v30, 16, v164
    v_and_b32 v31, s27, v164
    v_lshlrev_b32 v32, 16, v85
    v_and_b32 v33, s27, v85
    v_lshlrev_b32 v34, 16, v165
    v_and_b32 v35, s27, v165
    v_mul_f32 v28, v28, v30
    v_mul_f32 v29, v29, v31
    v_mul_f32 v32, v32, v34
    v_mul_f32 v33, v33, v35
    v_cvt_pk_bf16_f32 v84, v28, v29
    v_cvt_pk_bf16_f32 v85, v32, v33
    v_lshlrev_b32 v28, 16, v86
    v_and_b32 v29, s27, v86
    v_lshlrev_b32 v30, 16, v166
    v_and_b32 v31, s27, v166
    v_lshlrev_b32 v32, 16, v87
    v_and_b32 v33, s27, v87
    v_lshlrev_b32 v34, 16, v167
    v_and_b32 v35, s27, v167
    v_mul_f32 v28, v28, v30
    v_mul_f32 v29, v29, v31
    v_mul_f32 v32, v32, v34
    v_mul_f32 v33, v33, v35
    v_cvt_pk_bf16_f32 v86, v28, v29
    v_cvt_pk_bf16_f32 v87, v32, v33
    s_add_u32 s31, s38, 1
    s_mul_i32 s31, s31, 54
    s_lshr_b32 s34, s39, 4
    s_add_u32 s31, s31, s34
    s_add_u32 s31, s31, 0
    s_lshl_b32 s31, s31, 10
    buffer_store_dwordx4 v[80:83], v26, s[12:15], s31 offen offset:0
    buffer_store_dwordx4 v[84:87], v26, s[12:15], s31 offen offset:1024
spwo_kernel_sp_skip_9:
    s_add_u32 s31, s39, 32
    s_cmp_ge_u32 s31, 864
    s_cbranch_scc1 spwo_kernel_sp_skip_10
    v_cvt_pk_bf16_f32 v28, v96, v97
    v_lshlrev_b32 v96, 16, v28
    v_and_b32 v97, s27, v28
    v_cvt_pk_bf16_f32 v32, v98, v99
    v_lshlrev_b32 v98, 16, v32
    v_and_b32 v99, s27, v32
    v_add_f32 v96, v96, v7
    v_add_f32 v97, v97, v7
    v_add_f32 v98, v98, v7
    v_add_f32 v99, v99, v7
    v_cvt_pk_bf16_f32 v96, v96, v97
    v_cvt_pk_bf16_f32 v97, v98, v99
    v_cvt_pk_bf16_f32 v28, v100, v101
    v_lshlrev_b32 v100, 16, v28
    v_and_b32 v101, s27, v28
    v_cvt_pk_bf16_f32 v32, v102, v103
    v_lshlrev_b32 v102, 16, v32
    v_and_b32 v103, s27, v32
    v_add_f32 v100, v100, v7
    v_add_f32 v101, v101, v7
    v_add_f32 v102, v102, v7
    v_add_f32 v103, v103, v7
    v_cvt_pk_bf16_f32 v98, v100, v101
    v_cvt_pk_bf16_f32 v99, v102, v103
    v_cvt_pk_bf16_f32 v28, v104, v105
    v_lshlrev_b32 v104, 16, v28
    v_and_b32 v105, s27, v28
    v_cvt_pk_bf16_f32 v32, v106, v107
    v_lshlrev_b32 v106, 16, v32
    v_and_b32 v107, s27, v32
    v_add_f32 v104, v104, v7
    v_add_f32 v105, v105, v7
    v_add_f32 v106, v106, v7
    v_add_f32 v107, v107, v7
    v_cvt_pk_bf16_f32 v100, v104, v105
    v_cvt_pk_bf16_f32 v101, v106, v107
    v_cvt_pk_bf16_f32 v28, v108, v109
    v_lshlrev_b32 v108, 16, v28
    v_and_b32 v109, s27, v28
    v_cvt_pk_bf16_f32 v32, v110, v111
    v_lshlrev_b32 v110, 16, v32
    v_and_b32 v111, s27, v32
    v_add_f32 v108, v108, v7
    v_add_f32 v109, v109, v7
    v_add_f32 v110, v110, v7
    v_add_f32 v111, v111, v7
    v_cvt_pk_bf16_f32 v102, v108, v109
    v_cvt_pk_bf16_f32 v103, v110, v111
    s_nop 1
    v_permlane32_swap_b32 v96, v98
    v_permlane32_swap_b32 v97, v99
    v_permlane32_swap_b32 v100, v102
    v_permlane32_swap_b32 v101, v103
    s_nop 1
    v_lshlrev_b32 v28, 16, v96
    v_and_b32 v29, s27, v96
    v_lshlrev_b32 v30, 16, v168
    v_and_b32 v31, s27, v168
    v_lshlrev_b32 v32, 16, v97
    v_and_b32 v33, s27, v97
    v_lshlrev_b32 v34, 16, v169
    v_and_b32 v35, s27, v169
    v_mul_f32 v28, v28, v30
    v_mul_f32 v29, v29, v31
    v_mul_f32 v32, v32, v34
    v_mul_f32 v33, v33, v35
    v_cvt_pk_bf16_f32 v96, v28, v29
    v_cvt_pk_bf16_f32 v97, v32, v33
    v_lshlrev_b32 v28, 16, v98
    v_and_b32 v29, s27, v98
    v_lshlrev_b32 v30, 16, v170
    v_and_b32 v31, s27, v170
    v_lshlrev_b32 v32, 16, v99
    v_and_b32 v33, s27, v99
    v_lshlrev_b32 v34, 16, v171
    v_and_b32 v35, s27, v171
    v_mul_f32 v28, v28, v30
    v_mul_f32 v29, v29, v31
    v_mul_f32 v32, v32, v34
    v_mul_f32 v33, v33, v35
    v_cvt_pk_bf16_f32 v98, v28, v29
    v_cvt_pk_bf16_f32 v99, v32, v33
    v_lshlrev_b32 v28, 16, v100
    v_and_b32 v29, s27, v100
    v_lshlrev_b32 v30, 16, v172
    v_and_b32 v31, s27, v172
    v_lshlrev_b32 v32, 16, v101
    v_and_b32 v33, s27, v101
    v_lshlrev_b32 v34, 16, v173
    v_and_b32 v35, s27, v173
    v_mul_f32 v28, v28, v30
    v_mul_f32 v29, v29, v31
    v_mul_f32 v32, v32, v34
    v_mul_f32 v33, v33, v35
    v_cvt_pk_bf16_f32 v100, v28, v29
    v_cvt_pk_bf16_f32 v101, v32, v33
    v_lshlrev_b32 v28, 16, v102
    v_and_b32 v29, s27, v102
    v_lshlrev_b32 v30, 16, v174
    v_and_b32 v31, s27, v174
    v_lshlrev_b32 v32, 16, v103
    v_and_b32 v33, s27, v103
    v_lshlrev_b32 v34, 16, v175
    v_and_b32 v35, s27, v175
    v_mul_f32 v28, v28, v30
    v_mul_f32 v29, v29, v31
    v_mul_f32 v32, v32, v34
    v_mul_f32 v33, v33, v35
    v_cvt_pk_bf16_f32 v102, v28, v29
    v_cvt_pk_bf16_f32 v103, v32, v33
    s_add_u32 s31, s38, 1
    s_mul_i32 s31, s31, 54
    s_lshr_b32 s34, s39, 4
    s_add_u32 s31, s31, s34
    s_add_u32 s31, s31, 2
    s_lshl_b32 s31, s31, 10
    buffer_store_dwordx4 v[96:99], v26, s[12:15], s31 offen offset:0
    buffer_store_dwordx4 v[100:103], v26, s[12:15], s31 offen offset:1024
spwo_kernel_sp_skip_10:
    s_endpgm
spwo_kernel_wo:
    s_load_dwordx2 s[4:5], s[0:1], 96
    s_load_dwordx2 s[8:9], s[0:1], 32
    s_load_dwordx2 s[12:13], s[0:1], 96
    v_lshrrev_b32 v1, 6, v0
    v_and_b32 v2, 63, v0
    s_nop 0
    v_readfirstlane_b32 s24, v1
    s_waitcnt lgkmcnt(0)
    s_add_u32 s4, s4, 50331648
    s_addc_u32 s5, s5, 0
    s_mov_b32 s6, 16777216
    s_mov_b32 s7, 0x20000
    s_mov_b32 s10, 5242880
    s_mov_b32 s11, 0x20000
    s_add_u32 s12, s12, 20971520
    s_addc_u32 s13, s13, 0
    s_mov_b32 s14, 7864320
    s_mov_b32 s15, 0x20000
    s_mul_i32 s42, s40, 13
    s_lshr_b32 s42, s42, 6
    s_mul_i32 s43, s42, 5
    s_sub_u32 s43, s40, s43
    s_mul_i32 s45, s41, 3
    s_add_u32 s45, s45, s42
    s_lshr_b32 s42, s45, 3
    s_and_b32 s45, s45, 7
    s_lshl_b32 s29, s45, 8
    s_lshl_b32 s30, s43, 7
    s_mul_i32 s37, s42, 22
    s_mul_i32 s44, s42, 2621440
    s_and_b32 s33, s24, 0
    s_lshr_b32 s32, s24, 0
    s_lshr_b32 s38, s29, 5
    s_mul_i32 s31, s32, 2
    s_add_u32 s38, s38, s31
    v_lshlrev_b32 v16, 4, v2
    v_lshlrev_b32 v17, 4, v2
    v_add_u32 v17, 262144, v17
    s_mul_i32 s26, s38, 262144
    s_lshl_b32 s31, s37, 12
    s_add_u32 s26, s26, s31
    v_lshrrev_b32 v3, 4, v2
    v_and_b32 v4, 15, v2
    s_mul_i32 s31, s24, 16
    v_add_u32 v3, s31, v3
    s_mov_b32 s34, 1280
    s_lshl_b32 s35, s30, 1
    v_add_u32 v5, 0, v3
    v_and_b32 v6, 3, v5
    v_lshlrev_b32 v6, 2, v6
    v_xor_b32 v6, v6, v4
    v_mul_lo_u32 v5, v5, s34
    v_lshl_add_u32 v5, v6, 4, v5
    v_add_u32 v5, s35, v5
    v_mov_b32 v20, v5
    v_add_u32 v5, 4, v3
    v_and_b32 v6, 3, v5
    v_lshlrev_b32 v6, 2, v6
    v_xor_b32 v6, v6, v4
    v_mul_lo_u32 v5, v5, s34
    v_lshl_add_u32 v5, v6, 4, v5
    v_add_u32 v5, s35, v5
    v_subrev_u32 v5, 1024, v5
    v_mov_b32 v21, v5
    v_add_u32 v5, 8, v3
    v_and_b32 v6, 3, v5
    v_lshlrev_b32 v6, 2, v6
    v_xor_b32 v6, v6, v4
    v_mul_lo_u32 v5, v5, s34
    v_lshl_add_u32 v5, v6, 4, v5
    v_add_u32 v5, s35, v5
    v_subrev_u32 v5, 2048, v5
    v_mov_b32 v22, v5
    v_add_u32 v5, 12, v3
    v_and_b32 v6, 3, v5
    v_lshlrev_b32 v6, 2, v6
    v_xor_b32 v6, v6, v4
    v_mul_lo_u32 v5, v5, s34
    v_lshl_add_u32 v5, v6, 4, v5
    v_add_u32 v5, s35, v5
    v_subrev_u32 v5, 3072, v5
    v_mov_b32 v23, v5
    s_mul_i32 s25, s24, 0
    s_mul_i32 s36, s24, 4096
    s_mul_i32 s27, s37, 81920
    s_add_u32 m0, s36, 0
    s_nop 0
    buffer_load_dwordx4 v20, s[8:11], s27 offen offset:0 lds
    buffer_load_dwordx4 v21, s[8:11], s27 offen offset:1024 lds
    buffer_load_dwordx4 v22, s[8:11], s27 offen offset:2048 lds
    buffer_load_dwordx4 v23, s[8:11], s27 offen offset:3072 lds
    s_add_u32 s27, s27, 81920
    buffer_load_dwordx4 a[0:3], v16, s[4:7], s26 offen offset:0
    buffer_load_dwordx4 a[4:7], v16, s[4:7], s26 offen offset:1024
    buffer_load_dwordx4 a[8:11], v16, s[4:7], s26 offen offset:2048
    buffer_load_dwordx4 a[12:15], v16, s[4:7], s26 offen offset:3072
    buffer_load_dwordx4 a[16:19], v17, s[4:7], s26 offen offset:0
    buffer_load_dwordx4 a[20:23], v17, s[4:7], s26 offen offset:1024
    buffer_load_dwordx4 a[24:27], v17, s[4:7], s26 offen offset:2048
    buffer_load_dwordx4 a[28:31], v17, s[4:7], s26 offen offset:3072
    s_add_u32 s26, s26, 4096
    v_and_b32 v3, 31, v2
    v_lshrrev_b32 v4, 5, v2
    v_bfe_u32 v5, v2, 2, 2
    v_lshl_add_u32 v6, v4, 3, v5
    v_mul_u32_u24 v6, 256, v6
    v_and_b32 v7, 3, v2
    v_lshl_add_u32 v6, v7, 3, v6
    v_bfe_u32 v7, v2, 4, 1
    v_lshl_add_u32 v6, v7, 5, v6
    s_mul_i32 s31, s33, 4
    s_add_u32 s34, s31, 0
    v_xor_b32 v7, s34, v5
    v_lshl_add_u32 v12, v7, 6, v6
    s_add_u32 s34, s31, 1
    v_xor_b32 v7, s34, v5
    v_lshl_add_u32 v13, v7, 6, v6
    s_add_u32 s34, s31, 2
    v_xor_b32 v7, s34, v5
    v_lshl_add_u32 v14, v7, 6, v6
    s_add_u32 s34, s31, 3
    v_xor_b32 v7, s34, v5
    v_lshl_add_u32 v15, v7, 6, v6
    s_mul_i32 s31, s33, 128
    s_add_u32 s39, s30, s31
    v_lshlrev_b32 v26, 4, v2
    s_add_u32 m0, s36, 16384
    s_nop 0
    buffer_load_dwordx4 v20, s[8:11], s27 offen offset:0 lds
    buffer_load_dwordx4 v21, s[8:11], s27 offen offset:1024 lds
    buffer_load_dwordx4 v22, s[8:11], s27 offen offset:2048 lds
    buffer_load_dwordx4 v23, s[8:11], s27 offen offset:3072 lds
    s_add_u32 s27, s27, 81920
    buffer_load_dwordx4 a[32:35], v16, s[4:7], s26 offen offset:0
    buffer_load_dwordx4 a[36:39], v16, s[4:7], s26 offen offset:1024
    buffer_load_dwordx4 a[40:43], v16, s[4:7], s26 offen offset:2048
    buffer_load_dwordx4 a[44:47], v16, s[4:7], s26 offen offset:3072
    buffer_load_dwordx4 a[48:51], v17, s[4:7], s26 offen offset:0
    buffer_load_dwordx4 a[52:55], v17, s[4:7], s26 offen offset:1024
    buffer_load_dwordx4 a[56:59], v17, s[4:7], s26 offen offset:2048
    buffer_load_dwordx4 a[60:63], v17, s[4:7], s26 offen offset:3072
    s_add_u32 s26, s26, 4096
    v_mov_b32 v48, 0
    v_mov_b32 v49, 0
    v_mov_b32 v50, 0
    v_mov_b32 v51, 0
    v_mov_b32 v52, 0
    v_mov_b32 v53, 0
    v_mov_b32 v54, 0
    v_mov_b32 v55, 0
    v_mov_b32 v56, 0
    v_mov_b32 v57, 0
    v_mov_b32 v58, 0
    v_mov_b32 v59, 0
    v_mov_b32 v60, 0
    v_mov_b32 v61, 0
    v_mov_b32 v62, 0
    v_mov_b32 v63, 0
    v_mov_b32 v64, 0
    v_mov_b32 v65, 0
    v_mov_b32 v66, 0
    v_mov_b32 v67, 0
    v_mov_b32 v68, 0
    v_mov_b32 v69, 0
    v_mov_b32 v70, 0
    v_mov_b32 v71, 0
    v_mov_b32 v72, 0
    v_mov_b32 v73, 0
    v_mov_b32 v74, 0
    v_mov_b32 v75, 0
    v_mov_b32 v76, 0
    v_mov_b32 v77, 0
    v_mov_b32 v78, 0
    v_mov_b32 v79, 0
    v_mov_b32 v80, 0
    v_mov_b32 v81, 0
    v_mov_b32 v82, 0
    v_mov_b32 v83, 0
    v_mov_b32 v84, 0
    v_mov_b32 v85, 0
    v_mov_b32 v86, 0
    v_mov_b32 v87, 0
    v_mov_b32 v88, 0
    v_mov_b32 v89, 0
    v_mov_b32 v90, 0
    v_mov_b32 v91, 0
    v_mov_b32 v92, 0
    v_mov_b32 v93, 0
    v_mov_b32 v94, 0
    v_mov_b32 v95, 0
    v_mov_b32 v96, 0
    v_mov_b32 v97, 0
    v_mov_b32 v98, 0
    v_mov_b32 v99, 0
    v_mov_b32 v100, 0
    v_mov_b32 v101, 0
    v_mov_b32 v102, 0
    v_mov_b32 v103, 0
    v_mov_b32 v104, 0
    v_mov_b32 v105, 0
    v_mov_b32 v106, 0
    v_mov_b32 v107, 0
    v_mov_b32 v108, 0
    v_mov_b32 v109, 0
    v_mov_b32 v110, 0
    v_mov_b32 v111, 0
    v_mov_b32 v112, 0
    v_mov_b32 v113, 0
    v_mov_b32 v114, 0
    v_mov_b32 v115, 0
    v_mov_b32 v116, 0
    v_mov_b32 v117, 0
    v_mov_b32 v118, 0
    v_mov_b32 v119, 0
    v_mov_b32 v120, 0
    v_mov_b32 v121, 0
    v_mov_b32 v122, 0
    v_mov_b32 v123, 0
    v_mov_b32 v124, 0
    v_mov_b32 v125, 0
    v_mov_b32 v126, 0
    v_mov_b32 v127, 0
    v_mov_b32 v128, 0
    v_mov_b32 v129, 0
    v_mov_b32 v130, 0
    v_mov_b32 v131, 0
    v_mov_b32 v132, 0
    v_mov_b32 v133, 0
    v_mov_b32 v134, 0
    v_mov_b32 v135, 0
    v_mov_b32 v136, 0
    v_mov_b32 v137, 0
    v_mov_b32 v138, 0
    v_mov_b32 v139, 0
    v_mov_b32 v140, 0
    v_mov_b32 v141, 0
    v_mov_b32 v142, 0
    v_mov_b32 v143, 0
    v_mov_b32 v144, 0
    v_mov_b32 v145, 0
    v_mov_b32 v146, 0
    v_mov_b32 v147, 0
    v_mov_b32 v148, 0
    v_mov_b32 v149, 0
    v_mov_b32 v150, 0
    v_mov_b32 v151, 0
    v_mov_b32 v152, 0
    v_mov_b32 v153, 0
    v_mov_b32 v154, 0
    v_mov_b32 v155, 0
    v_mov_b32 v156, 0
    v_mov_b32 v157, 0
    v_mov_b32 v158, 0
    v_mov_b32 v159, 0
    v_mov_b32 v160, 0
    v_mov_b32 v161, 0
    v_mov_b32 v162, 0
    v_mov_b32 v163, 0
    v_mov_b32 v164, 0
    v_mov_b32 v165, 0
    v_mov_b32 v166, 0
    v_mov_b32 v167, 0
    v_mov_b32 v168, 0
    v_mov_b32 v169, 0
    v_mov_b32 v170, 0
    v_mov_b32 v171, 0
    v_mov_b32 v172, 0
    v_mov_b32 v173, 0
    v_mov_b32 v174, 0
    v_mov_b32 v175, 0
    s_add_u32 m0, s36, 32768
    s_nop 0
    buffer_load_dwordx4 v20, s[8:11], s27 offen offset:0 lds
    buffer_load_dwordx4 v21, s[8:11], s27 offen offset:1024 lds
    buffer_load_dwordx4 v22, s[8:11], s27 offen offset:2048 lds
    buffer_load_dwordx4 v23, s[8:11], s27 offen offset:3072 lds
    s_add_u32 s27, s27, 81920
    buffer_load_dwordx4 a[64:67], v16, s[4:7], s26 offen offset:0
    buffer_load_dwordx4 a[68:71], v16, s[4:7], s26 offen offset:1024
    buffer_load_dwordx4 a[72:75], v16, s[4:7], s26 offen offset:2048
    buffer_load_dwordx4 a[76:79], v16, s[4:7], s26 offen offset:3072
    buffer_load_dwordx4 a[80:83], v17, s[4:7], s26 offen offset:0
    buffer_load_dwordx4 a[84:87], v17, s[4:7], s26 offen offset:1024
    buffer_load_dwordx4 a[88:91], v17, s[4:7], s26 offen offset:2048
    buffer_load_dwordx4 a[92:95], v17, s[4:7], s26 offen offset:3072
    s_add_u32 s26, s26, 4096
    s_add_u32 m0, s36, 49152
    s_nop 0
    buffer_load_dwordx4 v20, s[8:11], s27 offen offset:0 lds
    buffer_load_dwordx4 v21, s[8:11], s27 offen offset:1024 lds
    buffer_load_dwordx4 v22, s[8:11], s27 offen offset:2048 lds
    buffer_load_dwordx4 v23, s[8:11], s27 offen offset:3072 lds
    s_add_u32 s27, s27, 81920
    s_waitcnt vmcnt(28)
    s_barrier
    ds_read_b64_tr_b16 v[176:177], v12 offset:0
    ds_read_b64_tr_b16 v[178:179], v12 offset:1024
    ds_read_b64_tr_b16 v[180:181], v13 offset:0
    ds_read_b64_tr_b16 v[182:183], v13 offset:1024
    ds_read_b64_tr_b16 v[184:185], v14 offset:0
    ds_read_b64_tr_b16 v[186:187], v14 offset:1024
    ds_read_b64_tr_b16 v[188:189], v15 offset:0
    ds_read_b64_tr_b16 v[190:191], v15 offset:1024
    s_waitcnt lgkmcnt(0)
    v_mfma_f32_32x32x16_bf16 v[48:63], v[176:179], a[0:3], v[48:63]
    ds_read_b64_tr_b16 v[192:193], v12 offset:4096
    ds_read_b64_tr_b16 v[194:195], v12 offset:5120
    v_mfma_f32_32x32x16_bf16 v[64:79], v[180:183], a[0:3], v[64:79]
    ds_read_b64_tr_b16 v[196:197], v13 offset:4096
    ds_read_b64_tr_b16 v[198:199], v13 offset:5120
    v_mfma_f32_32x32x16_bf16 v[80:95], v[184:187], a[0:3], v[80:95]
    ds_read_b64_tr_b16 v[200:201], v14 offset:4096
    ds_read_b64_tr_b16 v[202:203], v14 offset:5120
    v_mfma_f32_32x32x16_bf16 v[96:111], v[188:191], a[0:3], v[96:111]
    ds_read_b64_tr_b16 v[204:205], v15 offset:4096
    ds_read_b64_tr_b16 v[206:207], v15 offset:5120
    v_mfma_f32_32x32x16_bf16 v[112:127], v[176:179], a[16:19], v[112:127]
    v_mfma_f32_32x32x16_bf16 v[128:143], v[180:183], a[16:19], v[128:143]
    buffer_load_dwordx4 a[96:99], v16, s[4:7], s26 offen offset:0
    v_mfma_f32_32x32x16_bf16 v[144:159], v[184:187], a[16:19], v[144:159]
    buffer_load_dwordx4 a[100:103], v16, s[4:7], s26 offen offset:1024
    v_mfma_f32_32x32x16_bf16 v[160:175], v[188:191], a[16:19], v[160:175]
    buffer_load_dwordx4 a[104:107], v16, s[4:7], s26 offen offset:2048
    s_waitcnt lgkmcnt(0)
    v_mfma_f32_32x32x16_bf16 v[48:63], v[192:195], a[4:7], v[48:63]
    ds_read_b64_tr_b16 v[176:177], v12 offset:8192
    ds_read_b64_tr_b16 v[178:179], v12 offset:9216
    v_mfma_f32_32x32x16_bf16 v[64:79], v[196:199], a[4:7], v[64:79]
    ds_read_b64_tr_b16 v[180:181], v13 offset:8192
    ds_read_b64_tr_b16 v[182:183], v13 offset:9216
    v_mfma_f32_32x32x16_bf16 v[80:95], v[200:203], a[4:7], v[80:95]
    ds_read_b64_tr_b16 v[184:185], v14 offset:8192
    ds_read_b64_tr_b16 v[186:187], v14 offset:9216
    v_mfma_f32_32x32x16_bf16 v[96:111], v[204:207], a[4:7], v[96:111]
    ds_read_b64_tr_b16 v[188:189], v15 offset:8192
    ds_read_b64_tr_b16 v[190:191], v15 offset:9216
    v_mfma_f32_32x32x16_bf16 v[112:127], v[192:195], a[20:23], v[112:127]
    v_mfma_f32_32x32x16_bf16 v[128:143], v[196:199], a[20:23], v[128:143]
    buffer_load_dwordx4 a[108:111], v16, s[4:7], s26 offen offset:3072
    v_mfma_f32_32x32x16_bf16 v[144:159], v[200:203], a[20:23], v[144:159]
    buffer_load_dwordx4 a[112:115], v17, s[4:7], s26 offen offset:0
    v_mfma_f32_32x32x16_bf16 v[160:175], v[204:207], a[20:23], v[160:175]
    buffer_load_dwordx4 a[116:119], v17, s[4:7], s26 offen offset:1024
    s_waitcnt lgkmcnt(0)
    v_mfma_f32_32x32x16_bf16 v[48:63], v[176:179], a[8:11], v[48:63]
    ds_read_b64_tr_b16 v[192:193], v12 offset:12288
    ds_read_b64_tr_b16 v[194:195], v12 offset:13312
    v_mfma_f32_32x32x16_bf16 v[64:79], v[180:183], a[8:11], v[64:79]
    ds_read_b64_tr_b16 v[196:197], v13 offset:12288
    ds_read_b64_tr_b16 v[198:199], v13 offset:13312
    v_mfma_f32_32x32x16_bf16 v[80:95], v[184:187], a[8:11], v[80:95]
    ds_read_b64_tr_b16 v[200:201], v14 offset:12288
    ds_read_b64_tr_b16 v[202:203], v14 offset:13312
    v_mfma_f32_32x32x16_bf16 v[96:111], v[188:191], a[8:11], v[96:111]
    ds_read_b64_tr_b16 v[204:205], v15 offset:12288
    ds_read_b64_tr_b16 v[206:207], v15 offset:13312
    v_mfma_f32_32x32x16_bf16 v[112:127], v[176:179], a[24:27], v[112:127]
    v_mfma_f32_32x32x16_bf16 v[128:143], v[180:183], a[24:27], v[128:143]
    v_mfma_f32_32x32x16_bf16 v[144:159], v[184:187], a[24:27], v[144:159]
    buffer_load_dwordx4 a[120:123], v17, s[4:7], s26 offen offset:2048
    v_mfma_f32_32x32x16_bf16 v[160:175], v[188:191], a[24:27], v[160:175]
    buffer_load_dwordx4 a[124:127], v17, s[4:7], s26 offen offset:3072
    s_add_u32 s26, s26, 4096
    s_waitcnt vmcnt(24) lgkmcnt(0)
    s_barrier
    v_mfma_f32_32x32x16_bf16 v[48:63], v[192:195], a[12:15], v[48:63]
    ds_read_b64_tr_b16 v[176:177], v12 offset:16384
    ds_read_b64_tr_b16 v[178:179], v12 offset:17408
    v_mfma_f32_32x32x16_bf16 v[64:79], v[196:199], a[12:15], v[64:79]
    ds_read_b64_tr_b16 v[180:181], v13 offset:16384
    ds_read_b64_tr_b16 v[182:183], v13 offset:17408
    v_mfma_f32_32x32x16_bf16 v[80:95], v[200:203], a[12:15], v[80:95]
    ds_read_b64_tr_b16 v[184:185], v14 offset:16384
    ds_read_b64_tr_b16 v[186:187], v14 offset:17408
    v_mfma_f32_32x32x16_bf16 v[96:111], v[204:207], a[12:15], v[96:111]
    ds_read_b64_tr_b16 v[188:189], v15 offset:16384
    ds_read_b64_tr_b16 v[190:191], v15 offset:17408
    v_mfma_f32_32x32x16_bf16 v[112:127], v[192:195], a[28:31], v[112:127]
    v_mfma_f32_32x32x16_bf16 v[128:143], v[196:199], a[28:31], v[128:143]
    v_mfma_f32_32x32x16_bf16 v[144:159], v[200:203], a[28:31], v[144:159]
    v_mfma_f32_32x32x16_bf16 v[160:175], v[204:207], a[28:31], v[160:175]
    s_add_u32 m0, s36, 0
    s_nop 0
    buffer_load_dwordx4 v20, s[8:11], s27 offen offset:0 lds
    s_waitcnt lgkmcnt(0)
    v_mfma_f32_32x32x16_bf16 v[48:63], v[176:179], a[32:35], v[48:63]
    ds_read_b64_tr_b16 v[192:193], v12 offset:20480
    ds_read_b64_tr_b16 v[194:195], v12 offset:21504
    v_mfma_f32_32x32x16_bf16 v[64:79], v[180:183], a[32:35], v[64:79]
    ds_read_b64_tr_b16 v[196:197], v13 offset:20480
    ds_read_b64_tr_b16 v[198:199], v13 offset:21504
    v_mfma_f32_32x32x16_bf16 v[80:95], v[184:187], a[32:35], v[80:95]
    ds_read_b64_tr_b16 v[200:201], v14 offset:20480
    ds_read_b64_tr_b16 v[202:203], v14 offset:21504
    v_mfma_f32_32x32x16_bf16 v[96:111], v[188:191], a[32:35], v[96:111]
    ds_read_b64_tr_b16 v[204:205], v15 offset:20480
    ds_read_b64_tr_b16 v[206:207], v15 offset:21504
    v_mfma_f32_32x32x16_bf16 v[112:127], v[176:179], a[48:51], v[112:127]
    buffer_load_dwordx4 v21, s[8:11], s27 offen offset:1024 lds
    v_mfma_f32_32x32x16_bf16 v[128:143], v[180:183], a[48:51], v[128:143]
    buffer_load_dwordx4 v22, s[8:11], s27 offen offset:2048 lds
    v_mfma_f32_32x32x16_bf16 v[144:159], v[184:187], a[48:51], v[144:159]
    buffer_load_dwordx4 v23, s[8:11], s27 offen offset:3072 lds
    s_add_u32 s27, s27, 81920
    v_mfma_f32_32x32x16_bf16 v[160:175], v[188:191], a[48:51], v[160:175]
    buffer_load_dwordx4 a[0:3], v16, s[4:7], s26 offen offset:0
    s_waitcnt lgkmcnt(0)
    v_mfma_f32_32x32x16_bf16 v[48:63], v[192:195], a[36:39], v[48:63]
    ds_read_b64_tr_b16 v[176:177], v12 offset:24576
    ds_read_b64_tr_b16 v[178:179], v12 offset:25600
    v_mfma_f32_32x32x16_bf16 v[64:79], v[196:199], a[36:39], v[64:79]
    ds_read_b64_tr_b16 v[180:181], v13 offset:24576
    ds_read_b64_tr_b16 v[182:183], v13 offset:25600
    v_mfma_f32_32x32x16_bf16 v[80:95], v[200:203], a[36:39], v[80:95]
    ds_read_b64_tr_b16 v[184:185], v14 offset:24576
    ds_read_b64_tr_b16 v[186:187], v14 offset:25600
    v_mfma_f32_32x32x16_bf16 v[96:111], v[204:207], a[36:39], v[96:111]
    ds_read_b64_tr_b16 v[188:189], v15 offset:24576
    ds_read_b64_tr_b16 v[190:191], v15 offset:25600
    v_mfma_f32_32x32x16_bf16 v[112:127], v[192:195], a[52:55], v[112:127]
    buffer_load_dwordx4 a[4:7], v16, s[4:7], s26 offen offset:1024
    v_mfma_f32_32x32x16_bf16 v[128:143], v[196:199], a[52:55], v[128:143]
    buffer_load_dwordx4 a[8:11], v16, s[4:7], s26 offen offset:2048
    v_mfma_f32_32x32x16_bf16 v[144:159], v[200:203], a[52:55], v[144:159]
    buffer_load_dwordx4 a[12:15], v16, s[4:7], s26 offen offset:3072
    v_mfma_f32_32x32x16_bf16 v[160:175], v[204:207], a[52:55], v[160:175]
    buffer_load_dwordx4 a[16:19], v17, s[4:7], s26 offen offset:0
    s_waitcnt lgkmcnt(0)
    v_mfma_f32_32x32x16_bf16 v[48:63], v[176:179], a[40:43], v[48:63]
    ds_read_b64_tr_b16 v[192:193], v12 offset:28672
    ds_read_b64_tr_b16 v[194:195], v12 offset:29696
    v_mfma_f32_32x32x16_bf16 v[64:79], v[180:183], a[40:43], v[64:79]
    ds_read_b64_tr_b16 v[196:197], v13 offset:28672
    ds_read_b64_tr_b16 v[198:199], v13 offset:29696
    v_mfma_f32_32x32x16_bf16 v[80:95], v[184:187], a[40:43], v[80:95]
    ds_read_b64_tr_b16 v[200:201], v14 offset:28672
    ds_read_b64_tr_b16 v[202:203], v14 offset:29696
    v_mfma_f32_32x32x16_bf16 v[96:111], v[188:191], a[40:43], v[96:111]
    ds_read_b64_tr_b16 v[204:205], v15 offset:28672
    ds_read_b64_tr_b16 v[206:207], v15 offset:29696
    v_mfma_f32_32x32x16_bf16 v[112:127], v[176:179], a[56:59], v[112:127]
    v_mfma_f32_32x32x16_bf16 v[128:143], v[180:183], a[56:59], v[128:143]
    buffer_load_dwordx4 a[20:23], v17, s[4:7], s26 offen offset:1024
    v_mfma_f32_32x32x16_bf16 v[144:159], v[184:187], a[56:59], v[144:159]
    buffer_load_dwordx4 a[24:27], v17, s[4:7], s26 offen offset:2048
    v_mfma_f32_32x32x16_bf16 v[160:175], v[188:191], a[56:59], v[160:175]
    buffer_load_dwordx4 a[28:31], v17, s[4:7], s26 offen offset:3072
    s_add_u32 s26, s26, 4096
    s_waitcnt vmcnt(24) lgkmcnt(0)
    s_barrier
    v_mfma_f32_32x32x16_bf16 v[48:63], v[192:195], a[44:47], v[48:63]
    ds_read_b64_tr_b16 v[176:177], v12 offset:32768
    ds_read_b64_tr_b16 v[178:179], v12 offset:33792
    v_mfma_f32_32x32x16_bf16 v[64:79], v[196:199], a[44:47], v[64:79]
    ds_read_b64_tr_b16 v[180:181], v13 offset:32768
    ds_read_b64_tr_b16 v[182:183], v13 offset:33792
    v_mfma_f32_32x32x16_bf16 v[80:95], v[200:203], a[44:47], v[80:95]
    ds_read_b64_tr_b16 v[184:185], v14 offset:32768
    ds_read_b64_tr_b16 v[186:187], v14 offset:33792
    v_mfma_f32_32x32x16_bf16 v[96:111], v[204:207], a[44:47], v[96:111]
    ds_read_b64_tr_b16 v[188:189], v15 offset:32768
    ds_read_b64_tr_b16 v[190:191], v15 offset:33792
    v_mfma_f32_32x32x16_bf16 v[112:127], v[192:195], a[60:63], v[112:127]
    v_mfma_f32_32x32x16_bf16 v[128:143], v[196:199], a[60:63], v[128:143]
    v_mfma_f32_32x32x16_bf16 v[144:159], v[200:203], a[60:63], v[144:159]
    v_mfma_f32_32x32x16_bf16 v[160:175], v[204:207], a[60:63], v[160:175]
    s_add_u32 m0, s36, 16384
    s_nop 0
    buffer_load_dwordx4 v20, s[8:11], s27 offen offset:0 lds
    s_waitcnt lgkmcnt(0)
    v_mfma_f32_32x32x16_bf16 v[48:63], v[176:179], a[64:67], v[48:63]
    ds_read_b64_tr_b16 v[192:193], v12 offset:36864
    ds_read_b64_tr_b16 v[194:195], v12 offset:37888
    v_mfma_f32_32x32x16_bf16 v[64:79], v[180:183], a[64:67], v[64:79]
    ds_read_b64_tr_b16 v[196:197], v13 offset:36864
    ds_read_b64_tr_b16 v[198:199], v13 offset:37888
    v_mfma_f32_32x32x16_bf16 v[80:95], v[184:187], a[64:67], v[80:95]
    ds_read_b64_tr_b16 v[200:201], v14 offset:36864
    ds_read_b64_tr_b16 v[202:203], v14 offset:37888
    v_mfma_f32_32x32x16_bf16 v[96:111], v[188:191], a[64:67], v[96:111]
    ds_read_b64_tr_b16 v[204:205], v15 offset:36864
    ds_read_b64_tr_b16 v[206:207], v15 offset:37888
    v_mfma_f32_32x32x16_bf16 v[112:127], v[176:179], a[80:83], v[112:127]
    buffer_load_dwordx4 v21, s[8:11], s27 offen offset:1024 lds
    v_mfma_f32_32x32x16_bf16 v[128:143], v[180:183], a[80:83], v[128:143]
    buffer_load_dwordx4 v22, s[8:11], s27 offen offset:2048 lds
    v_mfma_f32_32x32x16_bf16 v[144:159], v[184:187], a[80:83], v[144:159]
    buffer_load_dwordx4 v23, s[8:11], s27 offen offset:3072 lds
    s_add_u32 s27, s27, 81920
    v_mfma_f32_32x32x16_bf16 v[160:175], v[188:191], a[80:83], v[160:175]
    buffer_load_dwordx4 a[32:35], v16, s[4:7], s26 offen offset:0
    s_waitcnt lgkmcnt(0)
    v_mfma_f32_32x32x16_bf16 v[48:63], v[192:195], a[68:71], v[48:63]
    ds_read_b64_tr_b16 v[176:177], v12 offset:40960
    ds_read_b64_tr_b16 v[178:179], v12 offset:41984
    v_mfma_f32_32x32x16_bf16 v[64:79], v[196:199], a[68:71], v[64:79]
    ds_read_b64_tr_b16 v[180:181], v13 offset:40960
    ds_read_b64_tr_b16 v[182:183], v13 offset:41984
    v_mfma_f32_32x32x16_bf16 v[80:95], v[200:203], a[68:71], v[80:95]
    ds_read_b64_tr_b16 v[184:185], v14 offset:40960
    ds_read_b64_tr_b16 v[186:187], v14 offset:41984
    v_mfma_f32_32x32x16_bf16 v[96:111], v[204:207], a[68:71], v[96:111]
    ds_read_b64_tr_b16 v[188:189], v15 offset:40960
    ds_read_b64_tr_b16 v[190:191], v15 offset:41984
    v_mfma_f32_32x32x16_bf16 v[112:127], v[192:195], a[84:87], v[112:127]
    buffer_load_dwordx4 a[36:39], v16, s[4:7], s26 offen offset:1024
    v_mfma_f32_32x32x16_bf16 v[128:143], v[196:199], a[84:87], v[128:143]
    buffer_load_dwordx4 a[40:43], v16, s[4:7], s26 offen offset:2048
    v_mfma_f32_32x32x16_bf16 v[144:159], v[200:203], a[84:87], v[144:159]
    buffer_load_dwordx4 a[44:47], v16, s[4:7], s26 offen offset:3072
    v_mfma_f32_32x32x16_bf16 v[160:175], v[204:207], a[84:87], v[160:175]
    buffer_load_dwordx4 a[48:51], v17, s[4:7], s26 offen offset:0
    s_waitcnt lgkmcnt(0)
    v_mfma_f32_32x32x16_bf16 v[48:63], v[176:179], a[72:75], v[48:63]
    ds_read_b64_tr_b16 v[192:193], v12 offset:45056
    ds_read_b64_tr_b16 v[194:195], v12 offset:46080
    v_mfma_f32_32x32x16_bf16 v[64:79], v[180:183], a[72:75], v[64:79]
    ds_read_b64_tr_b16 v[196:197], v13 offset:45056
    ds_read_b64_tr_b16 v[198:199], v13 offset:46080
    v_mfma_f32_32x32x16_bf16 v[80:95], v[184:187], a[72:75], v[80:95]
    ds_read_b64_tr_b16 v[200:201], v14 offset:45056
    ds_read_b64_tr_b16 v[202:203], v14 offset:46080
    v_mfma_f32_32x32x16_bf16 v[96:111], v[188:191], a[72:75], v[96:111]
    ds_read_b64_tr_b16 v[204:205], v15 offset:45056
    ds_read_b64_tr_b16 v[206:207], v15 offset:46080
    v_mfma_f32_32x32x16_bf16 v[112:127], v[176:179], a[88:91], v[112:127]
    v_mfma_f32_32x32x16_bf16 v[128:143], v[180:183], a[88:91], v[128:143]
    buffer_load_dwordx4 a[52:55], v17, s[4:7], s26 offen offset:1024
    v_mfma_f32_32x32x16_bf16 v[144:159], v[184:187], a[88:91], v[144:159]
    buffer_load_dwordx4 a[56:59], v17, s[4:7], s26 offen offset:2048
    v_mfma_f32_32x32x16_bf16 v[160:175], v[188:191], a[88:91], v[160:175]
    buffer_load_dwordx4 a[60:63], v17, s[4:7], s26 offen offset:3072
    s_add_u32 s26, s26, 4096
    s_waitcnt vmcnt(24) lgkmcnt(0)
    s_barrier
    v_mfma_f32_32x32x16_bf16 v[48:63], v[192:195], a[76:79], v[48:63]
    ds_read_b64_tr_b16 v[176:177], v12 offset:49152
    ds_read_b64_tr_b16 v[178:179], v12 offset:50176
    v_mfma_f32_32x32x16_bf16 v[64:79], v[196:199], a[76:79], v[64:79]
    ds_read_b64_tr_b16 v[180:181], v13 offset:49152
    ds_read_b64_tr_b16 v[182:183], v13 offset:50176
    v_mfma_f32_32x32x16_bf16 v[80:95], v[200:203], a[76:79], v[80:95]
    ds_read_b64_tr_b16 v[184:185], v14 offset:49152
    ds_read_b64_tr_b16 v[186:187], v14 offset:50176
    v_mfma_f32_32x32x16_bf16 v[96:111], v[204:207], a[76:79], v[96:111]
    ds_read_b64_tr_b16 v[188:189], v15 offset:49152
    ds_read_b64_tr_b16 v[190:191], v15 offset:50176
    v_mfma_f32_32x32x16_bf16 v[112:127], v[192:195], a[92:95], v[112:127]
    v_mfma_f32_32x32x16_bf16 v[128:143], v[196:199], a[92:95], v[128:143]
    v_mfma_f32_32x32x16_bf16 v[144:159], v[200:203], a[92:95], v[144:159]
    v_mfma_f32_32x32x16_bf16 v[160:175], v[204:207], a[92:95], v[160:175]
    s_add_u32 m0, s36, 32768
    s_nop 0
    buffer_load_dwordx4 v20, s[8:11], s27 offen offset:0 lds
    s_waitcnt lgkmcnt(0)
    v_mfma_f32_32x32x16_bf16 v[48:63], v[176:179], a[96:99], v[48:63]
    ds_read_b64_tr_b16 v[192:193], v12 offset:53248
    ds_read_b64_tr_b16 v[194:195], v12 offset:54272
    v_mfma_f32_32x32x16_bf16 v[64:79], v[180:183], a[96:99], v[64:79]
    ds_read_b64_tr_b16 v[196:197], v13 offset:53248
    ds_read_b64_tr_b16 v[198:199], v13 offset:54272
    v_mfma_f32_32x32x16_bf16 v[80:95], v[184:187], a[96:99], v[80:95]
    ds_read_b64_tr_b16 v[200:201], v14 offset:53248
    ds_read_b64_tr_b16 v[202:203], v14 offset:54272
    v_mfma_f32_32x32x16_bf16 v[96:111], v[188:191], a[96:99], v[96:111]
    ds_read_b64_tr_b16 v[204:205], v15 offset:53248
    ds_read_b64_tr_b16 v[206:207], v15 offset:54272
    v_mfma_f32_32x32x16_bf16 v[112:127], v[176:179], a[112:115], v[112:127]
    buffer_load_dwordx4 v21, s[8:11], s27 offen offset:1024 lds
    v_mfma_f32_32x32x16_bf16 v[128:143], v[180:183], a[112:115], v[128:143]
    buffer_load_dwordx4 v22, s[8:11], s27 offen offset:2048 lds
    v_mfma_f32_32x32x16_bf16 v[144:159], v[184:187], a[112:115], v[144:159]
    buffer_load_dwordx4 v23, s[8:11], s27 offen offset:3072 lds
    s_add_u32 s27, s27, 81920
    v_mfma_f32_32x32x16_bf16 v[160:175], v[188:191], a[112:115], v[160:175]
    buffer_load_dwordx4 a[64:67], v16, s[4:7], s26 offen offset:0
    s_waitcnt lgkmcnt(0)
    v_mfma_f32_32x32x16_bf16 v[48:63], v[192:195], a[100:103], v[48:63]
    ds_read_b64_tr_b16 v[176:177], v12 offset:57344
    ds_read_b64_tr_b16 v[178:179], v12 offset:58368
    v_mfma_f32_32x32x16_bf16 v[64:79], v[196:199], a[100:103], v[64:79]
    ds_read_b64_tr_b16 v[180:181], v13 offset:57344
    ds_read_b64_tr_b16 v[182:183], v13 offset:58368
    v_mfma_f32_32x32x16_bf16 v[80:95], v[200:203], a[100:103], v[80:95]
    ds_read_b64_tr_b16 v[184:185], v14 offset:57344
    ds_read_b64_tr_b16 v[186:187], v14 offset:58368
    v_mfma_f32_32x32x16_bf16 v[96:111], v[204:207], a[100:103], v[96:111]
    ds_read_b64_tr_b16 v[188:189], v15 offset:57344
    ds_read_b64_tr_b16 v[190:191], v15 offset:58368
    v_mfma_f32_32x32x16_bf16 v[112:127], v[192:195], a[116:119], v[112:127]
    buffer_load_dwordx4 a[68:71], v16, s[4:7], s26 offen offset:1024
    v_mfma_f32_32x32x16_bf16 v[128:143], v[196:199], a[116:119], v[128:143]
    buffer_load_dwordx4 a[72:75], v16, s[4:7], s26 offen offset:2048
    v_mfma_f32_32x32x16_bf16 v[144:159], v[200:203], a[116:119], v[144:159]
    buffer_load_dwordx4 a[76:79], v16, s[4:7], s26 offen offset:3072
    v_mfma_f32_32x32x16_bf16 v[160:175], v[204:207], a[116:119], v[160:175]
    buffer_load_dwordx4 a[80:83], v17, s[4:7], s26 offen offset:0
    s_waitcnt lgkmcnt(0)
    v_mfma_f32_32x32x16_bf16 v[48:63], v[176:179], a[104:107], v[48:63]
    ds_read_b64_tr_b16 v[192:193], v12 offset:61440
    ds_read_b64_tr_b16 v[194:195], v12 offset:62464
    v_mfma_f32_32x32x16_bf16 v[64:79], v[180:183], a[104:107], v[64:79]
    ds_read_b64_tr_b16 v[196:197], v13 offset:61440
    ds_read_b64_tr_b16 v[198:199], v13 offset:62464
    v_mfma_f32_32x32x16_bf16 v[80:95], v[184:187], a[104:107], v[80:95]
    ds_read_b64_tr_b16 v[200:201], v14 offset:61440
    ds_read_b64_tr_b16 v[202:203], v14 offset:62464
    v_mfma_f32_32x32x16_bf16 v[96:111], v[188:191], a[104:107], v[96:111]
    ds_read_b64_tr_b16 v[204:205], v15 offset:61440
    ds_read_b64_tr_b16 v[206:207], v15 offset:62464
    v_mfma_f32_32x32x16_bf16 v[112:127], v[176:179], a[120:123], v[112:127]
    v_mfma_f32_32x32x16_bf16 v[128:143], v[180:183], a[120:123], v[128:143]
    buffer_load_dwordx4 a[84:87], v17, s[4:7], s26 offen offset:1024
    v_mfma_f32_32x32x16_bf16 v[144:159], v[184:187], a[120:123], v[144:159]
    buffer_load_dwordx4 a[88:91], v17, s[4:7], s26 offen offset:2048
    v_mfma_f32_32x32x16_bf16 v[160:175], v[188:191], a[120:123], v[160:175]
    buffer_load_dwordx4 a[92:95], v17, s[4:7], s26 offen offset:3072
    s_add_u32 s26, s26, 4096
    s_waitcnt vmcnt(24) lgkmcnt(0)
    s_barrier
    v_mfma_f32_32x32x16_bf16 v[48:63], v[192:195], a[108:111], v[48:63]
    ds_read_b64_tr_b16 v[176:177], v12 offset:0
    ds_read_b64_tr_b16 v[178:179], v12 offset:1024
    v_mfma_f32_32x32x16_bf16 v[64:79], v[196:199], a[108:111], v[64:79]
    ds_read_b64_tr_b16 v[180:181], v13 offset:0
    ds_read_b64_tr_b16 v[182:183], v13 offset:1024
    v_mfma_f32_32x32x16_bf16 v[80:95], v[200:203], a[108:111], v[80:95]
    ds_read_b64_tr_b16 v[184:185], v14 offset:0
    ds_read_b64_tr_b16 v[186:187], v14 offset:1024
    v_mfma_f32_32x32x16_bf16 v[96:111], v[204:207], a[108:111], v[96:111]
    ds_read_b64_tr_b16 v[188:189], v15 offset:0
    ds_read_b64_tr_b16 v[190:191], v15 offset:1024
    v_mfma_f32_32x32x16_bf16 v[112:127], v[192:195], a[124:127], v[112:127]
    v_mfma_f32_32x32x16_bf16 v[128:143], v[196:199], a[124:127], v[128:143]
    v_mfma_f32_32x32x16_bf16 v[144:159], v[200:203], a[124:127], v[144:159]
    v_mfma_f32_32x32x16_bf16 v[160:175], v[204:207], a[124:127], v[160:175]
    s_add_u32 m0, s36, 49152
    s_nop 0
    buffer_load_dwordx4 v20, s[8:11], s27 offen offset:0 lds
    s_mov_b32 s28, 1
.p2align 6
spwo_kernel_wo_loop:
    s_waitcnt lgkmcnt(0)
    v_mfma_f32_32x32x16_bf16 v[48:63], v[176:179], a[0:3], v[48:63]
    ds_read_b64_tr_b16 v[192:193], v12 offset:4096
    ds_read_b64_tr_b16 v[194:195], v12 offset:5120
    v_mfma_f32_32x32x16_bf16 v[64:79], v[180:183], a[0:3], v[64:79]
    ds_read_b64_tr_b16 v[196:197], v13 offset:4096
    ds_read_b64_tr_b16 v[198:199], v13 offset:5120
    v_mfma_f32_32x32x16_bf16 v[80:95], v[184:187], a[0:3], v[80:95]
    ds_read_b64_tr_b16 v[200:201], v14 offset:4096
    ds_read_b64_tr_b16 v[202:203], v14 offset:5120
    v_mfma_f32_32x32x16_bf16 v[96:111], v[188:191], a[0:3], v[96:111]
    ds_read_b64_tr_b16 v[204:205], v15 offset:4096
    ds_read_b64_tr_b16 v[206:207], v15 offset:5120
    v_mfma_f32_32x32x16_bf16 v[112:127], v[176:179], a[16:19], v[112:127]
    buffer_load_dwordx4 v21, s[8:11], s27 offen offset:1024 lds
    v_mfma_f32_32x32x16_bf16 v[128:143], v[180:183], a[16:19], v[128:143]
    buffer_load_dwordx4 v22, s[8:11], s27 offen offset:2048 lds
    v_mfma_f32_32x32x16_bf16 v[144:159], v[184:187], a[16:19], v[144:159]
    buffer_load_dwordx4 v23, s[8:11], s27 offen offset:3072 lds
    s_add_u32 s27, s27, 81920
    v_mfma_f32_32x32x16_bf16 v[160:175], v[188:191], a[16:19], v[160:175]
    buffer_load_dwordx4 a[96:99], v16, s[4:7], s26 offen offset:0
    s_waitcnt lgkmcnt(0)
    v_mfma_f32_32x32x16_bf16 v[48:63], v[192:195], a[4:7], v[48:63]
    ds_read_b64_tr_b16 v[176:177], v12 offset:8192
    ds_read_b64_tr_b16 v[178:179], v12 offset:9216
    v_mfma_f32_32x32x16_bf16 v[64:79], v[196:199], a[4:7], v[64:79]
    ds_read_b64_tr_b16 v[180:181], v13 offset:8192
    ds_read_b64_tr_b16 v[182:183], v13 offset:9216
    v_mfma_f32_32x32x16_bf16 v[80:95], v[200:203], a[4:7], v[80:95]
    ds_read_b64_tr_b16 v[184:185], v14 offset:8192
    ds_read_b64_tr_b16 v[186:187], v14 offset:9216
    v_mfma_f32_32x32x16_bf16 v[96:111], v[204:207], a[4:7], v[96:111]
    ds_read_b64_tr_b16 v[188:189], v15 offset:8192
    ds_read_b64_tr_b16 v[190:191], v15 offset:9216
    v_mfma_f32_32x32x16_bf16 v[112:127], v[192:195], a[20:23], v[112:127]
    buffer_load_dwordx4 a[100:103], v16, s[4:7], s26 offen offset:1024
    v_mfma_f32_32x32x16_bf16 v[128:143], v[196:199], a[20:23], v[128:143]
    buffer_load_dwordx4 a[104:107], v16, s[4:7], s26 offen offset:2048
    v_mfma_f32_32x32x16_bf16 v[144:159], v[200:203], a[20:23], v[144:159]
    buffer_load_dwordx4 a[108:111], v16, s[4:7], s26 offen offset:3072
    v_mfma_f32_32x32x16_bf16 v[160:175], v[204:207], a[20:23], v[160:175]
    buffer_load_dwordx4 a[112:115], v17, s[4:7], s26 offen offset:0
    s_waitcnt lgkmcnt(0)
    v_mfma_f32_32x32x16_bf16 v[48:63], v[176:179], a[8:11], v[48:63]
    ds_read_b64_tr_b16 v[192:193], v12 offset:12288
    ds_read_b64_tr_b16 v[194:195], v12 offset:13312
    v_mfma_f32_32x32x16_bf16 v[64:79], v[180:183], a[8:11], v[64:79]
    ds_read_b64_tr_b16 v[196:197], v13 offset:12288
    ds_read_b64_tr_b16 v[198:199], v13 offset:13312
    v_mfma_f32_32x32x16_bf16 v[80:95], v[184:187], a[8:11], v[80:95]
    ds_read_b64_tr_b16 v[200:201], v14 offset:12288
    ds_read_b64_tr_b16 v[202:203], v14 offset:13312
    v_mfma_f32_32x32x16_bf16 v[96:111], v[188:191], a[8:11], v[96:111]
    ds_read_b64_tr_b16 v[204:205], v15 offset:12288
    ds_read_b64_tr_b16 v[206:207], v15 offset:13312
    v_mfma_f32_32x32x16_bf16 v[112:127], v[176:179], a[24:27], v[112:127]
    v_mfma_f32_32x32x16_bf16 v[128:143], v[180:183], a[24:27], v[128:143]
    buffer_load_dwordx4 a[116:119], v17, s[4:7], s26 offen offset:1024
    v_mfma_f32_32x32x16_bf16 v[144:159], v[184:187], a[24:27], v[144:159]
    buffer_load_dwordx4 a[120:123], v17, s[4:7], s26 offen offset:2048
    v_mfma_f32_32x32x16_bf16 v[160:175], v[188:191], a[24:27], v[160:175]
    buffer_load_dwordx4 a[124:127], v17, s[4:7], s26 offen offset:3072
    s_add_u32 s26, s26, 4096
    s_waitcnt vmcnt(24) lgkmcnt(0)
    s_barrier
    v_mfma_f32_32x32x16_bf16 v[48:63], v[192:195], a[12:15], v[48:63]
    ds_read_b64_tr_b16 v[176:177], v12 offset:16384
    ds_read_b64_tr_b16 v[178:179], v12 offset:17408
    v_mfma_f32_32x32x16_bf16 v[64:79], v[196:199], a[12:15], v[64:79]
    ds_read_b64_tr_b16 v[180:181], v13 offset:16384
    ds_read_b64_tr_b16 v[182:183], v13 offset:17408
    v_mfma_f32_32x32x16_bf16 v[80:95], v[200:203], a[12:15], v[80:95]
    ds_read_b64_tr_b16 v[184:185], v14 offset:16384
    ds_read_b64_tr_b16 v[186:187], v14 offset:17408
    v_mfma_f32_32x32x16_bf16 v[96:111], v[204:207], a[12:15], v[96:111]
    ds_read_b64_tr_b16 v[188:189], v15 offset:16384
    ds_read_b64_tr_b16 v[190:191], v15 offset:17408
    v_mfma_f32_32x32x16_bf16 v[112:127], v[192:195], a[28:31], v[112:127]
    v_mfma_f32_32x32x16_bf16 v[128:143], v[196:199], a[28:31], v[128:143]
    v_mfma_f32_32x32x16_bf16 v[144:159], v[200:203], a[28:31], v[144:159]
    v_mfma_f32_32x32x16_bf16 v[160:175], v[204:207], a[28:31], v[160:175]
    s_add_u32 m0, s36, 0
    s_nop 0
    buffer_load_dwordx4 v20, s[8:11], s27 offen offset:0 lds
    s_waitcnt lgkmcnt(0)
    v_mfma_f32_32x32x16_bf16 v[48:63], v[176:179], a[32:35], v[48:63]
    ds_read_b64_tr_b16 v[192:193], v12 offset:20480
    ds_read_b64_tr_b16 v[194:195], v12 offset:21504
    v_mfma_f32_32x32x16_bf16 v[64:79], v[180:183], a[32:35], v[64:79]
    ds_read_b64_tr_b16 v[196:197], v13 offset:20480
    ds_read_b64_tr_b16 v[198:199], v13 offset:21504
    v_mfma_f32_32x32x16_bf16 v[80:95], v[184:187], a[32:35], v[80:95]
    ds_read_b64_tr_b16 v[200:201], v14 offset:20480
    ds_read_b64_tr_b16 v[202:203], v14 offset:21504
    v_mfma_f32_32x32x16_bf16 v[96:111], v[188:191], a[32:35], v[96:111]
    ds_read_b64_tr_b16 v[204:205], v15 offset:20480
    ds_read_b64_tr_b16 v[206:207], v15 offset:21504
    v_mfma_f32_32x32x16_bf16 v[112:127], v[176:179], a[48:51], v[112:127]
    buffer_load_dwordx4 v21, s[8:11], s27 offen offset:1024 lds
    v_mfma_f32_32x32x16_bf16 v[128:143], v[180:183], a[48:51], v[128:143]
    buffer_load_dwordx4 v22, s[8:11], s27 offen offset:2048 lds
    v_mfma_f32_32x32x16_bf16 v[144:159], v[184:187], a[48:51], v[144:159]
    buffer_load_dwordx4 v23, s[8:11], s27 offen offset:3072 lds
    s_add_u32 s27, s27, 81920
    v_mfma_f32_32x32x16_bf16 v[160:175], v[188:191], a[48:51], v[160:175]
    buffer_load_dwordx4 a[0:3], v16, s[4:7], s26 offen offset:0
    s_waitcnt lgkmcnt(0)
    v_mfma_f32_32x32x16_bf16 v[48:63], v[192:195], a[36:39], v[48:63]
    ds_read_b64_tr_b16 v[176:177], v12 offset:24576
    ds_read_b64_tr_b16 v[178:179], v12 offset:25600
    v_mfma_f32_32x32x16_bf16 v[64:79], v[196:199], a[36:39], v[64:79]
    ds_read_b64_tr_b16 v[180:181], v13 offset:24576
    ds_read_b64_tr_b16 v[182:183], v13 offset:25600
    v_mfma_f32_32x32x16_bf16 v[80:95], v[200:203], a[36:39], v[80:95]
    ds_read_b64_tr_b16 v[184:185], v14 offset:24576
    ds_read_b64_tr_b16 v[186:187], v14 offset:25600
    v_mfma_f32_32x32x16_bf16 v[96:111], v[204:207], a[36:39], v[96:111]
    ds_read_b64_tr_b16 v[188:189], v15 offset:24576
    ds_read_b64_tr_b16 v[190:191], v15 offset:25600
    v_mfma_f32_32x32x16_bf16 v[112:127], v[192:195], a[52:55], v[112:127]
    buffer_load_dwordx4 a[4:7], v16, s[4:7], s26 offen offset:1024
    v_mfma_f32_32x32x16_bf16 v[128:143], v[196:199], a[52:55], v[128:143]
    buffer_load_dwordx4 a[8:11], v16, s[4:7], s26 offen offset:2048
    v_mfma_f32_32x32x16_bf16 v[144:159], v[200:203], a[52:55], v[144:159]
    buffer_load_dwordx4 a[12:15], v16, s[4:7], s26 offen offset:3072
    v_mfma_f32_32x32x16_bf16 v[160:175], v[204:207], a[52:55], v[160:175]
    buffer_load_dwordx4 a[16:19], v17, s[4:7], s26 offen offset:0
    s_waitcnt lgkmcnt(0)
    v_mfma_f32_32x32x16_bf16 v[48:63], v[176:179], a[40:43], v[48:63]
    ds_read_b64_tr_b16 v[192:193], v12 offset:28672
    ds_read_b64_tr_b16 v[194:195], v12 offset:29696
    v_mfma_f32_32x32x16_bf16 v[64:79], v[180:183], a[40:43], v[64:79]
    ds_read_b64_tr_b16 v[196:197], v13 offset:28672
    ds_read_b64_tr_b16 v[198:199], v13 offset:29696
    v_mfma_f32_32x32x16_bf16 v[80:95], v[184:187], a[40:43], v[80:95]
    ds_read_b64_tr_b16 v[200:201], v14 offset:28672
    ds_read_b64_tr_b16 v[202:203], v14 offset:29696
    v_mfma_f32_32x32x16_bf16 v[96:111], v[188:191], a[40:43], v[96:111]
    ds_read_b64_tr_b16 v[204:205], v15 offset:28672
    ds_read_b64_tr_b16 v[206:207], v15 offset:29696
    v_mfma_f32_32x32x16_bf16 v[112:127], v[176:179], a[56:59], v[112:127]
    v_mfma_f32_32x32x16_bf16 v[128:143], v[180:183], a[56:59], v[128:143]
    buffer_load_dwordx4 a[20:23], v17, s[4:7], s26 offen offset:1024
    v_mfma_f32_32x32x16_bf16 v[144:159], v[184:187], a[56:59], v[144:159]
    buffer_load_dwordx4 a[24:27], v17, s[4:7], s26 offen offset:2048
    v_mfma_f32_32x32x16_bf16 v[160:175], v[188:191], a[56:59], v[160:175]
    buffer_load_dwordx4 a[28:31], v17, s[4:7], s26 offen offset:3072
    s_add_u32 s26, s26, 4096
    s_waitcnt vmcnt(24) lgkmcnt(0)
    s_barrier
    v_mfma_f32_32x32x16_bf16 v[48:63], v[192:195], a[44:47], v[48:63]
    ds_read_b64_tr_b16 v[176:177], v12 offset:32768
    ds_read_b64_tr_b16 v[178:179], v12 offset:33792
    v_mfma_f32_32x32x16_bf16 v[64:79], v[196:199], a[44:47], v[64:79]
    ds_read_b64_tr_b16 v[180:181], v13 offset:32768
    ds_read_b64_tr_b16 v[182:183], v13 offset:33792
    v_mfma_f32_32x32x16_bf16 v[80:95], v[200:203], a[44:47], v[80:95]
    ds_read_b64_tr_b16 v[184:185], v14 offset:32768
    ds_read_b64_tr_b16 v[186:187], v14 offset:33792
    v_mfma_f32_32x32x16_bf16 v[96:111], v[204:207], a[44:47], v[96:111]
    ds_read_b64_tr_b16 v[188:189], v15 offset:32768
    ds_read_b64_tr_b16 v[190:191], v15 offset:33792
    v_mfma_f32_32x32x16_bf16 v[112:127], v[192:195], a[60:63], v[112:127]
    v_mfma_f32_32x32x16_bf16 v[128:143], v[196:199], a[60:63], v[128:143]
    v_mfma_f32_32x32x16_bf16 v[144:159], v[200:203], a[60:63], v[144:159]
    v_mfma_f32_32x32x16_bf16 v[160:175], v[204:207], a[60:63], v[160:175]
    s_add_u32 m0, s36, 16384
    s_nop 0
    buffer_load_dwordx4 v20, s[8:11], s27 offen offset:0 lds
    s_waitcnt lgkmcnt(0)
    v_mfma_f32_32x32x16_bf16 v[48:63], v[176:179], a[64:67], v[48:63]
    ds_read_b64_tr_b16 v[192:193], v12 offset:36864
    ds_read_b64_tr_b16 v[194:195], v12 offset:37888
    v_mfma_f32_32x32x16_bf16 v[64:79], v[180:183], a[64:67], v[64:79]
    ds_read_b64_tr_b16 v[196:197], v13 offset:36864
    ds_read_b64_tr_b16 v[198:199], v13 offset:37888
    v_mfma_f32_32x32x16_bf16 v[80:95], v[184:187], a[64:67], v[80:95]
    ds_read_b64_tr_b16 v[200:201], v14 offset:36864
    ds_read_b64_tr_b16 v[202:203], v14 offset:37888
    v_mfma_f32_32x32x16_bf16 v[96:111], v[188:191], a[64:67], v[96:111]
    ds_read_b64_tr_b16 v[204:205], v15 offset:36864
    ds_read_b64_tr_b16 v[206:207], v15 offset:37888
    v_mfma_f32_32x32x16_bf16 v[112:127], v[176:179], a[80:83], v[112:127]
    buffer_load_dwordx4 v21, s[8:11], s27 offen offset:1024 lds
    v_mfma_f32_32x32x16_bf16 v[128:143], v[180:183], a[80:83], v[128:143]
    buffer_load_dwordx4 v22, s[8:11], s27 offen offset:2048 lds
    v_mfma_f32_32x32x16_bf16 v[144:159], v[184:187], a[80:83], v[144:159]
    buffer_load_dwordx4 v23, s[8:11], s27 offen offset:3072 lds
    s_add_u32 s27, s27, 81920
    v_mfma_f32_32x32x16_bf16 v[160:175], v[188:191], a[80:83], v[160:175]
    buffer_load_dwordx4 a[32:35], v16, s[4:7], s26 offen offset:0
    s_waitcnt lgkmcnt(0)
    v_mfma_f32_32x32x16_bf16 v[48:63], v[192:195], a[68:71], v[48:63]
    ds_read_b64_tr_b16 v[176:177], v12 offset:40960
    ds_read_b64_tr_b16 v[178:179], v12 offset:41984
    v_mfma_f32_32x32x16_bf16 v[64:79], v[196:199], a[68:71], v[64:79]
    ds_read_b64_tr_b16 v[180:181], v13 offset:40960
    ds_read_b64_tr_b16 v[182:183], v13 offset:41984
    v_mfma_f32_32x32x16_bf16 v[80:95], v[200:203], a[68:71], v[80:95]
    ds_read_b64_tr_b16 v[184:185], v14 offset:40960
    ds_read_b64_tr_b16 v[186:187], v14 offset:41984
    v_mfma_f32_32x32x16_bf16 v[96:111], v[204:207], a[68:71], v[96:111]
    ds_read_b64_tr_b16 v[188:189], v15 offset:40960
    ds_read_b64_tr_b16 v[190:191], v15 offset:41984
    v_mfma_f32_32x32x16_bf16 v[112:127], v[192:195], a[84:87], v[112:127]
    buffer_load_dwordx4 a[36:39], v16, s[4:7], s26 offen offset:1024
    v_mfma_f32_32x32x16_bf16 v[128:143], v[196:199], a[84:87], v[128:143]
    buffer_load_dwordx4 a[40:43], v16, s[4:7], s26 offen offset:2048
    v_mfma_f32_32x32x16_bf16 v[144:159], v[200:203], a[84:87], v[144:159]
    buffer_load_dwordx4 a[44:47], v16, s[4:7], s26 offen offset:3072
    v_mfma_f32_32x32x16_bf16 v[160:175], v[204:207], a[84:87], v[160:175]
    buffer_load_dwordx4 a[48:51], v17, s[4:7], s26 offen offset:0
    s_waitcnt lgkmcnt(0)
    v_mfma_f32_32x32x16_bf16 v[48:63], v[176:179], a[72:75], v[48:63]
    ds_read_b64_tr_b16 v[192:193], v12 offset:45056
    ds_read_b64_tr_b16 v[194:195], v12 offset:46080
    v_mfma_f32_32x32x16_bf16 v[64:79], v[180:183], a[72:75], v[64:79]
    ds_read_b64_tr_b16 v[196:197], v13 offset:45056
    ds_read_b64_tr_b16 v[198:199], v13 offset:46080
    v_mfma_f32_32x32x16_bf16 v[80:95], v[184:187], a[72:75], v[80:95]
    ds_read_b64_tr_b16 v[200:201], v14 offset:45056
    ds_read_b64_tr_b16 v[202:203], v14 offset:46080
    v_mfma_f32_32x32x16_bf16 v[96:111], v[188:191], a[72:75], v[96:111]
    ds_read_b64_tr_b16 v[204:205], v15 offset:45056
    ds_read_b64_tr_b16 v[206:207], v15 offset:46080
    v_mfma_f32_32x32x16_bf16 v[112:127], v[176:179], a[88:91], v[112:127]
    v_mfma_f32_32x32x16_bf16 v[128:143], v[180:183], a[88:91], v[128:143]
    buffer_load_dwordx4 a[52:55], v17, s[4:7], s26 offen offset:1024
    v_mfma_f32_32x32x16_bf16 v[144:159], v[184:187], a[88:91], v[144:159]
    buffer_load_dwordx4 a[56:59], v17, s[4:7], s26 offen offset:2048
    v_mfma_f32_32x32x16_bf16 v[160:175], v[188:191], a[88:91], v[160:175]
    buffer_load_dwordx4 a[60:63], v17, s[4:7], s26 offen offset:3072
    s_add_u32 s26, s26, 4096
    s_waitcnt vmcnt(24) lgkmcnt(0)
    s_barrier
    v_mfma_f32_32x32x16_bf16 v[48:63], v[192:195], a[76:79], v[48:63]
    ds_read_b64_tr_b16 v[176:177], v12 offset:49152
    ds_read_b64_tr_b16 v[178:179], v12 offset:50176
    v_mfma_f32_32x32x16_bf16 v[64:79], v[196:199], a[76:79], v[64:79]
    ds_read_b64_tr_b16 v[180:181], v13 offset:49152
    ds_read_b64_tr_b16 v[182:183], v13 offset:50176
    v_mfma_f32_32x32x16_bf16 v[80:95], v[200:203], a[76:79], v[80:95]
    ds_read_b64_tr_b16 v[184:185], v14 offset:49152
    ds_read_b64_tr_b16 v[186:187], v14 offset:50176
    v_mfma_f32_32x32x16_bf16 v[96:111], v[204:207], a[76:79], v[96:111]
    ds_read_b64_tr_b16 v[188:189], v15 offset:49152
    ds_read_b64_tr_b16 v[190:191], v15 offset:50176
    v_mfma_f32_32x32x16_bf16 v[112:127], v[192:195], a[92:95], v[112:127]
    v_mfma_f32_32x32x16_bf16 v[128:143], v[196:199], a[92:95], v[128:143]
    v_mfma_f32_32x32x16_bf16 v[144:159], v[200:203], a[92:95], v[144:159]
    v_mfma_f32_32x32x16_bf16 v[160:175], v[204:207], a[92:95], v[160:175]
    s_add_u32 m0, s36, 32768
    s_nop 0
    buffer_load_dwordx4 v20, s[8:11], s27 offen offset:0 lds
    s_waitcnt lgkmcnt(0)
    v_mfma_f32_32x32x16_bf16 v[48:63], v[176:179], a[96:99], v[48:63]
    ds_read_b64_tr_b16 v[192:193], v12 offset:53248
    ds_read_b64_tr_b16 v[194:195], v12 offset:54272
    v_mfma_f32_32x32x16_bf16 v[64:79], v[180:183], a[96:99], v[64:79]
    ds_read_b64_tr_b16 v[196:197], v13 offset:53248
    ds_read_b64_tr_b16 v[198:199], v13 offset:54272
    v_mfma_f32_32x32x16_bf16 v[80:95], v[184:187], a[96:99], v[80:95]
    ds_read_b64_tr_b16 v[200:201], v14 offset:53248
    ds_read_b64_tr_b16 v[202:203], v14 offset:54272
    v_mfma_f32_32x32x16_bf16 v[96:111], v[188:191], a[96:99], v[96:111]
    ds_read_b64_tr_b16 v[204:205], v15 offset:53248
    ds_read_b64_tr_b16 v[206:207], v15 offset:54272
    v_mfma_f32_32x32x16_bf16 v[112:127], v[176:179], a[112:115], v[112:127]
    buffer_load_dwordx4 v21, s[8:11], s27 offen offset:1024 lds
    v_mfma_f32_32x32x16_bf16 v[128:143], v[180:183], a[112:115], v[128:143]
    buffer_load_dwordx4 v22, s[8:11], s27 offen offset:2048 lds
    v_mfma_f32_32x32x16_bf16 v[144:159], v[184:187], a[112:115], v[144:159]
    buffer_load_dwordx4 v23, s[8:11], s27 offen offset:3072 lds
    s_add_u32 s27, s27, 81920
    v_mfma_f32_32x32x16_bf16 v[160:175], v[188:191], a[112:115], v[160:175]
    buffer_load_dwordx4 a[64:67], v16, s[4:7], s26 offen offset:0
    s_waitcnt lgkmcnt(0)
    v_mfma_f32_32x32x16_bf16 v[48:63], v[192:195], a[100:103], v[48:63]
    ds_read_b64_tr_b16 v[176:177], v12 offset:57344
    ds_read_b64_tr_b16 v[178:179], v12 offset:58368
    v_mfma_f32_32x32x16_bf16 v[64:79], v[196:199], a[100:103], v[64:79]
    ds_read_b64_tr_b16 v[180:181], v13 offset:57344
    ds_read_b64_tr_b16 v[182:183], v13 offset:58368
    v_mfma_f32_32x32x16_bf16 v[80:95], v[200:203], a[100:103], v[80:95]
    ds_read_b64_tr_b16 v[184:185], v14 offset:57344
    ds_read_b64_tr_b16 v[186:187], v14 offset:58368
    v_mfma_f32_32x32x16_bf16 v[96:111], v[204:207], a[100:103], v[96:111]
    ds_read_b64_tr_b16 v[188:189], v15 offset:57344
    ds_read_b64_tr_b16 v[190:191], v15 offset:58368
    v_mfma_f32_32x32x16_bf16 v[112:127], v[192:195], a[116:119], v[112:127]
    buffer_load_dwordx4 a[68:71], v16, s[4:7], s26 offen offset:1024
    v_mfma_f32_32x32x16_bf16 v[128:143], v[196:199], a[116:119], v[128:143]
    buffer_load_dwordx4 a[72:75], v16, s[4:7], s26 offen offset:2048
    v_mfma_f32_32x32x16_bf16 v[144:159], v[200:203], a[116:119], v[144:159]
    buffer_load_dwordx4 a[76:79], v16, s[4:7], s26 offen offset:3072
    v_mfma_f32_32x32x16_bf16 v[160:175], v[204:207], a[116:119], v[160:175]
    buffer_load_dwordx4 a[80:83], v17, s[4:7], s26 offen offset:0
    s_waitcnt lgkmcnt(0)
    v_mfma_f32_32x32x16_bf16 v[48:63], v[176:179], a[104:107], v[48:63]
    ds_read_b64_tr_b16 v[192:193], v12 offset:61440
    ds_read_b64_tr_b16 v[194:195], v12 offset:62464
    v_mfma_f32_32x32x16_bf16 v[64:79], v[180:183], a[104:107], v[64:79]
    ds_read_b64_tr_b16 v[196:197], v13 offset:61440
    ds_read_b64_tr_b16 v[198:199], v13 offset:62464
    v_mfma_f32_32x32x16_bf16 v[80:95], v[184:187], a[104:107], v[80:95]
    ds_read_b64_tr_b16 v[200:201], v14 offset:61440
    ds_read_b64_tr_b16 v[202:203], v14 offset:62464
    v_mfma_f32_32x32x16_bf16 v[96:111], v[188:191], a[104:107], v[96:111]
    ds_read_b64_tr_b16 v[204:205], v15 offset:61440
    ds_read_b64_tr_b16 v[206:207], v15 offset:62464
    v_mfma_f32_32x32x16_bf16 v[112:127], v[176:179], a[120:123], v[112:127]
    v_mfma_f32_32x32x16_bf16 v[128:143], v[180:183], a[120:123], v[128:143]
    buffer_load_dwordx4 a[84:87], v17, s[4:7], s26 offen offset:1024
    v_mfma_f32_32x32x16_bf16 v[144:159], v[184:187], a[120:123], v[144:159]
    buffer_load_dwordx4 a[88:91], v17, s[4:7], s26 offen offset:2048
    v_mfma_f32_32x32x16_bf16 v[160:175], v[188:191], a[120:123], v[160:175]
    buffer_load_dwordx4 a[92:95], v17, s[4:7], s26 offen offset:3072
    s_add_u32 s26, s26, 4096
    s_waitcnt vmcnt(24) lgkmcnt(0)
    s_barrier
    v_mfma_f32_32x32x16_bf16 v[48:63], v[192:195], a[108:111], v[48:63]
    ds_read_b64_tr_b16 v[176:177], v12 offset:0
    ds_read_b64_tr_b16 v[178:179], v12 offset:1024
    v_mfma_f32_32x32x16_bf16 v[64:79], v[196:199], a[108:111], v[64:79]
    ds_read_b64_tr_b16 v[180:181], v13 offset:0
    ds_read_b64_tr_b16 v[182:183], v13 offset:1024
    v_mfma_f32_32x32x16_bf16 v[80:95], v[200:203], a[108:111], v[80:95]
    ds_read_b64_tr_b16 v[184:185], v14 offset:0
    ds_read_b64_tr_b16 v[186:187], v14 offset:1024
    v_mfma_f32_32x32x16_bf16 v[96:111], v[204:207], a[108:111], v[96:111]
    ds_read_b64_tr_b16 v[188:189], v15 offset:0
    ds_read_b64_tr_b16 v[190:191], v15 offset:1024
    v_mfma_f32_32x32x16_bf16 v[112:127], v[192:195], a[124:127], v[112:127]
    v_mfma_f32_32x32x16_bf16 v[128:143], v[196:199], a[124:127], v[128:143]
    v_mfma_f32_32x32x16_bf16 v[144:159], v[200:203], a[124:127], v[144:159]
    v_mfma_f32_32x32x16_bf16 v[160:175], v[204:207], a[124:127], v[160:175]
    s_add_u32 m0, s36, 49152
    s_nop 0
    buffer_load_dwordx4 v20, s[8:11], s27 offen offset:0 lds
    s_add_u32 s28, s28, 1
    s_cmp_lt_u32 s28, 4
    s_cbranch_scc1 spwo_kernel_wo_loop
    s_waitcnt lgkmcnt(0)
    v_mfma_f32_32x32x16_bf16 v[48:63], v[176:179], a[0:3], v[48:63]
    ds_read_b64_tr_b16 v[192:193], v12 offset:4096
    ds_read_b64_tr_b16 v[194:195], v12 offset:5120
    v_mfma_f32_32x32x16_bf16 v[64:79], v[180:183], a[0:3], v[64:79]
    ds_read_b64_tr_b16 v[196:197], v13 offset:4096
    ds_read_b64_tr_b16 v[198:199], v13 offset:5120
    v_mfma_f32_32x32x16_bf16 v[80:95], v[184:187], a[0:3], v[80:95]
    ds_read_b64_tr_b16 v[200:201], v14 offset:4096
    ds_read_b64_tr_b16 v[202:203], v14 offset:5120
    v_mfma_f32_32x32x16_bf16 v[96:111], v[188:191], a[0:3], v[96:111]
    ds_read_b64_tr_b16 v[204:205], v15 offset:4096
    ds_read_b64_tr_b16 v[206:207], v15 offset:5120
    v_mfma_f32_32x32x16_bf16 v[112:127], v[176:179], a[16:19], v[112:127]
    buffer_load_dwordx4 v21, s[8:11], s27 offen offset:1024 lds
    v_mfma_f32_32x32x16_bf16 v[128:143], v[180:183], a[16:19], v[128:143]
    buffer_load_dwordx4 v22, s[8:11], s27 offen offset:2048 lds
    v_mfma_f32_32x32x16_bf16 v[144:159], v[184:187], a[16:19], v[144:159]
    buffer_load_dwordx4 v23, s[8:11], s27 offen offset:3072 lds
    s_add_u32 s27, s27, 81920
    v_mfma_f32_32x32x16_bf16 v[160:175], v[188:191], a[16:19], v[160:175]
    buffer_load_dwordx4 a[96:99], v16, s[4:7], s26 offen offset:0
    s_waitcnt lgkmcnt(0)
    v_mfma_f32_32x32x16_bf16 v[48:63], v[192:195], a[4:7], v[48:63]
    ds_read_b64_tr_b16 v[176:177], v12 offset:8192
    ds_read_b64_tr_b16 v[178:179], v12 offset:9216
    v_mfma_f32_32x32x16_bf16 v[64:79], v[196:199], a[4:7], v[64:79]
    ds_read_b64_tr_b16 v[180:181], v13 offset:8192
    ds_read_b64_tr_b16 v[182:183], v13 offset:9216
    v_mfma_f32_32x32x16_bf16 v[80:95], v[200:203], a[4:7], v[80:95]
    ds_read_b64_tr_b16 v[184:185], v14 offset:8192
    ds_read_b64_tr_b16 v[186:187], v14 offset:9216
    v_mfma_f32_32x32x16_bf16 v[96:111], v[204:207], a[4:7], v[96:111]
    ds_read_b64_tr_b16 v[188:189], v15 offset:8192
    ds_read_b64_tr_b16 v[190:191], v15 offset:9216
    v_mfma_f32_32x32x16_bf16 v[112:127], v[192:195], a[20:23], v[112:127]
    buffer_load_dwordx4 a[100:103], v16, s[4:7], s26 offen offset:1024
    v_mfma_f32_32x32x16_bf16 v[128:143], v[196:199], a[20:23], v[128:143]
    buffer_load_dwordx4 a[104:107], v16, s[4:7], s26 offen offset:2048
    v_mfma_f32_32x32x16_bf16 v[144:159], v[200:203], a[20:23], v[144:159]
    buffer_load_dwordx4 a[108:111], v16, s[4:7], s26 offen offset:3072
    v_mfma_f32_32x32x16_bf16 v[160:175], v[204:207], a[20:23], v[160:175]
    buffer_load_dwordx4 a[112:115], v17, s[4:7], s26 offen offset:0
    s_waitcnt lgkmcnt(0)
    v_mfma_f32_32x32x16_bf16 v[48:63], v[176:179], a[8:11], v[48:63]
    ds_read_b64_tr_b16 v[192:193], v12 offset:12288
    ds_read_b64_tr_b16 v[194:195], v12 offset:13312
    v_mfma_f32_32x32x16_bf16 v[64:79], v[180:183], a[8:11], v[64:79]
    ds_read_b64_tr_b16 v[196:197], v13 offset:12288
    ds_read_b64_tr_b16 v[198:199], v13 offset:13312
    v_mfma_f32_32x32x16_bf16 v[80:95], v[184:187], a[8:11], v[80:95]
    ds_read_b64_tr_b16 v[200:201], v14 offset:12288
    ds_read_b64_tr_b16 v[202:203], v14 offset:13312
    v_mfma_f32_32x32x16_bf16 v[96:111], v[188:191], a[8:11], v[96:111]
    ds_read_b64_tr_b16 v[204:205], v15 offset:12288
    ds_read_b64_tr_b16 v[206:207], v15 offset:13312
    v_mfma_f32_32x32x16_bf16 v[112:127], v[176:179], a[24:27], v[112:127]
    v_mfma_f32_32x32x16_bf16 v[128:143], v[180:183], a[24:27], v[128:143]
    buffer_load_dwordx4 a[116:119], v17, s[4:7], s26 offen offset:1024
    v_mfma_f32_32x32x16_bf16 v[144:159], v[184:187], a[24:27], v[144:159]
    buffer_load_dwordx4 a[120:123], v17, s[4:7], s26 offen offset:2048
    v_mfma_f32_32x32x16_bf16 v[160:175], v[188:191], a[24:27], v[160:175]
    buffer_load_dwordx4 a[124:127], v17, s[4:7], s26 offen offset:3072
    s_add_u32 s26, s26, 4096
    s_waitcnt vmcnt(24) lgkmcnt(0)
    s_barrier
    v_mfma_f32_32x32x16_bf16 v[48:63], v[192:195], a[12:15], v[48:63]
    ds_read_b64_tr_b16 v[176:177], v12 offset:16384
    ds_read_b64_tr_b16 v[178:179], v12 offset:17408
    v_mfma_f32_32x32x16_bf16 v[64:79], v[196:199], a[12:15], v[64:79]
    ds_read_b64_tr_b16 v[180:181], v13 offset:16384
    ds_read_b64_tr_b16 v[182:183], v13 offset:17408
    v_mfma_f32_32x32x16_bf16 v[80:95], v[200:203], a[12:15], v[80:95]
    ds_read_b64_tr_b16 v[184:185], v14 offset:16384
    ds_read_b64_tr_b16 v[186:187], v14 offset:17408
    v_mfma_f32_32x32x16_bf16 v[96:111], v[204:207], a[12:15], v[96:111]
    ds_read_b64_tr_b16 v[188:189], v15 offset:16384
    ds_read_b64_tr_b16 v[190:191], v15 offset:17408
    v_mfma_f32_32x32x16_bf16 v[112:127], v[192:195], a[28:31], v[112:127]
    v_mfma_f32_32x32x16_bf16 v[128:143], v[196:199], a[28:31], v[128:143]
    v_mfma_f32_32x32x16_bf16 v[144:159], v[200:203], a[28:31], v[144:159]
    v_mfma_f32_32x32x16_bf16 v[160:175], v[204:207], a[28:31], v[160:175]
    s_add_u32 m0, s36, 0
    s_nop 0
    buffer_load_dwordx4 v20, s[8:11], s27 offen offset:0 lds
    s_waitcnt lgkmcnt(0)
    v_mfma_f32_32x32x16_bf16 v[48:63], v[176:179], a[32:35], v[48:63]
    ds_read_b64_tr_b16 v[192:193], v12 offset:20480
    ds_read_b64_tr_b16 v[194:195], v12 offset:21504
    v_mfma_f32_32x32x16_bf16 v[64:79], v[180:183], a[32:35], v[64:79]
    ds_read_b64_tr_b16 v[196:197], v13 offset:20480
    ds_read_b64_tr_b16 v[198:199], v13 offset:21504
    v_mfma_f32_32x32x16_bf16 v[80:95], v[184:187], a[32:35], v[80:95]
    ds_read_b64_tr_b16 v[200:201], v14 offset:20480
    ds_read_b64_tr_b16 v[202:203], v14 offset:21504
    v_mfma_f32_32x32x16_bf16 v[96:111], v[188:191], a[32:35], v[96:111]
    ds_read_b64_tr_b16 v[204:205], v15 offset:20480
    ds_read_b64_tr_b16 v[206:207], v15 offset:21504
    v_mfma_f32_32x32x16_bf16 v[112:127], v[176:179], a[48:51], v[112:127]
    buffer_load_dwordx4 v21, s[8:11], s27 offen offset:1024 lds
    v_mfma_f32_32x32x16_bf16 v[128:143], v[180:183], a[48:51], v[128:143]
    buffer_load_dwordx4 v22, s[8:11], s27 offen offset:2048 lds
    v_mfma_f32_32x32x16_bf16 v[144:159], v[184:187], a[48:51], v[144:159]
    buffer_load_dwordx4 v23, s[8:11], s27 offen offset:3072 lds
    s_add_u32 s27, s27, 81920
    v_mfma_f32_32x32x16_bf16 v[160:175], v[188:191], a[48:51], v[160:175]
    buffer_load_dwordx4 a[0:3], v16, s[4:7], s26 offen offset:0
    s_waitcnt lgkmcnt(0)
    v_mfma_f32_32x32x16_bf16 v[48:63], v[192:195], a[36:39], v[48:63]
    ds_read_b64_tr_b16 v[176:177], v12 offset:24576
    ds_read_b64_tr_b16 v[178:179], v12 offset:25600
    v_mfma_f32_32x32x16_bf16 v[64:79], v[196:199], a[36:39], v[64:79]
    ds_read_b64_tr_b16 v[180:181], v13 offset:24576
    ds_read_b64_tr_b16 v[182:183], v13 offset:25600
    v_mfma_f32_32x32x16_bf16 v[80:95], v[200:203], a[36:39], v[80:95]
    ds_read_b64_tr_b16 v[184:185], v14 offset:24576
    ds_read_b64_tr_b16 v[186:187], v14 offset:25600
    v_mfma_f32_32x32x16_bf16 v[96:111], v[204:207], a[36:39], v[96:111]
    ds_read_b64_tr_b16 v[188:189], v15 offset:24576
    ds_read_b64_tr_b16 v[190:191], v15 offset:25600
    v_mfma_f32_32x32x16_bf16 v[112:127], v[192:195], a[52:55], v[112:127]
    buffer_load_dwordx4 a[4:7], v16, s[4:7], s26 offen offset:1024
    v_mfma_f32_32x32x16_bf16 v[128:143], v[196:199], a[52:55], v[128:143]
    buffer_load_dwordx4 a[8:11], v16, s[4:7], s26 offen offset:2048
    v_mfma_f32_32x32x16_bf16 v[144:159], v[200:203], a[52:55], v[144:159]
    buffer_load_dwordx4 a[12:15], v16, s[4:7], s26 offen offset:3072
    v_mfma_f32_32x32x16_bf16 v[160:175], v[204:207], a[52:55], v[160:175]
    buffer_load_dwordx4 a[16:19], v17, s[4:7], s26 offen offset:0
    s_waitcnt lgkmcnt(0)
    v_mfma_f32_32x32x16_bf16 v[48:63], v[176:179], a[40:43], v[48:63]
    ds_read_b64_tr_b16 v[192:193], v12 offset:28672
    ds_read_b64_tr_b16 v[194:195], v12 offset:29696
    v_mfma_f32_32x32x16_bf16 v[64:79], v[180:183], a[40:43], v[64:79]
    ds_read_b64_tr_b16 v[196:197], v13 offset:28672
    ds_read_b64_tr_b16 v[198:199], v13 offset:29696
    v_mfma_f32_32x32x16_bf16 v[80:95], v[184:187], a[40:43], v[80:95]
    ds_read_b64_tr_b16 v[200:201], v14 offset:28672
    ds_read_b64_tr_b16 v[202:203], v14 offset:29696
    v_mfma_f32_32x32x16_bf16 v[96:111], v[188:191], a[40:43], v[96:111]
    ds_read_b64_tr_b16 v[204:205], v15 offset:28672
    ds_read_b64_tr_b16 v[206:207], v15 offset:29696
    v_mfma_f32_32x32x16_bf16 v[112:127], v[176:179], a[56:59], v[112:127]
    v_mfma_f32_32x32x16_bf16 v[128:143], v[180:183], a[56:59], v[128:143]
    buffer_load_dwordx4 a[20:23], v17, s[4:7], s26 offen offset:1024
    v_mfma_f32_32x32x16_bf16 v[144:159], v[184:187], a[56:59], v[144:159]
    buffer_load_dwordx4 a[24:27], v17, s[4:7], s26 offen offset:2048
    v_mfma_f32_32x32x16_bf16 v[160:175], v[188:191], a[56:59], v[160:175]
    buffer_load_dwordx4 a[28:31], v17, s[4:7], s26 offen offset:3072
    s_add_u32 s26, s26, 4096
    s_waitcnt vmcnt(24) lgkmcnt(0)
    s_barrier
    v_mfma_f32_32x32x16_bf16 v[48:63], v[192:195], a[44:47], v[48:63]
    ds_read_b64_tr_b16 v[176:177], v12 offset:32768
    ds_read_b64_tr_b16 v[178:179], v12 offset:33792
    v_mfma_f32_32x32x16_bf16 v[64:79], v[196:199], a[44:47], v[64:79]
    ds_read_b64_tr_b16 v[180:181], v13 offset:32768
    ds_read_b64_tr_b16 v[182:183], v13 offset:33792
    v_mfma_f32_32x32x16_bf16 v[80:95], v[200:203], a[44:47], v[80:95]
    ds_read_b64_tr_b16 v[184:185], v14 offset:32768
    ds_read_b64_tr_b16 v[186:187], v14 offset:33792
    v_mfma_f32_32x32x16_bf16 v[96:111], v[204:207], a[44:47], v[96:111]
    ds_read_b64_tr_b16 v[188:189], v15 offset:32768
    ds_read_b64_tr_b16 v[190:191], v15 offset:33792
    v_mfma_f32_32x32x16_bf16 v[112:127], v[192:195], a[60:63], v[112:127]
    v_mfma_f32_32x32x16_bf16 v[128:143], v[196:199], a[60:63], v[128:143]
    v_mfma_f32_32x32x16_bf16 v[144:159], v[200:203], a[60:63], v[144:159]
    v_mfma_f32_32x32x16_bf16 v[160:175], v[204:207], a[60:63], v[160:175]
    s_add_u32 m0, s36, 16384
    s_nop 0
    buffer_load_dwordx4 v20, s[8:11], s27 offen offset:0 lds
    s_waitcnt lgkmcnt(0)
    v_mfma_f32_32x32x16_bf16 v[48:63], v[176:179], a[64:67], v[48:63]
    ds_read_b64_tr_b16 v[192:193], v12 offset:36864
    ds_read_b64_tr_b16 v[194:195], v12 offset:37888
    v_mfma_f32_32x32x16_bf16 v[64:79], v[180:183], a[64:67], v[64:79]
    ds_read_b64_tr_b16 v[196:197], v13 offset:36864
    ds_read_b64_tr_b16 v[198:199], v13 offset:37888
    v_mfma_f32_32x32x16_bf16 v[80:95], v[184:187], a[64:67], v[80:95]
    ds_read_b64_tr_b16 v[200:201], v14 offset:36864
    ds_read_b64_tr_b16 v[202:203], v14 offset:37888
    v_mfma_f32_32x32x16_bf16 v[96:111], v[188:191], a[64:67], v[96:111]
    ds_read_b64_tr_b16 v[204:205], v15 offset:36864
    ds_read_b64_tr_b16 v[206:207], v15 offset:37888
    v_mfma_f32_32x32x16_bf16 v[112:127], v[176:179], a[80:83], v[112:127]
    buffer_load_dwordx4 v21, s[8:11], s27 offen offset:1024 lds
    v_mfma_f32_32x32x16_bf16 v[128:143], v[180:183], a[80:83], v[128:143]
    buffer_load_dwordx4 v22, s[8:11], s27 offen offset:2048 lds
    v_mfma_f32_32x32x16_bf16 v[144:159], v[184:187], a[80:83], v[144:159]
    buffer_load_dwordx4 v23, s[8:11], s27 offen offset:3072 lds
    s_add_u32 s27, s27, 81920
    v_mfma_f32_32x32x16_bf16 v[160:175], v[188:191], a[80:83], v[160:175]
    buffer_load_dwordx4 a[32:35], v16, s[4:7], s26 offen offset:0
    s_waitcnt lgkmcnt(0)
    v_mfma_f32_32x32x16_bf16 v[48:63], v[192:195], a[68:71], v[48:63]
    ds_read_b64_tr_b16 v[176:177], v12 offset:40960
    ds_read_b64_tr_b16 v[178:179], v12 offset:41984
    v_mfma_f32_32x32x16_bf16 v[64:79], v[196:199], a[68:71], v[64:79]
    ds_read_b64_tr_b16 v[180:181], v13 offset:40960
    ds_read_b64_tr_b16 v[182:183], v13 offset:41984
    v_mfma_f32_32x32x16_bf16 v[80:95], v[200:203], a[68:71], v[80:95]
    ds_read_b64_tr_b16 v[184:185], v14 offset:40960
    ds_read_b64_tr_b16 v[186:187], v14 offset:41984
    v_mfma_f32_32x32x16_bf16 v[96:111], v[204:207], a[68:71], v[96:111]
    ds_read_b64_tr_b16 v[188:189], v15 offset:40960
    ds_read_b64_tr_b16 v[190:191], v15 offset:41984
    v_mfma_f32_32x32x16_bf16 v[112:127], v[192:195], a[84:87], v[112:127]
    buffer_load_dwordx4 a[36:39], v16, s[4:7], s26 offen offset:1024
    v_mfma_f32_32x32x16_bf16 v[128:143], v[196:199], a[84:87], v[128:143]
    buffer_load_dwordx4 a[40:43], v16, s[4:7], s26 offen offset:2048
    v_mfma_f32_32x32x16_bf16 v[144:159], v[200:203], a[84:87], v[144:159]
    buffer_load_dwordx4 a[44:47], v16, s[4:7], s26 offen offset:3072
    v_mfma_f32_32x32x16_bf16 v[160:175], v[204:207], a[84:87], v[160:175]
    buffer_load_dwordx4 a[48:51], v17, s[4:7], s26 offen offset:0
    s_waitcnt lgkmcnt(0)
    v_mfma_f32_32x32x16_bf16 v[48:63], v[176:179], a[72:75], v[48:63]
    ds_read_b64_tr_b16 v[192:193], v12 offset:45056
    ds_read_b64_tr_b16 v[194:195], v12 offset:46080
    v_mfma_f32_32x32x16_bf16 v[64:79], v[180:183], a[72:75], v[64:79]
    ds_read_b64_tr_b16 v[196:197], v13 offset:45056
    ds_read_b64_tr_b16 v[198:199], v13 offset:46080
    v_mfma_f32_32x32x16_bf16 v[80:95], v[184:187], a[72:75], v[80:95]
    ds_read_b64_tr_b16 v[200:201], v14 offset:45056
    ds_read_b64_tr_b16 v[202:203], v14 offset:46080
    v_mfma_f32_32x32x16_bf16 v[96:111], v[188:191], a[72:75], v[96:111]
    ds_read_b64_tr_b16 v[204:205], v15 offset:45056
    ds_read_b64_tr_b16 v[206:207], v15 offset:46080
    v_mfma_f32_32x32x16_bf16 v[112:127], v[176:179], a[88:91], v[112:127]
    v_mfma_f32_32x32x16_bf16 v[128:143], v[180:183], a[88:91], v[128:143]
    buffer_load_dwordx4 a[52:55], v17, s[4:7], s26 offen offset:1024
    v_mfma_f32_32x32x16_bf16 v[144:159], v[184:187], a[88:91], v[144:159]
    buffer_load_dwordx4 a[56:59], v17, s[4:7], s26 offen offset:2048
    v_mfma_f32_32x32x16_bf16 v[160:175], v[188:191], a[88:91], v[160:175]
    buffer_load_dwordx4 a[60:63], v17, s[4:7], s26 offen offset:3072
    s_add_u32 s26, s26, 4096
    s_waitcnt vmcnt(24) lgkmcnt(0)
    s_barrier
    v_mfma_f32_32x32x16_bf16 v[48:63], v[192:195], a[76:79], v[48:63]
    ds_read_b64_tr_b16 v[176:177], v12 offset:49152
    ds_read_b64_tr_b16 v[178:179], v12 offset:50176
    v_mfma_f32_32x32x16_bf16 v[64:79], v[196:199], a[76:79], v[64:79]
    ds_read_b64_tr_b16 v[180:181], v13 offset:49152
    ds_read_b64_tr_b16 v[182:183], v13 offset:50176
    v_mfma_f32_32x32x16_bf16 v[80:95], v[200:203], a[76:79], v[80:95]
    ds_read_b64_tr_b16 v[184:185], v14 offset:49152
    ds_read_b64_tr_b16 v[186:187], v14 offset:50176
    v_mfma_f32_32x32x16_bf16 v[96:111], v[204:207], a[76:79], v[96:111]
    ds_read_b64_tr_b16 v[188:189], v15 offset:49152
    ds_read_b64_tr_b16 v[190:191], v15 offset:50176
    v_mfma_f32_32x32x16_bf16 v[112:127], v[192:195], a[92:95], v[112:127]
    v_mfma_f32_32x32x16_bf16 v[128:143], v[196:199], a[92:95], v[128:143]
    v_mfma_f32_32x32x16_bf16 v[144:159], v[200:203], a[92:95], v[144:159]
    v_mfma_f32_32x32x16_bf16 v[160:175], v[204:207], a[92:95], v[160:175]
    s_waitcnt lgkmcnt(0)
    v_mfma_f32_32x32x16_bf16 v[48:63], v[176:179], a[96:99], v[48:63]
    ds_read_b64_tr_b16 v[192:193], v12 offset:53248
    ds_read_b64_tr_b16 v[194:195], v12 offset:54272
    v_mfma_f32_32x32x16_bf16 v[64:79], v[180:183], a[96:99], v[64:79]
    ds_read_b64_tr_b16 v[196:197], v13 offset:53248
    ds_read_b64_tr_b16 v[198:199], v13 offset:54272
    v_mfma_f32_32x32x16_bf16 v[80:95], v[184:187], a[96:99], v[80:95]
    ds_read_b64_tr_b16 v[200:201], v14 offset:53248
    ds_read_b64_tr_b16 v[202:203], v14 offset:54272
    v_mfma_f32_32x32x16_bf16 v[96:111], v[188:191], a[96:99], v[96:111]
    ds_read_b64_tr_b16 v[204:205], v15 offset:53248
    ds_read_b64_tr_b16 v[206:207], v15 offset:54272
    v_mfma_f32_32x32x16_bf16 v[112:127], v[176:179], a[112:115], v[112:127]
    v_mfma_f32_32x32x16_bf16 v[128:143], v[180:183], a[112:115], v[128:143]
    v_mfma_f32_32x32x16_bf16 v[144:159], v[184:187], a[112:115], v[144:159]
    v_mfma_f32_32x32x16_bf16 v[160:175], v[188:191], a[112:115], v[160:175]
    s_waitcnt lgkmcnt(0)
    v_mfma_f32_32x32x16_bf16 v[48:63], v[192:195], a[100:103], v[48:63]
    ds_read_b64_tr_b16 v[176:177], v12 offset:57344
    ds_read_b64_tr_b16 v[178:179], v12 offset:58368
    v_mfma_f32_32x32x16_bf16 v[64:79], v[196:199], a[100:103], v[64:79]
    ds_read_b64_tr_b16 v[180:181], v13 offset:57344
    ds_read_b64_tr_b16 v[182:183], v13 offset:58368
    v_mfma_f32_32x32x16_bf16 v[80:95], v[200:203], a[100:103], v[80:95]
    ds_read_b64_tr_b16 v[184:185], v14 offset:57344
    ds_read_b64_tr_b16 v[186:187], v14 offset:58368
    v_mfma_f32_32x32x16_bf16 v[96:111], v[204:207], a[100:103], v[96:111]
    ds_read_b64_tr_b16 v[188:189], v15 offset:57344
    ds_read_b64_tr_b16 v[190:191], v15 offset:58368
    v_mfma_f32_32x32x16_bf16 v[112:127], v[192:195], a[116:119], v[112:127]
    v_mfma_f32_32x32x16_bf16 v[128:143], v[196:199], a[116:119], v[128:143]
    v_mfma_f32_32x32x16_bf16 v[144:159], v[200:203], a[116:119], v[144:159]
    v_mfma_f32_32x32x16_bf16 v[160:175], v[204:207], a[116:119], v[160:175]
    s_waitcnt lgkmcnt(0)
    v_mfma_f32_32x32x16_bf16 v[48:63], v[176:179], a[104:107], v[48:63]
    ds_read_b64_tr_b16 v[192:193], v12 offset:61440
    ds_read_b64_tr_b16 v[194:195], v12 offset:62464
    v_mfma_f32_32x32x16_bf16 v[64:79], v[180:183], a[104:107], v[64:79]
    ds_read_b64_tr_b16 v[196:197], v13 offset:61440
    ds_read_b64_tr_b16 v[198:199], v13 offset:62464
    v_mfma_f32_32x32x16_bf16 v[80:95], v[184:187], a[104:107], v[80:95]
    ds_read_b64_tr_b16 v[200:201], v14 offset:61440
    ds_read_b64_tr_b16 v[202:203], v14 offset:62464
    v_mfma_f32_32x32x16_bf16 v[96:111], v[188:191], a[104:107], v[96:111]
    ds_read_b64_tr_b16 v[204:205], v15 offset:61440
    ds_read_b64_tr_b16 v[206:207], v15 offset:62464
    v_mfma_f32_32x32x16_bf16 v[112:127], v[176:179], a[120:123], v[112:127]
    v_mfma_f32_32x32x16_bf16 v[128:143], v[180:183], a[120:123], v[128:143]
    v_mfma_f32_32x32x16_bf16 v[144:159], v[184:187], a[120:123], v[144:159]
    v_mfma_f32_32x32x16_bf16 v[160:175], v[188:191], a[120:123], v[160:175]
    s_waitcnt vmcnt(12) lgkmcnt(0)
    s_barrier
    v_mfma_f32_32x32x16_bf16 v[48:63], v[192:195], a[108:111], v[48:63]
    ds_read_b64_tr_b16 v[176:177], v12 offset:0
    ds_read_b64_tr_b16 v[178:179], v12 offset:1024
    v_mfma_f32_32x32x16_bf16 v[64:79], v[196:199], a[108:111], v[64:79]
    ds_read_b64_tr_b16 v[180:181], v13 offset:0
    ds_read_b64_tr_b16 v[182:183], v13 offset:1024
    v_mfma_f32_32x32x16_bf16 v[80:95], v[200:203], a[108:111], v[80:95]
    ds_read_b64_tr_b16 v[184:185], v14 offset:0
    ds_read_b64_tr_b16 v[186:187], v14 offset:1024
    v_mfma_f32_32x32x16_bf16 v[96:111], v[204:207], a[108:111], v[96:111]
    ds_read_b64_tr_b16 v[188:189], v15 offset:0
    ds_read_b64_tr_b16 v[190:191], v15 offset:1024
    v_mfma_f32_32x32x16_bf16 v[112:127], v[192:195], a[124:127], v[112:127]
    v_mfma_f32_32x32x16_bf16 v[128:143], v[196:199], a[124:127], v[128:143]
    v_mfma_f32_32x32x16_bf16 v[144:159], v[200:203], a[124:127], v[144:159]
    v_mfma_f32_32x32x16_bf16 v[160:175], v[204:207], a[124:127], v[160:175]
    s_waitcnt lgkmcnt(0)
    v_mfma_f32_32x32x16_bf16 v[48:63], v[176:179], a[0:3], v[48:63]
    ds_read_b64_tr_b16 v[192:193], v12 offset:4096
    ds_read_b64_tr_b16 v[194:195], v12 offset:5120
    v_mfma_f32_32x32x16_bf16 v[64:79], v[180:183], a[0:3], v[64:79]
    ds_read_b64_tr_b16 v[196:197], v13 offset:4096
    ds_read_b64_tr_b16 v[198:199], v13 offset:5120
    v_mfma_f32_32x32x16_bf16 v[80:95], v[184:187], a[0:3], v[80:95]
    ds_read_b64_tr_b16 v[200:201], v14 offset:4096
    ds_read_b64_tr_b16 v[202:203], v14 offset:5120
    v_mfma_f32_32x32x16_bf16 v[96:111], v[188:191], a[0:3], v[96:111]
    ds_read_b64_tr_b16 v[204:205], v15 offset:4096
    ds_read_b64_tr_b16 v[206:207], v15 offset:5120
    v_mfma_f32_32x32x16_bf16 v[112:127], v[176:179], a[16:19], v[112:127]
    v_mfma_f32_32x32x16_bf16 v[128:143], v[180:183], a[16:19], v[128:143]
    v_mfma_f32_32x32x16_bf16 v[144:159], v[184:187], a[16:19], v[144:159]
    v_mfma_f32_32x32x16_bf16 v[160:175], v[188:191], a[16:19], v[160:175]
    s_waitcnt lgkmcnt(0)
    v_mfma_f32_32x32x16_bf16 v[48:63], v[192:195], a[4:7], v[48:63]
    ds_read_b64_tr_b16 v[176:177], v12 offset:8192
    ds_read_b64_tr_b16 v[178:179], v12 offset:9216
    v_mfma_f32_32x32x16_bf16 v[64:79], v[196:199], a[4:7], v[64:79]
    ds_read_b64_tr_b16 v[180:181], v13 offset:8192
    ds_read_b64_tr_b16 v[182:183], v13 offset:9216
    v_mfma_f32_32x32x16_bf16 v[80:95], v[200:203], a[4:7], v[80:95]
    ds_read_b64_tr_b16 v[184:185], v14 offset:8192
    ds_read_b64_tr_b16 v[186:187], v14 offset:9216
    v_mfma_f32_32x32x16_bf16 v[96:111], v[204:207], a[4:7], v[96:111]
    ds_read_b64_tr_b16 v[188:189], v15 offset:8192
    ds_read_b64_tr_b16 v[190:191], v15 offset:9216
    v_mfma_f32_32x32x16_bf16 v[112:127], v[192:195], a[20:23], v[112:127]
    v_mfma_f32_32x32x16_bf16 v[128:143], v[196:199], a[20:23], v[128:143]
    v_mfma_f32_32x32x16_bf16 v[144:159], v[200:203], a[20:23], v[144:159]
    v_mfma_f32_32x32x16_bf16 v[160:175], v[204:207], a[20:23], v[160:175]
    s_waitcnt lgkmcnt(0)
    v_mfma_f32_32x32x16_bf16 v[48:63], v[176:179], a[8:11], v[48:63]
    ds_read_b64_tr_b16 v[192:193], v12 offset:12288
    ds_read_b64_tr_b16 v[194:195], v12 offset:13312
    v_mfma_f32_32x32x16_bf16 v[64:79], v[180:183], a[8:11], v[64:79]
    ds_read_b64_tr_b16 v[196:197], v13 offset:12288
    ds_read_b64_tr_b16 v[198:199], v13 offset:13312
    v_mfma_f32_32x32x16_bf16 v[80:95], v[184:187], a[8:11], v[80:95]
    ds_read_b64_tr_b16 v[200:201], v14 offset:12288
    ds_read_b64_tr_b16 v[202:203], v14 offset:13312
    v_mfma_f32_32x32x16_bf16 v[96:111], v[188:191], a[8:11], v[96:111]
    ds_read_b64_tr_b16 v[204:205], v15 offset:12288
    ds_read_b64_tr_b16 v[206:207], v15 offset:13312
    v_mfma_f32_32x32x16_bf16 v[112:127], v[176:179], a[24:27], v[112:127]
    v_mfma_f32_32x32x16_bf16 v[128:143], v[180:183], a[24:27], v[128:143]
    v_mfma_f32_32x32x16_bf16 v[144:159], v[184:187], a[24:27], v[144:159]
    v_mfma_f32_32x32x16_bf16 v[160:175], v[188:191], a[24:27], v[160:175]
    s_waitcnt vmcnt(0) lgkmcnt(0)
    s_barrier
    v_mfma_f32_32x32x16_bf16 v[48:63], v[192:195], a[12:15], v[48:63]
    ds_read_b64_tr_b16 v[176:177], v12 offset:16384
    ds_read_b64_tr_b16 v[178:179], v12 offset:17408
    v_mfma_f32_32x32x16_bf16 v[64:79], v[196:199], a[12:15], v[64:79]
    ds_read_b64_tr_b16 v[180:181], v13 offset:16384
    ds_read_b64_tr_b16 v[182:183], v13 offset:17408
    v_mfma_f32_32x32x16_bf16 v[80:95], v[200:203], a[12:15], v[80:95]
    ds_read_b64_tr_b16 v[184:185], v14 offset:16384
    ds_read_b64_tr_b16 v[186:187], v14 offset:17408
    v_mfma_f32_32x32x16_bf16 v[96:111], v[204:207], a[12:15], v[96:111]
    ds_read_b64_tr_b16 v[188:189], v15 offset:16384
    ds_read_b64_tr_b16 v[190:191], v15 offset:17408
    v_mfma_f32_32x32x16_bf16 v[112:127], v[192:195], a[28:31], v[112:127]
    v_mfma_f32_32x32x16_bf16 v[128:143], v[196:199], a[28:31], v[128:143]
    v_mfma_f32_32x32x16_bf16 v[144:159], v[200:203], a[28:31], v[144:159]
    v_mfma_f32_32x32x16_bf16 v[160:175], v[204:207], a[28:31], v[160:175]
    s_waitcnt lgkmcnt(0)
    v_mfma_f32_32x32x16_bf16 v[48:63], v[176:179], a[32:35], v[48:63]
    ds_read_b64_tr_b16 v[192:193], v12 offset:20480
    ds_read_b64_tr_b16 v[194:195], v12 offset:21504
    v_mfma_f32_32x32x16_bf16 v[64:79], v[180:183], a[32:35], v[64:79]
    ds_read_b64_tr_b16 v[196:197], v13 offset:20480
    ds_read_b64_tr_b16 v[198:199], v13 offset:21504
    v_mfma_f32_32x32x16_bf16 v[80:95], v[184:187], a[32:35], v[80:95]
    ds_read_b64_tr_b16 v[200:201], v14 offset:20480
    ds_read_b64_tr_b16 v[202:203], v14 offset:21504
    v_mfma_f32_32x32x16_bf16 v[96:111], v[188:191], a[32:35], v[96:111]
    ds_read_b64_tr_b16 v[204:205], v15 offset:20480
    ds_read_b64_tr_b16 v[206:207], v15 offset:21504
    v_mfma_f32_32x32x16_bf16 v[112:127], v[176:179], a[48:51], v[112:127]
    v_mfma_f32_32x32x16_bf16 v[128:143], v[180:183], a[48:51], v[128:143]
    v_mfma_f32_32x32x16_bf16 v[144:159], v[184:187], a[48:51], v[144:159]
    v_mfma_f32_32x32x16_bf16 v[160:175], v[188:191], a[48:51], v[160:175]
    s_waitcnt lgkmcnt(0)
    v_mfma_f32_32x32x16_bf16 v[48:63], v[192:195], a[36:39], v[48:63]
    ds_read_b64_tr_b16 v[176:177], v12 offset:24576
    ds_read_b64_tr_b16 v[178:179], v12 offset:25600
    v_mfma_f32_32x32x16_bf16 v[64:79], v[196:199], a[36:39], v[64:79]
    ds_read_b64_tr_b16 v[180:181], v13 offset:24576
    ds_read_b64_tr_b16 v[182:183], v13 offset:25600
    v_mfma_f32_32x32x16_bf16 v[80:95], v[200:203], a[36:39], v[80:95]
    ds_read_b64_tr_b16 v[184:185], v14 offset:24576
    ds_read_b64_tr_b16 v[186:187], v14 offset:25600
    v_mfma_f32_32x32x16_bf16 v[96:111], v[204:207], a[36:39], v[96:111]
    ds_read_b64_tr_b16 v[188:189], v15 offset:24576
    ds_read_b64_tr_b16 v[190:191], v15 offset:25600
    v_mfma_f32_32x32x16_bf16 v[112:127], v[192:195], a[52:55], v[112:127]
    v_mfma_f32_32x32x16_bf16 v[128:143], v[196:199], a[52:55], v[128:143]
    v_mfma_f32_32x32x16_bf16 v[144:159], v[200:203], a[52:55], v[144:159]
    v_mfma_f32_32x32x16_bf16 v[160:175], v[204:207], a[52:55], v[160:175]
    s_waitcnt lgkmcnt(0)
    v_mfma_f32_32x32x16_bf16 v[48:63], v[176:179], a[40:43], v[48:63]
    ds_read_b64_tr_b16 v[192:193], v12 offset:28672
    ds_read_b64_tr_b16 v[194:195], v12 offset:29696
    v_mfma_f32_32x32x16_bf16 v[64:79], v[180:183], a[40:43], v[64:79]
    ds_read_b64_tr_b16 v[196:197], v13 offset:28672
    ds_read_b64_tr_b16 v[198:199], v13 offset:29696
    v_mfma_f32_32x32x16_bf16 v[80:95], v[184:187], a[40:43], v[80:95]
    ds_read_b64_tr_b16 v[200:201], v14 offset:28672
    ds_read_b64_tr_b16 v[202:203], v14 offset:29696
    v_mfma_f32_32x32x16_bf16 v[96:111], v[188:191], a[40:43], v[96:111]
    ds_read_b64_tr_b16 v[204:205], v15 offset:28672
    ds_read_b64_tr_b16 v[206:207], v15 offset:29696
    v_mfma_f32_32x32x16_bf16 v[112:127], v[176:179], a[56:59], v[112:127]
    v_mfma_f32_32x32x16_bf16 v[128:143], v[180:183], a[56:59], v[128:143]
    v_mfma_f32_32x32x16_bf16 v[144:159], v[184:187], a[56:59], v[144:159]
    v_mfma_f32_32x32x16_bf16 v[160:175], v[188:191], a[56:59], v[160:175]
    s_waitcnt lgkmcnt(0)
    v_mfma_f32_32x32x16_bf16 v[48:63], v[192:195], a[44:47], v[48:63]
    v_mfma_f32_32x32x16_bf16 v[64:79], v[196:199], a[44:47], v[64:79]
    v_mfma_f32_32x32x16_bf16 v[80:95], v[200:203], a[44:47], v[80:95]
    v_mfma_f32_32x32x16_bf16 v[96:111], v[204:207], a[44:47], v[96:111]
    v_mfma_f32_32x32x16_bf16 v[112:127], v[192:195], a[60:63], v[112:127]
    v_mfma_f32_32x32x16_bf16 v[128:143], v[196:199], a[60:63], v[128:143]
    v_mfma_f32_32x32x16_bf16 v[144:159], v[200:203], a[60:63], v[144:159]
    v_mfma_f32_32x32x16_bf16 v[160:175], v[204:207], a[60:63], v[160:175]
    s_nop 15
    s_mov_b32 s35, s44
    s_mov_b32 s27, 0xffff0000
    s_lshr_b32 s46, s2, 3
    s_mul_i32 s46, s46, 4
    s_add_u32 s46, s46, s24
    s_getpc_b64 s[48:49]
Lpc_11:
    s_sub_u32 s48, s48, Lpc_11-ln1_kernel
    s_subb_u32 s49, s49, 0
    s_mov_b32 s50, text_end-ln1_kernel
    s_mov_b32 s51, 0x20000
    s_lshl_b32 s46, s46, 10
    v_lshl_add_u32 v1, v2, 4, s46
    buffer_load_dwordx4 v[40:43], v1, s[48:51], 0 offen
    s_add_u32 s31, s38, 0
    s_mul_i32 s31, s31, 20
    s_lshr_b32 s34, s39, 5
    s_add_u32 s31, s31, s34
    s_add_u32 s31, s31, 0
    s_lshl_b32 s31, s31, 11
    s_add_u32 s31, s31, s35
    v_cvt_pk_bf16_f32 v48, v48, v49
    v_cvt_pk_bf16_f32 v49, v50, v51
    v_cvt_pk_bf16_f32 v50, v52, v53
    v_cvt_pk_bf16_f32 v51, v54, v55
    v_cvt_pk_bf16_f32 v52, v56, v57
    v_cvt_pk_bf16_f32 v53, v58, v59
    v_cvt_pk_bf16_f32 v54, v60, v61
    v_cvt_pk_bf16_f32 v55, v62, v63
    buffer_store_dwordx4 v[48:51], v26, s[12:15], s31 offen offset:0
    buffer_store_dwordx4 v[52:55], v26, s[12:15], s31 offen offset:1024
    s_add_u32 s31, s38, 0
    s_mul_i32 s31, s31, 20
    s_lshr_b32 s34, s39, 5
    s_add_u32 s31, s31, s34
    s_add_u32 s31, s31, 1
    s_lshl_b32 s31, s31, 11
    s_add_u32 s31, s31, s35
    v_cvt_pk_bf16_f32 v64, v64, v65
    v_cvt_pk_bf16_f32 v65, v66, v67
    v_cvt_pk_bf16_f32 v66, v68, v69
    v_cvt_pk_bf16_f32 v67, v70, v71
    v_cvt_pk_bf16_f32 v68, v72, v73
    v_cvt_pk_bf16_f32 v69, v74, v75
    v_cvt_pk_bf16_f32 v70, v76, v77
    v_cvt_pk_bf16_f32 v71, v78, v79
    buffer_store_dwordx4 v[64:67], v26, s[12:15], s31 offen offset:0
    buffer_store_dwordx4 v[68:71], v26, s[12:15], s31 offen offset:1024
    s_add_u32 s31, s38, 0
    s_mul_i32 s31, s31, 20
    s_lshr_b32 s34, s39, 5
    s_add_u32 s31, s31, s34
    s_add_u32 s31, s31, 2
    s_lshl_b32 s31, s31, 11
    s_add_u32 s31, s31, s35
    v_cvt_pk_bf16_f32 v80, v80, v81
    v_cvt_pk_bf16_f32 v81, v82, v83
    v_cvt_pk_bf16_f32 v82, v84, v85
    v_cvt_pk_bf16_f32 v83, v86, v87
    v_cvt_pk_bf16_f32 v84, v88, v89
    v_cvt_pk_bf16_f32 v85, v90, v91
    v_cvt_pk_bf16_f32 v86, v92, v93
    v_cvt_pk_bf16_f32 v87, v94, v95
    buffer_store_dwordx4 v[80:83], v26, s[12:15], s31 offen offset:0
    buffer_store_dwordx4 v[84:87], v26, s[12:15], s31 offen offset:1024
    s_add_u32 s31, s38, 0
    s_mul_i32 s31, s31, 20
    s_lshr_b32 s34, s39, 5
    s_add_u32 s31, s31, s34
    s_add_u32 s31, s31, 3
    s_lshl_b32 s31, s31, 11
    s_add_u32 s31, s31, s35
    v_cvt_pk_bf16_f32 v96, v96, v97
    v_cvt_pk_bf16_f32 v97, v98, v99
    v_cvt_pk_bf16_f32 v98, v100, v101
    v_cvt_pk_bf16_f32 v99, v102, v103
    v_cvt_pk_bf16_f32 v100, v104, v105
    v_cvt_pk_bf16_f32 v101, v106, v107
    v_cvt_pk_bf16_f32 v102, v108, v109
    v_cvt_pk_bf16_f32 v103, v110, v111
    buffer_store_dwordx4 v[96:99], v26, s[12:15], s31 offen offset:0
    buffer_store_dwordx4 v[100:103], v26, s[12:15], s31 offen offset:1024
    s_add_u32 s31, s38, 1
    s_mul_i32 s31, s31, 20
    s_lshr_b32 s34, s39, 5
    s_add_u32 s31, s31, s34
    s_add_u32 s31, s31, 0
    s_lshl_b32 s31, s31, 11
    s_add_u32 s31, s31, s35
    v_cvt_pk_bf16_f32 v112, v112, v113
    v_cvt_pk_bf16_f32 v113, v114, v115
    v_cvt_pk_bf16_f32 v114, v116, v117
    v_cvt_pk_bf16_f32 v115, v118, v119
    v_cvt_pk_bf16_f32 v116, v120, v121
    v_cvt_pk_bf16_f32 v117, v122, v123
    v_cvt_pk_bf16_f32 v118, v124, v125
    v_cvt_pk_bf16_f32 v119, v126, v127
    buffer_store_dwordx4 v[112:115], v26, s[12:15], s31 offen offset:0
    buffer_store_dwordx4 v[116:119], v26, s[12:15], s31 offen offset:1024
    s_add_u32 s31, s38, 1
    s_mul_i32 s31, s31, 20
    s_lshr_b32 s34, s39, 5
    s_add_u32 s31, s31, s34
    s_add_u32 s31, s31, 1
    s_lshl_b32 s31, s31, 11
    s_add_u32 s31, s31, s35
    v_cvt_pk_bf16_f32 v128, v128, v129
    v_cvt_pk_bf16_f32 v129, v130, v131
    v_cvt_pk_bf16_f32 v130, v132, v133
    v_cvt_pk_bf16_f32 v131, v134, v135
    v_cvt_pk_bf16_f32 v132, v136, v137
    v_cvt_pk_bf16_f32 v133, v138, v139
    v_cvt_pk_bf16_f32 v134, v140, v141
    v_cvt_pk_bf16_f32 v135, v142, v143
    buffer_store_dwordx4 v[128:131], v26, s[12:15], s31 offen offset:0
    buffer_store_dwordx4 v[132:135], v26, s[12:15], s31 offen offset:1024
    s_add_u32 s31, s38, 1
    s_mul_i32 s31, s31, 20
    s_lshr_b32 s34, s39, 5
    s_add_u32 s31, s31, s34
    s_add_u32 s31, s31, 2
    s_lshl_b32 s31, s31, 11
    s_add_u32 s31, s31, s35
    v_cvt_pk_bf16_f32 v144, v144, v145
    v_cvt_pk_bf16_f32 v145, v146, v147
    v_cvt_pk_bf16_f32 v146, v148, v149
    v_cvt_pk_bf16_f32 v147, v150, v151
    v_cvt_pk_bf16_f32 v148, v152, v153
    v_cvt_pk_bf16_f32 v149, v154, v155
    v_cvt_pk_bf16_f32 v150, v156, v157
    v_cvt_pk_bf16_f32 v151, v158, v159
    buffer_store_dwordx4 v[144:147], v26, s[12:15], s31 offen offset:0
    buffer_store_dwordx4 v[148:151], v26, s[12:15], s31 offen offset:1024
    s_add_u32 s31, s38, 1
    s_mul_i32 s31, s31, 20
    s_lshr_b32 s34, s39, 5
    s_add_u32 s31, s31, s34
    s_add_u32 s31, s31, 3
    s_lshl_b32 s31, s31, 11
    s_add_u32 s31, s31, s35
    v_cvt_pk_bf16_f32 v160, v160, v161
    v_cvt_pk_bf16_f32 v161, v162, v163
    v_cvt_pk_bf16_f32 v162, v164, v165
    v_cvt_pk_bf16_f32 v163, v166, v167
    v_cvt_pk_bf16_f32 v164, v168, v169
    v_cvt_pk_bf16_f32 v165, v170, v171
    v_cvt_pk_bf16_f32 v166, v172, v173
    v_cvt_pk_bf16_f32 v167, v174, v175
    buffer_store_dwordx4 v[160:163], v26, s[12:15], s31 offen offset:0
    buffer_store_dwordx4 v[164:167], v26, s[12:15], s31 offen offset:1024
spwo_kernel_done:
    s_endpgm
.globl fin_kernel
.p2align 8
.type fin_kernel,@function
fin_kernel:
    s_cmp_ge_u32 s2, 160
    s_cbranch_scc1 fin_kernel_done
    s_load_dwordx2 s[4:5], s[0:1], 96
    s_load_dwordx2 s[8:9], s[0:1], 72
    s_load_dwordx2 s[12:13], s[0:1], 80
    s_load_dwordx2 s[16:17], s[0:1], 96
    s_load_dwordx2 s[20:21], s[0:1], 0
    v_lshrrev_b32 v1, 6, v0
    v_and_b32 v2, 63, v0
    s_nop 0
    v_readfirstlane_b32 s24, v1
    s_waitcnt lgkmcnt(0)
    s_add_u32 s4, s4, 16777216
    s_addc_u32 s5, s5, 0
    s_mov_b32 s6, 3538944
    s_mov_b32 s7, 0x20000
    s_mov_b32 s10, 1105920
    s_mov_b32 s11, 0x20000
    s_mov_b32 s14, 2621440
    s_mov_b32 s15, 0x20000
    s_add_u32 s16, s16, 20971520
    s_addc_u32 s17, s17, 0
    s_mov_b32 s18, 7864320
    s_mov_b32 s19, 0x20000
    s_mov_b32 s22, 2621440
    s_mov_b32 s23, 0x20000
    s_and_b32 s29, s2, 7
    s_lshl_b32 s29, s29, 1
    s_lshr_b32 s31, s2, 3
    s_and_b32 s30, s31, 1
    s_add_u32 s29, s29, s30
    s_lshr_b32 s30, s31, 1
    s_mul_i32 s29, s29, 128
    s_mul_i32 s30, s30, 64
    s_mov_b32 s37, 0
    s_and_b32 s33, s24, 0
    s_lshr_b32 s32, s24, 0
    s_lshr_b32 s38, s29, 5
    s_mul_i32 s31, s32, 1
    s_add_u32 s38, s38, s31
    v_lshlrev_b32 v16, 4, v2
    s_mul_i32 s26, s38, 55296
    s_lshl_b32 s31, s37, 12
    s_add_u32 s26, s26, s31
    v_lshrrev_b32 v3, 3, v2
    v_and_b32 v4, 7, v2
    s_mul_i32 s31, s24, 16
    v_add_u32 v3, s31, v3
    s_mov_b32 s34, 1280
    s_lshl_b32 s35, s30, 1
    v_add_u32 v5, 0, v3
    v_bfe_u32 v6, v5, 1, 1
    v_lshlrev_b32 v6, 2, v6
    v_xor_b32 v6, v6, v4
    v_mul_lo_u32 v5, v5, s34
    v_lshl_add_u32 v5, v6, 4, v5
    v_add_u32 v5, s35, v5
    v_mov_b32 v20, v5
    v_add_u32 v5, 8, v3
    v_bfe_u32 v6, v5, 1, 1
    v_lshlrev_b32 v6, 2, v6
    v_xor_b32 v6, v6, v4
    v_mul_lo_u32 v5, v5, s34
    v_lshl_add_u32 v5, v6, 4, v5
    v_add_u32 v5, s35, v5
    v_subrev_u32 v5, 1024, v5
    v_mov_b32 v21, v5
    s_mul_i32 s25, s24, 0
    s_mul_i32 s36, s24, 2048
    s_mul_i32 s27, s37, 81920
    s_add_u32 m0, s36, 0
    s_nop 0
    buffer_load_dwordx4 v20, s[8:11], s27 offen offset:0 lds
    buffer_load_dwordx4 v21, s[8:11], s27 offen offset:1024 lds
    s_add_u32 s27, s27, 81920
    buffer_load_dwordx4 a[0:3], v16, s[4:7], s26 offen offset:0
    buffer_load_dwordx4 a[4:7], v16, s[4:7], s26 offen offset:1024
    buffer_load_dwordx4 a[8:11], v16, s[4:7], s26 offen offset:2048
    buffer_load_dwordx4 a[12:15], v16, s[4:7], s26 offen offset:3072
    s_add_u32 s26, s26, 4096
    v_and_b32 v3, 31, v2
    v_lshrrev_b32 v4, 5, v2
    v_bfe_u32 v5, v2, 2, 2
    v_lshl_add_u32 v6, v4, 3, v5
    v_mul_u32_u24 v6, 128, v6
    v_and_b32 v7, 3, v2
    v_lshl_add_u32 v6, v7, 3, v6
    v_bfe_u32 v7, v2, 4, 1
    v_lshl_add_u32 v6, v7, 5, v6
    v_lshrrev_b32 v5, 1, v5
    s_mul_i32 s31, s33, 2
    s_add_u32 s34, s31, 0
    v_xor_b32 v7, s34, v5
    v_lshl_add_u32 v12, v7, 6, v6
    s_add_u32 s34, s31, 1
    v_xor_b32 v7, s34, v5
    v_lshl_add_u32 v13, v7, 6, v6
    s_mul_i32 s31, s33, 64
    s_add_u32 s39, s30, s31
    v_lshlrev_b32 v26, 4, v2
    s_lshl_b32 s31, s38, 5
    v_add_u32 v5, s31, v3
    s_mov_b32 s34, 1280
    v_mul_lo_u32 v24, v5, s34
    v_lshl_add_u32 v24, v4, 4, v24
    s_lshl_b32 s34, s39, 1
    v_add_u32 v24, s34, v24
    s_add_u32 m0, s36, 8192
    s_nop 0
    buffer_load_dwordx4 v20, s[8:11], s27 offen offset:0 lds
    buffer_load_dwordx4 v21, s[8:11], s27 offen offset:1024 lds
    s_add_u32 s27, s27, 81920
    buffer_load_dwordx4 a[16:19], v16, s[4:7], s26 offen offset:0
    buffer_load_dwordx4 a[20:23], v16, s[4:7], s26 offen offset:1024
    buffer_load_dwordx4 a[24:27], v16, s[4:7], s26 offen offset:2048
    buffer_load_dwordx4 a[28:31], v16, s[4:7], s26 offen offset:3072
    s_add_u32 s26, s26, 4096
    v_mov_b32 v48, 0
    v_mov_b32 v49, 0
    v_mov_b32 v50, 0
    v_mov_b32 v51, 0
    v_mov_b32 v52, 0
    v_mov_b32 v53, 0
    v_mov_b32 v54, 0
    v_mov_b32 v55, 0
    v_mov_b32 v56, 0
    v_mov_b32 v57, 0
    v_mov_b32 v58, 0
    v_mov_b32 v59, 0
    v_mov_b32 v60, 0
    v_mov_b32 v61, 0
    v_mov_b32 v62, 0
    v_mov_b32 v63, 0
    v_mov_b32 v64, 0
    v_mov_b32 v65, 0
    v_mov_b32 v66, 0
    v_mov_b32 v67, 0
    v_mov_b32 v68, 0
    v_mov_b32 v69, 0
    v_mov_b32 v70, 0
    v_mov_b32 v71, 0
    v_mov_b32 v72, 0
    v_mov_b32 v73, 0
    v_mov_b32 v74, 0
    v_mov_b32 v75, 0
    v_mov_b32 v76, 0
    v_mov_b32 v77, 0
    v_mov_b32 v78, 0
    v_mov_b32 v79, 0
    s_add_u32 m0, s36, 16384
    s_nop 0
    buffer_load_dwordx4 v20, s[8:11], s27 offen offset:0 lds
    buffer_load_dwordx4 v21, s[8:11], s27 offen offset:1024 lds
    s_add_u32 s27, s27, 81920
    buffer_load_dwordx4 a[32:35], v16, s[4:7], s26 offen offset:0
    buffer_load_dwordx4 a[36:39], v16, s[4:7], s26 offen offset:1024
    buffer_load_dwordx4 a[40:43], v16, s[4:7], s26 offen offset:2048
    buffer_load_dwordx4 a[44:47], v16, s[4:7], s26 offen offset:3072
    s_add_u32 s26, s26, 4096
    s_add_u32 m0, s36, 24576
    s_nop 0
    buffer_load_dwordx4 v20, s[8:11], s27 offen offset:0 lds
    buffer_load_dwordx4 v21, s[8:11], s27 offen offset:1024 lds
    s_add_u32 s27, s27, 81920
    buffer_load_dwordx4 a[48:51], v16, s[4:7], s26 offen offset:0
    buffer_load_dwordx4 a[52:55], v16, s[4:7], s26 offen offset:1024
    buffer_load_dwordx4 a[56:59], v16, s[4:7], s26 offen offset:2048
    buffer_load_dwordx4 a[60:63], v16, s[4:7], s26 offen offset:3072
    s_add_u32 s26, s26, 4096
    s_add_u32 m0, s36, 32768
    s_nop 0
    buffer_load_dwordx4 v20, s[8:11], s27 offen offset:0 lds
    buffer_load_dwordx4 v21, s[8:11], s27 offen offset:1024 lds
    s_add_u32 s27, s27, 81920
    s_add_u32 m0, s36, 40960
    s_nop 0
    buffer_load_dwordx4 v20, s[8:11], s27 offen offset:0 lds
    buffer_load_dwordx4 v21, s[8:11], s27 offen offset:1024 lds
    s_add_u32 s27, s27, 81920
    s_waitcnt vmcnt(22)
    s_barrier
    ds_read_b64_tr_b16 v[80:81], v12 offset:0
    ds_read_b64_tr_b16 v[82:83], v12 offset:512
    ds_read_b64_tr_b16 v[84:85], v13 offset:0
    ds_read_b64_tr_b16 v[86:87], v13 offset:512
    s_waitcnt lgkmcnt(0)
    v_mfma_f32_32x32x16_bf16 v[48:63], v[80:83], a[0:3], v[48:63]
    ds_read_b64_tr_b16 v[88:89], v12 offset:2048
    ds_read_b64_tr_b16 v[90:91], v12 offset:2560
    ds_read_b64_tr_b16 v[92:93], v13 offset:2048
    ds_read_b64_tr_b16 v[94:95], v13 offset:2560
    v_mfma_f32_32x32x16_bf16 v[64:79], v[84:87], a[0:3], v[64:79]
    buffer_load_dwordx4 a[64:67], v16, s[4:7], s26 offen offset:0
    buffer_load_dwordx4 a[68:71], v16, s[4:7], s26 offen offset:1024
    s_waitcnt lgkmcnt(0)
    v_mfma_f32_32x32x16_bf16 v[48:63], v[88:91], a[4:7], v[48:63]
    ds_read_b64_tr_b16 v[80:81], v12 offset:4096
    ds_read_b64_tr_b16 v[82:83], v12 offset:4608
    ds_read_b64_tr_b16 v[84:85], v13 offset:4096
    ds_read_b64_tr_b16 v[86:87], v13 offset:4608
    v_mfma_f32_32x32x16_bf16 v[64:79], v[92:95], a[4:7], v[64:79]
    buffer_load_dwordx4 a[72:75], v16, s[4:7], s26 offen offset:2048
    s_waitcnt lgkmcnt(0)
    v_mfma_f32_32x32x16_bf16 v[48:63], v[80:83], a[8:11], v[48:63]
    ds_read_b64_tr_b16 v[88:89], v12 offset:6144
    ds_read_b64_tr_b16 v[90:91], v12 offset:6656
    ds_read_b64_tr_b16 v[92:93], v13 offset:6144
    ds_read_b64_tr_b16 v[94:95], v13 offset:6656
    v_mfma_f32_32x32x16_bf16 v[64:79], v[84:87], a[8:11], v[64:79]
    buffer_load_dwordx4 a[76:79], v16, s[4:7], s26 offen offset:3072
    s_add_u32 s26, s26, 4096
    s_waitcnt vmcnt(20) lgkmcnt(0)
    s_barrier
    v_mfma_f32_32x32x16_bf16 v[48:63], v[88:91], a[12:15], v[48:63]
    ds_read_b64_tr_b16 v[80:81], v12 offset:8192
    ds_read_b64_tr_b16 v[82:83], v12 offset:8704
    ds_read_b64_tr_b16 v[84:85], v13 offset:8192
    ds_read_b64_tr_b16 v[86:87], v13 offset:8704
    v_mfma_f32_32x32x16_bf16 v[64:79], v[92:95], a[12:15], v[64:79]
    s_add_u32 m0, s36, 0
    s_nop 0
    buffer_load_dwordx4 v20, s[8:11], s27 offen offset:0 lds
    s_waitcnt lgkmcnt(0)
    v_mfma_f32_32x32x16_bf16 v[48:63], v[80:83], a[16:19], v[48:63]
    ds_read_b64_tr_b16 v[88:89], v12 offset:10240
    ds_read_b64_tr_b16 v[90:91], v12 offset:10752
    ds_read_b64_tr_b16 v[92:93], v13 offset:10240
    ds_read_b64_tr_b16 v[94:95], v13 offset:10752
    v_mfma_f32_32x32x16_bf16 v[64:79], v[84:87], a[16:19], v[64:79]
    buffer_load_dwordx4 v21, s[8:11], s27 offen offset:1024 lds
    s_add_u32 s27, s27, 81920
    buffer_load_dwordx4 a[0:3], v16, s[4:7], s26 offen offset:0
    s_waitcnt lgkmcnt(0)
    v_mfma_f32_32x32x16_bf16 v[48:63], v[88:91], a[20:23], v[48:63]
    ds_read_b64_tr_b16 v[80:81], v12 offset:12288
    ds_read_b64_tr_b16 v[82:83], v12 offset:12800
    ds_read_b64_tr_b16 v[84:85], v13 offset:12288
    ds_read_b64_tr_b16 v[86:87], v13 offset:12800
    v_mfma_f32_32x32x16_bf16 v[64:79], v[92:95], a[20:23], v[64:79]
    buffer_load_dwordx4 a[4:7], v16, s[4:7], s26 offen offset:1024
    buffer_load_dwordx4 a[8:11], v16, s[4:7], s26 offen offset:2048
    s_waitcnt lgkmcnt(0)
    v_mfma_f32_32x32x16_bf16 v[48:63], v[80:83], a[24:27], v[48:63]
    ds_read_b64_tr_b16 v[88:89], v12 offset:14336
    ds_read_b64_tr_b16 v[90:91], v12 offset:14848
    ds_read_b64_tr_b16 v[92:93], v13 offset:14336
    ds_read_b64_tr_b16 v[94:95], v13 offset:14848
    v_mfma_f32_32x32x16_bf16 v[64:79], v[84:87], a[24:27], v[64:79]
    buffer_load_dwordx4 a[12:15], v16, s[4:7], s26 offen offset:3072
    s_add_u32 s26, s26, 4096
    s_waitcnt vmcnt(20) lgkmcnt(0)
    s_barrier
    v_mfma_f32_32x32x16_bf16 v[48:63], v[88:91], a[28:31], v[48:63]
    ds_read_b64_tr_b16 v[80:81], v12 offset:16384
    ds_read_b64_tr_b16 v[82:83], v12 offset:16896
    ds_read_b64_tr_b16 v[84:85], v13 offset:16384
    ds_read_b64_tr_b16 v[86:87], v13 offset:16896
    v_mfma_f32_32x32x16_bf16 v[64:79], v[92:95], a[28:31], v[64:79]
    s_add_u32 m0, s36, 8192
    s_nop 0
    buffer_load_dwordx4 v20, s[8:11], s27 offen offset:0 lds
    s_waitcnt lgkmcnt(0)
    v_mfma_f32_32x32x16_bf16 v[48:63], v[80:83], a[32:35], v[48:63]
    ds_read_b64_tr_b16 v[88:89], v12 offset:18432
    ds_read_b64_tr_b16 v[90:91], v12 offset:18944
    ds_read_b64_tr_b16 v[92:93], v13 offset:18432
    ds_read_b64_tr_b16 v[94:95], v13 offset:18944
    buffer_load_dwordx4 v21, s[8:11], s27 offen offset:1024 lds
    s_add_u32 s27, s27, 81920
    v_mfma_f32_32x32x16_bf16 v[64:79], v[84:87], a[32:35], v[64:79]
    buffer_load_dwordx4 a[16:19], v16, s[4:7], s26 offen offset:0
    buffer_load_dwordx4 a[20:23], v16, s[4:7], s26 offen offset:1024
    s_waitcnt lgkmcnt(0)
    v_mfma_f32_32x32x16_bf16 v[48:63], v[88:91], a[36:39], v[48:63]
    ds_read_b64_tr_b16 v[80:81], v12 offset:20480
    ds_read_b64_tr_b16 v[82:83], v12 offset:20992
    ds_read_b64_tr_b16 v[84:85], v13 offset:20480
    ds_read_b64_tr_b16 v[86:87], v13 offset:20992
    v_mfma_f32_32x32x16_bf16 v[64:79], v[92:95], a[36:39], v[64:79]
    buffer_load_dwordx4 a[24:27], v16, s[4:7], s26 offen offset:2048
    buffer_load_dwordx4 a[28:31], v16, s[4:7], s26 offen offset:3072
    s_add_u32 s26, s26, 4096
    s_waitcnt lgkmcnt(0)
    v_mfma_f32_32x32x16_bf16 v[48:63], v[80:83], a[40:43], v[48:63]
    ds_read_b64_tr_b16 v[88:89], v12 offset:22528
    ds_read_b64_tr_b16 v[90:91], v12 offset:23040
    ds_read_b64_tr_b16 v[92:93], v13 offset:22528
    ds_read_b64_tr_b16 v[94:95], v13 offset:23040
    v_mfma_f32_32x32x16_bf16 v[64:79], v[84:87], a[40:43], v[64:79]
    s_add_u32 s31, s38, 0
    s_mul_i32 s31, s31, 20
    s_lshr_b32 s34, s39, 5
    s_add_u32 s31, s31, s34
    s_add_u32 s31, s31, 0
    s_lshl_b32 s31, s31, 11
    buffer_load_dwordx4 v[96:99], v26, s[16:19], s31 offen offset:0
    buffer_load_dwordx4 v[100:103], v26, s[16:19], s31 offen offset:1024
    s_waitcnt vmcnt(22) lgkmcnt(0)
    s_barrier
    v_mfma_f32_32x32x16_bf16 v[48:63], v[88:91], a[44:47], v[48:63]
    ds_read_b64_tr_b16 v[80:81], v12 offset:24576
    ds_read_b64_tr_b16 v[82:83], v12 offset:25088
    ds_read_b64_tr_b16 v[84:85], v13 offset:24576
    ds_read_b64_tr_b16 v[86:87], v13 offset:25088
    v_mfma_f32_32x32x16_bf16 v[64:79], v[92:95], a[44:47], v[64:79]
    s_add_u32 m0, s36, 16384
    s_nop 0
    buffer_load_dwordx4 v20, s[8:11], s27 offen offset:0 lds
    s_waitcnt lgkmcnt(0)
    v_mfma_f32_32x32x16_bf16 v[48:63], v[80:83], a[48:51], v[48:63]
    ds_read_b64_tr_b16 v[88:89], v12 offset:26624
    ds_read_b64_tr_b16 v[90:91], v12 offset:27136
    ds_read_b64_tr_b16 v[92:93], v13 offset:26624
    ds_read_b64_tr_b16 v[94:95], v13 offset:27136
    buffer_load_dwordx4 v21, s[8:11], s27 offen offset:1024 lds
    s_add_u32 s27, s27, 81920
    v_mfma_f32_32x32x16_bf16 v[64:79], v[84:87], a[48:51], v[64:79]
    buffer_load_dwordx4 a[32:35], v16, s[4:7], s26 offen offset:0
    buffer_load_dwordx4 a[36:39], v16, s[4:7], s26 offen offset:1024
    s_waitcnt lgkmcnt(0)
    v_mfma_f32_32x32x16_bf16 v[48:63], v[88:91], a[52:55], v[48:63]
    ds_read_b64_tr_b16 v[80:81], v12 offset:28672
    ds_read_b64_tr_b16 v[82:83], v12 offset:29184
    ds_read_b64_tr_b16 v[84:85], v13 offset:28672
    ds_read_b64_tr_b16 v[86:87], v13 offset:29184
    v_mfma_f32_32x32x16_bf16 v[64:79], v[92:95], a[52:55], v[64:79]
    buffer_load_dwordx4 a[40:43], v16, s[4:7], s26 offen offset:2048
    buffer_load_dwordx4 a[44:47], v16, s[4:7], s26 offen offset:3072
    s_add_u32 s26, s26, 4096
    s_waitcnt lgkmcnt(0)
    v_mfma_f32_32x32x16_bf16 v[48:63], v[80:83], a[56:59], v[48:63]
    ds_read_b64_tr_b16 v[88:89], v12 offset:30720
    ds_read_b64_tr_b16 v[90:91], v12 offset:31232
    ds_read_b64_tr_b16 v[92:93], v13 offset:30720
    ds_read_b64_tr_b16 v[94:95], v13 offset:31232
    v_mfma_f32_32x32x16_bf16 v[64:79], v[84:87], a[56:59], v[64:79]
    s_add_u32 s31, s31, 2621440
    buffer_load_dwordx4 v[104:107], v26, s[16:19], s31 offen offset:0
    buffer_load_dwordx4 v[108:111], v26, s[16:19], s31 offen offset:1024
    s_waitcnt vmcnt(22) lgkmcnt(0)
    s_barrier
    v_mfma_f32_32x32x16_bf16 v[48:63], v[88:91], a[60:63], v[48:63]
    ds_read_b64_tr_b16 v[80:81], v12 offset:32768
    ds_read_b64_tr_b16 v[82:83], v12 offset:33280
    ds_read_b64_tr_b16 v[84:85], v13 offset:32768
    ds_read_b64_tr_b16 v[86:87], v13 offset:33280
    v_mfma_f32_32x32x16_bf16 v[64:79], v[92:95], a[60:63], v[64:79]
    s_add_u32 m0, s36, 24576
    s_nop 0
    buffer_load_dwordx4 v20, s[8:11], s27 offen offset:0 lds
    s_waitcnt lgkmcnt(0)
    v_mfma_f32_32x32x16_bf16 v[48:63], v[80:83], a[64:67], v[48:63]
    ds_read_b64_tr_b16 v[88:89], v12 offset:34816
    ds_read_b64_tr_b16 v[90:91], v12 offset:35328
    ds_read_b64_tr_b16 v[92:93], v13 offset:34816
    ds_read_b64_tr_b16 v[94:95], v13 offset:35328
    buffer_load_dwordx4 v21, s[8:11], s27 offen offset:1024 lds
    s_add_u32 s27, s27, 81920
    v_mfma_f32_32x32x16_bf16 v[64:79], v[84:87], a[64:67], v[64:79]
    buffer_load_dwordx4 a[48:51], v16, s[4:7], s26 offen offset:0
    buffer_load_dwordx4 a[52:55], v16, s[4:7], s26 offen offset:1024
    s_waitcnt lgkmcnt(0)
    v_mfma_f32_32x32x16_bf16 v[48:63], v[88:91], a[68:71], v[48:63]
    ds_read_b64_tr_b16 v[80:81], v12 offset:36864
    ds_read_b64_tr_b16 v[82:83], v12 offset:37376
    ds_read_b64_tr_b16 v[84:85], v13 offset:36864
    ds_read_b64_tr_b16 v[86:87], v13 offset:37376
    v_mfma_f32_32x32x16_bf16 v[64:79], v[92:95], a[68:71], v[64:79]
    buffer_load_dwordx4 a[56:59], v16, s[4:7], s26 offen offset:2048
    buffer_load_dwordx4 a[60:63], v16, s[4:7], s26 offen offset:3072
    s_add_u32 s26, s26, 4096
    s_waitcnt lgkmcnt(0)
    v_mfma_f32_32x32x16_bf16 v[48:63], v[80:83], a[72:75], v[48:63]
    ds_read_b64_tr_b16 v[88:89], v12 offset:38912
    ds_read_b64_tr_b16 v[90:91], v12 offset:39424
    ds_read_b64_tr_b16 v[92:93], v13 offset:38912
    ds_read_b64_tr_b16 v[94:95], v13 offset:39424
    v_mfma_f32_32x32x16_bf16 v[64:79], v[84:87], a[72:75], v[64:79]
    s_add_u32 s31, s31, 2621440
    buffer_load_dwordx4 v[112:115], v26, s[16:19], s31 offen offset:0
    buffer_load_dwordx4 v[116:119], v26, s[16:19], s31 offen offset:1024
    s_waitcnt vmcnt(24) lgkmcnt(0)
    s_barrier
    v_mfma_f32_32x32x16_bf16 v[48:63], v[88:91], a[76:79], v[48:63]
    ds_read_b64_tr_b16 v[80:81], v12 offset:40960
    ds_read_b64_tr_b16 v[82:83], v12 offset:41472
    ds_read_b64_tr_b16 v[84:85], v13 offset:40960
    ds_read_b64_tr_b16 v[86:87], v13 offset:41472
    v_mfma_f32_32x32x16_bf16 v[64:79], v[92:95], a[76:79], v[64:79]
    s_add_u32 m0, s36, 32768
    s_nop 0
    buffer_load_dwordx4 v20, s[8:11], s27 offen offset:0 lds
    s_waitcnt lgkmcnt(0)
    v_mfma_f32_32x32x16_bf16 v[48:63], v[80:83], a[0:3], v[48:63]
    ds_read_b64_tr_b16 v[88:89], v12 offset:43008
    ds_read_b64_tr_b16 v[90:91], v12 offset:43520
    ds_read_b64_tr_b16 v[92:93], v13 offset:43008
    ds_read_b64_tr_b16 v[94:95], v13 offset:43520
    buffer_load_dwordx4 v21, s[8:11], s27 offen offset:1024 lds
    s_add_u32 s27, s27, 81920
    v_mfma_f32_32x32x16_bf16 v[64:79], v[84:87], a[0:3], v[64:79]
    buffer_load_dwordx4 a[64:67], v16, s[4:7], s26 offen offset:0
    buffer_load_dwordx4 a[68:71], v16, s[4:7], s26 offen offset:1024
    s_waitcnt lgkmcnt(0)
    v_mfma_f32_32x32x16_bf16 v[48:63], v[88:91], a[4:7], v[48:63]
    ds_read_b64_tr_b16 v[80:81], v12 offset:45056
    ds_read_b64_tr_b16 v[82:83], v12 offset:45568
    ds_read_b64_tr_b16 v[84:85], v13 offset:45056
    ds_read_b64_tr_b16 v[86:87], v13 offset:45568
    v_mfma_f32_32x32x16_bf16 v[64:79], v[92:95], a[4:7], v[64:79]
    buffer_load_dwordx4 a[72:75], v16, s[4:7], s26 offen offset:2048
    buffer_load_dwordx4 a[76:79], v16, s[4:7], s26 offen offset:3072
    s_add_u32 s26, s26, 4096
    s_waitcnt lgkmcnt(0)
    v_mfma_f32_32x32x16_bf16 v[48:63], v[80:83], a[8:11], v[48:63]
    ds_read_b64_tr_b16 v[88:89], v12 offset:47104
    ds_read_b64_tr_b16 v[90:91], v12 offset:47616
    ds_read_b64_tr_b16 v[92:93], v13 offset:47104
    ds_read_b64_tr_b16 v[94:95], v13 offset:47616
    v_mfma_f32_32x32x16_bf16 v[64:79], v[84:87], a[8:11], v[64:79]
    s_mov_b32 s31, 0
    buffer_load_dwordx4 v[144:147], v24, s[20:23], s31 offen offset:0
    buffer_load_dwordx4 v[148:151], v24, s[20:23], s31 offen offset:32
    s_waitcnt vmcnt(26) lgkmcnt(0)
    s_barrier
    v_mfma_f32_32x32x16_bf16 v[48:63], v[88:91], a[12:15], v[48:63]
    ds_read_b64_tr_b16 v[80:81], v12 offset:0
    ds_read_b64_tr_b16 v[82:83], v12 offset:512
    ds_read_b64_tr_b16 v[84:85], v13 offset:0
    ds_read_b64_tr_b16 v[86:87], v13 offset:512
    v_mfma_f32_32x32x16_bf16 v[64:79], v[92:95], a[12:15], v[64:79]
    s_add_u32 m0, s36, 40960
    s_nop 0
    buffer_load_dwordx4 v20, s[8:11], s27 offen offset:0 lds
    s_waitcnt lgkmcnt(0)
    v_mfma_f32_32x32x16_bf16 v[48:63], v[80:83], a[16:19], v[48:63]
    ds_read_b64_tr_b16 v[88:89], v12 offset:2048
    ds_read_b64_tr_b16 v[90:91], v12 offset:2560
    ds_read_b64_tr_b16 v[92:93], v13 offset:2048
    ds_read_b64_tr_b16 v[94:95], v13 offset:2560
    buffer_load_dwordx4 v21, s[8:11], s27 offen offset:1024 lds
    s_add_u32 s27, s27, 81920
    v_mfma_f32_32x32x16_bf16 v[64:79], v[84:87], a[16:19], v[64:79]
    buffer_load_dwordx4 a[0:3], v16, s[4:7], s26 offen offset:0
    buffer_load_dwordx4 a[4:7], v16, s[4:7], s26 offen offset:1024
    s_waitcnt lgkmcnt(0)
    v_mfma_f32_32x32x16_bf16 v[48:63], v[88:91], a[20:23], v[48:63]
    ds_read_b64_tr_b16 v[80:81], v12 offset:4096
    ds_read_b64_tr_b16 v[82:83], v12 offset:4608
    ds_read_b64_tr_b16 v[84:85], v13 offset:4096
    ds_read_b64_tr_b16 v[86:87], v13 offset:4608
    v_mfma_f32_32x32x16_bf16 v[64:79], v[92:95], a[20:23], v[64:79]
    buffer_load_dwordx4 a[8:11], v16, s[4:7], s26 offen offset:2048
    buffer_load_dwordx4 a[12:15], v16, s[4:7], s26 offen offset:3072
    s_add_u32 s26, s26, 4096
    s_waitcnt lgkmcnt(0)
    v_mfma_f32_32x32x16_bf16 v[48:63], v[80:83], a[24:27], v[48:63]
    ds_read_b64_tr_b16 v[88:89], v12 offset:6144
    ds_read_b64_tr_b16 v[90:91], v12 offset:6656
    ds_read_b64_tr_b16 v[92:93], v13 offset:6144
    ds_read_b64_tr_b16 v[94:95], v13 offset:6656
    v_mfma_f32_32x32x16_bf16 v[64:79], v[84:87], a[24:27], v[64:79]
    s_add_u32 s31, s38, 0
    s_mul_i32 s31, s31, 20
    s_lshr_b32 s34, s39, 5
    s_add_u32 s31, s31, s34
    s_add_u32 s31, s31, 1
    s_lshl_b32 s31, s31, 11
    buffer_load_dwordx4 v[120:123], v26, s[16:19], s31 offen offset:0
    buffer_load_dwordx4 v[124:127], v26, s[16:19], s31 offen offset:1024
    s_waitcnt vmcnt(26) lgkmcnt(0)
    s_barrier
    v_mfma_f32_32x32x16_bf16 v[48:63], v[88:91], a[28:31], v[48:63]
    ds_read_b64_tr_b16 v[80:81], v12 offset:8192
    ds_read_b64_tr_b16 v[82:83], v12 offset:8704
    ds_read_b64_tr_b16 v[84:85], v13 offset:8192
    ds_read_b64_tr_b16 v[86:87], v13 offset:8704
    v_mfma_f32_32x32x16_bf16 v[64:79], v[92:95], a[28:31], v[64:79]
    s_add_u32 m0, s36, 0
    s_nop 0
    buffer_load_dwordx4 v20, s[8:11], s27 offen offset:0 lds
    s_waitcnt lgkmcnt(0)
    v_mfma_f32_32x32x16_bf16 v[48:63], v[80:83], a[32:35], v[48:63]
    ds_read_b64_tr_b16 v[88:89], v12 offset:10240
    ds_read_b64_tr_b16 v[90:91], v12 offset:10752
    ds_read_b64_tr_b16 v[92:93], v13 offset:10240
    ds_read_b64_tr_b16 v[94:95], v13 offset:10752
    buffer_load_dwordx4 v21, s[8:11], s27 offen offset:1024 lds
    s_add_u32 s27, s27, 81920
    v_mfma_f32_32x32x16_bf16 v[64:79], v[84:87], a[32:35], v[64:79]
    buffer_load_dwordx4 a[16:19], v16, s[4:7], s26 offen offset:0
    buffer_load_dwordx4 a[20:23], v16, s[4:7], s26 offen offset:1024
    s_waitcnt lgkmcnt(0)
    v_mfma_f32_32x32x16_bf16 v[48:63], v[88:91], a[36:39], v[48:63]
    ds_read_b64_tr_b16 v[80:81], v12 offset:12288
    ds_read_b64_tr_b16 v[82:83], v12 offset:12800
    ds_read_b64_tr_b16 v[84:85], v13 offset:12288
    ds_read_b64_tr_b16 v[86:87], v13 offset:12800
    v_mfma_f32_32x32x16_bf16 v[64:79], v[92:95], a[36:39], v[64:79]
    buffer_load_dwordx4 a[24:27], v16, s[4:7], s26 offen offset:2048
    buffer_load_dwordx4 a[28:31], v16, s[4:7], s26 offen offset:3072
    s_add_u32 s26, s26, 4096
    s_waitcnt lgkmcnt(0)
    v_mfma_f32_32x32x16_bf16 v[48:63], v[80:83], a[40:43], v[48:63]
    ds_read_b64_tr_b16 v[88:89], v12 offset:14336
    ds_read_b64_tr_b16 v[90:91], v12 offset:14848
    ds_read_b64_tr_b16 v[92:93], v13 offset:14336
    ds_read_b64_tr_b16 v[94:95], v13 offset:14848
    v_mfma_f32_32x32x16_bf16 v[64:79], v[84:87], a[40:43], v[64:79]
    s_add_u32 s31, s31, 2621440
    buffer_load_dwordx4 v[128:131], v26, s[16:19], s31 offen offset:0
    buffer_load_dwordx4 v[132:135], v26, s[16:19], s31 offen offset:1024
    s_waitcnt vmcnt(26) lgkmcnt(0)
    s_barrier
    v_mfma_f32_32x32x16_bf16 v[48:63], v[88:91], a[44:47], v[48:63]
    ds_read_b64_tr_b16 v[80:81], v12 offset:16384
    ds_read_b64_tr_b16 v[82:83], v12 offset:16896
    ds_read_b64_tr_b16 v[84:85], v13 offset:16384
    ds_read_b64_tr_b16 v[86:87], v13 offset:16896
    v_mfma_f32_32x32x16_bf16 v[64:79], v[92:95], a[44:47], v[64:79]
    s_add_u32 m0, s36, 8192
    s_nop 0
    buffer_load_dwordx4 v20, s[8:11], s27 offen offset:0 lds
    s_waitcnt lgkmcnt(0)
    v_mfma_f32_32x32x16_bf16 v[48:63], v[80:83], a[48:51], v[48:63]
    ds_read_b64_tr_b16 v[88:89], v12 offset:18432
    ds_read_b64_tr_b16 v[90:91], v12 offset:18944
    ds_read_b64_tr_b16 v[92:93], v13 offset:18432
    ds_read_b64_tr_b16 v[94:95], v13 offset:18944
    v_mfma_f32_32x32x16_bf16 v[64:79], v[84:87], a[48:51], v[64:79]
    buffer_load_dwordx4 v21, s[8:11], s27 offen offset:1024 lds
    s_add_u32 s27, s27, 81920
    buffer_load_dwordx4 a[32:35], v16, s[4:7], s26 offen offset:0
    s_waitcnt lgkmcnt(0)
    v_mfma_f32_32x32x16_bf16 v[48:63], v[88:91], a[52:55], v[48:63]
    ds_read_b64_tr_b16 v[80:81], v12 offset:20480
    ds_read_b64_tr_b16 v[82:83], v12 offset:20992
    ds_read_b64_tr_b16 v[84:85], v13 offset:20480
    ds_read_b64_tr_b16 v[86:87], v13 offset:20992
    v_mfma_f32_32x32x16_bf16 v[64:79], v[92:95], a[52:55], v[64:79]
    buffer_load_dwordx4 a[36:39], v16, s[4:7], s26 offen offset:1024
    buffer_load_dwordx4 a[40:43], v16, s[4:7], s26 offen offset:2048
    s_waitcnt lgkmcnt(0)
    v_mfma_f32_32x32x16_bf16 v[48:63], v[80:83], a[56:59], v[48:63]
    ds_read_b64_tr_b16 v[88:89], v12 offset:22528
    ds_read_b64_tr_b16 v[90:91], v12 offset:23040
    ds_read_b64_tr_b16 v[92:93], v13 offset:22528
    ds_read_b64_tr_b16 v[94:95], v13 offset:23040
    v_mfma_f32_32x32x16_bf16 v[64:79], v[84:87], a[56:59], v[64:79]
    buffer_load_dwordx4 a[44:47], v16, s[4:7], s26 offen offset:3072
    s_add_u32 s26, s26, 4096
    s_add_u32 s31, s31, 2621440
    buffer_load_dwordx4 v[136:139], v26, s[16:19], s31 offen offset:0
    s_waitcnt vmcnt(25) lgkmcnt(0)
    s_barrier
    v_mfma_f32_32x32x16_bf16 v[48:63], v[88:91], a[60:63], v[48:63]
    ds_read_b64_tr_b16 v[80:81], v12 offset:24576
    ds_read_b64_tr_b16 v[82:83], v12 offset:25088
    ds_read_b64_tr_b16 v[84:85], v13 offset:24576
    ds_read_b64_tr_b16 v[86:87], v13 offset:25088
    v_mfma_f32_32x32x16_bf16 v[64:79], v[92:95], a[60:63], v[64:79]
    s_waitcnt lgkmcnt(0)
    v_mfma_f32_32x32x16_bf16 v[48:63], v[80:83], a[64:67], v[48:63]
    ds_read_b64_tr_b16 v[88:89], v12 offset:26624
    ds_read_b64_tr_b16 v[90:91], v12 offset:27136
    ds_read_b64_tr_b16 v[92:93], v13 offset:26624
    ds_read_b64_tr_b16 v[94:95], v13 offset:27136
    v_mfma_f32_32x32x16_bf16 v[64:79], v[84:87], a[64:67], v[64:79]
    buffer_load_dwordx4 a[48:51], v16, s[4:7], s26 offen offset:0
    buffer_load_dwordx4 a[52:55], v16, s[4:7], s26 offen offset:1024
    s_waitcnt lgkmcnt(0)
    v_mfma_f32_32x32x16_bf16 v[48:63], v[88:91], a[68:71], v[48:63]
    ds_read_b64_tr_b16 v[80:81], v12 offset:28672
    ds_read_b64_tr_b16 v[82:83], v12 offset:29184
    ds_read_b64_tr_b16 v[84:85], v13 offset:28672
    ds_read_b64_tr_b16 v[86:87], v13 offset:29184
    v_mfma_f32_32x32x16_bf16 v[64:79], v[92:95], a[68:71], v[64:79]
    buffer_load_dwordx4 a[56:59], v16, s[4:7], s26 offen offset:2048
    buffer_load_dwordx4 a[60:63], v16, s[4:7], s26 offen offset:3072
    s_add_u32 s26, s26, 4096
    s_waitcnt lgkmcnt(0)
    v_mfma_f32_32x32x16_bf16 v[48:63], v[80:83], a[72:75], v[48:63]
    ds_read_b64_tr_b16 v[88:89], v12 offset:30720
    ds_read_b64_tr_b16 v[90:91], v12 offset:31232
    ds_read_b64_tr_b16 v[92:93], v13 offset:30720
    ds_read_b64_tr_b16 v[94:95], v13 offset:31232
    v_mfma_f32_32x32x16_bf16 v[64:79], v[84:87], a[72:75], v[64:79]
    buffer_load_dwordx4 v[140:143], v26, s[16:19], s31 offen offset:1024
    s_waitcnt vmcnt(22) lgkmcnt(0)
    s_barrier
    v_mfma_f32_32x32x16_bf16 v[48:63], v[88:91], a[76:79], v[48:63]
    ds_read_b64_tr_b16 v[80:81], v12 offset:32768
    ds_read_b64_tr_b16 v[82:83], v12 offset:33280
    ds_read_b64_tr_b16 v[84:85], v13 offset:32768
    ds_read_b64_tr_b16 v[86:87], v13 offset:33280
    v_mfma_f32_32x32x16_bf16 v[64:79], v[92:95], a[76:79], v[64:79]
    s_waitcnt lgkmcnt(0)
    v_mfma_f32_32x32x16_bf16 v[48:63], v[80:83], a[0:3], v[48:63]
    ds_read_b64_tr_b16 v[88:89], v12 offset:34816
    ds_read_b64_tr_b16 v[90:91], v12 offset:35328
    ds_read_b64_tr_b16 v[92:93], v13 offset:34816
    ds_read_b64_tr_b16 v[94:95], v13 offset:35328
    v_mfma_f32_32x32x16_bf16 v[64:79], v[84:87], a[0:3], v[64:79]
    s_mov_b32 s31, 0
    buffer_load_dwordx4 v[152:155], v24, s[20:23], s31 offen offset:64
    s_waitcnt lgkmcnt(0)
    v_mfma_f32_32x32x16_bf16 v[48:63], v[88:91], a[4:7], v[48:63]
    ds_read_b64_tr_b16 v[80:81], v12 offset:36864
    ds_read_b64_tr_b16 v[82:83], v12 offset:37376
    ds_read_b64_tr_b16 v[84:85], v13 offset:36864
    ds_read_b64_tr_b16 v[86:87], v13 offset:37376
    v_mfma_f32_32x32x16_bf16 v[64:79], v[92:95], a[4:7], v[64:79]
    s_waitcnt lgkmcnt(0)
    v_mfma_f32_32x32x16_bf16 v[48:63], v[80:83], a[8:11], v[48:63]
    ds_read_b64_tr_b16 v[88:89], v12 offset:38912
    ds_read_b64_tr_b16 v[90:91], v12 offset:39424
    ds_read_b64_tr_b16 v[92:93], v13 offset:38912
    ds_read_b64_tr_b16 v[94:95], v13 offset:39424
    v_mfma_f32_32x32x16_bf16 v[64:79], v[84:87], a[8:11], v[64:79]
    s_waitcnt vmcnt(15) lgkmcnt(0)
    s_barrier
    v_mfma_f32_32x32x16_bf16 v[48:63], v[88:91], a[12:15], v[48:63]
    ds_read_b64_tr_b16 v[80:81], v12 offset:40960
    ds_read_b64_tr_b16 v[82:83], v12 offset:41472
    ds_read_b64_tr_b16 v[84:85], v13 offset:40960
    ds_read_b64_tr_b16 v[86:87], v13 offset:41472
    v_mfma_f32_32x32x16_bf16 v[64:79], v[92:95], a[12:15], v[64:79]
    s_waitcnt lgkmcnt(0)
    v_mfma_f32_32x32x16_bf16 v[48:63], v[80:83], a[16:19], v[48:63]
    ds_read_b64_tr_b16 v[88:89], v12 offset:43008
    ds_read_b64_tr_b16 v[90:91], v12 offset:43520
    ds_read_b64_tr_b16 v[92:93], v13 offset:43008
    ds_read_b64_tr_b16 v[94:95], v13 offset:43520
    v_mfma_f32_32x32x16_bf16 v[64:79], v[84:87], a[16:19], v[64:79]
    buffer_load_dwordx4 v[156:159], v24, s[20:23], s31 offen offset:96
    s_waitcnt lgkmcnt(0)
    v_mfma_f32_32x32x16_bf16 v[48:63], v[88:91], a[20:23], v[48:63]
    ds_read_b64_tr_b16 v[80:81], v12 offset:45056
    ds_read_b64_tr_b16 v[82:83], v12 offset:45568
    ds_read_b64_tr_b16 v[84:85], v13 offset:45056
    ds_read_b64_tr_b16 v[86:87], v13 offset:45568
    v_mfma_f32_32x32x16_bf16 v[64:79], v[92:95], a[20:23], v[64:79]
    s_waitcnt lgkmcnt(0)
    v_mfma_f32_32x32x16_bf16 v[48:63], v[80:83], a[24:27], v[48:63]
    ds_read_b64_tr_b16 v[88:89], v12 offset:47104
    ds_read_b64_tr_b16 v[90:91], v12 offset:47616
    ds_read_b64_tr_b16 v[92:93], v13 offset:47104
    ds_read_b64_tr_b16 v[94:95], v13 offset:47616
    v_mfma_f32_32x32x16_bf16 v[64:79], v[84:87], a[24:27], v[64:79]
    s_waitcnt vmcnt(8) lgkmcnt(0)
    s_barrier
    v_mfma_f32_32x32x16_bf16 v[48:63], v[88:91], a[28:31], v[48:63]
    ds_read_b64_tr_b16 v[80:81], v12 offset:0
    ds_read_b64_tr_b16 v[82:83], v12 offset:512
    ds_read_b64_tr_b16 v[84:85], v13 offset:0
    ds_read_b64_tr_b16 v[86:87], v13 offset:512
    v_mfma_f32_32x32x16_bf16 v[64:79], v[92:95], a[28:31], v[64:79]
    s_waitcnt lgkmcnt(0)
    v_mfma_f32_32x32x16_bf16 v[48:63], v[80:83], a[32:35], v[48:63]
    ds_read_b64_tr_b16 v[88:89], v12 offset:2048
    ds_read_b64_tr_b16 v[90:91], v12 offset:2560
    ds_read_b64_tr_b16 v[92:93], v13 offset:2048
    ds_read_b64_tr_b16 v[94:95], v13 offset:2560
    v_mfma_f32_32x32x16_bf16 v[64:79], v[84:87], a[32:35], v[64:79]
    s_waitcnt lgkmcnt(0)
    v_mfma_f32_32x32x16_bf16 v[48:63], v[88:91], a[36:39], v[48:63]
    ds_read_b64_tr_b16 v[80:81], v12 offset:4096
    ds_read_b64_tr_b16 v[82:83], v12 offset:4608
    ds_read_b64_tr_b16 v[84:85], v13 offset:4096
    ds_read_b64_tr_b16 v[86:87], v13 offset:4608
    v_mfma_f32_32x32x16_bf16 v[64:79], v[92:95], a[36:39], v[64:79]
    s_waitcnt lgkmcnt(0)
    v_mfma_f32_32x32x16_bf16 v[48:63], v[80:83], a[40:43], v[48:63]
    ds_read_b64_tr_b16 v[88:89], v12 offset:6144
    ds_read_b64_tr_b16 v[90:91], v12 offset:6656
    ds_read_b64_tr_b16 v[92:93], v13 offset:6144
    ds_read_b64_tr_b16 v[94:95], v13 offset:6656
    v_mfma_f32_32x32x16_bf16 v[64:79], v[84:87], a[40:43], v[64:79]
    s_waitcnt vmcnt(3) lgkmcnt(0)
    s_barrier
    v_mfma_f32_32x32x16_bf16 v[48:63], v[88:91], a[44:47], v[48:63]
    ds_read_b64_tr_b16 v[80:81], v12 offset:8192
    ds_read_b64_tr_b16 v[82:83], v12 offset:8704
    ds_read_b64_tr_b16 v[84:85], v13 offset:8192
    ds_read_b64_tr_b16 v[86:87], v13 offset:8704
    v_mfma_f32_32x32x16_bf16 v[64:79], v[92:95], a[44:47], v[64:79]
    s_waitcnt lgkmcnt(0)
    v_mfma_f32_32x32x16_bf16 v[48:63], v[80:83], a[48:51], v[48:63]
    ds_read_b64_tr_b16 v[88:89], v12 offset:10240
    ds_read_b64_tr_b16 v[90:91], v12 offset:10752
    ds_read_b64_tr_b16 v[92:93], v13 offset:10240
    ds_read_b64_tr_b16 v[94:95], v13 offset:10752
    v_mfma_f32_32x32x16_bf16 v[64:79], v[84:87], a[48:51], v[64:79]
    s_waitcnt lgkmcnt(0)
    v_mfma_f32_32x32x16_bf16 v[48:63], v[88:91], a[52:55], v[48:63]
    v_mfma_f32_32x32x16_bf16 v[64:79], v[92:95], a[52:55], v[64:79]
    s_nop 15
    s_mov_b32 s27, 0xffff0000
    s_mov_b32 s36, 0xbfb8aa3b
    s_waitcnt vmcnt(0)
    v_cvt_pk_bf16_f32 v28, v48, v49
    v_lshlrev_b32 v48, 16, v28
    v_and_b32 v49, s27, v28
    v_cvt_pk_bf16_f32 v32, v50, v51
    v_lshlrev_b32 v50, 16, v32
    v_and_b32 v51, s27, v32
    v_mul_f32 v36, s36, v48
    v_mul_f32 v37, s36, v49
    v_mul_f32 v38, s36, v50
    v_mul_f32 v39, s36, v51
    v_exp_f32 v36, v36
    v_exp_f32 v37, v37
    v_exp_f32 v38, v38
    v_exp_f32 v39, v39
    v_lshlrev_b32 v40, 16, v96
    v_and_b32 v41, s27, v96
    v_lshlrev_b32 v42, 16, v97
    v_and_b32 v43, s27, v97
    v_lshlrev_b32 v44, 16, v104
    v_and_b32 v45, s27, v104
    v_lshlrev_b32 v46, 16, v105
    v_and_b32 v47, s27, v105
    v_add_f32 v40, v40, v44
    v_add_f32 v41, v41, v45
    v_add_f32 v42, v42, v46
    v_add_f32 v43, v43, v47
    v_lshlrev_b32 v44, 16, v112
    v_and_b32 v45, s27, v112
    v_lshlrev_b32 v46, 16, v113
    v_and_b32 v47, s27, v113
    v_add_f32 v40, v40, v44
    v_add_f32 v41, v41, v45
    v_add_f32 v42, v42, v46
    v_add_f32 v43, v43, v47
    v_add_f32 v36, 1.0, v36
    v_add_f32 v37, 1.0, v37
    v_add_f32 v38, 1.0, v38
    v_add_f32 v39, 1.0, v39
    v_rcp_f32 v36, v36
    v_rcp_f32 v37, v37
    v_rcp_f32 v38, v38
    v_rcp_f32 v39, v39
    v_cvt_pk_bf16_f32 v28, v40, v41
    v_lshlrev_b32 v40, 16, v28
    v_and_b32 v41, s27, v28
    v_cvt_pk_bf16_f32 v32, v42, v43
    v_lshlrev_b32 v42, 16, v32
    v_and_b32 v43, s27, v32
    v_mul_f32 v48, v48, v36
    v_mul_f32 v49, v49, v37
    v_mul_f32 v50, v50, v38
    v_mul_f32 v51, v51, v39
    v_cvt_pk_bf16_f32 v28, v48, v49
    v_lshlrev_b32 v48, 16, v28
    v_and_b32 v49, s27, v28
    v_cvt_pk_bf16_f32 v32, v50, v51
    v_lshlrev_b32 v50, 16, v32
    v_and_b32 v51, s27, v32
    v_mul_f32 v48, v48, v40
    v_mul_f32 v49, v49, v41
    v_mul_f32 v50, v50, v42
    v_mul_f32 v51, v51, v43
    v_cvt_pk_bf16_f32 v48, v48, v49
    v_cvt_pk_bf16_f32 v49, v50, v51
    v_cvt_pk_bf16_f32 v28, v52, v53
    v_lshlrev_b32 v52, 16, v28
    v_and_b32 v53, s27, v28
    v_cvt_pk_bf16_f32 v32, v54, v55
    v_lshlrev_b32 v54, 16, v32
    v_and_b32 v55, s27, v32
    v_mul_f32 v36, s36, v52
    v_mul_f32 v37, s36, v53
    v_mul_f32 v38, s36, v54
    v_mul_f32 v39, s36, v55
    v_exp_f32 v36, v36
    v_exp_f32 v37, v37
    v_exp_f32 v38, v38
    v_exp_f32 v39, v39
    v_lshlrev_b32 v40, 16, v98
    v_and_b32 v41, s27, v98
    v_lshlrev_b32 v42, 16, v99
    v_and_b32 v43, s27, v99
    v_lshlrev_b32 v44, 16, v106
    v_and_b32 v45, s27, v106
    v_lshlrev_b32 v46, 16, v107
    v_and_b32 v47, s27, v107
    v_add_f32 v40, v40, v44
    v_add_f32 v41, v41, v45
    v_add_f32 v42, v42, v46
    v_add_f32 v43, v43, v47
    v_lshlrev_b32 v44, 16, v114
    v_and_b32 v45, s27, v114
    v_lshlrev_b32 v46, 16, v115
    v_and_b32 v47, s27, v115
    v_add_f32 v40, v40, v44
    v_add_f32 v41, v41, v45
    v_add_f32 v42, v42, v46
    v_add_f32 v43, v43, v47
    v_add_f32 v36, 1.0, v36
    v_add_f32 v37, 1.0, v37
    v_add_f32 v38, 1.0, v38
    v_add_f32 v39, 1.0, v39
    v_rcp_f32 v36, v36
    v_rcp_f32 v37, v37
    v_rcp_f32 v38, v38
    v_rcp_f32 v39, v39
    v_cvt_pk_bf16_f32 v28, v40, v41
    v_lshlrev_b32 v40, 16, v28
    v_and_b32 v41, s27, v28
    v_cvt_pk_bf16_f32 v32, v42, v43
    v_lshlrev_b32 v42, 16, v32
    v_and_b32 v43, s27, v32
    v_mul_f32 v52, v52, v36
    v_mul_f32 v53, v53, v37
    v_mul_f32 v54, v54, v38
    v_mul_f32 v55, v55, v39
    v_cvt_pk_bf16_f32 v28, v52, v53
    v_lshlrev_b32 v52, 16, v28
    v_and_b32 v53, s27, v28
    v_cvt_pk_bf16_f32 v32, v54, v55
    v_lshlrev_b32 v54, 16, v32
    v_and_b32 v55, s27, v32
    v_mul_f32 v52, v52, v40
    v_mul_f32 v53, v53, v41
    v_mul_f32 v54, v54, v42
    v_mul_f32 v55, v55, v43
    v_cvt_pk_bf16_f32 v50, v52, v53
    v_cvt_pk_bf16_f32 v51, v54, v55
    v_cvt_pk_bf16_f32 v28, v56, v57
    v_lshlrev_b32 v56, 16, v28
    v_and_b32 v57, s27, v28
    v_cvt_pk_bf16_f32 v32, v58, v59
    v_lshlrev_b32 v58, 16, v32
    v_and_b32 v59, s27, v32
    v_mul_f32 v36, s36, v56
    v_mul_f32 v37, s36, v57
    v_mul_f32 v38, s36, v58
    v_mul_f32 v39, s36, v59
    v_exp_f32 v36, v36
    v_exp_f32 v37, v37
    v_exp_f32 v38, v38
    v_exp_f32 v39, v39
    v_lshlrev_b32 v40, 16, v100
    v_and_b32 v41, s27, v100
    v_lshlrev_b32 v42, 16, v101
    v_and_b32 v43, s27, v101
    v_lshlrev_b32 v44, 16, v108
    v_and_b32 v45, s27, v108
    v_lshlrev_b32 v46, 16, v109
    v_and_b32 v47, s27, v109
    v_add_f32 v40, v40, v44
    v_add_f32 v41, v41, v45
    v_add_f32 v42, v42, v46
    v_add_f32 v43, v43, v47
    v_lshlrev_b32 v44, 16, v116
    v_and_b32 v45, s27, v116
    v_lshlrev_b32 v46, 16, v117
    v_and_b32 v47, s27, v117
    v_add_f32 v40, v40, v44
    v_add_f32 v41, v41, v45
    v_add_f32 v42, v42, v46
    v_add_f32 v43, v43, v47
    v_add_f32 v36, 1.0, v36
    v_add_f32 v37, 1.0, v37
    v_add_f32 v38, 1.0, v38
    v_add_f32 v39, 1.0, v39
    v_rcp_f32 v36, v36
    v_rcp_f32 v37, v37
    v_rcp_f32 v38, v38
    v_rcp_f32 v39, v39
    v_cvt_pk_bf16_f32 v28, v40, v41
    v_lshlrev_b32 v40, 16, v28
    v_and_b32 v41, s27, v28
    v_cvt_pk_bf16_f32 v32, v42, v43
    v_lshlrev_b32 v42, 16, v32
    v_and_b32 v43, s27, v32
    v_mul_f32 v56, v56, v36
    v_mul_f32 v57, v57, v37
    v_mul_f32 v58, v58, v38
    v_mul_f32 v59, v59, v39
    v_cvt_pk_bf16_f32 v28, v56, v57
    v_lshlrev_b32 v56, 16, v28
    v_and_b32 v57, s27, v28
    v_cvt_pk_bf16_f32 v32, v58, v59
    v_lshlrev_b32 v58, 16, v32
    v_and_b32 v59, s27, v32
    v_mul_f32 v56, v56, v40
    v_mul_f32 v57, v57, v41
    v_mul_f32 v58, v58, v42
    v_mul_f32 v59, v59, v43
    v_cvt_pk_bf16_f32 v52, v56, v57
    v_cvt_pk_bf16_f32 v53, v58, v59
    v_cvt_pk_bf16_f32 v28, v60, v61
    v_lshlrev_b32 v60, 16, v28
    v_and_b32 v61, s27, v28
    v_cvt_pk_bf16_f32 v32, v62, v63
    v_lshlrev_b32 v62, 16, v32
    v_and_b32 v63, s27, v32
    v_mul_f32 v36, s36, v60
    v_mul_f32 v37, s36, v61
    v_mul_f32 v38, s36, v62
    v_mul_f32 v39, s36, v63
    v_exp_f32 v36, v36
    v_exp_f32 v37, v37
    v_exp_f32 v38, v38
    v_exp_f32 v39, v39
    v_lshlrev_b32 v40, 16, v102
    v_and_b32 v41, s27, v102
    v_lshlrev_b32 v42, 16, v103
    v_and_b32 v43, s27, v103
    v_lshlrev_b32 v44, 16, v110
    v_and_b32 v45, s27, v110
    v_lshlrev_b32 v46, 16, v111
    v_and_b32 v47, s27, v111
    v_add_f32 v40, v40, v44
    v_add_f32 v41, v41, v45
    v_add_f32 v42, v42, v46
    v_add_f32 v43, v43, v47
    v_lshlrev_b32 v44, 16, v118
    v_and_b32 v45, s27, v118
    v_lshlrev_b32 v46, 16, v119
    v_and_b32 v47, s27, v119
    v_add_f32 v40, v40, v44
    v_add_f32 v41, v41, v45
    v_add_f32 v42, v42, v46
    v_add_f32 v43, v43, v47
    v_add_f32 v36, 1.0, v36
    v_add_f32 v37, 1.0, v37
    v_add_f32 v38, 1.0, v38
    v_add_f32 v39, 1.0, v39
    v_rcp_f32 v36, v36
    v_rcp_f32 v37, v37
    v_rcp_f32 v38, v38
    v_rcp_f32 v39, v39
    v_cvt_pk_bf16_f32 v28, v40, v41
    v_lshlrev_b32 v40, 16, v28
    v_and_b32 v41, s27, v28
    v_cvt_pk_bf16_f32 v32, v42, v43
    v_lshlrev_b32 v42, 16, v32
    v_and_b32 v43, s27, v32
    v_mul_f32 v60, v60, v36
    v_mul_f32 v61, v61, v37
    v_mul_f32 v62, v62, v38
    v_mul_f32 v63, v63, v39
    v_cvt_pk_bf16_f32 v28, v60, v61
    v_lshlrev_b32 v60, 16, v28
    v_and_b32 v61, s27, v28
    v_cvt_pk_bf16_f32 v32, v62, v63
    v_lshlrev_b32 v62, 16, v32
    v_and_b32 v63, s27, v32
    v_mul_f32 v60, v60, v40
    v_mul_f32 v61, v61, v41
    v_mul_f32 v62, v62, v42
    v_mul_f32 v63, v63, v43
    v_cvt_pk_bf16_f32 v54, v60, v61
    v_cvt_pk_bf16_f32 v55, v62, v63
    s_nop 1
    v_permlane32_swap_b32 v48, v50
    v_permlane32_swap_b32 v49, v51
    v_permlane32_swap_b32 v52, v54
    v_permlane32_swap_b32 v53, v55
    s_nop 1
    v_lshlrev_b32 v28, 16, v48
    v_and_b32 v29, s27, v48
    v_lshlrev_b32 v30, 16, v144
    v_and_b32 v31, s27, v144
    v_lshlrev_b32 v32, 16, v49
    v_and_b32 v33, s27, v49
    v_lshlrev_b32 v34, 16, v145
    v_and_b32 v35, s27, v145
    v_add_f32 v28, v28, v30
    v_add_f32 v29, v29, v31
    v_add_f32 v32, v32, v34
    v_add_f32 v33, v33, v35
    v_cvt_pk_bf16_f32 v48, v28, v29
    v_cvt_pk_bf16_f32 v49, v32, v33
    v_lshlrev_b32 v28, 16, v50
    v_and_b32 v29, s27, v50
    v_lshlrev_b32 v30, 16, v146
    v_and_b32 v31, s27, v146
    v_lshlrev_b32 v32, 16, v51
    v_and_b32 v33, s27, v51
    v_lshlrev_b32 v34, 16, v147
    v_and_b32 v35, s27, v147
    v_add_f32 v28, v28, v30
    v_add_f32 v29, v29, v31
    v_add_f32 v32, v32, v34
    v_add_f32 v33, v33, v35
    v_cvt_pk_bf16_f32 v50, v28, v29
    v_cvt_pk_bf16_f32 v51, v32, v33
    v_lshlrev_b32 v28, 16, v52
    v_and_b32 v29, s27, v52
    v_lshlrev_b32 v30, 16, v148
    v_and_b32 v31, s27, v148
    v_lshlrev_b32 v32, 16, v53
    v_and_b32 v33, s27, v53
    v_lshlrev_b32 v34, 16, v149
    v_and_b32 v35, s27, v149
    v_add_f32 v28, v28, v30
    v_add_f32 v29, v29, v31
    v_add_f32 v32, v32, v34
    v_add_f32 v33, v33, v35
    v_cvt_pk_bf16_f32 v52, v28, v29
    v_cvt_pk_bf16_f32 v53, v32, v33
    v_lshlrev_b32 v28, 16, v54
    v_and_b32 v29, s27, v54
    v_lshlrev_b32 v30, 16, v150
    v_and_b32 v31, s27, v150
    v_lshlrev_b32 v32, 16, v55
    v_and_b32 v33, s27, v55
    v_lshlrev_b32 v34, 16, v151
    v_and_b32 v35, s27, v151
    v_add_f32 v28, v28, v30
    v_add_f32 v29, v29, v31
    v_add_f32 v32, v32, v34
    v_add_f32 v33, v33, v35
    v_cvt_pk_bf16_f32 v54, v28, v29
    v_cvt_pk_bf16_f32 v55, v32, v33
    s_mov_b32 s31, 0
    buffer_store_dwordx4 v[48:51], v24, s[12:15], s31 offen offset:0
    buffer_store_dwordx4 v[52:55], v24, s[12:15], s31 offen offset:32
    v_cvt_pk_bf16_f32 v28, v64, v65
    v_lshlrev_b32 v64, 16, v28
    v_and_b32 v65, s27, v28
    v_cvt_pk_bf16_f32 v32, v66, v67
    v_lshlrev_b32 v66, 16, v32
    v_and_b32 v67, s27, v32
    v_mul_f32 v36, s36, v64
    v_mul_f32 v37, s36, v65
    v_mul_f32 v38, s36, v66
    v_mul_f32 v39, s36, v67
    v_exp_f32 v36, v36
    v_exp_f32 v37, v37
    v_exp_f32 v38, v38
    v_exp_f32 v39, v39
    v_lshlrev_b32 v40, 16, v120
    v_and_b32 v41, s27, v120
    v_lshlrev_b32 v42, 16, v121
    v_and_b32 v43, s27, v121
    v_lshlrev_b32 v44, 16, v128
    v_and_b32 v45, s27, v128
    v_lshlrev_b32 v46, 16, v129
    v_and_b32 v47, s27, v129
    v_add_f32 v40, v40, v44
    v_add_f32 v41, v41, v45
    v_add_f32 v42, v42, v46
    v_add_f32 v43, v43, v47
    v_lshlrev_b32 v44, 16, v136
    v_and_b32 v45, s27, v136
    v_lshlrev_b32 v46, 16, v137
    v_and_b32 v47, s27, v137
    v_add_f32 v40, v40, v44
    v_add_f32 v41, v41, v45
    v_add_f32 v42, v42, v46
    v_add_f32 v43, v43, v47
    v_add_f32 v36, 1.0, v36
    v_add_f32 v37, 1.0, v37
    v_add_f32 v38, 1.0, v38
    v_add_f32 v39, 1.0, v39
    v_rcp_f32 v36, v36
    v_rcp_f32 v37, v37
    v_rcp_f32 v38, v38
    v_rcp_f32 v39, v39
    v_cvt_pk_bf16_f32 v28, v40, v41
    v_lshlrev_b32 v40, 16, v28
    v_and_b32 v41, s27, v28
    v_cvt_pk_bf16_f32 v32, v42, v43
    v_lshlrev_b32 v42, 16, v32
    v_and_b32 v43, s27, v32
    v_mul_f32 v64, v64, v36
    v_mul_f32 v65, v65, v37
    v_mul_f32 v66, v66, v38
    v_mul_f32 v67, v67, v39
    v_cvt_pk_bf16_f32 v28, v64, v65
    v_lshlrev_b32 v64, 16, v28
    v_and_b32 v65, s27, v28
    v_cvt_pk_bf16_f32 v32, v66, v67
    v_lshlrev_b32 v66, 16, v32
    v_and_b32 v67, s27, v32
    v_mul_f32 v64, v64, v40
    v_mul_f32 v65, v65, v41
    v_mul_f32 v66, v66, v42
    v_mul_f32 v67, v67, v43
    v_cvt_pk_bf16_f32 v64, v64, v65
    v_cvt_pk_bf16_f32 v65, v66, v67
    v_cvt_pk_bf16_f32 v28, v68, v69
    v_lshlrev_b32 v68, 16, v28
    v_and_b32 v69, s27, v28
    v_cvt_pk_bf16_f32 v32, v70, v71
    v_lshlrev_b32 v70, 16, v32
    v_and_b32 v71, s27, v32
    v_mul_f32 v36, s36, v68
    v_mul_f32 v37, s36, v69
    v_mul_f32 v38, s36, v70
    v_mul_f32 v39, s36, v71
    v_exp_f32 v36, v36
    v_exp_f32 v37, v37
    v_exp_f32 v38, v38
    v_exp_f32 v39, v39
    v_lshlrev_b32 v40, 16, v122
    v_and_b32 v41, s27, v122
    v_lshlrev_b32 v42, 16, v123
    v_and_b32 v43, s27, v123
    v_lshlrev_b32 v44, 16, v130
    v_and_b32 v45, s27, v130
    v_lshlrev_b32 v46, 16, v131
    v_and_b32 v47, s27, v131
    v_add_f32 v40, v40, v44
    v_add_f32 v41, v41, v45
    v_add_f32 v42, v42, v46
    v_add_f32 v43, v43, v47
    v_lshlrev_b32 v44, 16, v138
    v_and_b32 v45, s27, v138
    v_lshlrev_b32 v46, 16, v139
    v_and_b32 v47, s27, v139
    v_add_f32 v40, v40, v44
    v_add_f32 v41, v41, v45
    v_add_f32 v42, v42, v46
    v_add_f32 v43, v43, v47
    v_add_f32 v36, 1.0, v36
    v_add_f32 v37, 1.0, v37
    v_add_f32 v38, 1.0, v38
    v_add_f32 v39, 1.0, v39
    v_rcp_f32 v36, v36
    v_rcp_f32 v37, v37
    v_rcp_f32 v38, v38
    v_rcp_f32 v39, v39
    v_cvt_pk_bf16_f32 v28, v40, v41
    v_lshlrev_b32 v40, 16, v28
    v_and_b32 v41, s27, v28
    v_cvt_pk_bf16_f32 v32, v42, v43
    v_lshlrev_b32 v42, 16, v32
    v_and_b32 v43, s27, v32
    v_mul_f32 v68, v68, v36
    v_mul_f32 v69, v69, v37
    v_mul_f32 v70, v70, v38
    v_mul_f32 v71, v71, v39
    v_cvt_pk_bf16_f32 v28, v68, v69
    v_lshlrev_b32 v68, 16, v28
    v_and_b32 v69, s27, v28
    v_cvt_pk_bf16_f32 v32, v70, v71
    v_lshlrev_b32 v70, 16, v32
    v_and_b32 v71, s27, v32
    v_mul_f32 v68, v68, v40
    v_mul_f32 v69, v69, v41
    v_mul_f32 v70, v70, v42
    v_mul_f32 v71, v71, v43
    v_cvt_pk_bf16_f32 v66, v68, v69
    v_cvt_pk_bf16_f32 v67, v70, v71
    v_cvt_pk_bf16_f32 v28, v72, v73
    v_lshlrev_b32 v72, 16, v28
    v_and_b32 v73, s27, v28
    v_cvt_pk_bf16_f32 v32, v74, v75
    v_lshlrev_b32 v74, 16, v32
    v_and_b32 v75, s27, v32
    v_mul_f32 v36, s36, v72
    v_mul_f32 v37, s36, v73
    v_mul_f32 v38, s36, v74
    v_mul_f32 v39, s36, v75
    v_exp_f32 v36, v36
    v_exp_f32 v37, v37
    v_exp_f32 v38, v38
    v_exp_f32 v39, v39
    v_lshlrev_b32 v40, 16, v124
    v_and_b32 v41, s27, v124
    v_lshlrev_b32 v42, 16, v125
    v_and_b32 v43, s27, v125
    v_lshlrev_b32 v44, 16, v132
    v_and_b32 v45, s27, v132
    v_lshlrev_b32 v46, 16, v133
    v_and_b32 v47, s27, v133
    v_add_f32 v40, v40, v44
    v_add_f32 v41, v41, v45
    v_add_f32 v42, v42, v46
    v_add_f32 v43, v43, v47
    v_lshlrev_b32 v44, 16, v140
    v_and_b32 v45, s27, v140
    v_lshlrev_b32 v46, 16, v141
    v_and_b32 v47, s27, v141
    v_add_f32 v40, v40, v44
    v_add_f32 v41, v41, v45
    v_add_f32 v42, v42, v46
    v_add_f32 v43, v43, v47
    v_add_f32 v36, 1.0, v36
    v_add_f32 v37, 1.0, v37
    v_add_f32 v38, 1.0, v38
    v_add_f32 v39, 1.0, v39
    v_rcp_f32 v36, v36
    v_rcp_f32 v37, v37
    v_rcp_f32 v38, v38
    v_rcp_f32 v39, v39
    v_cvt_pk_bf16_f32 v28, v40, v41
    v_lshlrev_b32 v40, 16, v28
    v_and_b32 v41, s27, v28
    v_cvt_pk_bf16_f32 v32, v42, v43
    v_lshlrev_b32 v42, 16, v32
    v_and_b32 v43, s27, v32
    v_mul_f32 v72, v72, v36
    v_mul_f32 v73, v73, v37
    v_mul_f32 v74, v74, v38
    v_mul_f32 v75, v75, v39
    v_cvt_pk_bf16_f32 v28, v72, v73
    v_lshlrev_b32 v72, 16, v28
    v_and_b32 v73, s27, v28
    v_cvt_pk_bf16_f32 v32, v74, v75
    v_lshlrev_b32 v74, 16, v32
    v_and_b32 v75, s27, v32
    v_mul_f32 v72, v72, v40
    v_mul_f32 v73, v73, v41
    v_mul_f32 v74, v74, v42
    v_mul_f32 v75, v75, v43
    v_cvt_pk_bf16_f32 v68, v72, v73
    v_cvt_pk_bf16_f32 v69, v74, v75
    v_cvt_pk_bf16_f32 v28, v76, v77
    v_lshlrev_b32 v76, 16, v28
    v_and_b32 v77, s27, v28
    v_cvt_pk_bf16_f32 v32, v78, v79
    v_lshlrev_b32 v78, 16, v32
    v_and_b32 v79, s27, v32
    v_mul_f32 v36, s36, v76
    v_mul_f32 v37, s36, v77
    v_mul_f32 v38, s36, v78
    v_mul_f32 v39, s36, v79
    v_exp_f32 v36, v36
    v_exp_f32 v37, v37
    v_exp_f32 v38, v38
    v_exp_f32 v39, v39
    v_lshlrev_b32 v40, 16, v126
    v_and_b32 v41, s27, v126
    v_lshlrev_b32 v42, 16, v127
    v_and_b32 v43, s27, v127
    v_lshlrev_b32 v44, 16, v134
    v_and_b32 v45, s27, v134
    v_lshlrev_b32 v46, 16, v135
    v_and_b32 v47, s27, v135
    v_add_f32 v40, v40, v44
    v_add_f32 v41, v41, v45
    v_add_f32 v42, v42, v46
    v_add_f32 v43, v43, v47
    v_lshlrev_b32 v44, 16, v142
    v_and_b32 v45, s27, v142
    v_lshlrev_b32 v46, 16, v143
    v_and_b32 v47, s27, v143
    v_add_f32 v40, v40, v44
    v_add_f32 v41, v41, v45
    v_add_f32 v42, v42, v46
    v_add_f32 v43, v43, v47
    v_add_f32 v36, 1.0, v36
    v_add_f32 v37, 1.0, v37
    v_add_f32 v38, 1.0, v38
    v_add_f32 v39, 1.0, v39
    v_rcp_f32 v36, v36
    v_rcp_f32 v37, v37
    v_rcp_f32 v38, v38
    v_rcp_f32 v39, v39
    v_cvt_pk_bf16_f32 v28, v40, v41
    v_lshlrev_b32 v40, 16, v28
    v_and_b32 v41, s27, v28
    v_cvt_pk_bf16_f32 v32, v42, v43
    v_lshlrev_b32 v42, 16, v32
    v_and_b32 v43, s27, v32
    v_mul_f32 v76, v76, v36
    v_mul_f32 v77, v77, v37
    v_mul_f32 v78, v78, v38
    v_mul_f32 v79, v79, v39
    v_cvt_pk_bf16_f32 v28, v76, v77
    v_lshlrev_b32 v76, 16, v28
    v_and_b32 v77, s27, v28
    v_cvt_pk_bf16_f32 v32, v78, v79
    v_lshlrev_b32 v78, 16, v32
    v_and_b32 v79, s27, v32
    v_mul_f32 v76, v76, v40
    v_mul_f32 v77, v77, v41
    v_mul_f32 v78, v78, v42
    v_mul_f32 v79, v79, v43
    v_cvt_pk_bf16_f32 v70, v76, v77
    v_cvt_pk_bf16_f32 v71, v78, v79
    s_nop 1
    v_permlane32_swap_b32 v64, v66
    v_permlane32_swap_b32 v65, v67
    v_permlane32_swap_b32 v68, v70
    v_permlane32_swap_b32 v69, v71
    s_nop 1
    v_lshlrev_b32 v28, 16, v64
    v_and_b32 v29, s27, v64
    v_lshlrev_b32 v30, 16, v152
    v_and_b32 v31, s27, v152
    v_lshlrev_b32 v32, 16, v65
    v_and_b32 v33, s27, v65
    v_lshlrev_b32 v34, 16, v153
    v_and_b32 v35, s27, v153
    v_add_f32 v28, v28, v30
    v_add_f32 v29, v29, v31
    v_add_f32 v32, v32, v34
    v_add_f32 v33, v33, v35
    v_cvt_pk_bf16_f32 v64, v28, v29
    v_cvt_pk_bf16_f32 v65, v32, v33
    v_lshlrev_b32 v28, 16, v66
    v_and_b32 v29, s27, v66
    v_lshlrev_b32 v30, 16, v154
    v_and_b32 v31, s27, v154
    v_lshlrev_b32 v32, 16, v67
    v_and_b32 v33, s27, v67
    v_lshlrev_b32 v34, 16, v155
    v_and_b32 v35, s27, v155
    v_add_f32 v28, v28, v30
    v_add_f32 v29, v29, v31
    v_add_f32 v32, v32, v34
    v_add_f32 v33, v33, v35
    v_cvt_pk_bf16_f32 v66, v28, v29
    v_cvt_pk_bf16_f32 v67, v32, v33
    v_lshlrev_b32 v28, 16, v68
    v_and_b32 v29, s27, v68
    v_lshlrev_b32 v30, 16, v156
    v_and_b32 v31, s27, v156
    v_lshlrev_b32 v32, 16, v69
    v_and_b32 v33, s27, v69
    v_lshlrev_b32 v34, 16, v157
    v_and_b32 v35, s27, v157
    v_add_f32 v28, v28, v30
    v_add_f32 v29, v29, v31
    v_add_f32 v32, v32, v34
    v_add_f32 v33, v33, v35
    v_cvt_pk_bf16_f32 v68, v28, v29
    v_cvt_pk_bf16_f32 v69, v32, v33
    v_lshlrev_b32 v28, 16, v70
    v_and_b32 v29, s27, v70
    v_lshlrev_b32 v30, 16, v158
    v_and_b32 v31, s27, v158
    v_lshlrev_b32 v32, 16, v71
    v_and_b32 v33, s27, v71
    v_lshlrev_b32 v34, 16, v159
    v_and_b32 v35, s27, v159
    v_add_f32 v28, v28, v30
    v_add_f32 v29, v29, v31
    v_add_f32 v32, v32, v34
    v_add_f32 v33, v33, v35
    v_cvt_pk_bf16_f32 v70, v28, v29
    v_cvt_pk_bf16_f32 v71, v32, v33
    s_mov_b32 s31, 0
    buffer_store_dwordx4 v[64:67], v24, s[12:15], s31 offen offset:64
    buffer_store_dwordx4 v[68:71], v24, s[12:15], s31 offen offset:96
fin_kernel_done:
    s_endpgm
text_end:
.section .rodata,"a"
.p2align 6
.p2align 6
.amdhsa_kernel ln1_kernel
  .amdhsa_next_free_vgpr 84
  .amdhsa_next_free_sgpr 40
  .amdhsa_accum_offset 84
  .amdhsa_group_segment_fixed_size 0
  .amdhsa_kernarg_size 104
  .amdhsa_user_sgpr_count 2
  .amdhsa_user_sgpr_kernarg_segment_ptr 1
  .amdhsa_system_sgpr_workgroup_id_x 1
.end_amdhsa_kernel
.p2align 6
.amdhsa_kernel win_kernel
  .amdhsa_next_free_vgpr 160
  .amdhsa_next_free_sgpr 90
  .amdhsa_accum_offset 96
  .amdhsa_group_segment_fixed_size 0
  .amdhsa_kernarg_size 104
  .amdhsa_user_sgpr_count 2
  .amdhsa_user_sgpr_kernarg_segment_ptr 1
  .amdhsa_system_sgpr_workgroup_id_x 1
.end_amdhsa_kernel
.p2align 6
.amdhsa_kernel attn_kernel
  .amdhsa_next_free_vgpr 492
  .amdhsa_next_free_sgpr 100
  .amdhsa_accum_offset 236
  .amdhsa_group_segment_fixed_size 0
  .amdhsa_kernarg_size 104
  .amdhsa_user_sgpr_count 2
  .amdhsa_user_sgpr_kernarg_segment_ptr 1
  .amdhsa_system_sgpr_workgroup_id_x 1
.end_amdhsa_kernel
.p2align 6
.amdhsa_kernel spwo_kernel
  .amdhsa_next_free_vgpr 336
  .amdhsa_next_free_sgpr 90
  .amdhsa_accum_offset 208
  .amdhsa_group_segment_fixed_size 0
  .amdhsa_kernarg_size 104
  .amdhsa_user_sgpr_count 2
  .amdhsa_user_sgpr_kernarg_segment_ptr 1
  .amdhsa_system_sgpr_workgroup_id_x 1
.end_amdhsa_kernel
.p2align 6
.amdhsa_kernel fin_kernel
  .amdhsa_next_free_vgpr 240
  .amdhsa_next_free_sgpr 90
  .amdhsa_accum_offset 160
  .amdhsa_group_segment_fixed_size 0
  .amdhsa_kernarg_size 104
  .amdhsa_user_sgpr_count 2
  .amdhsa_user_sgpr_kernarg_segment_ptr 1
  .amdhsa_system_sgpr_workgroup_id_x 1
.end_amdhsa_kernel
```
